```python
import torch

def _softmax(x, axis=-1):
    return torch.softmax(x, dim=axis)

def _gelu(x):
    return torch.nn.functional.gelu(x, approximate='tanh')

def _silu(x):
    return torch.nn.functional.silu(x)

def _sigmoid(x):
    return torch.sigmoid(x)

def _layernorm(x, axis=-1, eps=1e-05):
    m = x.mean(dim=axis, keepdim=True)
    v = x.var(dim=axis, keepdim=True, unbiased=False)
    return (x - m) / torch.sqrt(v + eps)

def _scatter_add(tgt, idx, src, axis=0):
    return tgt.clone().index_add_(axis, idx, src)

def _segment_sum(src, seg, n):
    out = torch.zeros((n,) + src.shape[1:], dtype=src.dtype)
    return out.index_add_(0, seg, src)

def _pad(x, pw):
    flat = tuple((v for pair in reversed(pw) for v in pair))
    return torch.nn.functional.pad(x, flat)
kernel_name = 'gated_mix__mha_block__mixer_gmlp__prompt'

def setup_inputs():

    _w = lambda a: (lambda t: t.to(torch.bfloat16) if t.is_floating_point() else t)(torch.as_tensor(a))

    def _A_setup():
        B, S, D, H = (1, 2048, 576, 32)
        return {'x': _w((lambda *s: torch.randn(*s, dtype=torch.bfloat16) * 0.05)(B, S, D)), 'wqkv': _w((lambda *s: torch.randn(*s, dtype=torch.bfloat16) * 1.6)(D, 3 * D)), 'wo': _w((lambda *s: torch.randn(*s, dtype=torch.bfloat16) * 0.1)(D, D))}
    _A_in = _A_setup()

    def _B_setup():
        B, S, D, F = (1, 2048, 576, 4608)
        Fh = F // 2
        return {'x': _w((lambda *s: torch.randn(*s, dtype=torch.bfloat16) * 0.05)(B, S, D)), 'w_in': _w((lambda *s: torch.randn(*s, dtype=torch.bfloat16) * 1.6)(D, 2 * Fh)), 'w_sp': _w(0.01 * (lambda *s: torch.randn(*s, dtype=torch.bfloat16) * 1.6)(S, S)), 'b_sp': _w(1.0 + 0.01 * (lambda *s: torch.randn(*s, dtype=torch.bfloat16) * 0.05)(S)), 'w_out': _w((lambda *s: torch.randn(*s, dtype=torch.bfloat16) * 0.05)(Fh, D))}
    _B_in = _B_setup()
    return {'A_x': _A_in['x'], 'A_wqkv': _A_in['wqkv'], 'A_wo': _A_in['wo'], 'B_x': _B_in['x'], 'B_w_in': _B_in['w_in'], 'B_w_sp': _B_in['w_sp'], 'B_b_sp': _B_in['b_sp'], 'B_w_out': _B_in['w_out'], 'gate_w': _w((lambda *s: torch.randn(*s, dtype=torch.bfloat16) * 0.05)(576) * 16.0)}

def reference(A_x, A_wqkv, A_wo, B_x, B_w_in, B_w_sp, B_b_sp, B_w_out, gate_w):

    def _A_ref(x, wqkv, wo):
        B, S, D = x.shape
        H = 32
        Dh = D // H
        qkv = (lambda x, *d: x.permute(*d))((x @ wqkv).reshape(B, S, 3, H, Dh), 2, 0, 3, 1, 4)
        q, k, v = (qkv[0], qkv[1], qkv[2])
        scores = torch.einsum('bhqd,bhkd->bhqk', q, k) * Dh ** (-0.5)
        p = _softmax(scores, axis=-1)
        o = torch.einsum('bhqk,bhkd->bhqd', p, v)
        return (lambda x, *d: x.permute(*d))(o, 0, 2, 1, 3).reshape(B, S, D) @ wo

    def _B_ref(x, w_in, w_sp, b_sp, w_out):
        B, S, D = x.shape
        F = w_in.shape[-1]
        Fh = F // 2
        z = _gelu(torch.einsum('bsd,df->bsf', x, w_in))
        z1 = z[..., :Fh].clone()
        z2 = _layernorm(z[..., Fh:], axis=-1)
        g = torch.einsum('ts,bsf->btf', w_sp, z2) + b_sp[None, :, None]
        return torch.einsum('bsf,fd->bsd', z1 * g, w_out)
    x = A_x
    g = _sigmoid((x * gate_w).sum(-1, keepdims=True))
    a = _A_ref(x, A_wqkv, A_wo)
    b = _B_ref(x, B_w_in, B_w_sp, B_b_sp, B_w_out)
    return g * a + (1 - g) * b
```

```asm
; @launch grid=(512,1,1) block=(256,1,1) lds=81920
.amdgcn_target "amdgcn-amd-amdhsa--gfx950"
.text
.p2align 8
.globl gated_mix__mha_block__mixer_gmlp__prompt_kernel
.type gated_mix__mha_block__mixer_gmlp__prompt_kernel,@function
gated_mix__mha_block__mixer_gmlp__prompt_kernel:
    s_cmp_ge_u32 s2, 512
    s_cbranch_scc1 gated_mix__mha_block__mixer_gmlp__prompt_kernel_end
    s_load_dwordx4 s[8:11], s[0:1], 0
    s_load_dwordx2 s[12:13], s[0:1], 32
    s_load_dwordx2 s[14:15], s[0:1], 88
    s_load_dwordx2 s[66:67], s[0:1], 64
    s_load_dwordx2 s[68:69], s[0:1], 80
    s_memrealtime s[28:29]
    s_and_b32 s3, s2, 7
    s_bfe_u32 s4, s2, 0x50003
    v_lshrrev_b32 v1, 6, v0
    v_and_b32 v0, 63, v0
    v_readfirstlane_b32 s6, v1
    s_lshr_b32 s5, s3, 2
    s_lshl_b32 s5, s5, 3
    s_lshr_b32 s24, s4, 2
    s_add_u32 s5, s5, s24
    s_and_b32 s24, s4, 3
    s_and_b32 s7, s3, 3
    s_waitcnt lgkmcnt(0)
    s_add_u32 s72, s14, 39845888
    s_addc_u32 s73, s15, 0
    s_mov_b32 s74, 196608
    s_mov_b32 s75, 0x00020000
    s_mov_b32 s78, s28
    s_cmp_lt_u32 s2, 256
    s_cbranch_scc0 gated_mix__mha_block__mixer_gmlp__prompt_kernel_G
gated_mix__mha_block__mixer_gmlp__prompt_kernel_A:
    s_nop 1
    s_lshl_b32 s25, s2, 2
    s_add_u32 s25, s25, s6
    s_cmp_lg_u32 s25, 0
    s_cbranch_scc1 gated_mix__mha_block__mixer_gmlp__prompt_kernel_nn
    s_add_u32 s48, s68, 0
    s_addc_u32 s49, s69, 0
    s_mov_b32 s50, 256
    s_mov_b32 s51, 0x00020000
    s_or_b32 s26, s28, 1
    v_mov_b32 v4, s26
    v_mov_b32 v5, s29
    v_lshlrev_b32 v3, 16, v0
    buffer_store_dwordx2 v[4:5], v3, s[48:51], 0 offen sc0 sc1
gated_mix__mha_block__mixer_gmlp__prompt_kernel_nn:
    s_cmp_eq_u32 s24, 0
    s_cbranch_scc1 gated_mix__mha_block__mixer_gmlp__prompt_kernel_v
    s_sub_u32 s24, s24, 1
    s_mul_i32 s64, s7, 9
    s_mul_i32 s25, s24, 4
    s_add_u32 s64, s64, s25
    s_mul_i32 s7, s7, 3
    s_add_u32 s7, s7, s24
    s_cmp_eq_u32 s24, 2
    s_cbranch_scc1 gated_mix__mha_block__mixer_gmlp__prompt_kernel_zs
    s_setprio 1
    s_lshl_b32 s26, s5, 7
    s_lshl_b32 s27, s6, 5
    s_add_u32 s26, s26, s27
    v_lshrrev_b32 v4, 3, v0
    v_and_b32 v5, 7, v0
    v_add_u32 v6, s26, v4
    v_lshrrev_b32 v7, 1, v4
    v_mul_u32_u24 v6, 1152, v6
    v_xor_b32 v7, v7, v5
    s_lshl_b32 s55, s6, 12
    s_mov_b32 s56, 0
    v_lshl_add_u32 v246, v7, 4, v6
    v_xor_b32 v7, 4, v7
    v_lshl_add_u32 v247, v7, 4, v6
    v_add_u32 v248, 16384, v246
    v_add_u32 v249, 24576, v247
    v_add_u32 v247, 8192, v247
    s_add_u32 s16, s8, 0
    s_addc_u32 s17, s9, 0
    s_mov_b32 s18, 2359296
    s_mov_b32 s19, 0x00020000
    s_add_u32 s20, s12, 0
    s_addc_u32 s21, s13, 0
    s_mov_b32 s22, 5308416
    s_mov_b32 s23, 0x00020000
    s_lshl_b32 s26, s64, 7
    s_add_u32 s26, s26, 0
    s_lshl_b32 s27, s6, 3
    s_movk_i32 s28, 9216
    v_lshlrev_b32 v6, 1, v4
    v_and_b32 v6, 4, v6
    v_xor_b32 v6, v6, v5
    v_lshlrev_b32 v6, 4, v6
    v_add_u32 v6, s26, v6
    v_add_u32 v7, s27, v4
    v_mul_lo_u32 v7, v7, s28
    v_add_u32 v250, v7, v6
    s_lshl_b32 s54, s6, 10
    s_add_u32 s54, s54, 32768
    s_mov_b32 s57, 0
    s_add_u32 s40, s12, 0
    s_addc_u32 s41, s13, 0
    s_mov_b32 s42, 5308416
    s_mov_b32 s43, 0x00020000
    s_add_u32 s44, s10, 0
    s_addc_u32 s45, s11, 0
    s_mov_b32 s46, 1990656
    s_mov_b32 s47, 0x00020000
    s_lshl_b32 s25, s2, 2
    s_add_u32 s25, s25, s6
    s_lshl_b32 s25, s25, 10
    s_add_u32 s26, s25, 2097152
    s_add_u32 s27, s25, 4194304
    v_lshlrev_b32 v3, 4, v0
    buffer_load_dwordx4 v[252:255], v3, s[16:19], s25 offen
    buffer_load_dwordx4 v[252:255], v3, s[40:43], s25 offen
    buffer_load_dwordx4 v[252:255], v3, s[44:47], s25 offen
    buffer_load_dwordx4 v[252:255], v3, s[40:43], s26 offen
    buffer_load_dwordx4 v[252:255], v3, s[16:19], s26 offen
    buffer_load_dwordx4 v[252:255], v3, s[40:43], s27 offen
    s_add_u32 s48, s68, 0
    s_addc_u32 s49, s69, 0
    s_mov_b32 s50, 256
    s_mov_b32 s51, 0x00020000
    v_mov_b32 v22, 0
    buffer_load_dwordx2 v[20:21], v22, s[48:51], 0 offen sc0 sc1
    s_waitcnt vmcnt(0)
    v_readfirstlane_b32 s76, v20
    v_readfirstlane_b32 s77, v21
    s_mov_b32 s38, 0x40000
gated_mix__mha_block__mixer_gmlp__prompt_kernel_z1_n:
    s_nop 1
    s_cmp_eq_u32 s76, 0
    s_cbranch_scc1 gated_mix__mha_block__mixer_gmlp__prompt_kernel_z1_n_r
    s_sub_u32 s39, s76, s78
    s_add_u32 s39, s39, 2000
    s_cmp_ge_i32 s39, 0
    s_cbranch_scc1 gated_mix__mha_block__mixer_gmlp__prompt_kernel_z1_n_ok
    s_cmp_lt_u32 s38, 262080
    s_cbranch_scc1 gated_mix__mha_block__mixer_gmlp__prompt_kernel_z1_n_ok
gated_mix__mha_block__mixer_gmlp__prompt_kernel_z1_n_r:
    buffer_load_dwordx2 v[20:21], v22, s[48:51], 0 offen sc0 sc1
    s_waitcnt vmcnt(0)
    v_readfirstlane_b32 s76, v20
    v_readfirstlane_b32 s77, v21
    s_sub_u32 s38, s38, 1
    s_cmp_lg_u32 s38, 0
    s_nop 3
    s_cbranch_scc1 gated_mix__mha_block__mixer_gmlp__prompt_kernel_z1_n
gated_mix__mha_block__mixer_gmlp__prompt_kernel_z1_n_ok:
    s_nop 1
    s_lshl_b32 s39, s2, 7
    v_mov_b32 v23, s39
    s_cmp_lg_u32 s6, 0
    s_cbranch_scc1 gated_mix__mha_block__mixer_gmlp__prompt_kernel_z1_go_ok
    s_mov_b32 s38, 0x40000
gated_mix__mha_block__mixer_gmlp__prompt_kernel_z1_go:
    buffer_load_dwordx2 v[24:25], v23, s[72:75], 0 offen sc0 sc1
    s_waitcnt vmcnt(0)
    v_cmp_ne_u64 vcc, s[76:77], v[24:25]
    s_sub_u32 s38, s38, 1
    s_nop 2
    s_cbranch_vccz gated_mix__mha_block__mixer_gmlp__prompt_kernel_z1_go_ok
    s_cmp_eq_u32 s38, 0
    s_cbranch_scc1 gated_mix__mha_block__mixer_gmlp__prompt_kernel_z1_go_ok
    s_sleep 4
    s_branch gated_mix__mha_block__mixer_gmlp__prompt_kernel_z1_go
gated_mix__mha_block__mixer_gmlp__prompt_kernel_z1_go_ok:
    s_barrier
    s_add_u32 m0, s55, 0
    s_nop 0
    buffer_load_dwordx4 v246, s[16:19], s56 offen offset:0 lds
    buffer_load_dwordx4 v247, s[16:19], s56 offen offset:1024 lds
    buffer_load_dwordx4 v248, s[16:19], s56 offen offset:2048 lds
    buffer_load_dwordx4 v249, s[16:19], s56 offen offset:3072 lds
    s_add_u32 s56, s56, 128
    s_add_u32 m0, s54, 0
    s_nop 0
    buffer_load_dwordx4 v250, s[20:23], s57 offen offset:0 lds
    s_add_u32 m0, s54, 3968
    s_nop 0
    buffer_load_dwordx4 v250, s[20:23], s57 offen offset:128 lds
    s_add_u32 m0, s54, 7936
    s_nop 0
    buffer_load_dwordx4 v250, s[20:23], s57 offen offset:256 lds
    s_add_u32 m0, s54, 11904
    s_nop 0
    buffer_load_dwordx4 v250, s[20:23], s57 offen offset:384 lds
    s_add_u32 s57, s57, 294912
    s_add_u32 m0, s54, 16384
    s_nop 0
    buffer_load_dwordx4 v250, s[20:23], s57 offen offset:0 lds
    s_add_u32 m0, s54, 20352
    s_nop 0
    buffer_load_dwordx4 v250, s[20:23], s57 offen offset:128 lds
    s_add_u32 m0, s54, 24320
    s_nop 0
    buffer_load_dwordx4 v250, s[20:23], s57 offen offset:256 lds
    s_add_u32 m0, s54, 28288
    s_nop 0
    buffer_load_dwordx4 v250, s[20:23], s57 offen offset:384 lds
    s_add_u32 s57, s57, 294912
    s_add_u32 m0, s55, 16384
    s_nop 0
    buffer_load_dwordx4 v246, s[16:19], s56 offen offset:0 lds
    buffer_load_dwordx4 v247, s[16:19], s56 offen offset:1024 lds
    buffer_load_dwordx4 v248, s[16:19], s56 offen offset:2048 lds
    buffer_load_dwordx4 v249, s[16:19], s56 offen offset:3072 lds
    s_add_u32 s56, s56, 128
    s_add_u32 m0, s54, 32768
    s_nop 0
    buffer_load_dwordx4 v250, s[20:23], s57 offen offset:0 lds
    s_add_u32 m0, s54, 36736
    s_nop 0
    buffer_load_dwordx4 v250, s[20:23], s57 offen offset:128 lds
    s_add_u32 m0, s54, 40704
    s_nop 0
    buffer_load_dwordx4 v250, s[20:23], s57 offen offset:256 lds
    s_add_u32 m0, s54, 44672
    s_nop 0
    buffer_load_dwordx4 v250, s[20:23], s57 offen offset:384 lds
    s_add_u32 s57, s57, 294912
    s_and_b32 s29, s6, 1
    s_lshl_b32 s29, s29, 13
    v_and_b32 v8, 31, v0
    v_and_b32 v9, 0x33, v8
    v_and_b32 v10, 4, v8
    v_lshl_or_b32 v9, v10, 1, v9
    v_and_b32 v10, 8, v8
    v_lshrrev_b32 v10, 1, v10
    v_or_b32 v9, v9, v10
    v_lshrrev_b32 v10, 5, v0
    v_bfe_u32 v11, v9, 1, 3
    v_xor_b32 v11, v11, v10
    v_lshlrev_b32 v11, 4, v11
    v_lshl_add_u32 v11, v9, 7, v11
    v_add_u32 v240, s29, v11
    v_xor_b32 v241, 32, v240
    v_xor_b32 v242, 64, v240
    v_xor_b32 v243, 96, v240
    v_mov_b32 v15, v10
    v_bfe_u32 v12, v0, 2, 2
    v_lshl_add_u32 v13, v10, 3, v12
    v_lshlrev_b32 v13, 7, v13
    v_and_b32 v14, 2, v12
    v_lshl_add_u32 v13, v14, 5, v13
    v_and_b32 v14, 16, v0
    v_lshl_add_u32 v13, v14, 1, v13
    v_and_b32 v14, 1, v0
    v_lshl_add_u32 v13, v14, 4, v13
    v_and_b32 v14, 2, v0
    v_lshl_add_u32 v13, v14, 2, v13
    s_lshr_b32 s30, s6, 1
    s_mul_i32 s31, s30, 4
    s_add_u32 s32, s31, 0
    s_and_b32 s33, s32, 1
    s_lshl_b32 s33, s33, 6
    s_lshr_b32 s32, s32, 1
    s_lshl_b32 s32, s32, 12
    s_add_u32 s32, s32, 32768
    v_xor_b32 v14, s33, v13
    v_add_u32 v244, s32, v14
    s_add_u32 s32, s31, 1
    s_and_b32 s33, s32, 1
    s_lshl_b32 s33, s33, 6
    s_lshr_b32 s32, s32, 1
    s_lshl_b32 s32, s32, 12
    s_add_u32 s32, s32, 32768
    v_xor_b32 v14, s33, v13
    v_add_u32 v245, s32, v14
    s_waitcnt vmcnt(12)
    s_waitcnt lgkmcnt(0)
    s_barrier
    ds_read_b128 v[144:147], v240 offset:0
    ds_read_b128 v[148:151], v240 offset:4096
    ds_read_b64_tr_b16 v[208:209], v244 offset:0
    ds_read_b64_tr_b16 v[210:211], v244 offset:512
    ds_read_b64_tr_b16 v[212:213], v245 offset:0
    ds_read_b64_tr_b16 v[214:215], v245 offset:512
    ds_read_b64_tr_b16 v[216:217], v244 offset:4096
    ds_read_b64_tr_b16 v[218:219], v244 offset:4608
    ds_read_b64_tr_b16 v[220:221], v245 offset:4096
    ds_read_b64_tr_b16 v[222:223], v245 offset:4608
    ds_read_b128 v[152:155], v241 offset:0
    ds_read_b128 v[156:159], v241 offset:4096
    s_waitcnt lgkmcnt(8)
    v_mfma_f32_32x32x16_bf16 v[16:31], v[208:211], v[144:147], 0
    ds_read_b64_tr_b16 v[224:225], v244 offset:2048
    ds_read_b64_tr_b16 v[226:227], v244 offset:2560
    ds_read_b64_tr_b16 v[228:229], v245 offset:2048
    v_mfma_f32_32x32x16_bf16 v[80:95], v[208:211], v[148:151], 0
    ds_read_b64_tr_b16 v[230:231], v245 offset:2560
    ds_read_b64_tr_b16 v[232:233], v244 offset:6144
    ds_read_b64_tr_b16 v[234:235], v244 offset:6656
    s_waitcnt lgkmcnt(12)
    v_mfma_f32_32x32x16_bf16 v[32:47], v[212:215], v[144:147], 0
    ds_read_b64_tr_b16 v[236:237], v245 offset:6144
    ds_read_b64_tr_b16 v[238:239], v245 offset:6656
    ds_read_b128 v[160:163], v242 offset:0
    v_mfma_f32_32x32x16_bf16 v[96:111], v[212:215], v[148:151], 0
    s_waitcnt lgkmcnt(14)
    ds_read_b128 v[164:167], v242 offset:4096
    s_waitcnt lgkmcnt(14)
    ds_read_b128 v[168:171], v243 offset:0
    s_waitcnt lgkmcnt(14)
    ds_read_b128 v[172:175], v243 offset:4096
    v_mfma_f32_32x32x16_bf16 v[48:63], v[216:219], v[144:147], 0
    v_mfma_f32_32x32x16_bf16 v[112:127], v[216:219], v[148:151], 0
    s_waitcnt lgkmcnt(14)
    v_mfma_f32_32x32x16_bf16 v[64:79], v[220:223], v[144:147], 0
    v_mfma_f32_32x32x16_bf16 v[128:143], v[220:223], v[148:151], 0
    s_waitcnt vmcnt(8)
    s_waitcnt lgkmcnt(0)
    s_barrier
    v_mfma_f32_32x32x16_bf16 v[16:31], v[224:227], v[152:155], v[16:31]
    ds_read_b64_tr_b16 v[208:209], v244 offset:16384
    ds_read_b64_tr_b16 v[210:211], v244 offset:16896
    v_mfma_f32_32x32x16_bf16 v[80:95], v[224:227], v[156:159], v[80:95]
    ds_read_b64_tr_b16 v[212:213], v245 offset:16384
    ds_read_b64_tr_b16 v[214:215], v245 offset:16896
    v_mfma_f32_32x32x16_bf16 v[32:47], v[228:231], v[152:155], v[32:47]
    ds_read_b64_tr_b16 v[216:217], v244 offset:20480
    ds_read_b64_tr_b16 v[218:219], v244 offset:20992
    v_mfma_f32_32x32x16_bf16 v[96:111], v[228:231], v[156:159], v[96:111]
    ds_read_b64_tr_b16 v[220:221], v245 offset:20480
    ds_read_b64_tr_b16 v[222:223], v245 offset:20992
    v_mfma_f32_32x32x16_bf16 v[48:63], v[232:235], v[152:155], v[48:63]
    s_add_u32 m0, s54, 0
    s_nop 0
    buffer_load_dwordx4 v250, s[20:23], s57 offen offset:0 lds
    v_mfma_f32_32x32x16_bf16 v[112:127], v[232:235], v[156:159], v[112:127]
    s_add_u32 m0, s54, 3968
    s_nop 0
    buffer_load_dwordx4 v250, s[20:23], s57 offen offset:128 lds
    v_mfma_f32_32x32x16_bf16 v[64:79], v[236:239], v[152:155], v[64:79]
    s_add_u32 m0, s54, 7936
    s_nop 0
    buffer_load_dwordx4 v250, s[20:23], s57 offen offset:256 lds
    v_mfma_f32_32x32x16_bf16 v[128:143], v[236:239], v[156:159], v[128:143]
    s_add_u32 m0, s54, 11904
    s_nop 0
    buffer_load_dwordx4 v250, s[20:23], s57 offen offset:384 lds
    s_add_u32 s57, s57, 294912
    s_waitcnt lgkmcnt(6)
    v_mfma_f32_32x32x16_bf16 v[16:31], v[208:211], v[160:163], v[16:31]
    ds_read_b64_tr_b16 v[224:225], v244 offset:18432
    ds_read_b64_tr_b16 v[226:227], v244 offset:18944
    v_mfma_f32_32x32x16_bf16 v[80:95], v[208:211], v[164:167], v[80:95]
    ds_read_b64_tr_b16 v[228:229], v245 offset:18432
    ds_read_b64_tr_b16 v[230:231], v245 offset:18944
    s_waitcnt lgkmcnt(8)
    v_mfma_f32_32x32x16_bf16 v[32:47], v[212:215], v[160:163], v[32:47]
    ds_read_b64_tr_b16 v[232:233], v244 offset:22528
    ds_read_b64_tr_b16 v[234:235], v244 offset:23040
    v_mfma_f32_32x32x16_bf16 v[96:111], v[212:215], v[164:167], v[96:111]
    ds_read_b64_tr_b16 v[236:237], v245 offset:22528
    ds_read_b64_tr_b16 v[238:239], v245 offset:23040
    s_waitcnt lgkmcnt(10)
    v_mfma_f32_32x32x16_bf16 v[48:63], v[216:219], v[160:163], v[48:63]
    s_add_u32 m0, s55, 0
    s_nop 0
    buffer_load_dwordx4 v246, s[16:19], s56 offen offset:0 lds
    v_mfma_f32_32x32x16_bf16 v[112:127], v[216:219], v[164:167], v[112:127]
    buffer_load_dwordx4 v247, s[16:19], s56 offen offset:1024 lds
    s_waitcnt lgkmcnt(8)
    v_mfma_f32_32x32x16_bf16 v[64:79], v[220:223], v[160:163], v[64:79]
    buffer_load_dwordx4 v248, s[16:19], s56 offen offset:2048 lds
    v_mfma_f32_32x32x16_bf16 v[128:143], v[220:223], v[164:167], v[128:143]
    buffer_load_dwordx4 v249, s[16:19], s56 offen offset:3072 lds
    s_add_u32 s56, s56, 128
    s_waitcnt vmcnt(8)
    s_waitcnt lgkmcnt(0)
    s_barrier
    v_mfma_f32_32x32x16_bf16 v[16:31], v[224:227], v[168:171], v[16:31]
    ds_read_b128 v[176:179], v240 offset:16384
    ds_read_b128 v[180:183], v240 offset:20480
    ds_read_b64_tr_b16 v[208:209], v244 offset:32768
    v_mfma_f32_32x32x16_bf16 v[80:95], v[224:227], v[172:175], v[80:95]
    ds_read_b64_tr_b16 v[210:211], v244 offset:33280
    ds_read_b64_tr_b16 v[212:213], v245 offset:32768
    ds_read_b64_tr_b16 v[214:215], v245 offset:33280
    v_mfma_f32_32x32x16_bf16 v[32:47], v[228:231], v[168:171], v[32:47]
    ds_read_b64_tr_b16 v[216:217], v244 offset:36864
    ds_read_b64_tr_b16 v[218:219], v244 offset:37376
    ds_read_b64_tr_b16 v[220:221], v245 offset:36864
    v_mfma_f32_32x32x16_bf16 v[96:111], v[228:231], v[172:175], v[96:111]
    ds_read_b64_tr_b16 v[222:223], v245 offset:37376
    ds_read_b128 v[184:187], v241 offset:16384
    ds_read_b128 v[188:191], v241 offset:20480
    v_mfma_f32_32x32x16_bf16 v[48:63], v[232:235], v[168:171], v[48:63]
    s_add_u32 m0, s54, 16384
    s_nop 0
    buffer_load_dwordx4 v250, s[20:23], s57 offen offset:0 lds
    v_mfma_f32_32x32x16_bf16 v[112:127], v[232:235], v[172:175], v[112:127]
    s_add_u32 m0, s54, 20352
    s_nop 0
    buffer_load_dwordx4 v250, s[20:23], s57 offen offset:128 lds
    v_mfma_f32_32x32x16_bf16 v[64:79], v[236:239], v[168:171], v[64:79]
    s_add_u32 m0, s54, 24320
    s_nop 0
    buffer_load_dwordx4 v250, s[20:23], s57 offen offset:256 lds
    v_mfma_f32_32x32x16_bf16 v[128:143], v[236:239], v[172:175], v[128:143]
    s_add_u32 m0, s54, 28288
    s_nop 0
    buffer_load_dwordx4 v250, s[20:23], s57 offen offset:384 lds
    s_add_u32 s57, s57, 294912
    s_waitcnt lgkmcnt(8)
    v_mfma_f32_32x32x16_bf16 v[16:31], v[208:211], v[176:179], v[16:31]
    ds_read_b64_tr_b16 v[224:225], v244 offset:34816
    ds_read_b64_tr_b16 v[226:227], v244 offset:35328
    ds_read_b64_tr_b16 v[228:229], v245 offset:34816
    v_mfma_f32_32x32x16_bf16 v[80:95], v[208:211], v[180:183], v[80:95]
    ds_read_b64_tr_b16 v[230:231], v245 offset:35328
    ds_read_b64_tr_b16 v[232:233], v244 offset:38912
    ds_read_b64_tr_b16 v[234:235], v244 offset:39424
    s_waitcnt lgkmcnt(12)
    v_mfma_f32_32x32x16_bf16 v[32:47], v[212:215], v[176:179], v[32:47]
    ds_read_b64_tr_b16 v[236:237], v245 offset:38912
    ds_read_b64_tr_b16 v[238:239], v245 offset:39424
    ds_read_b128 v[192:195], v242 offset:16384
    v_mfma_f32_32x32x16_bf16 v[96:111], v[212:215], v[180:183], v[96:111]
    s_waitcnt lgkmcnt(14)
    ds_read_b128 v[196:199], v242 offset:20480
    s_waitcnt lgkmcnt(14)
    ds_read_b128 v[200:203], v243 offset:16384
    s_waitcnt lgkmcnt(14)
    ds_read_b128 v[204:207], v243 offset:20480
    v_mfma_f32_32x32x16_bf16 v[48:63], v[216:219], v[176:179], v[48:63]
    v_mfma_f32_32x32x16_bf16 v[112:127], v[216:219], v[180:183], v[112:127]
    s_waitcnt lgkmcnt(14)
    v_mfma_f32_32x32x16_bf16 v[64:79], v[220:223], v[176:179], v[64:79]
    v_mfma_f32_32x32x16_bf16 v[128:143], v[220:223], v[180:183], v[128:143]
    s_waitcnt vmcnt(8)
    s_waitcnt lgkmcnt(0)
    s_barrier
    v_mfma_f32_32x32x16_bf16 v[16:31], v[224:227], v[184:187], v[16:31]
    ds_read_b64_tr_b16 v[208:209], v244 offset:0
    ds_read_b64_tr_b16 v[210:211], v244 offset:512
    v_mfma_f32_32x32x16_bf16 v[80:95], v[224:227], v[188:191], v[80:95]
    ds_read_b64_tr_b16 v[212:213], v245 offset:0
    ds_read_b64_tr_b16 v[214:215], v245 offset:512
    v_mfma_f32_32x32x16_bf16 v[32:47], v[228:231], v[184:187], v[32:47]
    ds_read_b64_tr_b16 v[216:217], v244 offset:4096
    ds_read_b64_tr_b16 v[218:219], v244 offset:4608
    v_mfma_f32_32x32x16_bf16 v[96:111], v[228:231], v[188:191], v[96:111]
    ds_read_b64_tr_b16 v[220:221], v245 offset:4096
    ds_read_b64_tr_b16 v[222:223], v245 offset:4608
    v_mfma_f32_32x32x16_bf16 v[48:63], v[232:235], v[184:187], v[48:63]
    s_add_u32 m0, s54, 32768
    s_nop 0
    buffer_load_dwordx4 v250, s[20:23], s57 offen offset:0 lds
    v_mfma_f32_32x32x16_bf16 v[112:127], v[232:235], v[188:191], v[112:127]
    s_add_u32 m0, s54, 36736
    s_nop 0
    buffer_load_dwordx4 v250, s[20:23], s57 offen offset:128 lds
    v_mfma_f32_32x32x16_bf16 v[64:79], v[236:239], v[184:187], v[64:79]
    s_add_u32 m0, s54, 40704
    s_nop 0
    buffer_load_dwordx4 v250, s[20:23], s57 offen offset:256 lds
    v_mfma_f32_32x32x16_bf16 v[128:143], v[236:239], v[188:191], v[128:143]
    s_add_u32 m0, s54, 44672
    s_nop 0
    buffer_load_dwordx4 v250, s[20:23], s57 offen offset:384 lds
    s_add_u32 s57, s57, 294912
    s_waitcnt lgkmcnt(6)
    v_mfma_f32_32x32x16_bf16 v[16:31], v[208:211], v[192:195], v[16:31]
    ds_read_b64_tr_b16 v[224:225], v244 offset:2048
    ds_read_b64_tr_b16 v[226:227], v244 offset:2560
    v_mfma_f32_32x32x16_bf16 v[80:95], v[208:211], v[196:199], v[80:95]
    ds_read_b64_tr_b16 v[228:229], v245 offset:2048
    ds_read_b64_tr_b16 v[230:231], v245 offset:2560
    s_waitcnt lgkmcnt(8)
    v_mfma_f32_32x32x16_bf16 v[32:47], v[212:215], v[192:195], v[32:47]
    ds_read_b64_tr_b16 v[232:233], v244 offset:6144
    ds_read_b64_tr_b16 v[234:235], v244 offset:6656
    v_mfma_f32_32x32x16_bf16 v[96:111], v[212:215], v[196:199], v[96:111]
    ds_read_b64_tr_b16 v[236:237], v245 offset:6144
    ds_read_b64_tr_b16 v[238:239], v245 offset:6656
    s_waitcnt lgkmcnt(10)
    v_mfma_f32_32x32x16_bf16 v[48:63], v[216:219], v[192:195], v[48:63]
    s_add_u32 m0, s55, 16384
    s_nop 0
    buffer_load_dwordx4 v246, s[16:19], s56 offen offset:0 lds
    v_mfma_f32_32x32x16_bf16 v[112:127], v[216:219], v[196:199], v[112:127]
    buffer_load_dwordx4 v247, s[16:19], s56 offen offset:1024 lds
    s_waitcnt lgkmcnt(8)
    v_mfma_f32_32x32x16_bf16 v[64:79], v[220:223], v[192:195], v[64:79]
    buffer_load_dwordx4 v248, s[16:19], s56 offen offset:2048 lds
    v_mfma_f32_32x32x16_bf16 v[128:143], v[220:223], v[196:199], v[128:143]
    buffer_load_dwordx4 v249, s[16:19], s56 offen offset:3072 lds
    s_add_u32 s56, s56, 128
    s_waitcnt vmcnt(8)
    s_waitcnt lgkmcnt(0)
    s_barrier
    v_mfma_f32_32x32x16_bf16 v[16:31], v[224:227], v[200:203], v[16:31]
    ds_read_b128 v[144:147], v240 offset:0
    ds_read_b128 v[148:151], v240 offset:4096
    ds_read_b64_tr_b16 v[208:209], v244 offset:16384
    v_mfma_f32_32x32x16_bf16 v[80:95], v[224:227], v[204:207], v[80:95]
    ds_read_b64_tr_b16 v[210:211], v244 offset:16896
    ds_read_b64_tr_b16 v[212:213], v245 offset:16384
    ds_read_b64_tr_b16 v[214:215], v245 offset:16896
    v_mfma_f32_32x32x16_bf16 v[32:47], v[228:231], v[200:203], v[32:47]
    ds_read_b64_tr_b16 v[216:217], v244 offset:20480
    ds_read_b64_tr_b16 v[218:219], v244 offset:20992
    ds_read_b64_tr_b16 v[220:221], v245 offset:20480
    v_mfma_f32_32x32x16_bf16 v[96:111], v[228:231], v[204:207], v[96:111]
    ds_read_b64_tr_b16 v[222:223], v245 offset:20992
    ds_read_b128 v[152:155], v241 offset:0
    ds_read_b128 v[156:159], v241 offset:4096
    v_mfma_f32_32x32x16_bf16 v[48:63], v[232:235], v[200:203], v[48:63]
    s_add_u32 m0, s54, 0
    s_nop 0
    buffer_load_dwordx4 v250, s[20:23], s57 offen offset:0 lds
    v_mfma_f32_32x32x16_bf16 v[112:127], v[232:235], v[204:207], v[112:127]
    s_add_u32 m0, s54, 3968
    s_nop 0
    buffer_load_dwordx4 v250, s[20:23], s57 offen offset:128 lds
    v_mfma_f32_32x32x16_bf16 v[64:79], v[236:239], v[200:203], v[64:79]
    s_add_u32 m0, s54, 7936
    s_nop 0
    buffer_load_dwordx4 v250, s[20:23], s57 offen offset:256 lds
    v_mfma_f32_32x32x16_bf16 v[128:143], v[236:239], v[204:207], v[128:143]
    s_add_u32 m0, s54, 11904
    s_nop 0
    buffer_load_dwordx4 v250, s[20:23], s57 offen offset:384 lds
    s_add_u32 s57, s57, 294912
    s_waitcnt lgkmcnt(8)
    v_mfma_f32_32x32x16_bf16 v[16:31], v[208:211], v[144:147], v[16:31]
    ds_read_b64_tr_b16 v[224:225], v244 offset:18432
    ds_read_b64_tr_b16 v[226:227], v244 offset:18944
    ds_read_b64_tr_b16 v[228:229], v245 offset:18432
    v_mfma_f32_32x32x16_bf16 v[80:95], v[208:211], v[148:151], v[80:95]
    ds_read_b64_tr_b16 v[230:231], v245 offset:18944
    ds_read_b64_tr_b16 v[232:233], v244 offset:22528
    ds_read_b64_tr_b16 v[234:235], v244 offset:23040
    s_waitcnt lgkmcnt(12)
    v_mfma_f32_32x32x16_bf16 v[32:47], v[212:215], v[144:147], v[32:47]
    ds_read_b64_tr_b16 v[236:237], v245 offset:22528
    ds_read_b64_tr_b16 v[238:239], v245 offset:23040
    ds_read_b128 v[160:163], v242 offset:0
    v_mfma_f32_32x32x16_bf16 v[96:111], v[212:215], v[148:151], v[96:111]
    s_waitcnt lgkmcnt(14)
    ds_read_b128 v[164:167], v242 offset:4096
    s_waitcnt lgkmcnt(14)
    ds_read_b128 v[168:171], v243 offset:0
    s_waitcnt lgkmcnt(14)
    ds_read_b128 v[172:175], v243 offset:4096
    v_mfma_f32_32x32x16_bf16 v[48:63], v[216:219], v[144:147], v[48:63]
    v_mfma_f32_32x32x16_bf16 v[112:127], v[216:219], v[148:151], v[112:127]
    s_waitcnt lgkmcnt(14)
    v_mfma_f32_32x32x16_bf16 v[64:79], v[220:223], v[144:147], v[64:79]
    v_mfma_f32_32x32x16_bf16 v[128:143], v[220:223], v[148:151], v[128:143]
    s_waitcnt vmcnt(8)
    s_waitcnt lgkmcnt(0)
    s_barrier
    v_mfma_f32_32x32x16_bf16 v[16:31], v[224:227], v[152:155], v[16:31]
    ds_read_b64_tr_b16 v[208:209], v244 offset:32768
    ds_read_b64_tr_b16 v[210:211], v244 offset:33280
    v_mfma_f32_32x32x16_bf16 v[80:95], v[224:227], v[156:159], v[80:95]
    ds_read_b64_tr_b16 v[212:213], v245 offset:32768
    ds_read_b64_tr_b16 v[214:215], v245 offset:33280
    v_mfma_f32_32x32x16_bf16 v[32:47], v[228:231], v[152:155], v[32:47]
    ds_read_b64_tr_b16 v[216:217], v244 offset:36864
    ds_read_b64_tr_b16 v[218:219], v244 offset:37376
    v_mfma_f32_32x32x16_bf16 v[96:111], v[228:231], v[156:159], v[96:111]
    ds_read_b64_tr_b16 v[220:221], v245 offset:36864
    ds_read_b64_tr_b16 v[222:223], v245 offset:37376
    v_mfma_f32_32x32x16_bf16 v[48:63], v[232:235], v[152:155], v[48:63]
    s_add_u32 m0, s54, 16384
    s_nop 0
    buffer_load_dwordx4 v250, s[20:23], s57 offen offset:0 lds
    v_mfma_f32_32x32x16_bf16 v[112:127], v[232:235], v[156:159], v[112:127]
    s_add_u32 m0, s54, 20352
    s_nop 0
    buffer_load_dwordx4 v250, s[20:23], s57 offen offset:128 lds
    v_mfma_f32_32x32x16_bf16 v[64:79], v[236:239], v[152:155], v[64:79]
    s_add_u32 m0, s54, 24320
    s_nop 0
    buffer_load_dwordx4 v250, s[20:23], s57 offen offset:256 lds
    v_mfma_f32_32x32x16_bf16 v[128:143], v[236:239], v[156:159], v[128:143]
    s_add_u32 m0, s54, 28288
    s_nop 0
    buffer_load_dwordx4 v250, s[20:23], s57 offen offset:384 lds
    s_add_u32 s57, s57, 294912
    s_waitcnt lgkmcnt(6)
    v_mfma_f32_32x32x16_bf16 v[16:31], v[208:211], v[160:163], v[16:31]
    ds_read_b64_tr_b16 v[224:225], v244 offset:34816
    ds_read_b64_tr_b16 v[226:227], v244 offset:35328
    v_mfma_f32_32x32x16_bf16 v[80:95], v[208:211], v[164:167], v[80:95]
    ds_read_b64_tr_b16 v[228:229], v245 offset:34816
    ds_read_b64_tr_b16 v[230:231], v245 offset:35328
    s_waitcnt lgkmcnt(8)
    v_mfma_f32_32x32x16_bf16 v[32:47], v[212:215], v[160:163], v[32:47]
    ds_read_b64_tr_b16 v[232:233], v244 offset:38912
    ds_read_b64_tr_b16 v[234:235], v244 offset:39424
    v_mfma_f32_32x32x16_bf16 v[96:111], v[212:215], v[164:167], v[96:111]
    ds_read_b64_tr_b16 v[236:237], v245 offset:38912
    ds_read_b64_tr_b16 v[238:239], v245 offset:39424
    s_waitcnt lgkmcnt(10)
    v_mfma_f32_32x32x16_bf16 v[48:63], v[216:219], v[160:163], v[48:63]
    s_add_u32 m0, s55, 0
    s_nop 0
    buffer_load_dwordx4 v246, s[16:19], s56 offen offset:0 lds
    v_mfma_f32_32x32x16_bf16 v[112:127], v[216:219], v[164:167], v[112:127]
    buffer_load_dwordx4 v247, s[16:19], s56 offen offset:1024 lds
    s_waitcnt lgkmcnt(8)
    v_mfma_f32_32x32x16_bf16 v[64:79], v[220:223], v[160:163], v[64:79]
    buffer_load_dwordx4 v248, s[16:19], s56 offen offset:2048 lds
    v_mfma_f32_32x32x16_bf16 v[128:143], v[220:223], v[164:167], v[128:143]
    buffer_load_dwordx4 v249, s[16:19], s56 offen offset:3072 lds
    s_add_u32 s56, s56, 128
    s_waitcnt vmcnt(8)
    s_waitcnt lgkmcnt(0)
    s_barrier
    v_mfma_f32_32x32x16_bf16 v[16:31], v[224:227], v[168:171], v[16:31]
    ds_read_b128 v[176:179], v240 offset:16384
    ds_read_b128 v[180:183], v240 offset:20480
    ds_read_b64_tr_b16 v[208:209], v244 offset:0
    v_mfma_f32_32x32x16_bf16 v[80:95], v[224:227], v[172:175], v[80:95]
    ds_read_b64_tr_b16 v[210:211], v244 offset:512
    ds_read_b64_tr_b16 v[212:213], v245 offset:0
    ds_read_b64_tr_b16 v[214:215], v245 offset:512
    v_mfma_f32_32x32x16_bf16 v[32:47], v[228:231], v[168:171], v[32:47]
    ds_read_b64_tr_b16 v[216:217], v244 offset:4096
    ds_read_b64_tr_b16 v[218:219], v244 offset:4608
    ds_read_b64_tr_b16 v[220:221], v245 offset:4096
    v_mfma_f32_32x32x16_bf16 v[96:111], v[228:231], v[172:175], v[96:111]
    ds_read_b64_tr_b16 v[222:223], v245 offset:4608
    ds_read_b128 v[184:187], v241 offset:16384
    ds_read_b128 v[188:191], v241 offset:20480
    v_mfma_f32_32x32x16_bf16 v[48:63], v[232:235], v[168:171], v[48:63]
    s_add_u32 m0, s54, 32768
    s_nop 0
    buffer_load_dwordx4 v250, s[20:23], s57 offen offset:0 lds
    v_mfma_f32_32x32x16_bf16 v[112:127], v[232:235], v[172:175], v[112:127]
    s_add_u32 m0, s54, 36736
    s_nop 0
    buffer_load_dwordx4 v250, s[20:23], s57 offen offset:128 lds
    v_mfma_f32_32x32x16_bf16 v[64:79], v[236:239], v[168:171], v[64:79]
    s_add_u32 m0, s54, 40704
    s_nop 0
    buffer_load_dwordx4 v250, s[20:23], s57 offen offset:256 lds
    v_mfma_f32_32x32x16_bf16 v[128:143], v[236:239], v[172:175], v[128:143]
    s_add_u32 m0, s54, 44672
    s_nop 0
    buffer_load_dwordx4 v250, s[20:23], s57 offen offset:384 lds
    s_add_u32 s57, s57, 294912
    s_waitcnt lgkmcnt(8)
    v_mfma_f32_32x32x16_bf16 v[16:31], v[208:211], v[176:179], v[16:31]
    ds_read_b64_tr_b16 v[224:225], v244 offset:2048
    ds_read_b64_tr_b16 v[226:227], v244 offset:2560
    ds_read_b64_tr_b16 v[228:229], v245 offset:2048
    v_mfma_f32_32x32x16_bf16 v[80:95], v[208:211], v[180:183], v[80:95]
    ds_read_b64_tr_b16 v[230:231], v245 offset:2560
    ds_read_b64_tr_b16 v[232:233], v244 offset:6144
    ds_read_b64_tr_b16 v[234:235], v244 offset:6656
    s_waitcnt lgkmcnt(12)
    v_mfma_f32_32x32x16_bf16 v[32:47], v[212:215], v[176:179], v[32:47]
    ds_read_b64_tr_b16 v[236:237], v245 offset:6144
    ds_read_b64_tr_b16 v[238:239], v245 offset:6656
    ds_read_b128 v[192:195], v242 offset:16384
    v_mfma_f32_32x32x16_bf16 v[96:111], v[212:215], v[180:183], v[96:111]
    s_waitcnt lgkmcnt(14)
    ds_read_b128 v[196:199], v242 offset:20480
    s_waitcnt lgkmcnt(14)
    ds_read_b128 v[200:203], v243 offset:16384
    s_waitcnt lgkmcnt(14)
    ds_read_b128 v[204:207], v243 offset:20480
    v_mfma_f32_32x32x16_bf16 v[48:63], v[216:219], v[176:179], v[48:63]
    v_mfma_f32_32x32x16_bf16 v[112:127], v[216:219], v[180:183], v[112:127]
    s_waitcnt lgkmcnt(14)
    v_mfma_f32_32x32x16_bf16 v[64:79], v[220:223], v[176:179], v[64:79]
    v_mfma_f32_32x32x16_bf16 v[128:143], v[220:223], v[180:183], v[128:143]
    s_waitcnt vmcnt(8)
    s_waitcnt lgkmcnt(0)
    s_barrier
    v_mfma_f32_32x32x16_bf16 v[16:31], v[224:227], v[184:187], v[16:31]
    ds_read_b64_tr_b16 v[208:209], v244 offset:16384
    ds_read_b64_tr_b16 v[210:211], v244 offset:16896
    v_mfma_f32_32x32x16_bf16 v[80:95], v[224:227], v[188:191], v[80:95]
    ds_read_b64_tr_b16 v[212:213], v245 offset:16384
    ds_read_b64_tr_b16 v[214:215], v245 offset:16896
    v_mfma_f32_32x32x16_bf16 v[32:47], v[228:231], v[184:187], v[32:47]
    ds_read_b64_tr_b16 v[216:217], v244 offset:20480
    ds_read_b64_tr_b16 v[218:219], v244 offset:20992
    v_mfma_f32_32x32x16_bf16 v[96:111], v[228:231], v[188:191], v[96:111]
    ds_read_b64_tr_b16 v[220:221], v245 offset:20480
    ds_read_b64_tr_b16 v[222:223], v245 offset:20992
    v_mfma_f32_32x32x16_bf16 v[48:63], v[232:235], v[184:187], v[48:63]
    s_add_u32 m0, s54, 0
    s_nop 0
    buffer_load_dwordx4 v250, s[20:23], s57 offen offset:0 lds
    v_mfma_f32_32x32x16_bf16 v[112:127], v[232:235], v[188:191], v[112:127]
    s_add_u32 m0, s54, 3968
    s_nop 0
    buffer_load_dwordx4 v250, s[20:23], s57 offen offset:128 lds
    v_mfma_f32_32x32x16_bf16 v[64:79], v[236:239], v[184:187], v[64:79]
    s_add_u32 m0, s54, 7936
    s_nop 0
    buffer_load_dwordx4 v250, s[20:23], s57 offen offset:256 lds
    v_mfma_f32_32x32x16_bf16 v[128:143], v[236:239], v[188:191], v[128:143]
    s_add_u32 m0, s54, 11904
    s_nop 0
    buffer_load_dwordx4 v250, s[20:23], s57 offen offset:384 lds
    s_add_u32 s57, s57, 294912
    s_waitcnt lgkmcnt(6)
    v_mfma_f32_32x32x16_bf16 v[16:31], v[208:211], v[192:195], v[16:31]
    ds_read_b64_tr_b16 v[224:225], v244 offset:18432
    ds_read_b64_tr_b16 v[226:227], v244 offset:18944
    v_mfma_f32_32x32x16_bf16 v[80:95], v[208:211], v[196:199], v[80:95]
    ds_read_b64_tr_b16 v[228:229], v245 offset:18432
    ds_read_b64_tr_b16 v[230:231], v245 offset:18944
    s_waitcnt lgkmcnt(8)
    v_mfma_f32_32x32x16_bf16 v[32:47], v[212:215], v[192:195], v[32:47]
    ds_read_b64_tr_b16 v[232:233], v244 offset:22528
    ds_read_b64_tr_b16 v[234:235], v244 offset:23040
    v_mfma_f32_32x32x16_bf16 v[96:111], v[212:215], v[196:199], v[96:111]
    ds_read_b64_tr_b16 v[236:237], v245 offset:22528
    ds_read_b64_tr_b16 v[238:239], v245 offset:23040
    s_waitcnt lgkmcnt(10)
    v_mfma_f32_32x32x16_bf16 v[48:63], v[216:219], v[192:195], v[48:63]
    s_add_u32 m0, s55, 16384
    s_nop 0
    buffer_load_dwordx4 v246, s[16:19], s56 offen offset:0 lds
    v_mfma_f32_32x32x16_bf16 v[112:127], v[216:219], v[196:199], v[112:127]
    buffer_load_dwordx4 v247, s[16:19], s56 offen offset:1024 lds
    s_waitcnt lgkmcnt(8)
    v_mfma_f32_32x32x16_bf16 v[64:79], v[220:223], v[192:195], v[64:79]
    buffer_load_dwordx4 v248, s[16:19], s56 offen offset:2048 lds
    v_mfma_f32_32x32x16_bf16 v[128:143], v[220:223], v[196:199], v[128:143]
    buffer_load_dwordx4 v249, s[16:19], s56 offen offset:3072 lds
    s_add_u32 s56, s56, 128
    s_waitcnt vmcnt(8)
    s_waitcnt lgkmcnt(0)
    s_barrier
    v_mfma_f32_32x32x16_bf16 v[16:31], v[224:227], v[200:203], v[16:31]
    ds_read_b128 v[144:147], v240 offset:0
    ds_read_b128 v[148:151], v240 offset:4096
    ds_read_b64_tr_b16 v[208:209], v244 offset:32768
    v_mfma_f32_32x32x16_bf16 v[80:95], v[224:227], v[204:207], v[80:95]
    ds_read_b64_tr_b16 v[210:211], v244 offset:33280
    ds_read_b64_tr_b16 v[212:213], v245 offset:32768
    ds_read_b64_tr_b16 v[214:215], v245 offset:33280
    v_mfma_f32_32x32x16_bf16 v[32:47], v[228:231], v[200:203], v[32:47]
    ds_read_b64_tr_b16 v[216:217], v244 offset:36864
    ds_read_b64_tr_b16 v[218:219], v244 offset:37376
    ds_read_b64_tr_b16 v[220:221], v245 offset:36864
    v_mfma_f32_32x32x16_bf16 v[96:111], v[228:231], v[204:207], v[96:111]
    ds_read_b64_tr_b16 v[222:223], v245 offset:37376
    ds_read_b128 v[152:155], v241 offset:0
    ds_read_b128 v[156:159], v241 offset:4096
    v_mfma_f32_32x32x16_bf16 v[48:63], v[232:235], v[200:203], v[48:63]
    s_add_u32 m0, s54, 16384
    s_nop 0
    buffer_load_dwordx4 v250, s[20:23], s57 offen offset:0 lds
    v_mfma_f32_32x32x16_bf16 v[112:127], v[232:235], v[204:207], v[112:127]
    s_add_u32 m0, s54, 20352
    s_nop 0
    buffer_load_dwordx4 v250, s[20:23], s57 offen offset:128 lds
    v_mfma_f32_32x32x16_bf16 v[64:79], v[236:239], v[200:203], v[64:79]
    s_add_u32 m0, s54, 24320
    s_nop 0
    buffer_load_dwordx4 v250, s[20:23], s57 offen offset:256 lds
    v_mfma_f32_32x32x16_bf16 v[128:143], v[236:239], v[204:207], v[128:143]
    s_add_u32 m0, s54, 28288
    s_nop 0
    buffer_load_dwordx4 v250, s[20:23], s57 offen offset:384 lds
    s_add_u32 s57, s57, 294912
    s_waitcnt lgkmcnt(8)
    v_mfma_f32_32x32x16_bf16 v[16:31], v[208:211], v[144:147], v[16:31]
    ds_read_b64_tr_b16 v[224:225], v244 offset:34816
    ds_read_b64_tr_b16 v[226:227], v244 offset:35328
    ds_read_b64_tr_b16 v[228:229], v245 offset:34816
    v_mfma_f32_32x32x16_bf16 v[80:95], v[208:211], v[148:151], v[80:95]
    ds_read_b64_tr_b16 v[230:231], v245 offset:35328
    ds_read_b64_tr_b16 v[232:233], v244 offset:38912
    ds_read_b64_tr_b16 v[234:235], v244 offset:39424
    s_waitcnt lgkmcnt(12)
    v_mfma_f32_32x32x16_bf16 v[32:47], v[212:215], v[144:147], v[32:47]
    ds_read_b64_tr_b16 v[236:237], v245 offset:38912
    ds_read_b64_tr_b16 v[238:239], v245 offset:39424
    ds_read_b128 v[160:163], v242 offset:0
    v_mfma_f32_32x32x16_bf16 v[96:111], v[212:215], v[148:151], v[96:111]
    s_waitcnt lgkmcnt(14)
    ds_read_b128 v[164:167], v242 offset:4096
    s_waitcnt lgkmcnt(14)
    ds_read_b128 v[168:171], v243 offset:0
    s_waitcnt lgkmcnt(14)
    ds_read_b128 v[172:175], v243 offset:4096
    v_mfma_f32_32x32x16_bf16 v[48:63], v[216:219], v[144:147], v[48:63]
    v_mfma_f32_32x32x16_bf16 v[112:127], v[216:219], v[148:151], v[112:127]
    s_waitcnt lgkmcnt(14)
    v_mfma_f32_32x32x16_bf16 v[64:79], v[220:223], v[144:147], v[64:79]
    v_mfma_f32_32x32x16_bf16 v[128:143], v[220:223], v[148:151], v[128:143]
    s_waitcnt vmcnt(8)
    s_waitcnt lgkmcnt(0)
    s_barrier
    v_mfma_f32_32x32x16_bf16 v[16:31], v[224:227], v[152:155], v[16:31]
    ds_read_b64_tr_b16 v[208:209], v244 offset:0
    ds_read_b64_tr_b16 v[210:211], v244 offset:512
    v_mfma_f32_32x32x16_bf16 v[80:95], v[224:227], v[156:159], v[80:95]
    ds_read_b64_tr_b16 v[212:213], v245 offset:0
    ds_read_b64_tr_b16 v[214:215], v245 offset:512
    v_mfma_f32_32x32x16_bf16 v[32:47], v[228:231], v[152:155], v[32:47]
    ds_read_b64_tr_b16 v[216:217], v244 offset:4096
    ds_read_b64_tr_b16 v[218:219], v244 offset:4608
    v_mfma_f32_32x32x16_bf16 v[96:111], v[228:231], v[156:159], v[96:111]
    ds_read_b64_tr_b16 v[220:221], v245 offset:4096
    ds_read_b64_tr_b16 v[222:223], v245 offset:4608
    v_mfma_f32_32x32x16_bf16 v[48:63], v[232:235], v[152:155], v[48:63]
    s_add_u32 m0, s54, 32768
    s_nop 0
    buffer_load_dwordx4 v250, s[20:23], s57 offen offset:0 lds
    v_mfma_f32_32x32x16_bf16 v[112:127], v[232:235], v[156:159], v[112:127]
    s_add_u32 m0, s54, 36736
    s_nop 0
    buffer_load_dwordx4 v250, s[20:23], s57 offen offset:128 lds
    v_mfma_f32_32x32x16_bf16 v[64:79], v[236:239], v[152:155], v[64:79]
    s_add_u32 m0, s54, 40704
    s_nop 0
    buffer_load_dwordx4 v250, s[20:23], s57 offen offset:256 lds
    v_mfma_f32_32x32x16_bf16 v[128:143], v[236:239], v[156:159], v[128:143]
    s_add_u32 m0, s54, 44672
    s_nop 0
    buffer_load_dwordx4 v250, s[20:23], s57 offen offset:384 lds
    s_add_u32 s57, s57, 294912
    s_waitcnt lgkmcnt(6)
    v_mfma_f32_32x32x16_bf16 v[16:31], v[208:211], v[160:163], v[16:31]
    ds_read_b64_tr_b16 v[224:225], v244 offset:2048
    ds_read_b64_tr_b16 v[226:227], v244 offset:2560
    v_mfma_f32_32x32x16_bf16 v[80:95], v[208:211], v[164:167], v[80:95]
    ds_read_b64_tr_b16 v[228:229], v245 offset:2048
    ds_read_b64_tr_b16 v[230:231], v245 offset:2560
    s_waitcnt lgkmcnt(8)
    v_mfma_f32_32x32x16_bf16 v[32:47], v[212:215], v[160:163], v[32:47]
    ds_read_b64_tr_b16 v[232:233], v244 offset:6144
    ds_read_b64_tr_b16 v[234:235], v244 offset:6656
    v_mfma_f32_32x32x16_bf16 v[96:111], v[212:215], v[164:167], v[96:111]
    ds_read_b64_tr_b16 v[236:237], v245 offset:6144
    ds_read_b64_tr_b16 v[238:239], v245 offset:6656
    s_waitcnt lgkmcnt(10)
    v_mfma_f32_32x32x16_bf16 v[48:63], v[216:219], v[160:163], v[48:63]
    s_add_u32 m0, s55, 0
    s_nop 0
    buffer_load_dwordx4 v246, s[16:19], s56 offen offset:0 lds
    v_mfma_f32_32x32x16_bf16 v[112:127], v[216:219], v[164:167], v[112:127]
    buffer_load_dwordx4 v247, s[16:19], s56 offen offset:1024 lds
    s_waitcnt lgkmcnt(8)
    v_mfma_f32_32x32x16_bf16 v[64:79], v[220:223], v[160:163], v[64:79]
    buffer_load_dwordx4 v248, s[16:19], s56 offen offset:2048 lds
    v_mfma_f32_32x32x16_bf16 v[128:143], v[220:223], v[164:167], v[128:143]
    buffer_load_dwordx4 v249, s[16:19], s56 offen offset:3072 lds
    s_add_u32 s56, s56, 128
    s_waitcnt vmcnt(8)
    s_waitcnt lgkmcnt(0)
    s_barrier
    v_mfma_f32_32x32x16_bf16 v[16:31], v[224:227], v[168:171], v[16:31]
    ds_read_b128 v[176:179], v240 offset:16384
    ds_read_b128 v[180:183], v240 offset:20480
    ds_read_b64_tr_b16 v[208:209], v244 offset:16384
    v_mfma_f32_32x32x16_bf16 v[80:95], v[224:227], v[172:175], v[80:95]
    ds_read_b64_tr_b16 v[210:211], v244 offset:16896
    ds_read_b64_tr_b16 v[212:213], v245 offset:16384
    ds_read_b64_tr_b16 v[214:215], v245 offset:16896
    v_mfma_f32_32x32x16_bf16 v[32:47], v[228:231], v[168:171], v[32:47]
    ds_read_b64_tr_b16 v[216:217], v244 offset:20480
    ds_read_b64_tr_b16 v[218:219], v244 offset:20992
    ds_read_b64_tr_b16 v[220:221], v245 offset:20480
    v_mfma_f32_32x32x16_bf16 v[96:111], v[228:231], v[172:175], v[96:111]
    ds_read_b64_tr_b16 v[222:223], v245 offset:20992
    ds_read_b128 v[184:187], v241 offset:16384
    ds_read_b128 v[188:191], v241 offset:20480
    v_mfma_f32_32x32x16_bf16 v[48:63], v[232:235], v[168:171], v[48:63]
    s_add_u32 m0, s54, 0
    s_nop 0
    buffer_load_dwordx4 v250, s[20:23], s57 offen offset:0 lds
    v_mfma_f32_32x32x16_bf16 v[112:127], v[232:235], v[172:175], v[112:127]
    s_add_u32 m0, s54, 3968
    s_nop 0
    buffer_load_dwordx4 v250, s[20:23], s57 offen offset:128 lds
    v_mfma_f32_32x32x16_bf16 v[64:79], v[236:239], v[168:171], v[64:79]
    s_add_u32 m0, s54, 7936
    s_nop 0
    buffer_load_dwordx4 v250, s[20:23], s57 offen offset:256 lds
    v_mfma_f32_32x32x16_bf16 v[128:143], v[236:239], v[172:175], v[128:143]
    s_add_u32 m0, s54, 11904
    s_nop 0
    buffer_load_dwordx4 v250, s[20:23], s57 offen offset:384 lds
    s_add_u32 s57, s57, 294912
    s_waitcnt lgkmcnt(8)
    v_mfma_f32_32x32x16_bf16 v[16:31], v[208:211], v[176:179], v[16:31]
    ds_read_b64_tr_b16 v[224:225], v244 offset:18432
    ds_read_b64_tr_b16 v[226:227], v244 offset:18944
    ds_read_b64_tr_b16 v[228:229], v245 offset:18432
    v_mfma_f32_32x32x16_bf16 v[80:95], v[208:211], v[180:183], v[80:95]
    ds_read_b64_tr_b16 v[230:231], v245 offset:18944
    ds_read_b64_tr_b16 v[232:233], v244 offset:22528
    ds_read_b64_tr_b16 v[234:235], v244 offset:23040
    s_waitcnt lgkmcnt(12)
    v_mfma_f32_32x32x16_bf16 v[32:47], v[212:215], v[176:179], v[32:47]
    ds_read_b64_tr_b16 v[236:237], v245 offset:22528
    ds_read_b64_tr_b16 v[238:239], v245 offset:23040
    ds_read_b128 v[192:195], v242 offset:16384
    v_mfma_f32_32x32x16_bf16 v[96:111], v[212:215], v[180:183], v[96:111]
    s_waitcnt lgkmcnt(14)
    ds_read_b128 v[196:199], v242 offset:20480
    s_waitcnt lgkmcnt(14)
    ds_read_b128 v[200:203], v243 offset:16384
    s_waitcnt lgkmcnt(14)
    ds_read_b128 v[204:207], v243 offset:20480
    v_mfma_f32_32x32x16_bf16 v[48:63], v[216:219], v[176:179], v[48:63]
    v_mfma_f32_32x32x16_bf16 v[112:127], v[216:219], v[180:183], v[112:127]
    s_waitcnt lgkmcnt(14)
    v_mfma_f32_32x32x16_bf16 v[64:79], v[220:223], v[176:179], v[64:79]
    v_mfma_f32_32x32x16_bf16 v[128:143], v[220:223], v[180:183], v[128:143]
    s_waitcnt vmcnt(8)
    s_waitcnt lgkmcnt(0)
    s_barrier
    v_mfma_f32_32x32x16_bf16 v[16:31], v[224:227], v[184:187], v[16:31]
    ds_read_b64_tr_b16 v[208:209], v244 offset:32768
    ds_read_b64_tr_b16 v[210:211], v244 offset:33280
    v_mfma_f32_32x32x16_bf16 v[80:95], v[224:227], v[188:191], v[80:95]
    ds_read_b64_tr_b16 v[212:213], v245 offset:32768
    ds_read_b64_tr_b16 v[214:215], v245 offset:33280
    v_mfma_f32_32x32x16_bf16 v[32:47], v[228:231], v[184:187], v[32:47]
    ds_read_b64_tr_b16 v[216:217], v244 offset:36864
    ds_read_b64_tr_b16 v[218:219], v244 offset:37376
    v_mfma_f32_32x32x16_bf16 v[96:111], v[228:231], v[188:191], v[96:111]
    ds_read_b64_tr_b16 v[220:221], v245 offset:36864
    ds_read_b64_tr_b16 v[222:223], v245 offset:37376
    v_mfma_f32_32x32x16_bf16 v[48:63], v[232:235], v[184:187], v[48:63]
    s_add_u32 m0, s54, 16384
    s_nop 0
    buffer_load_dwordx4 v250, s[20:23], s57 offen offset:0 lds
    v_mfma_f32_32x32x16_bf16 v[112:127], v[232:235], v[188:191], v[112:127]
    s_add_u32 m0, s54, 20352
    s_nop 0
    buffer_load_dwordx4 v250, s[20:23], s57 offen offset:128 lds
    v_mfma_f32_32x32x16_bf16 v[64:79], v[236:239], v[184:187], v[64:79]
    s_add_u32 m0, s54, 24320
    s_nop 0
    buffer_load_dwordx4 v250, s[20:23], s57 offen offset:256 lds
    v_mfma_f32_32x32x16_bf16 v[128:143], v[236:239], v[188:191], v[128:143]
    s_add_u32 m0, s54, 28288
    s_nop 0
    buffer_load_dwordx4 v250, s[20:23], s57 offen offset:384 lds
    s_add_u32 s57, s57, 294912
    s_waitcnt lgkmcnt(6)
    v_mfma_f32_32x32x16_bf16 v[16:31], v[208:211], v[192:195], v[16:31]
    ds_read_b64_tr_b16 v[224:225], v244 offset:34816
    ds_read_b64_tr_b16 v[226:227], v244 offset:35328
    v_mfma_f32_32x32x16_bf16 v[80:95], v[208:211], v[196:199], v[80:95]
    ds_read_b64_tr_b16 v[228:229], v245 offset:34816
    ds_read_b64_tr_b16 v[230:231], v245 offset:35328
    s_waitcnt lgkmcnt(8)
    v_mfma_f32_32x32x16_bf16 v[32:47], v[212:215], v[192:195], v[32:47]
    ds_read_b64_tr_b16 v[232:233], v244 offset:38912
    ds_read_b64_tr_b16 v[234:235], v244 offset:39424
    v_mfma_f32_32x32x16_bf16 v[96:111], v[212:215], v[196:199], v[96:111]
    ds_read_b64_tr_b16 v[236:237], v245 offset:38912
    ds_read_b64_tr_b16 v[238:239], v245 offset:39424
    s_waitcnt lgkmcnt(10)
    v_mfma_f32_32x32x16_bf16 v[48:63], v[216:219], v[192:195], v[48:63]
    s_add_u32 m0, s55, 16384
    s_nop 0
    buffer_load_dwordx4 v246, s[16:19], s56 offen offset:0 lds
    v_mfma_f32_32x32x16_bf16 v[112:127], v[216:219], v[196:199], v[112:127]
    buffer_load_dwordx4 v247, s[16:19], s56 offen offset:1024 lds
    s_waitcnt lgkmcnt(8)
    v_mfma_f32_32x32x16_bf16 v[64:79], v[220:223], v[192:195], v[64:79]
    buffer_load_dwordx4 v248, s[16:19], s56 offen offset:2048 lds
    v_mfma_f32_32x32x16_bf16 v[128:143], v[220:223], v[196:199], v[128:143]
    buffer_load_dwordx4 v249, s[16:19], s56 offen offset:3072 lds
    s_add_u32 s56, s56, 128
    s_waitcnt vmcnt(8)
    s_waitcnt lgkmcnt(0)
    s_barrier
    v_mfma_f32_32x32x16_bf16 v[16:31], v[224:227], v[200:203], v[16:31]
    ds_read_b128 v[144:147], v240 offset:0
    ds_read_b128 v[148:151], v240 offset:4096
    ds_read_b64_tr_b16 v[208:209], v244 offset:0
    v_mfma_f32_32x32x16_bf16 v[80:95], v[224:227], v[204:207], v[80:95]
    ds_read_b64_tr_b16 v[210:211], v244 offset:512
    ds_read_b64_tr_b16 v[212:213], v245 offset:0
    ds_read_b64_tr_b16 v[214:215], v245 offset:512
    v_mfma_f32_32x32x16_bf16 v[32:47], v[228:231], v[200:203], v[32:47]
    ds_read_b64_tr_b16 v[216:217], v244 offset:4096
    ds_read_b64_tr_b16 v[218:219], v244 offset:4608
    ds_read_b64_tr_b16 v[220:221], v245 offset:4096
    v_mfma_f32_32x32x16_bf16 v[96:111], v[228:231], v[204:207], v[96:111]
    ds_read_b64_tr_b16 v[222:223], v245 offset:4608
    ds_read_b128 v[152:155], v241 offset:0
    ds_read_b128 v[156:159], v241 offset:4096
    v_mfma_f32_32x32x16_bf16 v[48:63], v[232:235], v[200:203], v[48:63]
    s_add_u32 m0, s54, 32768
    s_nop 0
    buffer_load_dwordx4 v250, s[20:23], s57 offen offset:0 lds
    v_mfma_f32_32x32x16_bf16 v[112:127], v[232:235], v[204:207], v[112:127]
    s_add_u32 m0, s54, 36736
    s_nop 0
    buffer_load_dwordx4 v250, s[20:23], s57 offen offset:128 lds
    v_mfma_f32_32x32x16_bf16 v[64:79], v[236:239], v[200:203], v[64:79]
    s_add_u32 m0, s54, 40704
    s_nop 0
    buffer_load_dwordx4 v250, s[20:23], s57 offen offset:256 lds
    v_mfma_f32_32x32x16_bf16 v[128:143], v[236:239], v[204:207], v[128:143]
    s_add_u32 m0, s54, 44672
    s_nop 0
    buffer_load_dwordx4 v250, s[20:23], s57 offen offset:384 lds
    s_add_u32 s57, s57, 294912
    s_waitcnt lgkmcnt(8)
    v_mfma_f32_32x32x16_bf16 v[16:31], v[208:211], v[144:147], v[16:31]
    ds_read_b64_tr_b16 v[224:225], v244 offset:2048
    ds_read_b64_tr_b16 v[226:227], v244 offset:2560
    ds_read_b64_tr_b16 v[228:229], v245 offset:2048
    v_mfma_f32_32x32x16_bf16 v[80:95], v[208:211], v[148:151], v[80:95]
    ds_read_b64_tr_b16 v[230:231], v245 offset:2560
    ds_read_b64_tr_b16 v[232:233], v244 offset:6144
    ds_read_b64_tr_b16 v[234:235], v244 offset:6656
    s_waitcnt lgkmcnt(12)
    v_mfma_f32_32x32x16_bf16 v[32:47], v[212:215], v[144:147], v[32:47]
    ds_read_b64_tr_b16 v[236:237], v245 offset:6144
    ds_read_b64_tr_b16 v[238:239], v245 offset:6656
    ds_read_b128 v[160:163], v242 offset:0
    v_mfma_f32_32x32x16_bf16 v[96:111], v[212:215], v[148:151], v[96:111]
    s_waitcnt lgkmcnt(14)
    ds_read_b128 v[164:167], v242 offset:4096
    s_waitcnt lgkmcnt(14)
    ds_read_b128 v[168:171], v243 offset:0
    s_waitcnt lgkmcnt(14)
    ds_read_b128 v[172:175], v243 offset:4096
    v_mfma_f32_32x32x16_bf16 v[48:63], v[216:219], v[144:147], v[48:63]
    v_mfma_f32_32x32x16_bf16 v[112:127], v[216:219], v[148:151], v[112:127]
    s_waitcnt lgkmcnt(14)
    v_mfma_f32_32x32x16_bf16 v[64:79], v[220:223], v[144:147], v[64:79]
    v_mfma_f32_32x32x16_bf16 v[128:143], v[220:223], v[148:151], v[128:143]
    s_waitcnt vmcnt(8)
    s_waitcnt lgkmcnt(0)
    s_barrier
    v_mfma_f32_32x32x16_bf16 v[16:31], v[224:227], v[152:155], v[16:31]
    ds_read_b64_tr_b16 v[208:209], v244 offset:16384
    ds_read_b64_tr_b16 v[210:211], v244 offset:16896
    v_mfma_f32_32x32x16_bf16 v[80:95], v[224:227], v[156:159], v[80:95]
    ds_read_b64_tr_b16 v[212:213], v245 offset:16384
    ds_read_b64_tr_b16 v[214:215], v245 offset:16896
    v_mfma_f32_32x32x16_bf16 v[32:47], v[228:231], v[152:155], v[32:47]
    ds_read_b64_tr_b16 v[216:217], v244 offset:20480
    ds_read_b64_tr_b16 v[218:219], v244 offset:20992
    v_mfma_f32_32x32x16_bf16 v[96:111], v[228:231], v[156:159], v[96:111]
    ds_read_b64_tr_b16 v[220:221], v245 offset:20480
    ds_read_b64_tr_b16 v[222:223], v245 offset:20992
    v_mfma_f32_32x32x16_bf16 v[48:63], v[232:235], v[152:155], v[48:63]
    s_add_u32 m0, s54, 0
    s_nop 0
    buffer_load_dwordx4 v250, s[20:23], s57 offen offset:0 lds
    v_mfma_f32_32x32x16_bf16 v[112:127], v[232:235], v[156:159], v[112:127]
    s_add_u32 m0, s54, 3968
    s_nop 0
    buffer_load_dwordx4 v250, s[20:23], s57 offen offset:128 lds
    v_mfma_f32_32x32x16_bf16 v[64:79], v[236:239], v[152:155], v[64:79]
    s_add_u32 m0, s54, 7936
    s_nop 0
    buffer_load_dwordx4 v250, s[20:23], s57 offen offset:256 lds
    v_mfma_f32_32x32x16_bf16 v[128:143], v[236:239], v[156:159], v[128:143]
    s_add_u32 m0, s54, 11904
    s_nop 0
    buffer_load_dwordx4 v250, s[20:23], s57 offen offset:384 lds
    s_add_u32 s57, s57, 294912
    s_waitcnt lgkmcnt(6)
    v_mfma_f32_32x32x16_bf16 v[16:31], v[208:211], v[160:163], v[16:31]
    ds_read_b64_tr_b16 v[224:225], v244 offset:18432
    ds_read_b64_tr_b16 v[226:227], v244 offset:18944
    v_mfma_f32_32x32x16_bf16 v[80:95], v[208:211], v[164:167], v[80:95]
    ds_read_b64_tr_b16 v[228:229], v245 offset:18432
    ds_read_b64_tr_b16 v[230:231], v245 offset:18944
    s_waitcnt lgkmcnt(8)
    v_mfma_f32_32x32x16_bf16 v[32:47], v[212:215], v[160:163], v[32:47]
    ds_read_b64_tr_b16 v[232:233], v244 offset:22528
    ds_read_b64_tr_b16 v[234:235], v244 offset:23040
    v_mfma_f32_32x32x16_bf16 v[96:111], v[212:215], v[164:167], v[96:111]
    ds_read_b64_tr_b16 v[236:237], v245 offset:22528
    ds_read_b64_tr_b16 v[238:239], v245 offset:23040
    s_waitcnt lgkmcnt(10)
    v_mfma_f32_32x32x16_bf16 v[48:63], v[216:219], v[160:163], v[48:63]
    s_add_u32 m0, s55, 0
    s_nop 0
    buffer_load_dwordx4 v246, s[16:19], s56 offen offset:0 lds
    v_mfma_f32_32x32x16_bf16 v[112:127], v[216:219], v[164:167], v[112:127]
    buffer_load_dwordx4 v247, s[16:19], s56 offen offset:1024 lds
    s_waitcnt lgkmcnt(8)
    v_mfma_f32_32x32x16_bf16 v[64:79], v[220:223], v[160:163], v[64:79]
    buffer_load_dwordx4 v248, s[16:19], s56 offen offset:2048 lds
    v_mfma_f32_32x32x16_bf16 v[128:143], v[220:223], v[164:167], v[128:143]
    buffer_load_dwordx4 v249, s[16:19], s56 offen offset:3072 lds
    s_add_u32 s56, s56, 128
    s_waitcnt vmcnt(8)
    s_waitcnt lgkmcnt(0)
    s_barrier
    v_mfma_f32_32x32x16_bf16 v[16:31], v[224:227], v[168:171], v[16:31]
    ds_read_b128 v[176:179], v240 offset:16384
    ds_read_b128 v[180:183], v240 offset:20480
    ds_read_b64_tr_b16 v[208:209], v244 offset:32768
    v_mfma_f32_32x32x16_bf16 v[80:95], v[224:227], v[172:175], v[80:95]
    ds_read_b64_tr_b16 v[210:211], v244 offset:33280
    ds_read_b64_tr_b16 v[212:213], v245 offset:32768
    ds_read_b64_tr_b16 v[214:215], v245 offset:33280
    v_mfma_f32_32x32x16_bf16 v[32:47], v[228:231], v[168:171], v[32:47]
    ds_read_b64_tr_b16 v[216:217], v244 offset:36864
    ds_read_b64_tr_b16 v[218:219], v244 offset:37376
    ds_read_b64_tr_b16 v[220:221], v245 offset:36864
    v_mfma_f32_32x32x16_bf16 v[96:111], v[228:231], v[172:175], v[96:111]
    ds_read_b64_tr_b16 v[222:223], v245 offset:37376
    ds_read_b128 v[184:187], v241 offset:16384
    ds_read_b128 v[188:191], v241 offset:20480
    v_mfma_f32_32x32x16_bf16 v[48:63], v[232:235], v[168:171], v[48:63]
    s_add_u32 m0, s54, 16384
    s_nop 0
    buffer_load_dwordx4 v250, s[20:23], s57 offen offset:0 lds
    v_mfma_f32_32x32x16_bf16 v[112:127], v[232:235], v[172:175], v[112:127]
    s_add_u32 m0, s54, 20352
    s_nop 0
    buffer_load_dwordx4 v250, s[20:23], s57 offen offset:128 lds
    v_mfma_f32_32x32x16_bf16 v[64:79], v[236:239], v[168:171], v[64:79]
    s_add_u32 m0, s54, 24320
    s_nop 0
    buffer_load_dwordx4 v250, s[20:23], s57 offen offset:256 lds
    v_mfma_f32_32x32x16_bf16 v[128:143], v[236:239], v[172:175], v[128:143]
    s_add_u32 m0, s54, 28288
    s_nop 0
    buffer_load_dwordx4 v250, s[20:23], s57 offen offset:384 lds
    s_add_u32 s57, s57, 294912
    s_waitcnt lgkmcnt(8)
    v_mfma_f32_32x32x16_bf16 v[16:31], v[208:211], v[176:179], v[16:31]
    ds_read_b64_tr_b16 v[224:225], v244 offset:34816
    ds_read_b64_tr_b16 v[226:227], v244 offset:35328
    ds_read_b64_tr_b16 v[228:229], v245 offset:34816
    v_mfma_f32_32x32x16_bf16 v[80:95], v[208:211], v[180:183], v[80:95]
    ds_read_b64_tr_b16 v[230:231], v245 offset:35328
    ds_read_b64_tr_b16 v[232:233], v244 offset:38912
    ds_read_b64_tr_b16 v[234:235], v244 offset:39424
    s_waitcnt lgkmcnt(12)
    v_mfma_f32_32x32x16_bf16 v[32:47], v[212:215], v[176:179], v[32:47]
    ds_read_b64_tr_b16 v[236:237], v245 offset:38912
    ds_read_b64_tr_b16 v[238:239], v245 offset:39424
    ds_read_b128 v[192:195], v242 offset:16384
    v_mfma_f32_32x32x16_bf16 v[96:111], v[212:215], v[180:183], v[96:111]
    s_waitcnt lgkmcnt(14)
    ds_read_b128 v[196:199], v242 offset:20480
    s_waitcnt lgkmcnt(14)
    ds_read_b128 v[200:203], v243 offset:16384
    s_waitcnt lgkmcnt(14)
    ds_read_b128 v[204:207], v243 offset:20480
    v_mfma_f32_32x32x16_bf16 v[48:63], v[216:219], v[176:179], v[48:63]
    v_mfma_f32_32x32x16_bf16 v[112:127], v[216:219], v[180:183], v[112:127]
    s_waitcnt lgkmcnt(14)
    v_mfma_f32_32x32x16_bf16 v[64:79], v[220:223], v[176:179], v[64:79]
    v_mfma_f32_32x32x16_bf16 v[128:143], v[220:223], v[180:183], v[128:143]
    s_waitcnt vmcnt(8)
    s_waitcnt lgkmcnt(0)
    s_barrier
    v_mfma_f32_32x32x16_bf16 v[16:31], v[224:227], v[184:187], v[16:31]
    ds_read_b64_tr_b16 v[208:209], v244 offset:0
    ds_read_b64_tr_b16 v[210:211], v244 offset:512
    v_mfma_f32_32x32x16_bf16 v[80:95], v[224:227], v[188:191], v[80:95]
    ds_read_b64_tr_b16 v[212:213], v245 offset:0
    ds_read_b64_tr_b16 v[214:215], v245 offset:512
    v_mfma_f32_32x32x16_bf16 v[32:47], v[228:231], v[184:187], v[32:47]
    ds_read_b64_tr_b16 v[216:217], v244 offset:4096
    ds_read_b64_tr_b16 v[218:219], v244 offset:4608
    v_mfma_f32_32x32x16_bf16 v[96:111], v[228:231], v[188:191], v[96:111]
    ds_read_b64_tr_b16 v[220:221], v245 offset:4096
    ds_read_b64_tr_b16 v[222:223], v245 offset:4608
    v_mfma_f32_32x32x16_bf16 v[48:63], v[232:235], v[184:187], v[48:63]
    s_add_u32 m0, s54, 32768
    s_nop 0
    buffer_load_dwordx4 v250, s[20:23], s57 offen offset:0 lds
    v_mfma_f32_32x32x16_bf16 v[112:127], v[232:235], v[188:191], v[112:127]
    s_add_u32 m0, s54, 36736
    s_nop 0
    buffer_load_dwordx4 v250, s[20:23], s57 offen offset:128 lds
    v_mfma_f32_32x32x16_bf16 v[64:79], v[236:239], v[184:187], v[64:79]
    s_add_u32 m0, s54, 40704
    s_nop 0
    buffer_load_dwordx4 v250, s[20:23], s57 offen offset:256 lds
    v_mfma_f32_32x32x16_bf16 v[128:143], v[236:239], v[188:191], v[128:143]
    s_add_u32 m0, s54, 44672
    s_nop 0
    buffer_load_dwordx4 v250, s[20:23], s57 offen offset:384 lds
    s_add_u32 s57, s57, 294912
    s_waitcnt lgkmcnt(6)
    v_mfma_f32_32x32x16_bf16 v[16:31], v[208:211], v[192:195], v[16:31]
    ds_read_b64_tr_b16 v[224:225], v244 offset:2048
    ds_read_b64_tr_b16 v[226:227], v244 offset:2560
    v_mfma_f32_32x32x16_bf16 v[80:95], v[208:211], v[196:199], v[80:95]
    ds_read_b64_tr_b16 v[228:229], v245 offset:2048
    ds_read_b64_tr_b16 v[230:231], v245 offset:2560
    s_waitcnt lgkmcnt(8)
    v_mfma_f32_32x32x16_bf16 v[32:47], v[212:215], v[192:195], v[32:47]
    ds_read_b64_tr_b16 v[232:233], v244 offset:6144
    ds_read_b64_tr_b16 v[234:235], v244 offset:6656
    v_mfma_f32_32x32x16_bf16 v[96:111], v[212:215], v[196:199], v[96:111]
    ds_read_b64_tr_b16 v[236:237], v245 offset:6144
    ds_read_b64_tr_b16 v[238:239], v245 offset:6656
    s_waitcnt lgkmcnt(10)
    v_mfma_f32_32x32x16_bf16 v[48:63], v[216:219], v[192:195], v[48:63]
    v_mfma_f32_32x32x16_bf16 v[112:127], v[216:219], v[196:199], v[112:127]
    s_waitcnt lgkmcnt(8)
    v_mfma_f32_32x32x16_bf16 v[64:79], v[220:223], v[192:195], v[64:79]
    v_mfma_f32_32x32x16_bf16 v[128:143], v[220:223], v[196:199], v[128:143]
    s_waitcnt vmcnt(4)
    s_waitcnt lgkmcnt(0)
    s_barrier
    v_mfma_f32_32x32x16_bf16 v[16:31], v[224:227], v[200:203], v[16:31]
    ds_read_b128 v[144:147], v240 offset:0
    ds_read_b128 v[148:151], v240 offset:4096
    ds_read_b64_tr_b16 v[208:209], v244 offset:16384
    v_mfma_f32_32x32x16_bf16 v[80:95], v[224:227], v[204:207], v[80:95]
    ds_read_b64_tr_b16 v[210:211], v244 offset:16896
    ds_read_b64_tr_b16 v[212:213], v245 offset:16384
    ds_read_b64_tr_b16 v[214:215], v245 offset:16896
    v_mfma_f32_32x32x16_bf16 v[32:47], v[228:231], v[200:203], v[32:47]
    ds_read_b64_tr_b16 v[216:217], v244 offset:20480
    ds_read_b64_tr_b16 v[218:219], v244 offset:20992
    ds_read_b64_tr_b16 v[220:221], v245 offset:20480
    v_mfma_f32_32x32x16_bf16 v[96:111], v[228:231], v[204:207], v[96:111]
    ds_read_b64_tr_b16 v[222:223], v245 offset:20992
    ds_read_b128 v[152:155], v241 offset:0
    ds_read_b128 v[156:159], v241 offset:4096
    v_mfma_f32_32x32x16_bf16 v[48:63], v[232:235], v[200:203], v[48:63]
    v_mfma_f32_32x32x16_bf16 v[112:127], v[232:235], v[204:207], v[112:127]
    v_mfma_f32_32x32x16_bf16 v[64:79], v[236:239], v[200:203], v[64:79]
    v_mfma_f32_32x32x16_bf16 v[128:143], v[236:239], v[204:207], v[128:143]
    s_waitcnt lgkmcnt(8)
    v_mfma_f32_32x32x16_bf16 v[16:31], v[208:211], v[144:147], v[16:31]
    ds_read_b64_tr_b16 v[224:225], v244 offset:18432
    ds_read_b64_tr_b16 v[226:227], v244 offset:18944
    ds_read_b64_tr_b16 v[228:229], v245 offset:18432
    v_mfma_f32_32x32x16_bf16 v[80:95], v[208:211], v[148:151], v[80:95]
    ds_read_b64_tr_b16 v[230:231], v245 offset:18944
    ds_read_b64_tr_b16 v[232:233], v244 offset:22528
    ds_read_b64_tr_b16 v[234:235], v244 offset:23040
    s_waitcnt lgkmcnt(12)
    v_mfma_f32_32x32x16_bf16 v[32:47], v[212:215], v[144:147], v[32:47]
    ds_read_b64_tr_b16 v[236:237], v245 offset:22528
    ds_read_b64_tr_b16 v[238:239], v245 offset:23040
    ds_read_b128 v[160:163], v242 offset:0
    v_mfma_f32_32x32x16_bf16 v[96:111], v[212:215], v[148:151], v[96:111]
    s_waitcnt lgkmcnt(14)
    ds_read_b128 v[164:167], v242 offset:4096
    s_waitcnt lgkmcnt(14)
    ds_read_b128 v[168:171], v243 offset:0
    s_waitcnt lgkmcnt(14)
    ds_read_b128 v[172:175], v243 offset:4096
    v_mfma_f32_32x32x16_bf16 v[48:63], v[216:219], v[144:147], v[48:63]
    v_mfma_f32_32x32x16_bf16 v[112:127], v[216:219], v[148:151], v[112:127]
    s_waitcnt lgkmcnt(14)
    v_mfma_f32_32x32x16_bf16 v[64:79], v[220:223], v[144:147], v[64:79]
    v_mfma_f32_32x32x16_bf16 v[128:143], v[220:223], v[148:151], v[128:143]
    s_waitcnt vmcnt(0)
    s_waitcnt lgkmcnt(0)
    s_barrier
    v_mfma_f32_32x32x16_bf16 v[16:31], v[224:227], v[152:155], v[16:31]
    ds_read_b64_tr_b16 v[208:209], v244 offset:32768
    ds_read_b64_tr_b16 v[210:211], v244 offset:33280
    v_mfma_f32_32x32x16_bf16 v[80:95], v[224:227], v[156:159], v[80:95]
    ds_read_b64_tr_b16 v[212:213], v245 offset:32768
    ds_read_b64_tr_b16 v[214:215], v245 offset:33280
    v_mfma_f32_32x32x16_bf16 v[32:47], v[228:231], v[152:155], v[32:47]
    ds_read_b64_tr_b16 v[216:217], v244 offset:36864
    ds_read_b64_tr_b16 v[218:219], v244 offset:37376
    v_mfma_f32_32x32x16_bf16 v[96:111], v[228:231], v[156:159], v[96:111]
    ds_read_b64_tr_b16 v[220:221], v245 offset:36864
    ds_read_b64_tr_b16 v[222:223], v245 offset:37376
    v_mfma_f32_32x32x16_bf16 v[48:63], v[232:235], v[152:155], v[48:63]
    v_mfma_f32_32x32x16_bf16 v[112:127], v[232:235], v[156:159], v[112:127]
    v_mfma_f32_32x32x16_bf16 v[64:79], v[236:239], v[152:155], v[64:79]
    v_mfma_f32_32x32x16_bf16 v[128:143], v[236:239], v[156:159], v[128:143]
    s_waitcnt lgkmcnt(6)
    v_mfma_f32_32x32x16_bf16 v[16:31], v[208:211], v[160:163], v[16:31]
    ds_read_b64_tr_b16 v[224:225], v244 offset:34816
    ds_read_b64_tr_b16 v[226:227], v244 offset:35328
    v_mfma_f32_32x32x16_bf16 v[80:95], v[208:211], v[164:167], v[80:95]
    ds_read_b64_tr_b16 v[228:229], v245 offset:34816
    ds_read_b64_tr_b16 v[230:231], v245 offset:35328
    s_waitcnt lgkmcnt(8)
    v_mfma_f32_32x32x16_bf16 v[32:47], v[212:215], v[160:163], v[32:47]
    ds_read_b64_tr_b16 v[232:233], v244 offset:38912
    ds_read_b64_tr_b16 v[234:235], v244 offset:39424
    v_mfma_f32_32x32x16_bf16 v[96:111], v[212:215], v[164:167], v[96:111]
    ds_read_b64_tr_b16 v[236:237], v245 offset:38912
    ds_read_b64_tr_b16 v[238:239], v245 offset:39424
    s_waitcnt lgkmcnt(10)
    v_mfma_f32_32x32x16_bf16 v[48:63], v[216:219], v[160:163], v[48:63]
    v_mfma_f32_32x32x16_bf16 v[112:127], v[216:219], v[164:167], v[112:127]
    s_waitcnt lgkmcnt(8)
    v_mfma_f32_32x32x16_bf16 v[64:79], v[220:223], v[160:163], v[64:79]
    v_mfma_f32_32x32x16_bf16 v[128:143], v[220:223], v[164:167], v[128:143]
    s_waitcnt lgkmcnt(6)
    v_mfma_f32_32x32x16_bf16 v[16:31], v[224:227], v[168:171], v[16:31]
    v_mfma_f32_32x32x16_bf16 v[80:95], v[224:227], v[172:175], v[80:95]
    s_waitcnt lgkmcnt(4)
    v_mfma_f32_32x32x16_bf16 v[32:47], v[228:231], v[168:171], v[32:47]
    v_mfma_f32_32x32x16_bf16 v[96:111], v[228:231], v[172:175], v[96:111]
    s_waitcnt lgkmcnt(2)
    v_mfma_f32_32x32x16_bf16 v[48:63], v[232:235], v[168:171], v[48:63]
    v_mfma_f32_32x32x16_bf16 v[112:127], v[232:235], v[172:175], v[112:127]
    s_waitcnt lgkmcnt(0)
    v_mfma_f32_32x32x16_bf16 v[64:79], v[236:239], v[168:171], v[64:79]
    v_mfma_f32_32x32x16_bf16 v[128:143], v[236:239], v[172:175], v[128:143]
    s_and_b32 s29, s6, 1
    s_lshl_b32 s32, s5, 2
    s_lshl_b32 s33, s29, 1
    s_add_u32 s32, s32, s33
    s_lshl_b32 s33, s64, 1
    s_add_u32 s33, s33, s31
    s_nop 7
    v_mov_b32 v152, 0xbdd2d3e8
    s_setprio 0
    s_add_u32 s60, s14, 8388608
    s_addc_u32 s61, s15, 0
    s_mov_b32 s62, 9437184
    s_mov_b32 s63, 0x00020000
    v_lshlrev_b32 v1, 9, v15
    v_lshl_add_u32 v252, v9, 4, v1
    s_mul_i32 s34, s32, 72
    s_add_u32 s34, s34, s33
    s_lshl_b32 s34, s34, 11
    s_lshl_b32 s71, s5, 4
    s_add_u32 s71, s71, s7
    s_add_u32 s71, s71, 512
    s_add_u32 s70, s34, 2048
    v_mov_b32 v176, 0xbdd2d3e8
    v_mov_b32 v177, 0xbdd2d3e8
    v_mov_b32 v178, 0xc0135761
    v_mov_b32 v179, 0xc0135761
    v_pk_mul_f32 v[144:145], v[16:17], v[16:17]
    v_pk_mul_f32 v[146:147], v[18:19], v[18:19]
    v_pk_mul_f32 v[148:149], v[20:21], v[20:21]
    v_pk_mul_f32 v[150:151], v[22:23], v[22:23]
    v_pk_fma_f32 v[144:145], v[144:145], v[176:177], v[178:179]
    v_pk_fma_f32 v[146:147], v[146:147], v[176:177], v[178:179]
    v_pk_fma_f32 v[148:149], v[148:149], v[176:177], v[178:179]
    v_pk_fma_f32 v[150:151], v[150:151], v[176:177], v[178:179]
    v_pk_mul_f32 v[144:145], v[144:145], v[16:17]
    v_pk_mul_f32 v[146:147], v[146:147], v[18:19]
    v_pk_mul_f32 v[148:149], v[148:149], v[20:21]
    v_pk_mul_f32 v[150:151], v[150:151], v[22:23]
    v_exp_f32 v144, v144
    v_exp_f32 v145, v145
    v_exp_f32 v146, v146
    v_exp_f32 v147, v147
    v_exp_f32 v148, v148
    v_exp_f32 v149, v149
    v_exp_f32 v150, v150
    v_exp_f32 v151, v151
    v_pk_add_f32 v[144:145], v[144:145], 1.0 op_sel_hi:[1,0]
    v_pk_add_f32 v[146:147], v[146:147], 1.0 op_sel_hi:[1,0]
    v_pk_add_f32 v[148:149], v[148:149], 1.0 op_sel_hi:[1,0]
    v_pk_add_f32 v[150:151], v[150:151], 1.0 op_sel_hi:[1,0]
    v_rcp_f32 v144, v144
    v_rcp_f32 v145, v145
    v_rcp_f32 v146, v146
    v_rcp_f32 v147, v147
    v_rcp_f32 v148, v148
    v_rcp_f32 v149, v149
    v_rcp_f32 v150, v150
    v_rcp_f32 v151, v151
    v_pk_mul_f32 v[16:17], v[16:17], v[144:145]
    v_pk_mul_f32 v[18:19], v[18:19], v[146:147]
    v_pk_mul_f32 v[20:21], v[20:21], v[148:149]
    v_pk_mul_f32 v[22:23], v[22:23], v[150:151]
    v_pk_mul_f32 v[144:145], v[24:25], v[24:25]
    v_pk_mul_f32 v[146:147], v[26:27], v[26:27]
    v_pk_mul_f32 v[148:149], v[28:29], v[28:29]
    v_pk_mul_f32 v[150:151], v[30:31], v[30:31]
    v_pk_fma_f32 v[144:145], v[144:145], v[176:177], v[178:179]
    v_pk_fma_f32 v[146:147], v[146:147], v[176:177], v[178:179]
    v_pk_fma_f32 v[148:149], v[148:149], v[176:177], v[178:179]
    v_pk_fma_f32 v[150:151], v[150:151], v[176:177], v[178:179]
    v_pk_mul_f32 v[144:145], v[144:145], v[24:25]
    v_pk_mul_f32 v[146:147], v[146:147], v[26:27]
    v_pk_mul_f32 v[148:149], v[148:149], v[28:29]
    v_pk_mul_f32 v[150:151], v[150:151], v[30:31]
    v_exp_f32 v144, v144
    v_exp_f32 v145, v145
    v_exp_f32 v146, v146
    v_exp_f32 v147, v147
    v_exp_f32 v148, v148
    v_exp_f32 v149, v149
    v_exp_f32 v150, v150
    v_exp_f32 v151, v151
    v_pk_add_f32 v[144:145], v[144:145], 1.0 op_sel_hi:[1,0]
    v_pk_add_f32 v[146:147], v[146:147], 1.0 op_sel_hi:[1,0]
    v_pk_add_f32 v[148:149], v[148:149], 1.0 op_sel_hi:[1,0]
    v_pk_add_f32 v[150:151], v[150:151], 1.0 op_sel_hi:[1,0]
    v_rcp_f32 v144, v144
    v_rcp_f32 v145, v145
    v_rcp_f32 v146, v146
    v_rcp_f32 v147, v147
    v_rcp_f32 v148, v148
    v_rcp_f32 v149, v149
    v_rcp_f32 v150, v150
    v_rcp_f32 v151, v151
    v_pk_mul_f32 v[24:25], v[24:25], v[144:145]
    v_pk_mul_f32 v[26:27], v[26:27], v[146:147]
    v_pk_mul_f32 v[28:29], v[28:29], v[148:149]
    v_pk_mul_f32 v[30:31], v[30:31], v[150:151]
    v_cvt_pk_bf16_f32 v160, v16, v17
    v_cvt_pk_bf16_f32 v161, v18, v19
    v_cvt_pk_bf16_f32 v162, v20, v21
    v_cvt_pk_bf16_f32 v163, v22, v23
    v_cvt_pk_bf16_f32 v164, v24, v25
    v_cvt_pk_bf16_f32 v165, v26, v27
    v_cvt_pk_bf16_f32 v166, v28, v29
    v_cvt_pk_bf16_f32 v167, v30, v31
    s_add_u32 s35, s34, 0
    buffer_store_dwordx4 v[160:163], v252, s[60:63], s35 offen offset:0 sc0 sc1
    buffer_store_dwordx4 v[164:167], v252, s[60:63], s35 offen offset:1024 sc0 sc1
    v_pk_mul_f32 v[144:145], v[80:81], v[80:81]
    v_pk_mul_f32 v[146:147], v[82:83], v[82:83]
    v_pk_mul_f32 v[148:149], v[84:85], v[84:85]
    v_pk_mul_f32 v[150:151], v[86:87], v[86:87]
    v_pk_fma_f32 v[144:145], v[144:145], v[176:177], v[178:179]
    v_pk_fma_f32 v[146:147], v[146:147], v[176:177], v[178:179]
    v_pk_fma_f32 v[148:149], v[148:149], v[176:177], v[178:179]
    v_pk_fma_f32 v[150:151], v[150:151], v[176:177], v[178:179]
    v_pk_mul_f32 v[144:145], v[144:145], v[80:81]
    v_pk_mul_f32 v[146:147], v[146:147], v[82:83]
    v_pk_mul_f32 v[148:149], v[148:149], v[84:85]
    v_pk_mul_f32 v[150:151], v[150:151], v[86:87]
    v_exp_f32 v144, v144
    v_exp_f32 v145, v145
    v_exp_f32 v146, v146
    v_exp_f32 v147, v147
    v_exp_f32 v148, v148
    v_exp_f32 v149, v149
    v_exp_f32 v150, v150
    v_exp_f32 v151, v151
    v_pk_add_f32 v[144:145], v[144:145], 1.0 op_sel_hi:[1,0]
    v_pk_add_f32 v[146:147], v[146:147], 1.0 op_sel_hi:[1,0]
    v_pk_add_f32 v[148:149], v[148:149], 1.0 op_sel_hi:[1,0]
    v_pk_add_f32 v[150:151], v[150:151], 1.0 op_sel_hi:[1,0]
    v_rcp_f32 v144, v144
    v_rcp_f32 v145, v145
    v_rcp_f32 v146, v146
    v_rcp_f32 v147, v147
    v_rcp_f32 v148, v148
    v_rcp_f32 v149, v149
    v_rcp_f32 v150, v150
    v_rcp_f32 v151, v151
    v_pk_mul_f32 v[80:81], v[80:81], v[144:145]
    v_pk_mul_f32 v[82:83], v[82:83], v[146:147]
    v_pk_mul_f32 v[84:85], v[84:85], v[148:149]
    v_pk_mul_f32 v[86:87], v[86:87], v[150:151]
    v_pk_mul_f32 v[144:145], v[88:89], v[88:89]
    v_pk_mul_f32 v[146:147], v[90:91], v[90:91]
    v_pk_mul_f32 v[148:149], v[92:93], v[92:93]
    v_pk_mul_f32 v[150:151], v[94:95], v[94:95]
    v_pk_fma_f32 v[144:145], v[144:145], v[176:177], v[178:179]
    v_pk_fma_f32 v[146:147], v[146:147], v[176:177], v[178:179]
    v_pk_fma_f32 v[148:149], v[148:149], v[176:177], v[178:179]
    v_pk_fma_f32 v[150:151], v[150:151], v[176:177], v[178:179]
    v_pk_mul_f32 v[144:145], v[144:145], v[88:89]
    v_pk_mul_f32 v[146:147], v[146:147], v[90:91]
    v_pk_mul_f32 v[148:149], v[148:149], v[92:93]
    v_pk_mul_f32 v[150:151], v[150:151], v[94:95]
    v_exp_f32 v144, v144
    v_exp_f32 v145, v145
    v_exp_f32 v146, v146
    v_exp_f32 v147, v147
    v_exp_f32 v148, v148
    v_exp_f32 v149, v149
    v_exp_f32 v150, v150
    v_exp_f32 v151, v151
    v_pk_add_f32 v[144:145], v[144:145], 1.0 op_sel_hi:[1,0]
    v_pk_add_f32 v[146:147], v[146:147], 1.0 op_sel_hi:[1,0]
    v_pk_add_f32 v[148:149], v[148:149], 1.0 op_sel_hi:[1,0]
    v_pk_add_f32 v[150:151], v[150:151], 1.0 op_sel_hi:[1,0]
    v_rcp_f32 v144, v144
    v_rcp_f32 v145, v145
    v_rcp_f32 v146, v146
    v_rcp_f32 v147, v147
    v_rcp_f32 v148, v148
    v_rcp_f32 v149, v149
    v_rcp_f32 v150, v150
    v_rcp_f32 v151, v151
    v_pk_mul_f32 v[88:89], v[88:89], v[144:145]
    v_pk_mul_f32 v[90:91], v[90:91], v[146:147]
    v_pk_mul_f32 v[92:93], v[92:93], v[148:149]
    v_pk_mul_f32 v[94:95], v[94:95], v[150:151]
    v_cvt_pk_bf16_f32 v168, v80, v81
    v_cvt_pk_bf16_f32 v169, v82, v83
    v_cvt_pk_bf16_f32 v170, v84, v85
    v_cvt_pk_bf16_f32 v171, v86, v87
    v_cvt_pk_bf16_f32 v172, v88, v89
    v_cvt_pk_bf16_f32 v173, v90, v91
    v_cvt_pk_bf16_f32 v174, v92, v93
    v_cvt_pk_bf16_f32 v175, v94, v95
    s_add_u32 s35, s34, 147456
    buffer_store_dwordx4 v[168:171], v252, s[60:63], s35 offen offset:0 sc0 sc1
    buffer_store_dwordx4 v[172:175], v252, s[60:63], s35 offen offset:1024 sc0 sc1
    v_pk_mul_f32 v[144:145], v[32:33], v[32:33]
    v_pk_mul_f32 v[146:147], v[34:35], v[34:35]
    v_pk_mul_f32 v[148:149], v[36:37], v[36:37]
    v_pk_mul_f32 v[150:151], v[38:39], v[38:39]
    v_pk_fma_f32 v[144:145], v[144:145], v[176:177], v[178:179]
    v_pk_fma_f32 v[146:147], v[146:147], v[176:177], v[178:179]
    v_pk_fma_f32 v[148:149], v[148:149], v[176:177], v[178:179]
    v_pk_fma_f32 v[150:151], v[150:151], v[176:177], v[178:179]
    v_pk_mul_f32 v[144:145], v[144:145], v[32:33]
    v_pk_mul_f32 v[146:147], v[146:147], v[34:35]
    v_pk_mul_f32 v[148:149], v[148:149], v[36:37]
    v_pk_mul_f32 v[150:151], v[150:151], v[38:39]
    v_exp_f32 v144, v144
    v_exp_f32 v145, v145
    v_exp_f32 v146, v146
    v_exp_f32 v147, v147
    v_exp_f32 v148, v148
    v_exp_f32 v149, v149
    v_exp_f32 v150, v150
    v_exp_f32 v151, v151
    v_pk_add_f32 v[144:145], v[144:145], 1.0 op_sel_hi:[1,0]
    v_pk_add_f32 v[146:147], v[146:147], 1.0 op_sel_hi:[1,0]
    v_pk_add_f32 v[148:149], v[148:149], 1.0 op_sel_hi:[1,0]
    v_pk_add_f32 v[150:151], v[150:151], 1.0 op_sel_hi:[1,0]
    v_rcp_f32 v144, v144
    v_rcp_f32 v145, v145
    v_rcp_f32 v146, v146
    v_rcp_f32 v147, v147
    v_rcp_f32 v148, v148
    v_rcp_f32 v149, v149
    v_rcp_f32 v150, v150
    v_rcp_f32 v151, v151
    v_pk_mul_f32 v[32:33], v[32:33], v[144:145]
    v_pk_mul_f32 v[34:35], v[34:35], v[146:147]
    v_pk_mul_f32 v[36:37], v[36:37], v[148:149]
    v_pk_mul_f32 v[38:39], v[38:39], v[150:151]
    v_pk_mul_f32 v[144:145], v[40:41], v[40:41]
    v_pk_mul_f32 v[146:147], v[42:43], v[42:43]
    v_pk_mul_f32 v[148:149], v[44:45], v[44:45]
    v_pk_mul_f32 v[150:151], v[46:47], v[46:47]
    v_pk_fma_f32 v[144:145], v[144:145], v[176:177], v[178:179]
    v_pk_fma_f32 v[146:147], v[146:147], v[176:177], v[178:179]
    v_pk_fma_f32 v[148:149], v[148:149], v[176:177], v[178:179]
    v_pk_fma_f32 v[150:151], v[150:151], v[176:177], v[178:179]
    v_pk_mul_f32 v[144:145], v[144:145], v[40:41]
    v_pk_mul_f32 v[146:147], v[146:147], v[42:43]
    v_pk_mul_f32 v[148:149], v[148:149], v[44:45]
    v_pk_mul_f32 v[150:151], v[150:151], v[46:47]
    v_exp_f32 v144, v144
    v_exp_f32 v145, v145
    v_exp_f32 v146, v146
    v_exp_f32 v147, v147
    v_exp_f32 v148, v148
    v_exp_f32 v149, v149
    v_exp_f32 v150, v150
    v_exp_f32 v151, v151
    v_pk_add_f32 v[144:145], v[144:145], 1.0 op_sel_hi:[1,0]
    v_pk_add_f32 v[146:147], v[146:147], 1.0 op_sel_hi:[1,0]
    v_pk_add_f32 v[148:149], v[148:149], 1.0 op_sel_hi:[1,0]
    v_pk_add_f32 v[150:151], v[150:151], 1.0 op_sel_hi:[1,0]
    v_rcp_f32 v144, v144
    v_rcp_f32 v145, v145
    v_rcp_f32 v146, v146
    v_rcp_f32 v147, v147
    v_rcp_f32 v148, v148
    v_rcp_f32 v149, v149
    v_rcp_f32 v150, v150
    v_rcp_f32 v151, v151
    v_pk_mul_f32 v[40:41], v[40:41], v[144:145]
    v_pk_mul_f32 v[42:43], v[42:43], v[146:147]
    v_pk_mul_f32 v[44:45], v[44:45], v[148:149]
    v_pk_mul_f32 v[46:47], v[46:47], v[150:151]
    v_cvt_pk_bf16_f32 v200, v32, v33
    v_cvt_pk_bf16_f32 v201, v34, v35
    v_cvt_pk_bf16_f32 v202, v36, v37
    v_cvt_pk_bf16_f32 v203, v38, v39
    v_cvt_pk_bf16_f32 v204, v40, v41
    v_cvt_pk_bf16_f32 v205, v42, v43
    v_cvt_pk_bf16_f32 v206, v44, v45
    v_cvt_pk_bf16_f32 v207, v46, v47
    v_pk_mul_f32 v[144:145], v[48:49], v[48:49]
    v_pk_mul_f32 v[146:147], v[50:51], v[50:51]
    v_pk_mul_f32 v[148:149], v[52:53], v[52:53]
    v_pk_mul_f32 v[150:151], v[54:55], v[54:55]
    v_pk_fma_f32 v[144:145], v[144:145], v[176:177], v[178:179]
    v_pk_fma_f32 v[146:147], v[146:147], v[176:177], v[178:179]
    v_pk_fma_f32 v[148:149], v[148:149], v[176:177], v[178:179]
    v_pk_fma_f32 v[150:151], v[150:151], v[176:177], v[178:179]
    v_pk_mul_f32 v[144:145], v[144:145], v[48:49]
    v_pk_mul_f32 v[146:147], v[146:147], v[50:51]
    v_pk_mul_f32 v[148:149], v[148:149], v[52:53]
    v_pk_mul_f32 v[150:151], v[150:151], v[54:55]
    v_exp_f32 v144, v144
    v_exp_f32 v145, v145
    v_exp_f32 v146, v146
    v_exp_f32 v147, v147
    v_exp_f32 v148, v148
    v_exp_f32 v149, v149
    v_exp_f32 v150, v150
    v_exp_f32 v151, v151
    v_pk_add_f32 v[144:145], v[144:145], 1.0 op_sel_hi:[1,0]
    v_pk_add_f32 v[146:147], v[146:147], 1.0 op_sel_hi:[1,0]
    v_pk_add_f32 v[148:149], v[148:149], 1.0 op_sel_hi:[1,0]
    v_pk_add_f32 v[150:151], v[150:151], 1.0 op_sel_hi:[1,0]
    v_rcp_f32 v144, v144
    v_rcp_f32 v145, v145
    v_rcp_f32 v146, v146
    v_rcp_f32 v147, v147
    v_rcp_f32 v148, v148
    v_rcp_f32 v149, v149
    v_rcp_f32 v150, v150
    v_rcp_f32 v151, v151
    v_pk_mul_f32 v[48:49], v[48:49], v[144:145]
    v_pk_mul_f32 v[50:51], v[50:51], v[146:147]
    v_pk_mul_f32 v[52:53], v[52:53], v[148:149]
    v_pk_mul_f32 v[54:55], v[54:55], v[150:151]
    v_pk_mul_f32 v[144:145], v[56:57], v[56:57]
    v_pk_mul_f32 v[146:147], v[58:59], v[58:59]
    v_pk_mul_f32 v[148:149], v[60:61], v[60:61]
    v_pk_mul_f32 v[150:151], v[62:63], v[62:63]
    v_pk_fma_f32 v[144:145], v[144:145], v[176:177], v[178:179]
    v_pk_fma_f32 v[146:147], v[146:147], v[176:177], v[178:179]
    v_pk_fma_f32 v[148:149], v[148:149], v[176:177], v[178:179]
    v_pk_fma_f32 v[150:151], v[150:151], v[176:177], v[178:179]
    v_pk_mul_f32 v[144:145], v[144:145], v[56:57]
    v_pk_mul_f32 v[146:147], v[146:147], v[58:59]
    v_pk_mul_f32 v[148:149], v[148:149], v[60:61]
    v_pk_mul_f32 v[150:151], v[150:151], v[62:63]
    v_exp_f32 v144, v144
    v_exp_f32 v145, v145
    v_exp_f32 v146, v146
    v_exp_f32 v147, v147
    v_exp_f32 v148, v148
    v_exp_f32 v149, v149
    v_exp_f32 v150, v150
    v_exp_f32 v151, v151
    v_pk_add_f32 v[144:145], v[144:145], 1.0 op_sel_hi:[1,0]
    v_pk_add_f32 v[146:147], v[146:147], 1.0 op_sel_hi:[1,0]
    v_pk_add_f32 v[148:149], v[148:149], 1.0 op_sel_hi:[1,0]
    v_pk_add_f32 v[150:151], v[150:151], 1.0 op_sel_hi:[1,0]
    v_rcp_f32 v144, v144
    v_rcp_f32 v145, v145
    v_rcp_f32 v146, v146
    v_rcp_f32 v147, v147
    v_rcp_f32 v148, v148
    v_rcp_f32 v149, v149
    v_rcp_f32 v150, v150
    v_rcp_f32 v151, v151
    v_pk_mul_f32 v[56:57], v[56:57], v[144:145]
    v_pk_mul_f32 v[58:59], v[58:59], v[146:147]
    v_pk_mul_f32 v[60:61], v[60:61], v[148:149]
    v_pk_mul_f32 v[62:63], v[62:63], v[150:151]
    v_cvt_pk_bf16_f32 v208, v48, v49
    v_cvt_pk_bf16_f32 v209, v50, v51
    v_cvt_pk_bf16_f32 v210, v52, v53
    v_cvt_pk_bf16_f32 v211, v54, v55
    v_cvt_pk_bf16_f32 v212, v56, v57
    v_cvt_pk_bf16_f32 v213, v58, v59
    v_cvt_pk_bf16_f32 v214, v60, v61
    v_cvt_pk_bf16_f32 v215, v62, v63
    v_pk_mul_f32 v[144:145], v[64:65], v[64:65]
    v_pk_mul_f32 v[146:147], v[66:67], v[66:67]
    v_pk_mul_f32 v[148:149], v[68:69], v[68:69]
    v_pk_mul_f32 v[150:151], v[70:71], v[70:71]
    v_pk_fma_f32 v[144:145], v[144:145], v[176:177], v[178:179]
    v_pk_fma_f32 v[146:147], v[146:147], v[176:177], v[178:179]
    v_pk_fma_f32 v[148:149], v[148:149], v[176:177], v[178:179]
    v_pk_fma_f32 v[150:151], v[150:151], v[176:177], v[178:179]
    v_pk_mul_f32 v[144:145], v[144:145], v[64:65]
    v_pk_mul_f32 v[146:147], v[146:147], v[66:67]
    v_pk_mul_f32 v[148:149], v[148:149], v[68:69]
    v_pk_mul_f32 v[150:151], v[150:151], v[70:71]
    v_exp_f32 v144, v144
    v_exp_f32 v145, v145
    v_exp_f32 v146, v146
    v_exp_f32 v147, v147
    v_exp_f32 v148, v148
    v_exp_f32 v149, v149
    v_exp_f32 v150, v150
    v_exp_f32 v151, v151
    v_pk_add_f32 v[144:145], v[144:145], 1.0 op_sel_hi:[1,0]
    v_pk_add_f32 v[146:147], v[146:147], 1.0 op_sel_hi:[1,0]
    v_pk_add_f32 v[148:149], v[148:149], 1.0 op_sel_hi:[1,0]
    v_pk_add_f32 v[150:151], v[150:151], 1.0 op_sel_hi:[1,0]
    v_rcp_f32 v144, v144
    v_rcp_f32 v145, v145
    v_rcp_f32 v146, v146
    v_rcp_f32 v147, v147
    v_rcp_f32 v148, v148
    v_rcp_f32 v149, v149
    v_rcp_f32 v150, v150
    v_rcp_f32 v151, v151
    v_pk_mul_f32 v[64:65], v[64:65], v[144:145]
    v_pk_mul_f32 v[66:67], v[66:67], v[146:147]
    v_pk_mul_f32 v[68:69], v[68:69], v[148:149]
    v_pk_mul_f32 v[70:71], v[70:71], v[150:151]
    v_pk_mul_f32 v[144:145], v[72:73], v[72:73]
    v_pk_mul_f32 v[146:147], v[74:75], v[74:75]
    v_pk_mul_f32 v[148:149], v[76:77], v[76:77]
    v_pk_mul_f32 v[150:151], v[78:79], v[78:79]
    v_pk_fma_f32 v[144:145], v[144:145], v[176:177], v[178:179]
    v_pk_fma_f32 v[146:147], v[146:147], v[176:177], v[178:179]
    v_pk_fma_f32 v[148:149], v[148:149], v[176:177], v[178:179]
    v_pk_fma_f32 v[150:151], v[150:151], v[176:177], v[178:179]
    v_pk_mul_f32 v[144:145], v[144:145], v[72:73]
    v_pk_mul_f32 v[146:147], v[146:147], v[74:75]
    v_pk_mul_f32 v[148:149], v[148:149], v[76:77]
    v_pk_mul_f32 v[150:151], v[150:151], v[78:79]
    v_exp_f32 v144, v144
    v_exp_f32 v145, v145
    v_exp_f32 v146, v146
    v_exp_f32 v147, v147
    v_exp_f32 v148, v148
    v_exp_f32 v149, v149
    v_exp_f32 v150, v150
    v_exp_f32 v151, v151
    v_pk_add_f32 v[144:145], v[144:145], 1.0 op_sel_hi:[1,0]
    v_pk_add_f32 v[146:147], v[146:147], 1.0 op_sel_hi:[1,0]
    v_pk_add_f32 v[148:149], v[148:149], 1.0 op_sel_hi:[1,0]
    v_pk_add_f32 v[150:151], v[150:151], 1.0 op_sel_hi:[1,0]
    v_rcp_f32 v144, v144
    v_rcp_f32 v145, v145
    v_rcp_f32 v146, v146
    v_rcp_f32 v147, v147
    v_rcp_f32 v148, v148
    v_rcp_f32 v149, v149
    v_rcp_f32 v150, v150
    v_rcp_f32 v151, v151
    v_pk_mul_f32 v[72:73], v[72:73], v[144:145]
    v_pk_mul_f32 v[74:75], v[74:75], v[146:147]
    v_pk_mul_f32 v[76:77], v[76:77], v[148:149]
    v_pk_mul_f32 v[78:79], v[78:79], v[150:151]
    v_cvt_pk_bf16_f32 v216, v64, v65
    v_cvt_pk_bf16_f32 v217, v66, v67
    v_cvt_pk_bf16_f32 v218, v68, v69
    v_cvt_pk_bf16_f32 v219, v70, v71
    v_cvt_pk_bf16_f32 v220, v72, v73
    v_cvt_pk_bf16_f32 v221, v74, v75
    v_cvt_pk_bf16_f32 v222, v76, v77
    v_cvt_pk_bf16_f32 v223, v78, v79
    v_pk_mul_f32 v[144:145], v[96:97], v[96:97]
    v_pk_mul_f32 v[146:147], v[98:99], v[98:99]
    v_pk_mul_f32 v[148:149], v[100:101], v[100:101]
    v_pk_mul_f32 v[150:151], v[102:103], v[102:103]
    v_pk_fma_f32 v[144:145], v[144:145], v[176:177], v[178:179]
    v_pk_fma_f32 v[146:147], v[146:147], v[176:177], v[178:179]
    v_pk_fma_f32 v[148:149], v[148:149], v[176:177], v[178:179]
    v_pk_fma_f32 v[150:151], v[150:151], v[176:177], v[178:179]
    v_pk_mul_f32 v[144:145], v[144:145], v[96:97]
    v_pk_mul_f32 v[146:147], v[146:147], v[98:99]
    v_pk_mul_f32 v[148:149], v[148:149], v[100:101]
    v_pk_mul_f32 v[150:151], v[150:151], v[102:103]
    v_exp_f32 v144, v144
    v_exp_f32 v145, v145
    v_exp_f32 v146, v146
    v_exp_f32 v147, v147
    v_exp_f32 v148, v148
    v_exp_f32 v149, v149
    v_exp_f32 v150, v150
    v_exp_f32 v151, v151
    v_pk_add_f32 v[144:145], v[144:145], 1.0 op_sel_hi:[1,0]
    v_pk_add_f32 v[146:147], v[146:147], 1.0 op_sel_hi:[1,0]
    v_pk_add_f32 v[148:149], v[148:149], 1.0 op_sel_hi:[1,0]
    v_pk_add_f32 v[150:151], v[150:151], 1.0 op_sel_hi:[1,0]
    v_rcp_f32 v144, v144
    v_rcp_f32 v145, v145
    v_rcp_f32 v146, v146
    v_rcp_f32 v147, v147
    v_rcp_f32 v148, v148
    v_rcp_f32 v149, v149
    v_rcp_f32 v150, v150
    v_rcp_f32 v151, v151
    v_pk_mul_f32 v[96:97], v[96:97], v[144:145]
    v_pk_mul_f32 v[98:99], v[98:99], v[146:147]
    v_pk_mul_f32 v[100:101], v[100:101], v[148:149]
    v_pk_mul_f32 v[102:103], v[102:103], v[150:151]
    v_pk_mul_f32 v[144:145], v[104:105], v[104:105]
    v_pk_mul_f32 v[146:147], v[106:107], v[106:107]
    v_pk_mul_f32 v[148:149], v[108:109], v[108:109]
    v_pk_mul_f32 v[150:151], v[110:111], v[110:111]
    v_pk_fma_f32 v[144:145], v[144:145], v[176:177], v[178:179]
    v_pk_fma_f32 v[146:147], v[146:147], v[176:177], v[178:179]
    v_pk_fma_f32 v[148:149], v[148:149], v[176:177], v[178:179]
    v_pk_fma_f32 v[150:151], v[150:151], v[176:177], v[178:179]
    v_pk_mul_f32 v[144:145], v[144:145], v[104:105]
    v_pk_mul_f32 v[146:147], v[146:147], v[106:107]
    v_pk_mul_f32 v[148:149], v[148:149], v[108:109]
    v_pk_mul_f32 v[150:151], v[150:151], v[110:111]
    v_exp_f32 v144, v144
    v_exp_f32 v145, v145
    v_exp_f32 v146, v146
    v_exp_f32 v147, v147
    v_exp_f32 v148, v148
    v_exp_f32 v149, v149
    v_exp_f32 v150, v150
    v_exp_f32 v151, v151
    v_pk_add_f32 v[144:145], v[144:145], 1.0 op_sel_hi:[1,0]
    v_pk_add_f32 v[146:147], v[146:147], 1.0 op_sel_hi:[1,0]
    v_pk_add_f32 v[148:149], v[148:149], 1.0 op_sel_hi:[1,0]
    v_pk_add_f32 v[150:151], v[150:151], 1.0 op_sel_hi:[1,0]
    v_rcp_f32 v144, v144
    v_rcp_f32 v145, v145
    v_rcp_f32 v146, v146
    v_rcp_f32 v147, v147
    v_rcp_f32 v148, v148
    v_rcp_f32 v149, v149
    v_rcp_f32 v150, v150
    v_rcp_f32 v151, v151
    v_pk_mul_f32 v[104:105], v[104:105], v[144:145]
    v_pk_mul_f32 v[106:107], v[106:107], v[146:147]
    v_pk_mul_f32 v[108:109], v[108:109], v[148:149]
    v_pk_mul_f32 v[110:111], v[110:111], v[150:151]
    v_cvt_pk_bf16_f32 v224, v96, v97
    v_cvt_pk_bf16_f32 v225, v98, v99
    v_cvt_pk_bf16_f32 v226, v100, v101
    v_cvt_pk_bf16_f32 v227, v102, v103
    v_cvt_pk_bf16_f32 v228, v104, v105
    v_cvt_pk_bf16_f32 v229, v106, v107
    v_cvt_pk_bf16_f32 v230, v108, v109
    v_cvt_pk_bf16_f32 v231, v110, v111
    v_pk_mul_f32 v[144:145], v[112:113], v[112:113]
    v_pk_mul_f32 v[146:147], v[114:115], v[114:115]
    v_pk_mul_f32 v[148:149], v[116:117], v[116:117]
    v_pk_mul_f32 v[150:151], v[118:119], v[118:119]
    v_pk_fma_f32 v[144:145], v[144:145], v[176:177], v[178:179]
    v_pk_fma_f32 v[146:147], v[146:147], v[176:177], v[178:179]
    v_pk_fma_f32 v[148:149], v[148:149], v[176:177], v[178:179]
    v_pk_fma_f32 v[150:151], v[150:151], v[176:177], v[178:179]
    v_pk_mul_f32 v[144:145], v[144:145], v[112:113]
    v_pk_mul_f32 v[146:147], v[146:147], v[114:115]
    v_pk_mul_f32 v[148:149], v[148:149], v[116:117]
    v_pk_mul_f32 v[150:151], v[150:151], v[118:119]
    v_exp_f32 v144, v144
    v_exp_f32 v145, v145
    v_exp_f32 v146, v146
    v_exp_f32 v147, v147
    v_exp_f32 v148, v148
    v_exp_f32 v149, v149
    v_exp_f32 v150, v150
    v_exp_f32 v151, v151
    v_pk_add_f32 v[144:145], v[144:145], 1.0 op_sel_hi:[1,0]
    v_pk_add_f32 v[146:147], v[146:147], 1.0 op_sel_hi:[1,0]
    v_pk_add_f32 v[148:149], v[148:149], 1.0 op_sel_hi:[1,0]
    v_pk_add_f32 v[150:151], v[150:151], 1.0 op_sel_hi:[1,0]
    v_rcp_f32 v144, v144
    v_rcp_f32 v145, v145
    v_rcp_f32 v146, v146
    v_rcp_f32 v147, v147
    v_rcp_f32 v148, v148
    v_rcp_f32 v149, v149
    v_rcp_f32 v150, v150
    v_rcp_f32 v151, v151
    v_pk_mul_f32 v[112:113], v[112:113], v[144:145]
    v_pk_mul_f32 v[114:115], v[114:115], v[146:147]
    v_pk_mul_f32 v[116:117], v[116:117], v[148:149]
    v_pk_mul_f32 v[118:119], v[118:119], v[150:151]
    v_pk_mul_f32 v[144:145], v[120:121], v[120:121]
    v_pk_mul_f32 v[146:147], v[122:123], v[122:123]
    v_pk_mul_f32 v[148:149], v[124:125], v[124:125]
    v_pk_mul_f32 v[150:151], v[126:127], v[126:127]
    v_pk_fma_f32 v[144:145], v[144:145], v[176:177], v[178:179]
    v_pk_fma_f32 v[146:147], v[146:147], v[176:177], v[178:179]
    v_pk_fma_f32 v[148:149], v[148:149], v[176:177], v[178:179]
    v_pk_fma_f32 v[150:151], v[150:151], v[176:177], v[178:179]
    v_pk_mul_f32 v[144:145], v[144:145], v[120:121]
    v_pk_mul_f32 v[146:147], v[146:147], v[122:123]
    v_pk_mul_f32 v[148:149], v[148:149], v[124:125]
    v_pk_mul_f32 v[150:151], v[150:151], v[126:127]
    v_exp_f32 v144, v144
    v_exp_f32 v145, v145
    v_exp_f32 v146, v146
    v_exp_f32 v147, v147
    v_exp_f32 v148, v148
    v_exp_f32 v149, v149
    v_exp_f32 v150, v150
    v_exp_f32 v151, v151
    v_pk_add_f32 v[144:145], v[144:145], 1.0 op_sel_hi:[1,0]
    v_pk_add_f32 v[146:147], v[146:147], 1.0 op_sel_hi:[1,0]
    v_pk_add_f32 v[148:149], v[148:149], 1.0 op_sel_hi:[1,0]
    v_pk_add_f32 v[150:151], v[150:151], 1.0 op_sel_hi:[1,0]
    v_rcp_f32 v144, v144
    v_rcp_f32 v145, v145
    v_rcp_f32 v146, v146
    v_rcp_f32 v147, v147
    v_rcp_f32 v148, v148
    v_rcp_f32 v149, v149
    v_rcp_f32 v150, v150
    v_rcp_f32 v151, v151
    v_pk_mul_f32 v[120:121], v[120:121], v[144:145]
    v_pk_mul_f32 v[122:123], v[122:123], v[146:147]
    v_pk_mul_f32 v[124:125], v[124:125], v[148:149]
    v_pk_mul_f32 v[126:127], v[126:127], v[150:151]
    v_cvt_pk_bf16_f32 v232, v112, v113
    v_cvt_pk_bf16_f32 v233, v114, v115
    v_cvt_pk_bf16_f32 v234, v116, v117
    v_cvt_pk_bf16_f32 v235, v118, v119
    v_cvt_pk_bf16_f32 v236, v120, v121
    v_cvt_pk_bf16_f32 v237, v122, v123
    v_cvt_pk_bf16_f32 v238, v124, v125
    v_cvt_pk_bf16_f32 v239, v126, v127
    v_pk_mul_f32 v[144:145], v[128:129], v[128:129]
    v_pk_mul_f32 v[146:147], v[130:131], v[130:131]
    v_pk_mul_f32 v[148:149], v[132:133], v[132:133]
    v_pk_mul_f32 v[150:151], v[134:135], v[134:135]
    v_pk_fma_f32 v[144:145], v[144:145], v[176:177], v[178:179]
    v_pk_fma_f32 v[146:147], v[146:147], v[176:177], v[178:179]
    v_pk_fma_f32 v[148:149], v[148:149], v[176:177], v[178:179]
    v_pk_fma_f32 v[150:151], v[150:151], v[176:177], v[178:179]
    v_pk_mul_f32 v[144:145], v[144:145], v[128:129]
    v_pk_mul_f32 v[146:147], v[146:147], v[130:131]
    v_pk_mul_f32 v[148:149], v[148:149], v[132:133]
    v_pk_mul_f32 v[150:151], v[150:151], v[134:135]
    v_exp_f32 v144, v144
    v_exp_f32 v145, v145
    v_exp_f32 v146, v146
    v_exp_f32 v147, v147
    v_exp_f32 v148, v148
    v_exp_f32 v149, v149
    v_exp_f32 v150, v150
    v_exp_f32 v151, v151
    v_pk_add_f32 v[144:145], v[144:145], 1.0 op_sel_hi:[1,0]
    v_pk_add_f32 v[146:147], v[146:147], 1.0 op_sel_hi:[1,0]
    v_pk_add_f32 v[148:149], v[148:149], 1.0 op_sel_hi:[1,0]
    v_pk_add_f32 v[150:151], v[150:151], 1.0 op_sel_hi:[1,0]
    v_rcp_f32 v144, v144
    v_rcp_f32 v145, v145
    v_rcp_f32 v146, v146
    v_rcp_f32 v147, v147
    v_rcp_f32 v148, v148
    v_rcp_f32 v149, v149
    v_rcp_f32 v150, v150
    v_rcp_f32 v151, v151
    v_pk_mul_f32 v[128:129], v[128:129], v[144:145]
    v_pk_mul_f32 v[130:131], v[130:131], v[146:147]
    v_pk_mul_f32 v[132:133], v[132:133], v[148:149]
    v_pk_mul_f32 v[134:135], v[134:135], v[150:151]
    v_pk_mul_f32 v[144:145], v[136:137], v[136:137]
    v_pk_mul_f32 v[146:147], v[138:139], v[138:139]
    v_pk_mul_f32 v[148:149], v[140:141], v[140:141]
    v_pk_mul_f32 v[150:151], v[142:143], v[142:143]
    v_pk_fma_f32 v[144:145], v[144:145], v[176:177], v[178:179]
    v_pk_fma_f32 v[146:147], v[146:147], v[176:177], v[178:179]
    v_pk_fma_f32 v[148:149], v[148:149], v[176:177], v[178:179]
    v_pk_fma_f32 v[150:151], v[150:151], v[176:177], v[178:179]
    v_pk_mul_f32 v[144:145], v[144:145], v[136:137]
    v_pk_mul_f32 v[146:147], v[146:147], v[138:139]
    v_pk_mul_f32 v[148:149], v[148:149], v[140:141]
    v_pk_mul_f32 v[150:151], v[150:151], v[142:143]
    v_exp_f32 v144, v144
    v_exp_f32 v145, v145
    v_exp_f32 v146, v146
    v_exp_f32 v147, v147
    v_exp_f32 v148, v148
    v_exp_f32 v149, v149
    v_exp_f32 v150, v150
    v_exp_f32 v151, v151
    v_pk_add_f32 v[144:145], v[144:145], 1.0 op_sel_hi:[1,0]
    v_pk_add_f32 v[146:147], v[146:147], 1.0 op_sel_hi:[1,0]
    v_pk_add_f32 v[148:149], v[148:149], 1.0 op_sel_hi:[1,0]
    v_pk_add_f32 v[150:151], v[150:151], 1.0 op_sel_hi:[1,0]
    v_rcp_f32 v144, v144
    v_rcp_f32 v145, v145
    v_rcp_f32 v146, v146
    v_rcp_f32 v147, v147
    v_rcp_f32 v148, v148
    v_rcp_f32 v149, v149
    v_rcp_f32 v150, v150
    v_rcp_f32 v151, v151
    v_pk_mul_f32 v[136:137], v[136:137], v[144:145]
    v_pk_mul_f32 v[138:139], v[138:139], v[146:147]
    v_pk_mul_f32 v[140:141], v[140:141], v[148:149]
    v_pk_mul_f32 v[142:143], v[142:143], v[150:151]
    v_cvt_pk_bf16_f32 v240, v128, v129
    v_cvt_pk_bf16_f32 v241, v130, v131
    v_cvt_pk_bf16_f32 v242, v132, v133
    v_cvt_pk_bf16_f32 v243, v134, v135
    v_cvt_pk_bf16_f32 v244, v136, v137
    v_cvt_pk_bf16_f32 v245, v138, v139
    v_cvt_pk_bf16_f32 v246, v140, v141
    v_cvt_pk_bf16_f32 v247, v142, v143
    s_barrier
    s_branch gated_mix__mha_block__mixer_gmlp__prompt_kernel_att
gated_mix__mha_block__mixer_gmlp__prompt_kernel_zs:
    s_nop 1
    s_setprio 1
    s_lshl_b32 s26, s5, 7
    s_lshl_b32 s27, s6, 5
    s_add_u32 s26, s26, s27
    v_lshrrev_b32 v4, 3, v0
    v_and_b32 v5, 7, v0
    v_add_u32 v6, s26, v4
    v_lshrrev_b32 v7, 1, v4
    v_mul_u32_u24 v6, 1152, v6
    v_xor_b32 v7, v7, v5
    s_lshl_b32 s55, s6, 12
    s_mov_b32 s56, 0
    v_lshl_add_u32 v224, v7, 4, v6
    v_xor_b32 v7, 4, v7
    v_lshl_add_u32 v225, v7, 4, v6
    v_add_u32 v226, 16384, v224
    v_add_u32 v227, 24576, v225
    v_add_u32 v225, 8192, v225
    s_add_u32 s16, s8, 0
    s_addc_u32 s17, s9, 0
    s_mov_b32 s18, 2359296
    s_mov_b32 s19, 0x00020000
    s_add_u32 s20, s12, 0
    s_addc_u32 s21, s13, 0
    s_mov_b32 s22, 5308416
    s_mov_b32 s23, 0x00020000
    s_lshl_b32 s26, s64, 7
    s_add_u32 s26, s26, 0
    s_lshl_b32 s27, s6, 3
    s_movk_i32 s28, 9216
    v_lshlrev_b32 v6, 1, v4
    v_and_b32 v6, 4, v6
    v_xor_b32 v6, v6, v5
    v_lshlrev_b32 v6, 4, v6
    v_add_u32 v6, s26, v6
    v_add_u32 v7, s27, v4
    v_mul_lo_u32 v7, v7, s28
    v_add_u32 v228, v7, v6
    s_lshl_b32 s54, s6, 10
    s_add_u32 s54, s54, 32768
    s_mov_b32 s57, 0
    s_add_u32 s40, s12, 0
    s_addc_u32 s41, s13, 0
    s_mov_b32 s42, 5308416
    s_mov_b32 s43, 0x00020000
    s_add_u32 s44, s10, 0
    s_addc_u32 s45, s11, 0
    s_mov_b32 s46, 1990656
    s_mov_b32 s47, 0x00020000
    s_lshl_b32 s25, s2, 2
    s_add_u32 s25, s25, s6
    s_lshl_b32 s25, s25, 10
    s_add_u32 s26, s25, 2097152
    s_add_u32 s27, s25, 4194304
    v_lshlrev_b32 v3, 4, v0
    buffer_load_dwordx4 v[252:255], v3, s[16:19], s25 offen
    buffer_load_dwordx4 v[252:255], v3, s[40:43], s25 offen
    buffer_load_dwordx4 v[252:255], v3, s[44:47], s25 offen
    buffer_load_dwordx4 v[252:255], v3, s[40:43], s26 offen
    buffer_load_dwordx4 v[252:255], v3, s[16:19], s26 offen
    buffer_load_dwordx4 v[252:255], v3, s[40:43], s27 offen
    s_add_u32 s48, s68, 0
    s_addc_u32 s49, s69, 0
    s_mov_b32 s50, 256
    s_mov_b32 s51, 0x00020000
    v_mov_b32 v22, 0
    buffer_load_dwordx2 v[20:21], v22, s[48:51], 0 offen sc0 sc1
    s_waitcnt vmcnt(0)
    v_readfirstlane_b32 s76, v20
    v_readfirstlane_b32 s77, v21
    s_mov_b32 s38, 0x40000
gated_mix__mha_block__mixer_gmlp__prompt_kernel_zs_n:
    s_nop 1
    s_cmp_eq_u32 s76, 0
    s_cbranch_scc1 gated_mix__mha_block__mixer_gmlp__prompt_kernel_zs_n_r
    s_sub_u32 s39, s76, s78
    s_add_u32 s39, s39, 2000
    s_cmp_ge_i32 s39, 0
    s_cbranch_scc1 gated_mix__mha_block__mixer_gmlp__prompt_kernel_zs_n_ok
    s_cmp_lt_u32 s38, 262080
    s_cbranch_scc1 gated_mix__mha_block__mixer_gmlp__prompt_kernel_zs_n_ok
gated_mix__mha_block__mixer_gmlp__prompt_kernel_zs_n_r:
    buffer_load_dwordx2 v[20:21], v22, s[48:51], 0 offen sc0 sc1
    s_waitcnt vmcnt(0)
    v_readfirstlane_b32 s76, v20
    v_readfirstlane_b32 s77, v21
    s_sub_u32 s38, s38, 1
    s_cmp_lg_u32 s38, 0
    s_nop 3
    s_cbranch_scc1 gated_mix__mha_block__mixer_gmlp__prompt_kernel_zs_n
gated_mix__mha_block__mixer_gmlp__prompt_kernel_zs_n_ok:
    s_nop 1
    s_lshl_b32 s39, s2, 7
    v_mov_b32 v23, s39
    s_cmp_lg_u32 s6, 0
    s_cbranch_scc1 gated_mix__mha_block__mixer_gmlp__prompt_kernel_zs_go_ok
    s_mov_b32 s38, 0x40000
gated_mix__mha_block__mixer_gmlp__prompt_kernel_zs_go:
    buffer_load_dwordx2 v[24:25], v23, s[72:75], 0 offen sc0 sc1
    s_waitcnt vmcnt(0)
    v_cmp_ne_u64 vcc, s[76:77], v[24:25]
    s_sub_u32 s38, s38, 1
    s_nop 2
    s_cbranch_vccz gated_mix__mha_block__mixer_gmlp__prompt_kernel_zs_go_ok
    s_cmp_eq_u32 s38, 0
    s_cbranch_scc1 gated_mix__mha_block__mixer_gmlp__prompt_kernel_zs_go_ok
    s_sleep 4
    s_branch gated_mix__mha_block__mixer_gmlp__prompt_kernel_zs_go
gated_mix__mha_block__mixer_gmlp__prompt_kernel_zs_go_ok:
    s_barrier
    s_add_u32 m0, s55, 0
    s_nop 0
    buffer_load_dwordx4 v224, s[16:19], s56 offen offset:0 lds
    buffer_load_dwordx4 v225, s[16:19], s56 offen offset:1024 lds
    buffer_load_dwordx4 v226, s[16:19], s56 offen offset:2048 lds
    buffer_load_dwordx4 v227, s[16:19], s56 offen offset:3072 lds
    s_add_u32 s56, s56, 128
    s_add_u32 m0, s54, 0
    s_nop 0
    buffer_load_dwordx4 v228, s[20:23], s57 offen offset:0 lds
    s_add_u32 s57, s57, 294912
    s_add_u32 m0, s54, 4096
    s_nop 0
    buffer_load_dwordx4 v228, s[20:23], s57 offen offset:0 lds
    s_add_u32 s57, s57, 294912
    s_add_u32 m0, s55, 16384
    s_nop 0
    buffer_load_dwordx4 v224, s[16:19], s56 offen offset:0 lds
    buffer_load_dwordx4 v225, s[16:19], s56 offen offset:1024 lds
    buffer_load_dwordx4 v226, s[16:19], s56 offen offset:2048 lds
    buffer_load_dwordx4 v227, s[16:19], s56 offen offset:3072 lds
    s_add_u32 s56, s56, 128
    s_add_u32 m0, s54, 8192
    s_nop 0
    buffer_load_dwordx4 v228, s[20:23], s57 offen offset:0 lds
    s_add_u32 s57, s57, 294912
    s_add_u32 m0, s54, 12288
    s_nop 0
    buffer_load_dwordx4 v228, s[20:23], s57 offen offset:0 lds
    s_add_u32 s57, s57, 294912
    s_and_b32 s29, s6, 1
    s_lshl_b32 s29, s29, 13
    v_and_b32 v8, 31, v0
    v_and_b32 v9, 0x33, v8
    v_and_b32 v10, 4, v8
    v_lshl_or_b32 v9, v10, 1, v9
    v_and_b32 v10, 8, v8
    v_lshrrev_b32 v10, 1, v10
    v_or_b32 v9, v9, v10
    v_lshrrev_b32 v10, 5, v0
    v_bfe_u32 v11, v9, 1, 3
    v_xor_b32 v11, v11, v10
    v_lshlrev_b32 v11, 4, v11
    v_lshl_add_u32 v11, v9, 7, v11
    v_add_u32 v216, s29, v11
    v_xor_b32 v217, 32, v216
    v_xor_b32 v218, 64, v216
    v_xor_b32 v219, 96, v216
    v_mov_b32 v15, v10
    v_bfe_u32 v12, v0, 2, 2
    v_lshl_add_u32 v13, v10, 3, v12
    v_lshlrev_b32 v13, 7, v13
    v_and_b32 v14, 2, v12
    v_lshl_add_u32 v13, v14, 5, v13
    v_and_b32 v14, 16, v0
    v_lshl_add_u32 v13, v14, 1, v13
    v_and_b32 v14, 1, v0
    v_lshl_add_u32 v13, v14, 4, v13
    v_and_b32 v14, 2, v0
    v_lshl_add_u32 v13, v14, 2, v13
    s_lshr_b32 s30, s6, 1
    s_mul_i32 s31, s30, 1
    s_add_u32 s32, s31, 0
    s_and_b32 s33, s32, 1
    s_lshl_b32 s33, s33, 6
    s_lshr_b32 s32, s32, 1
    s_lshl_b32 s32, s32, 12
    s_add_u32 s32, s32, 32768
    v_xor_b32 v14, s33, v13
    v_add_u32 v220, s32, v14
    s_waitcnt vmcnt(7)
    s_waitcnt lgkmcnt(0)
    s_barrier
    ds_read_b128 v[112:115], v216 offset:0
    ds_read_b128 v[116:119], v216 offset:4096
    ds_read_b64_tr_b16 v[176:177], v220 offset:0
    ds_read_b64_tr_b16 v[178:179], v220 offset:512
    ds_read_b128 v[120:123], v217 offset:0
    ds_read_b128 v[124:127], v217 offset:4096
    s_waitcnt lgkmcnt(2)
    v_mfma_f32_32x32x16_bf16 v[16:31], v[176:179], v[112:115], 0
    ds_read_b64_tr_b16 v[180:181], v220 offset:2048
    ds_read_b64_tr_b16 v[182:183], v220 offset:2560
    ds_read_b128 v[128:131], v218 offset:0
    ds_read_b128 v[132:135], v218 offset:4096
    ds_read_b128 v[136:139], v219 offset:0
    ds_read_b128 v[140:143], v219 offset:4096
    v_mfma_f32_32x32x16_bf16 v[32:47], v[176:179], v[116:119], 0
    s_waitcnt vmcnt(6)
    s_waitcnt lgkmcnt(0)
    s_barrier
    v_mfma_f32_32x32x16_bf16 v[16:31], v[180:183], v[120:123], v[16:31]
    ds_read_b64_tr_b16 v[176:177], v220 offset:4096
    ds_read_b64_tr_b16 v[178:179], v220 offset:4608
    v_mfma_f32_32x32x16_bf16 v[32:47], v[180:183], v[124:127], v[32:47]
    s_add_u32 m0, s54, 0
    s_nop 0
    buffer_load_dwordx4 v228, s[20:23], s57 offen offset:0 lds
    s_add_u32 s57, s57, 294912
    s_waitcnt lgkmcnt(0)
    v_mfma_f32_32x32x16_bf16 v[16:31], v[176:179], v[128:131], v[16:31]
    ds_read_b64_tr_b16 v[180:181], v220 offset:6144
    ds_read_b64_tr_b16 v[182:183], v220 offset:6656
    v_mfma_f32_32x32x16_bf16 v[32:47], v[176:179], v[132:135], v[32:47]
    s_add_u32 m0, s55, 0
    s_nop 0
    buffer_load_dwordx4 v224, s[16:19], s56 offen offset:0 lds
    buffer_load_dwordx4 v225, s[16:19], s56 offen offset:1024 lds
    buffer_load_dwordx4 v226, s[16:19], s56 offen offset:2048 lds
    buffer_load_dwordx4 v227, s[16:19], s56 offen offset:3072 lds
    s_add_u32 s56, s56, 128
    s_waitcnt vmcnt(6)
    s_waitcnt lgkmcnt(0)
    s_barrier
    v_mfma_f32_32x32x16_bf16 v[16:31], v[180:183], v[136:139], v[16:31]
    ds_read_b128 v[144:147], v216 offset:16384
    ds_read_b128 v[148:151], v216 offset:20480
    ds_read_b64_tr_b16 v[176:177], v220 offset:8192
    ds_read_b64_tr_b16 v[178:179], v220 offset:8704
    ds_read_b128 v[152:155], v217 offset:16384
    ds_read_b128 v[156:159], v217 offset:20480
    v_mfma_f32_32x32x16_bf16 v[32:47], v[180:183], v[140:143], v[32:47]
    s_add_u32 m0, s54, 4096
    s_nop 0
    buffer_load_dwordx4 v228, s[20:23], s57 offen offset:0 lds
    s_add_u32 s57, s57, 294912
    s_waitcnt lgkmcnt(2)
    v_mfma_f32_32x32x16_bf16 v[16:31], v[176:179], v[144:147], v[16:31]
    ds_read_b64_tr_b16 v[180:181], v220 offset:10240
    ds_read_b64_tr_b16 v[182:183], v220 offset:10752
    ds_read_b128 v[160:163], v218 offset:16384
    ds_read_b128 v[164:167], v218 offset:20480
    ds_read_b128 v[168:171], v219 offset:16384
    ds_read_b128 v[172:175], v219 offset:20480
    v_mfma_f32_32x32x16_bf16 v[32:47], v[176:179], v[148:151], v[32:47]
    s_waitcnt vmcnt(6)
    s_waitcnt lgkmcnt(0)
    s_barrier
    v_mfma_f32_32x32x16_bf16 v[16:31], v[180:183], v[152:155], v[16:31]
    ds_read_b64_tr_b16 v[176:177], v220 offset:12288
    ds_read_b64_tr_b16 v[178:179], v220 offset:12800
    v_mfma_f32_32x32x16_bf16 v[32:47], v[180:183], v[156:159], v[32:47]
    s_add_u32 m0, s54, 8192
    s_nop 0
    buffer_load_dwordx4 v228, s[20:23], s57 offen offset:0 lds
    s_add_u32 s57, s57, 294912
    s_waitcnt lgkmcnt(0)
    v_mfma_f32_32x32x16_bf16 v[16:31], v[176:179], v[160:163], v[16:31]
    ds_read_b64_tr_b16 v[180:181], v220 offset:14336
    ds_read_b64_tr_b16 v[182:183], v220 offset:14848
    v_mfma_f32_32x32x16_bf16 v[32:47], v[176:179], v[164:167], v[32:47]
    s_add_u32 m0, s55, 16384
    s_nop 0
    buffer_load_dwordx4 v224, s[16:19], s56 offen offset:0 lds
    buffer_load_dwordx4 v225, s[16:19], s56 offen offset:1024 lds
    buffer_load_dwordx4 v226, s[16:19], s56 offen offset:2048 lds
    buffer_load_dwordx4 v227, s[16:19], s56 offen offset:3072 lds
    s_add_u32 s56, s56, 128
    s_waitcnt vmcnt(10)
    s_waitcnt vmcnt(6)
    s_waitcnt lgkmcnt(0)
    s_barrier
    v_mfma_f32_32x32x16_bf16 v[16:31], v[180:183], v[168:171], v[16:31]
    ds_read_b128 v[112:115], v216 offset:0
    ds_read_b128 v[116:119], v216 offset:4096
    ds_read_b64_tr_b16 v[176:177], v220 offset:0
    ds_read_b64_tr_b16 v[178:179], v220 offset:512
    ds_read_b128 v[120:123], v217 offset:0
    ds_read_b128 v[124:127], v217 offset:4096
    v_mfma_f32_32x32x16_bf16 v[32:47], v[180:183], v[172:175], v[32:47]
    s_add_u32 m0, s54, 12288
    s_nop 0
    buffer_load_dwordx4 v228, s[20:23], s57 offen offset:0 lds
    s_add_u32 s57, s57, 294912
    s_waitcnt lgkmcnt(2)
    v_mfma_f32_32x32x16_bf16 v[16:31], v[176:179], v[112:115], v[16:31]
    ds_read_b64_tr_b16 v[180:181], v220 offset:2048
    ds_read_b64_tr_b16 v[182:183], v220 offset:2560
    ds_read_b128 v[128:131], v218 offset:0
    ds_read_b128 v[132:135], v218 offset:4096
    ds_read_b128 v[136:139], v219 offset:0
    ds_read_b128 v[140:143], v219 offset:4096
    v_mfma_f32_32x32x16_bf16 v[32:47], v[176:179], v[116:119], v[32:47]
    s_mov_b32 s65, 2
.p2align 6
gated_mix__mha_block__mixer_gmlp__prompt_kernel_zs_l:
    s_waitcnt vmcnt(6)
    s_waitcnt lgkmcnt(0)
    s_barrier
    v_mfma_f32_32x32x16_bf16 v[16:31], v[180:183], v[120:123], v[16:31]
    ds_read_b64_tr_b16 v[176:177], v220 offset:4096
    ds_read_b64_tr_b16 v[178:179], v220 offset:4608
    v_mfma_f32_32x32x16_bf16 v[32:47], v[180:183], v[124:127], v[32:47]
    s_add_u32 m0, s54, 0
    s_nop 0
    buffer_load_dwordx4 v228, s[20:23], s57 offen offset:0 lds
    s_add_u32 s57, s57, 294912
    s_waitcnt lgkmcnt(0)
    v_mfma_f32_32x32x16_bf16 v[16:31], v[176:179], v[128:131], v[16:31]
    ds_read_b64_tr_b16 v[180:181], v220 offset:6144
    ds_read_b64_tr_b16 v[182:183], v220 offset:6656
    v_mfma_f32_32x32x16_bf16 v[32:47], v[176:179], v[132:135], v[32:47]
    s_add_u32 m0, s55, 0
    s_nop 0
    buffer_load_dwordx4 v224, s[16:19], s56 offen offset:0 lds
    buffer_load_dwordx4 v225, s[16:19], s56 offen offset:1024 lds
    buffer_load_dwordx4 v226, s[16:19], s56 offen offset:2048 lds
    buffer_load_dwordx4 v227, s[16:19], s56 offen offset:3072 lds
    s_add_u32 s56, s56, 128
    s_waitcnt vmcnt(10)
    s_waitcnt vmcnt(6)
    s_waitcnt lgkmcnt(0)
    s_barrier
    v_mfma_f32_32x32x16_bf16 v[16:31], v[180:183], v[136:139], v[16:31]
    ds_read_b128 v[144:147], v216 offset:16384
    ds_read_b128 v[148:151], v216 offset:20480
    ds_read_b64_tr_b16 v[176:177], v220 offset:8192
    ds_read_b64_tr_b16 v[178:179], v220 offset:8704
    ds_read_b128 v[152:155], v217 offset:16384
    ds_read_b128 v[156:159], v217 offset:20480
    v_mfma_f32_32x32x16_bf16 v[32:47], v[180:183], v[140:143], v[32:47]
    s_add_u32 m0, s54, 4096
    s_nop 0
    buffer_load_dwordx4 v228, s[20:23], s57 offen offset:0 lds
    s_add_u32 s57, s57, 294912
    s_waitcnt lgkmcnt(2)
    v_mfma_f32_32x32x16_bf16 v[16:31], v[176:179], v[144:147], v[16:31]
    ds_read_b64_tr_b16 v[180:181], v220 offset:10240
    ds_read_b64_tr_b16 v[182:183], v220 offset:10752
    ds_read_b128 v[160:163], v218 offset:16384
    ds_read_b128 v[164:167], v218 offset:20480
    ds_read_b128 v[168:171], v219 offset:16384
    ds_read_b128 v[172:175], v219 offset:20480
    v_mfma_f32_32x32x16_bf16 v[32:47], v[176:179], v[148:151], v[32:47]
    s_waitcnt vmcnt(6)
    s_waitcnt lgkmcnt(0)
    s_barrier
    v_mfma_f32_32x32x16_bf16 v[16:31], v[180:183], v[152:155], v[16:31]
    ds_read_b64_tr_b16 v[176:177], v220 offset:12288
    ds_read_b64_tr_b16 v[178:179], v220 offset:12800
    v_mfma_f32_32x32x16_bf16 v[32:47], v[180:183], v[156:159], v[32:47]
    s_add_u32 m0, s54, 8192
    s_nop 0
    buffer_load_dwordx4 v228, s[20:23], s57 offen offset:0 lds
    s_add_u32 s57, s57, 294912
    s_waitcnt lgkmcnt(0)
    v_mfma_f32_32x32x16_bf16 v[16:31], v[176:179], v[160:163], v[16:31]
    ds_read_b64_tr_b16 v[180:181], v220 offset:14336
    ds_read_b64_tr_b16 v[182:183], v220 offset:14848
    v_mfma_f32_32x32x16_bf16 v[32:47], v[176:179], v[164:167], v[32:47]
    s_add_u32 m0, s55, 16384
    s_nop 0
    buffer_load_dwordx4 v224, s[16:19], s56 offen offset:0 lds
    buffer_load_dwordx4 v225, s[16:19], s56 offen offset:1024 lds
    buffer_load_dwordx4 v226, s[16:19], s56 offen offset:2048 lds
    buffer_load_dwordx4 v227, s[16:19], s56 offen offset:3072 lds
    s_add_u32 s56, s56, 128
    s_waitcnt vmcnt(10)
    s_waitcnt vmcnt(6)
    s_waitcnt lgkmcnt(0)
    s_barrier
    v_mfma_f32_32x32x16_bf16 v[16:31], v[180:183], v[168:171], v[16:31]
    ds_read_b128 v[112:115], v216 offset:0
    ds_read_b128 v[116:119], v216 offset:4096
    ds_read_b64_tr_b16 v[176:177], v220 offset:0
    ds_read_b64_tr_b16 v[178:179], v220 offset:512
    ds_read_b128 v[120:123], v217 offset:0
    ds_read_b128 v[124:127], v217 offset:4096
    v_mfma_f32_32x32x16_bf16 v[32:47], v[180:183], v[172:175], v[32:47]
    s_add_u32 m0, s54, 12288
    s_nop 0
    buffer_load_dwordx4 v228, s[20:23], s57 offen offset:0 lds
    s_add_u32 s57, s57, 294912
    s_waitcnt lgkmcnt(2)
    v_mfma_f32_32x32x16_bf16 v[16:31], v[176:179], v[112:115], v[16:31]
    ds_read_b64_tr_b16 v[180:181], v220 offset:2048
    ds_read_b64_tr_b16 v[182:183], v220 offset:2560
    ds_read_b128 v[128:131], v218 offset:0
    ds_read_b128 v[132:135], v218 offset:4096
    ds_read_b128 v[136:139], v219 offset:0
    ds_read_b128 v[140:143], v219 offset:4096
    v_mfma_f32_32x32x16_bf16 v[32:47], v[176:179], v[116:119], v[32:47]
    s_sub_u32 s65, s65, 1
    s_cmp_lg_u32 s65, 0
    s_cbranch_scc1 gated_mix__mha_block__mixer_gmlp__prompt_kernel_zs_l
    s_waitcnt vmcnt(6)
    s_waitcnt lgkmcnt(0)
    s_barrier
    v_mfma_f32_32x32x16_bf16 v[16:31], v[180:183], v[120:123], v[16:31]
    ds_read_b64_tr_b16 v[176:177], v220 offset:4096
    ds_read_b64_tr_b16 v[178:179], v220 offset:4608
    v_mfma_f32_32x32x16_bf16 v[32:47], v[180:183], v[124:127], v[32:47]
    s_add_u32 m0, s54, 0
    s_nop 0
    buffer_load_dwordx4 v228, s[20:23], s57 offen offset:0 lds
    s_add_u32 s57, s57, 294912
    s_waitcnt lgkmcnt(0)
    v_mfma_f32_32x32x16_bf16 v[16:31], v[176:179], v[128:131], v[16:31]
    ds_read_b64_tr_b16 v[180:181], v220 offset:6144
    ds_read_b64_tr_b16 v[182:183], v220 offset:6656
    v_mfma_f32_32x32x16_bf16 v[32:47], v[176:179], v[132:135], v[32:47]
    s_add_u32 m0, s55, 0
    s_nop 0
    buffer_load_dwordx4 v224, s[16:19], s56 offen offset:0 lds
    buffer_load_dwordx4 v225, s[16:19], s56 offen offset:1024 lds
    buffer_load_dwordx4 v226, s[16:19], s56 offen offset:2048 lds
    buffer_load_dwordx4 v227, s[16:19], s56 offen offset:3072 lds
    s_add_u32 s56, s56, 128
    s_waitcnt vmcnt(10)
    s_waitcnt vmcnt(6)
    s_waitcnt lgkmcnt(0)
    s_barrier
    v_mfma_f32_32x32x16_bf16 v[16:31], v[180:183], v[136:139], v[16:31]
    ds_read_b128 v[144:147], v216 offset:16384
    ds_read_b128 v[148:151], v216 offset:20480
    ds_read_b64_tr_b16 v[176:177], v220 offset:8192
    ds_read_b64_tr_b16 v[178:179], v220 offset:8704
    ds_read_b128 v[152:155], v217 offset:16384
    ds_read_b128 v[156:159], v217 offset:20480
    v_mfma_f32_32x32x16_bf16 v[32:47], v[180:183], v[140:143], v[32:47]
    s_add_u32 m0, s54, 4096
    s_nop 0
    buffer_load_dwordx4 v228, s[20:23], s57 offen offset:0 lds
    s_add_u32 s57, s57, 294912
    s_waitcnt lgkmcnt(2)
    v_mfma_f32_32x32x16_bf16 v[16:31], v[176:179], v[144:147], v[16:31]
    ds_read_b64_tr_b16 v[180:181], v220 offset:10240
    ds_read_b64_tr_b16 v[182:183], v220 offset:10752
    ds_read_b128 v[160:163], v218 offset:16384
    ds_read_b128 v[164:167], v218 offset:20480
    ds_read_b128 v[168:171], v219 offset:16384
    ds_read_b128 v[172:175], v219 offset:20480
    v_mfma_f32_32x32x16_bf16 v[32:47], v[176:179], v[148:151], v[32:47]
    s_waitcnt vmcnt(6)
    s_waitcnt lgkmcnt(0)
    s_barrier
    v_mfma_f32_32x32x16_bf16 v[16:31], v[180:183], v[152:155], v[16:31]
    ds_read_b64_tr_b16 v[176:177], v220 offset:12288
    ds_read_b64_tr_b16 v[178:179], v220 offset:12800
    v_mfma_f32_32x32x16_bf16 v[32:47], v[180:183], v[156:159], v[32:47]
    s_waitcnt lgkmcnt(0)
    v_mfma_f32_32x32x16_bf16 v[16:31], v[176:179], v[160:163], v[16:31]
    ds_read_b64_tr_b16 v[180:181], v220 offset:14336
    ds_read_b64_tr_b16 v[182:183], v220 offset:14848
    v_mfma_f32_32x32x16_bf16 v[32:47], v[176:179], v[164:167], v[32:47]
    s_waitcnt vmcnt(5)
    s_waitcnt vmcnt(1)
    s_waitcnt lgkmcnt(0)
    s_barrier
    v_mfma_f32_32x32x16_bf16 v[16:31], v[180:183], v[168:171], v[16:31]
    ds_read_b128 v[112:115], v216 offset:0
    ds_read_b128 v[116:119], v216 offset:4096
    ds_read_b64_tr_b16 v[176:177], v220 offset:0
    ds_read_b64_tr_b16 v[178:179], v220 offset:512
    ds_read_b128 v[120:123], v217 offset:0
    ds_read_b128 v[124:127], v217 offset:4096
    v_mfma_f32_32x32x16_bf16 v[32:47], v[180:183], v[172:175], v[32:47]
    s_waitcnt lgkmcnt(2)
    v_mfma_f32_32x32x16_bf16 v[16:31], v[176:179], v[112:115], v[16:31]
    ds_read_b64_tr_b16 v[180:181], v220 offset:2048
    ds_read_b64_tr_b16 v[182:183], v220 offset:2560
    ds_read_b128 v[128:131], v218 offset:0
    ds_read_b128 v[132:135], v218 offset:4096
    ds_read_b128 v[136:139], v219 offset:0
    ds_read_b128 v[140:143], v219 offset:4096
    v_mfma_f32_32x32x16_bf16 v[32:47], v[176:179], v[116:119], v[32:47]
    s_waitcnt vmcnt(0)
    s_waitcnt lgkmcnt(0)
    s_barrier
    v_mfma_f32_32x32x16_bf16 v[16:31], v[180:183], v[120:123], v[16:31]
    ds_read_b64_tr_b16 v[176:177], v220 offset:4096
    ds_read_b64_tr_b16 v[178:179], v220 offset:4608
    v_mfma_f32_32x32x16_bf16 v[32:47], v[180:183], v[124:127], v[32:47]
    s_waitcnt lgkmcnt(0)
    v_mfma_f32_32x32x16_bf16 v[16:31], v[176:179], v[128:131], v[16:31]
    ds_read_b64_tr_b16 v[180:181], v220 offset:6144
    ds_read_b64_tr_b16 v[182:183], v220 offset:6656
    v_mfma_f32_32x32x16_bf16 v[32:47], v[176:179], v[132:135], v[32:47]
    s_waitcnt lgkmcnt(0)
    v_mfma_f32_32x32x16_bf16 v[16:31], v[180:183], v[136:139], v[16:31]
    v_mfma_f32_32x32x16_bf16 v[32:47], v[180:183], v[140:143], v[32:47]
    s_and_b32 s29, s6, 1
    s_lshl_b32 s32, s5, 2
    s_lshl_b32 s33, s29, 1
    s_add_u32 s32, s32, s33
    s_lshl_b32 s33, s64, 1
    s_add_u32 s33, s33, s31
    s_nop 7
    v_mov_b32 v168, 0xbdd2d3e8
    s_setprio 0
    s_add_u32 s60, s14, 8388608
    s_addc_u32 s61, s15, 0
    s_mov_b32 s62, 9437184
    s_mov_b32 s63, 0x00020000
    v_lshlrev_b32 v1, 9, v15
    v_lshl_add_u32 v252, v9, 4, v1
    s_mul_i32 s34, s32, 72
    s_add_u32 s34, s34, s33
    s_lshl_b32 s34, s34, 11
    s_lshl_b32 s71, s5, 4
    s_add_u32 s71, s71, s7
    s_add_u32 s71, s71, 512
    s_mov_b32 s70, 0x7ff00000
    v_mul_f32 v160, v16, v16
    v_mul_f32 v161, v17, v17
    v_mul_f32 v162, v18, v18
    v_mul_f32 v163, v19, v19
    v_mul_f32 v164, v20, v20
    v_mul_f32 v165, v21, v21
    v_mul_f32 v166, v22, v22
    v_mul_f32 v167, v23, v23
    v_fmaak_f32 v160, v160, v168, 0xc0135761
    v_fmaak_f32 v161, v161, v168, 0xc0135761
    v_fmaak_f32 v162, v162, v168, 0xc0135761
    v_fmaak_f32 v163, v163, v168, 0xc0135761
    v_fmaak_f32 v164, v164, v168, 0xc0135761
    v_fmaak_f32 v165, v165, v168, 0xc0135761
    v_fmaak_f32 v166, v166, v168, 0xc0135761
    v_fmaak_f32 v167, v167, v168, 0xc0135761
    v_mul_f32 v160, v160, v16
    v_mul_f32 v161, v161, v17
    v_mul_f32 v162, v162, v18
    v_mul_f32 v163, v163, v19
    v_mul_f32 v164, v164, v20
    v_mul_f32 v165, v165, v21
    v_mul_f32 v166, v166, v22
    v_mul_f32 v167, v167, v23
    v_exp_f32 v160, v160
    v_exp_f32 v161, v161
    v_exp_f32 v162, v162
    v_exp_f32 v163, v163
    v_exp_f32 v164, v164
    v_exp_f32 v165, v165
    v_exp_f32 v166, v166
    v_exp_f32 v167, v167
    v_add_f32 v160, 1.0, v160
    v_add_f32 v161, 1.0, v161
    v_add_f32 v162, 1.0, v162
    v_add_f32 v163, 1.0, v163
    v_add_f32 v164, 1.0, v164
    v_add_f32 v165, 1.0, v165
    v_add_f32 v166, 1.0, v166
    v_add_f32 v167, 1.0, v167
    v_rcp_f32 v160, v160
    v_rcp_f32 v161, v161
    v_rcp_f32 v162, v162
    v_rcp_f32 v163, v163
    v_rcp_f32 v164, v164
    v_rcp_f32 v165, v165
    v_rcp_f32 v166, v166
    v_rcp_f32 v167, v167
    v_mul_f32 v16, v16, v160
    v_mul_f32 v17, v17, v161
    v_mul_f32 v18, v18, v162
    v_mul_f32 v19, v19, v163
    v_mul_f32 v20, v20, v164
    v_mul_f32 v21, v21, v165
    v_mul_f32 v22, v22, v166
    v_mul_f32 v23, v23, v167
    v_mul_f32 v160, v24, v24
    v_mul_f32 v161, v25, v25
    v_mul_f32 v162, v26, v26
    v_mul_f32 v163, v27, v27
    v_mul_f32 v164, v28, v28
    v_mul_f32 v165, v29, v29
    v_mul_f32 v166, v30, v30
    v_mul_f32 v167, v31, v31
    v_fmaak_f32 v160, v160, v168, 0xc0135761
    v_fmaak_f32 v161, v161, v168, 0xc0135761
    v_fmaak_f32 v162, v162, v168, 0xc0135761
    v_fmaak_f32 v163, v163, v168, 0xc0135761
    v_fmaak_f32 v164, v164, v168, 0xc0135761
    v_fmaak_f32 v165, v165, v168, 0xc0135761
    v_fmaak_f32 v166, v166, v168, 0xc0135761
    v_fmaak_f32 v167, v167, v168, 0xc0135761
    v_mul_f32 v160, v160, v24
    v_mul_f32 v161, v161, v25
    v_mul_f32 v162, v162, v26
    v_mul_f32 v163, v163, v27
    v_mul_f32 v164, v164, v28
    v_mul_f32 v165, v165, v29
    v_mul_f32 v166, v166, v30
    v_mul_f32 v167, v167, v31
    v_exp_f32 v160, v160
    v_exp_f32 v161, v161
    v_exp_f32 v162, v162
    v_exp_f32 v163, v163
    v_exp_f32 v164, v164
    v_exp_f32 v165, v165
    v_exp_f32 v166, v166
    v_exp_f32 v167, v167
    v_add_f32 v160, 1.0, v160
    v_add_f32 v161, 1.0, v161
    v_add_f32 v162, 1.0, v162
    v_add_f32 v163, 1.0, v163
    v_add_f32 v164, 1.0, v164
    v_add_f32 v165, 1.0, v165
    v_add_f32 v166, 1.0, v166
    v_add_f32 v167, 1.0, v167
    v_rcp_f32 v160, v160
    v_rcp_f32 v161, v161
    v_rcp_f32 v162, v162
    v_rcp_f32 v163, v163
    v_rcp_f32 v164, v164
    v_rcp_f32 v165, v165
    v_rcp_f32 v166, v166
    v_rcp_f32 v167, v167
    v_mul_f32 v24, v24, v160
    v_mul_f32 v25, v25, v161
    v_mul_f32 v26, v26, v162
    v_mul_f32 v27, v27, v163
    v_mul_f32 v28, v28, v164
    v_mul_f32 v29, v29, v165
    v_mul_f32 v30, v30, v166
    v_mul_f32 v31, v31, v167
    v_cvt_pk_bf16_f32 v112, v16, v17
    v_cvt_pk_bf16_f32 v113, v18, v19
    v_cvt_pk_bf16_f32 v114, v20, v21
    v_cvt_pk_bf16_f32 v115, v22, v23
    v_cvt_pk_bf16_f32 v116, v24, v25
    v_cvt_pk_bf16_f32 v117, v26, v27
    v_cvt_pk_bf16_f32 v118, v28, v29
    v_cvt_pk_bf16_f32 v119, v30, v31
    s_add_u32 s35, s34, 0
    buffer_store_dwordx4 v[112:115], v252, s[60:63], s35 offen offset:0 sc0 sc1
    buffer_store_dwordx4 v[116:119], v252, s[60:63], s35 offen offset:1024 sc0 sc1
    v_mul_f32 v160, v32, v32
    v_mul_f32 v161, v33, v33
    v_mul_f32 v162, v34, v34
    v_mul_f32 v163, v35, v35
    v_mul_f32 v164, v36, v36
    v_mul_f32 v165, v37, v37
    v_mul_f32 v166, v38, v38
    v_mul_f32 v167, v39, v39
    v_fmaak_f32 v160, v160, v168, 0xc0135761
    v_fmaak_f32 v161, v161, v168, 0xc0135761
    v_fmaak_f32 v162, v162, v168, 0xc0135761
    v_fmaak_f32 v163, v163, v168, 0xc0135761
    v_fmaak_f32 v164, v164, v168, 0xc0135761
    v_fmaak_f32 v165, v165, v168, 0xc0135761
    v_fmaak_f32 v166, v166, v168, 0xc0135761
    v_fmaak_f32 v167, v167, v168, 0xc0135761
    v_mul_f32 v160, v160, v32
    v_mul_f32 v161, v161, v33
    v_mul_f32 v162, v162, v34
    v_mul_f32 v163, v163, v35
    v_mul_f32 v164, v164, v36
    v_mul_f32 v165, v165, v37
    v_mul_f32 v166, v166, v38
    v_mul_f32 v167, v167, v39
    v_exp_f32 v160, v160
    v_exp_f32 v161, v161
    v_exp_f32 v162, v162
    v_exp_f32 v163, v163
    v_exp_f32 v164, v164
    v_exp_f32 v165, v165
    v_exp_f32 v166, v166
    v_exp_f32 v167, v167
    v_add_f32 v160, 1.0, v160
    v_add_f32 v161, 1.0, v161
    v_add_f32 v162, 1.0, v162
    v_add_f32 v163, 1.0, v163
    v_add_f32 v164, 1.0, v164
    v_add_f32 v165, 1.0, v165
    v_add_f32 v166, 1.0, v166
    v_add_f32 v167, 1.0, v167
    v_rcp_f32 v160, v160
    v_rcp_f32 v161, v161
    v_rcp_f32 v162, v162
    v_rcp_f32 v163, v163
    v_rcp_f32 v164, v164
    v_rcp_f32 v165, v165
    v_rcp_f32 v166, v166
    v_rcp_f32 v167, v167
    v_mul_f32 v32, v32, v160
    v_mul_f32 v33, v33, v161
    v_mul_f32 v34, v34, v162
    v_mul_f32 v35, v35, v163
    v_mul_f32 v36, v36, v164
    v_mul_f32 v37, v37, v165
    v_mul_f32 v38, v38, v166
    v_mul_f32 v39, v39, v167
    v_mul_f32 v160, v40, v40
    v_mul_f32 v161, v41, v41
    v_mul_f32 v162, v42, v42
    v_mul_f32 v163, v43, v43
    v_mul_f32 v164, v44, v44
    v_mul_f32 v165, v45, v45
    v_mul_f32 v166, v46, v46
    v_mul_f32 v167, v47, v47
    v_fmaak_f32 v160, v160, v168, 0xc0135761
    v_fmaak_f32 v161, v161, v168, 0xc0135761
    v_fmaak_f32 v162, v162, v168, 0xc0135761
    v_fmaak_f32 v163, v163, v168, 0xc0135761
    v_fmaak_f32 v164, v164, v168, 0xc0135761
    v_fmaak_f32 v165, v165, v168, 0xc0135761
    v_fmaak_f32 v166, v166, v168, 0xc0135761
    v_fmaak_f32 v167, v167, v168, 0xc0135761
    v_mul_f32 v160, v160, v40
    v_mul_f32 v161, v161, v41
    v_mul_f32 v162, v162, v42
    v_mul_f32 v163, v163, v43
    v_mul_f32 v164, v164, v44
    v_mul_f32 v165, v165, v45
    v_mul_f32 v166, v166, v46
    v_mul_f32 v167, v167, v47
    v_exp_f32 v160, v160
    v_exp_f32 v161, v161
    v_exp_f32 v162, v162
    v_exp_f32 v163, v163
    v_exp_f32 v164, v164
    v_exp_f32 v165, v165
    v_exp_f32 v166, v166
    v_exp_f32 v167, v167
    v_add_f32 v160, 1.0, v160
    v_add_f32 v161, 1.0, v161
    v_add_f32 v162, 1.0, v162
    v_add_f32 v163, 1.0, v163
    v_add_f32 v164, 1.0, v164
    v_add_f32 v165, 1.0, v165
    v_add_f32 v166, 1.0, v166
    v_add_f32 v167, 1.0, v167
    v_rcp_f32 v160, v160
    v_rcp_f32 v161, v161
    v_rcp_f32 v162, v162
    v_rcp_f32 v163, v163
    v_rcp_f32 v164, v164
    v_rcp_f32 v165, v165
    v_rcp_f32 v166, v166
    v_rcp_f32 v167, v167
    v_mul_f32 v40, v40, v160
    v_mul_f32 v41, v41, v161
    v_mul_f32 v42, v42, v162
    v_mul_f32 v43, v43, v163
    v_mul_f32 v44, v44, v164
    v_mul_f32 v45, v45, v165
    v_mul_f32 v46, v46, v166
    v_mul_f32 v47, v47, v167
    v_cvt_pk_bf16_f32 v120, v32, v33
    v_cvt_pk_bf16_f32 v121, v34, v35
    v_cvt_pk_bf16_f32 v122, v36, v37
    v_cvt_pk_bf16_f32 v123, v38, v39
    v_cvt_pk_bf16_f32 v124, v40, v41
    v_cvt_pk_bf16_f32 v125, v42, v43
    v_cvt_pk_bf16_f32 v126, v44, v45
    v_cvt_pk_bf16_f32 v127, v46, v47
    s_add_u32 s35, s34, 147456
    buffer_store_dwordx4 v[120:123], v252, s[60:63], s35 offen offset:0 sc0 sc1
    buffer_store_dwordx4 v[124:127], v252, s[60:63], s35 offen offset:1024 sc0 sc1
    s_barrier
    s_branch gated_mix__mha_block__mixer_gmlp__prompt_kernel_att
gated_mix__mha_block__mixer_gmlp__prompt_kernel_v:
    s_nop 1
    s_setprio 0
    s_lshl_b32 s26, s5, 7
    s_lshl_b32 s27, s6, 5
    s_add_u32 s26, s26, s27
    v_lshrrev_b32 v4, 3, v0
    v_and_b32 v5, 7, v0
    v_add_u32 v6, s26, v4
    v_lshrrev_b32 v7, 1, v4
    v_mul_u32_u24 v6, 1152, v6
    v_xor_b32 v7, v7, v5
    s_lshl_b32 s55, s6, 12
    s_mov_b32 s56, 0
    v_lshl_add_u32 v150, v7, 4, v6
    v_xor_b32 v7, 4, v7
    v_lshl_add_u32 v151, v7, 4, v6
    v_add_u32 v152, 16384, v150
    v_add_u32 v153, 24576, v151
    v_add_u32 v151, 8192, v151
    s_add_u32 s16, s8, 0
    s_addc_u32 s17, s9, 0
    s_mov_b32 s18, 2359296
    s_mov_b32 s19, 0x00020000
    s_add_u32 s40, s12, 0
    s_addc_u32 s41, s13, 0
    s_mov_b32 s42, 5308416
    s_mov_b32 s43, 0x00020000
    s_add_u32 s44, s10, 0
    s_addc_u32 s45, s11, 0
    s_mov_b32 s46, 1990656
    s_mov_b32 s47, 0x00020000
    s_lshl_b32 s25, s2, 2
    s_add_u32 s25, s25, s6
    s_lshl_b32 s25, s25, 10
    s_add_u32 s26, s25, 2097152
    s_add_u32 s27, s25, 4194304
    v_lshlrev_b32 v3, 4, v0
    buffer_load_dwordx4 v[252:255], v3, s[16:19], s25 offen
    buffer_load_dwordx4 v[252:255], v3, s[40:43], s25 offen
    buffer_load_dwordx4 v[252:255], v3, s[44:47], s25 offen
    buffer_load_dwordx4 v[252:255], v3, s[40:43], s26 offen
    buffer_load_dwordx4 v[252:255], v3, s[16:19], s26 offen
    buffer_load_dwordx4 v[252:255], v3, s[40:43], s27 offen
    s_add_u32 s20, s10, 0
    s_addc_u32 s21, s11, 0
    s_mov_b32 s22, 1990656
    s_mov_b32 s23, 0x00020000
    s_mul_i32 s26, s7, 288
    s_add_u32 s26, s26, 2304
    s_movk_i32 s28, 3456
    s_mul_i32 s54, s6, 2304
    s_mov_b32 s57, 0
    s_mov_b32 s52, 0xffff
    s_mov_b32 s53, 0
    s_lshl_b32 s27, s6, 3
    v_add_u32 v6, 0, v0
    v_mul_u32_u24 v7, 1821, v6
    v_lshrrev_b32 v7, 16, v7
    v_mul_u32_u24 v11, 36, v7
    v_sub_u32 v6, v6, v11
    v_cmp_lt_u32 vcc, 17, v6
    s_nop 1
    v_cndmask_b32_e64 v11, 0, 1, vcc
    v_mul_u32_u24 v12, 18, v11
    v_sub_u32 v6, v6, v12
    v_add_u32 v7, s27, v7
    v_lshl_add_u32 v7, v11, 2, v7
    v_mul_lo_u32 v7, v7, s28
    v_lshl_add_u32 v7, v6, 4, v7
    v_add_u32 v7, s26, v7
    v_subrev_u32 v154, 0, v7
    v_add_u32 v6, 64, v0
    v_mul_u32_u24 v7, 1821, v6
    v_lshrrev_b32 v7, 16, v7
    v_mul_u32_u24 v11, 36, v7
    v_sub_u32 v6, v6, v11
    v_cmp_lt_u32 vcc, 17, v6
    s_nop 1
    v_cndmask_b32_e64 v11, 0, 1, vcc
    v_mul_u32_u24 v12, 18, v11
    v_sub_u32 v6, v6, v12
    v_add_u32 v7, s27, v7
    v_lshl_add_u32 v7, v11, 2, v7
    v_mul_lo_u32 v7, v7, s28
    v_lshl_add_u32 v7, v6, 4, v7
    v_add_u32 v7, s26, v7
    v_subrev_u32 v155, 1024, v7
    v_add_u32 v6, 128, v0
    v_mul_u32_u24 v7, 1821, v6
    v_lshrrev_b32 v7, 16, v7
    v_mul_u32_u24 v11, 36, v7
    v_sub_u32 v6, v6, v11
    v_cmp_lt_u32 vcc, 17, v6
    s_nop 1
    v_cndmask_b32_e64 v11, 0, 1, vcc
    v_mul_u32_u24 v12, 18, v11
    v_sub_u32 v6, v6, v12
    v_add_u32 v7, s27, v7
    v_lshl_add_u32 v7, v11, 2, v7
    v_mul_lo_u32 v7, v7, s28
    v_lshl_add_u32 v7, v6, 4, v7
    v_add_u32 v7, s26, v7
    v_subrev_u32 v156, 2048, v7
    s_add_u32 s48, s68, 0
    s_addc_u32 s49, s69, 0
    s_mov_b32 s50, 256
    s_mov_b32 s51, 0x00020000
    v_mov_b32 v22, 0
    buffer_load_dwordx2 v[20:21], v22, s[48:51], 0 offen sc0 sc1
    s_waitcnt vmcnt(0)
    v_readfirstlane_b32 s76, v20
    v_readfirstlane_b32 s77, v21
    s_mov_b32 s38, 0x40000
gated_mix__mha_block__mixer_gmlp__prompt_kernel_v_n:
    s_nop 1
    s_cmp_eq_u32 s76, 0
    s_cbranch_scc1 gated_mix__mha_block__mixer_gmlp__prompt_kernel_v_n_r
    s_sub_u32 s39, s76, s78
    s_add_u32 s39, s39, 2000
    s_cmp_ge_i32 s39, 0
    s_cbranch_scc1 gated_mix__mha_block__mixer_gmlp__prompt_kernel_v_n_ok
    s_cmp_lt_u32 s38, 262080
    s_cbranch_scc1 gated_mix__mha_block__mixer_gmlp__prompt_kernel_v_n_ok
gated_mix__mha_block__mixer_gmlp__prompt_kernel_v_n_r:
    buffer_load_dwordx2 v[20:21], v22, s[48:51], 0 offen sc0 sc1
    s_waitcnt vmcnt(0)
    v_readfirstlane_b32 s76, v20
    v_readfirstlane_b32 s77, v21
    s_sub_u32 s38, s38, 1
    s_cmp_lg_u32 s38, 0
    s_nop 3
    s_cbranch_scc1 gated_mix__mha_block__mixer_gmlp__prompt_kernel_v_n
gated_mix__mha_block__mixer_gmlp__prompt_kernel_v_n_ok:
    s_nop 1
    s_lshl_b32 s39, s2, 7
    v_mov_b32 v23, s39
    s_cmp_lg_u32 s6, 0
    s_cbranch_scc1 gated_mix__mha_block__mixer_gmlp__prompt_kernel_v_go_ok
    s_mov_b32 s38, 0x40000
gated_mix__mha_block__mixer_gmlp__prompt_kernel_v_go:
    buffer_load_dwordx2 v[24:25], v23, s[72:75], 0 offen sc0 sc1
    s_waitcnt vmcnt(0)
    v_cmp_ne_u64 vcc, s[76:77], v[24:25]
    s_sub_u32 s38, s38, 1
    s_nop 2
    s_cbranch_vccz gated_mix__mha_block__mixer_gmlp__prompt_kernel_v_go_ok
    s_cmp_eq_u32 s38, 0
    s_cbranch_scc1 gated_mix__mha_block__mixer_gmlp__prompt_kernel_v_go_ok
    s_sleep 4
    s_branch gated_mix__mha_block__mixer_gmlp__prompt_kernel_v_go
gated_mix__mha_block__mixer_gmlp__prompt_kernel_v_go_ok:
    s_barrier
    s_add_u32 m0, s55, 0
    s_nop 0
    buffer_load_dwordx4 v150, s[16:19], s56 offen offset:0 lds
    buffer_load_dwordx4 v151, s[16:19], s56 offen offset:1024 lds
    buffer_load_dwordx4 v152, s[16:19], s56 offen offset:2048 lds
    buffer_load_dwordx4 v153, s[16:19], s56 offen offset:3072 lds
    s_add_u32 s56, s56, 128
    s_add_u32 s48, s66, 0
    s_addc_u32 s49, s67, 0
    s_mov_b32 s50, 1152
    s_mov_b32 s51, 0x00020000
    v_lshlrev_b32 v2, 4, v0
    s_mov_b32 m0, 79872
    s_nop 0
    buffer_load_dwordx4 v2, s[48:51], 0 offen lds
    buffer_load_dwordx4 v2, s[48:51], 0 offen offset:1024 lds
    s_add_u32 m0, s54, 32768
    s_nop 0
    buffer_load_dwordx4 v154, s[20:23], s57 offen offset:0 lds
    buffer_load_dwordx4 v155, s[20:23], s57 offen offset:1024 lds
    s_mov_b64 exec, s[52:53]
    buffer_load_dwordx4 v156, s[20:23], s57 offen offset:2048 lds
    s_mov_b64 exec, -1
    s_add_u32 s57, s57, 110592
    s_add_u32 m0, s54, 41984
    s_nop 0
    buffer_load_dwordx4 v154, s[20:23], s57 offen offset:0 lds
    buffer_load_dwordx4 v155, s[20:23], s57 offen offset:1024 lds
    s_mov_b64 exec, s[52:53]
    buffer_load_dwordx4 v156, s[20:23], s57 offen offset:2048 lds
    s_mov_b64 exec, -1
    s_add_u32 s57, s57, 110592
    s_add_u32 m0, s55, 16384
    s_nop 0
    buffer_load_dwordx4 v150, s[16:19], s56 offen offset:0 lds
    buffer_load_dwordx4 v151, s[16:19], s56 offen offset:1024 lds
    buffer_load_dwordx4 v152, s[16:19], s56 offen offset:2048 lds
    buffer_load_dwordx4 v153, s[16:19], s56 offen offset:3072 lds
    s_add_u32 s56, s56, 128
    s_add_u32 m0, s54, 51200
    s_nop 0
    buffer_load_dwordx4 v154, s[20:23], s57 offen offset:0 lds
    buffer_load_dwordx4 v155, s[20:23], s57 offen offset:1024 lds
    s_mov_b64 exec, s[52:53]
    buffer_load_dwordx4 v156, s[20:23], s57 offen offset:2048 lds
    s_mov_b64 exec, -1
    s_add_u32 s57, s57, 110592
    s_add_u32 m0, s54, 60416
    s_nop 0
    buffer_load_dwordx4 v154, s[20:23], s57 offen offset:0 lds
    buffer_load_dwordx4 v155, s[20:23], s57 offen offset:1024 lds
    s_mov_b64 exec, s[52:53]
    buffer_load_dwordx4 v156, s[20:23], s57 offen offset:2048 lds
    s_mov_b64 exec, -1
    s_add_u32 s57, s57, 110592
    v_and_b32 v8, 31, v0
    v_and_b32 v9, 0x33, v8
    v_and_b32 v10, 4, v8
    v_lshl_or_b32 v9, v10, 1, v9
    v_and_b32 v10, 8, v8
    v_lshrrev_b32 v10, 1, v10
    v_or_b32 v9, v9, v10
    v_lshrrev_b32 v10, 5, v0
    v_bfe_u32 v11, v9, 1, 3
    v_xor_b32 v11, v11, v10
    v_lshlrev_b32 v11, 4, v11
    v_lshl_add_u32 v11, v9, 7, v11
    v_add_u32 v144, s55, v11
    v_xor_b32 v145, 32, v144
    v_xor_b32 v146, 64, v144
    v_xor_b32 v147, 96, v144
    v_mov_b32 v15, v10
    v_bfe_u32 v12, v0, 2, 2
    v_lshl_add_u32 v13, v10, 2, v12
    v_mul_u32_u24 v13, 576, v13
    v_and_b32 v14, 16, v0
    v_lshl_add_u32 v13, v14, 1, v13
    v_and_b32 v14, 3, v0
    v_lshl_add_u32 v13, v14, 3, v13
    v_add_u32 v148, 32768, v13
    v_lshlrev_b32 v149, 4, v10
    v_add_u32 v149, 79872, v149
    s_waitcnt lgkmcnt(0)
    s_mov_b32 s60, 0xffff0000
    s_mov_b32 s61, 0xffff0000
    s_setprio 1
    s_add_u32 s44, s14, 3145728
    s_addc_u32 s45, s15, 0
    s_mov_b32 s46, 5242880
    s_mov_b32 s47, 0x00020000
    s_add_u32 s40, s14, 2359296
    s_addc_u32 s41, s15, 0
    s_mov_b32 s42, 32768
    s_mov_b32 s43, 0x00020000
    s_lshl_b32 s32, s5, 2
    s_add_u32 s32, s32, s6
    s_lshl_b32 s33, s7, 9
    s_add_u32 s33, s33, s32
    s_mul_i32 s35, s33, 2560
    s_add_u32 s35, s35, 1024
    s_mul_i32 s36, s6, 10368
    v_mul_u32_u24 v5, 320, v15
    v_add_u32 v5, s36, v5
    v_add_u32 v1, 0, v8
    v_mul_u32_u24 v2, 3641, v1
    v_lshrrev_b32 v2, 16, v2
    v_mul_u32_u24 v3, 18, v2
    v_sub_u32 v3, v1, v3
    v_mul_u32_u24 v2, 1280, v2
    v_lshl_add_u32 v2, v3, 4, v2
    v_add_u32 v200, v2, v5
    v_add_u32 v1, 32, v8
    v_mul_u32_u24 v2, 3641, v1
    v_lshrrev_b32 v2, 16, v2
    v_mul_u32_u24 v3, 18, v2
    v_sub_u32 v3, v1, v3
    v_mul_u32_u24 v2, 1280, v2
    v_lshl_add_u32 v2, v3, 4, v2
    v_add_u32 v201, v2, v5
    v_add_u32 v1, 64, v8
    v_mul_u32_u24 v2, 3641, v1
    v_lshrrev_b32 v2, 16, v2
    v_mul_u32_u24 v3, 18, v2
    v_sub_u32 v3, v1, v3
    v_mul_u32_u24 v2, 1280, v2
    v_lshl_add_u32 v2, v3, 4, v2
    v_add_u32 v202, v2, v5
    v_add_u32 v1, 96, v8
    v_mul_u32_u24 v2, 3641, v1
    v_lshrrev_b32 v2, 16, v2
    v_mul_u32_u24 v3, 18, v2
    v_sub_u32 v3, v1, v3
    v_mul_u32_u24 v2, 1280, v2
    v_lshl_add_u32 v2, v3, 4, v2
    v_add_u32 v203, v2, v5
    v_add_u32 v1, 128, v8
    v_mul_u32_u24 v2, 3641, v1
    v_lshrrev_b32 v2, 16, v2
    v_mul_u32_u24 v3, 18, v2
    v_sub_u32 v3, v1, v3
    v_cmp_lt_u32 s[62:63], 15, v8
    v_and_b32 v4, 7, v8
    s_nop 0
    v_cndmask_b32 v2, v2, v4, s[62:63]
    v_lshrrev_b32 v4, 3, v8
    v_add_u32 v4, 16, v4
    v_cndmask_b32 v3, v3, v4, s[62:63]
    v_cmp_lt_u32 vcc, 23, v8
    v_mov_b32 v4, 0x3f803f80
    s_nop 0
    v_cndmask_b32_e64 v205, v4, 0, vcc
    v_mul_u32_u24 v2, 1280, v2
    v_lshl_add_u32 v2, v3, 4, v2
    v_add_u32 v204, v2, v5
    v_lshl_add_u32 v206, v15, 5, s36
    v_lshl_add_u32 v207, v0, 4, s36
    v_lshl_add_u32 v208, v8, 2, s36
    v_lshlrev_b32 v2, 2, v8
    v_lshl_add_u32 v209, v15, 30, v2
    s_mov_b32 s38, 162560
    s_lshl_b32 s37, s7, 13
    s_lshl_b32 s39, s32, 7
    s_add_u32 s37, s37, s39
    v_add_u32 v4, 0, v0
    v_mul_u32_u24 v5, 820, v4
    v_lshrrev_b32 v5, 16, v5
    v_mul_lo_u32 v5, v5, s38
    v_lshl_add_u32 v210, v4, 4, v5
    v_add_u32 v4, 64, v0
    v_mul_u32_u24 v5, 820, v4
    v_lshrrev_b32 v5, 16, v5
    v_mul_lo_u32 v5, v5, s38
    v_lshl_add_u32 v211, v4, 4, v5
    v_add_u32 v4, 128, v0
    v_mul_u32_u24 v5, 820, v4
    v_lshrrev_b32 v5, 16, v5
    v_mul_lo_u32 v5, v5, s38
    v_lshl_add_u32 v212, v4, 4, v5
    v_add_u32 v4, 192, v0
    v_mul_u32_u24 v5, 820, v4
    v_lshrrev_b32 v5, 16, v5
    v_mul_lo_u32 v5, v5, s38
    v_lshl_add_u32 v213, v4, 4, v5
    v_add_u32 v4, 256, v0
    v_mul_u32_u24 v5, 820, v4
    v_lshrrev_b32 v5, 16, v5
    v_mul_lo_u32 v5, v5, s38
    v_lshl_add_u32 v214, v4, 4, v5
    v_add_u32 v4, 320, v0
    v_mul_u32_u24 v5, 820, v4
    v_lshrrev_b32 v5, 16, v5
    v_mul_lo_u32 v5, v5, s38
    v_lshl_add_u32 v215, v4, 4, v5
    v_add_u32 v4, 384, v0
    v_mul_u32_u24 v5, 820, v4
    v_lshrrev_b32 v5, 16, v5
    v_mul_lo_u32 v5, v5, s38
    v_lshl_add_u32 v216, v4, 4, v5
    v_add_u32 v4, 448, v0
    v_mul_u32_u24 v5, 820, v4
    v_lshrrev_b32 v5, 16, v5
    v_mul_lo_u32 v5, v5, s38
    v_lshl_add_u32 v217, v4, 4, v5
    v_add_u32 v4, 512, v0
    v_mul_u32_u24 v5, 820, v4
    v_lshrrev_b32 v5, 16, v5
    v_mul_lo_u32 v5, v5, s38
    v_lshl_add_u32 v218, v4, 4, v5
    v_add_u32 v4, 576, v0
    v_mul_u32_u24 v5, 820, v4
    v_lshrrev_b32 v5, 16, v5
    v_mul_lo_u32 v5, v5, s38
    v_lshl_add_u32 v219, v4, 4, v5
    s_waitcnt vmcnt(13)
    s_waitcnt lgkmcnt(0)
    s_barrier
    ds_read_b128 v[160:163], v144 offset:0
    ds_read_b128 v[164:167], v145 offset:0
    ds_read_b64_tr_b16 v[104:105], v148 offset:0
    ds_read_b64_tr_b16 v[106:107], v148 offset:288
    ds_read_b64_tr_b16 v[108:109], v148 offset:64
    ds_read_b64_tr_b16 v[110:111], v148 offset:352
    ds_read_b64_tr_b16 v[112:113], v148 offset:128
    ds_read_b64_tr_b16 v[114:115], v148 offset:416
    ds_read_b64_tr_b16 v[116:117], v148 offset:192
    ds_read_b64_tr_b16 v[118:119], v148 offset:480
    ds_read_b64_tr_b16 v[120:121], v148 offset:256
    ds_read_b64_tr_b16 v[122:123], v148 offset:544
    s_mov_b64 exec, s[60:61]
    ds_read_b128 v[120:123], v149 offset:0
    s_mov_b64 exec, -1
    s_waitcnt lgkmcnt(9)
    v_mfma_f32_32x32x16_bf16 v[16:31], v[160:163], v[104:107], 0
    ds_read_b128 v[168:171], v146 offset:0
    ds_read_b128 v[172:175], v147 offset:0
    ds_read_b64_tr_b16 v[124:125], v148 offset:4608
    ds_read_b64_tr_b16 v[126:127], v148 offset:4896
    ds_read_b64_tr_b16 v[128:129], v148 offset:4672
    s_waitcnt lgkmcnt(12)
    v_mfma_f32_32x32x16_bf16 v[32:47], v[160:163], v[108:111], 0
    ds_read_b64_tr_b16 v[130:131], v148 offset:4960
    ds_read_b64_tr_b16 v[132:133], v148 offset:4736
    ds_read_b64_tr_b16 v[134:135], v148 offset:5024
    s_waitcnt lgkmcnt(14)
    ds_read_b64_tr_b16 v[136:137], v148 offset:4800
    s_waitcnt lgkmcnt(14)
    v_mfma_f32_32x32x16_bf16 v[48:63], v[160:163], v[112:115], 0
    ds_read_b64_tr_b16 v[138:139], v148 offset:5088
    s_waitcnt lgkmcnt(14)
    ds_read_b64_tr_b16 v[140:141], v148 offset:4864
    s_waitcnt lgkmcnt(14)
    ds_read_b64_tr_b16 v[142:143], v148 offset:5152
    s_mov_b64 exec, s[60:61]
    s_waitcnt lgkmcnt(14)
    ds_read_b128 v[140:143], v149 offset:32
    s_mov_b64 exec, -1
    v_mfma_f32_32x32x16_bf16 v[64:79], v[160:163], v[116:119], 0
    s_waitcnt lgkmcnt(13)
    v_mfma_f32_32x32x16_bf16 v[80:95], v[160:163], v[120:123], 0
    s_waitcnt vmcnt(10)
    s_waitcnt lgkmcnt(0)
    s_barrier
    v_mfma_f32_32x32x16_bf16 v[16:31], v[164:167], v[124:127], v[16:31]
    ds_read_b64_tr_b16 v[104:105], v148 offset:9216
    ds_read_b64_tr_b16 v[106:107], v148 offset:9504
    ds_read_b64_tr_b16 v[108:109], v148 offset:9280
    ds_read_b64_tr_b16 v[110:111], v148 offset:9568
    v_mfma_f32_32x32x16_bf16 v[32:47], v[164:167], v[128:131], v[32:47]
    ds_read_b64_tr_b16 v[112:113], v148 offset:9344
    ds_read_b64_tr_b16 v[114:115], v148 offset:9632
    ds_read_b64_tr_b16 v[116:117], v148 offset:9408
    ds_read_b64_tr_b16 v[118:119], v148 offset:9696
    v_mfma_f32_32x32x16_bf16 v[48:63], v[164:167], v[132:135], v[48:63]
    ds_read_b64_tr_b16 v[120:121], v148 offset:9472
    ds_read_b64_tr_b16 v[122:123], v148 offset:9760
    s_mov_b64 exec, s[60:61]
    ds_read_b128 v[120:123], v149 offset:64
    s_mov_b64 exec, -1
    v_mfma_f32_32x32x16_bf16 v[64:79], v[164:167], v[136:139], v[64:79]
    s_add_u32 m0, s54, 32768
    s_nop 0
    buffer_load_dwordx4 v154, s[20:23], s57 offen offset:0 lds
    buffer_load_dwordx4 v155, s[20:23], s57 offen offset:1024 lds
    v_mfma_f32_32x32x16_bf16 v[80:95], v[164:167], v[140:143], v[80:95]
    s_mov_b64 exec, s[52:53]
    buffer_load_dwordx4 v156, s[20:23], s57 offen offset:2048 lds
    s_mov_b64 exec, -1
    s_add_u32 s57, s57, 110592
    s_waitcnt lgkmcnt(9)
    v_mfma_f32_32x32x16_bf16 v[16:31], v[168:171], v[104:107], v[16:31]
    ds_read_b64_tr_b16 v[124:125], v148 offset:13824
    ds_read_b64_tr_b16 v[126:127], v148 offset:14112
    ds_read_b64_tr_b16 v[128:129], v148 offset:13888
    ds_read_b64_tr_b16 v[130:131], v148 offset:14176
    s_waitcnt lgkmcnt(11)
    v_mfma_f32_32x32x16_bf16 v[32:47], v[168:171], v[108:111], v[32:47]
    ds_read_b64_tr_b16 v[132:133], v148 offset:13952
    ds_read_b64_tr_b16 v[134:135], v148 offset:14240
    ds_read_b64_tr_b16 v[136:137], v148 offset:14016
    ds_read_b64_tr_b16 v[138:139], v148 offset:14304
    s_waitcnt lgkmcnt(13)
    v_mfma_f32_32x32x16_bf16 v[48:63], v[168:171], v[112:115], v[48:63]
    ds_read_b64_tr_b16 v[140:141], v148 offset:14080
    ds_read_b64_tr_b16 v[142:143], v148 offset:14368
    s_mov_b64 exec, s[60:61]
    s_waitcnt lgkmcnt(14)
    ds_read_b128 v[140:143], v149 offset:96
    s_mov_b64 exec, -1
    s_waitcnt lgkmcnt(14)
    v_mfma_f32_32x32x16_bf16 v[64:79], v[168:171], v[116:119], v[64:79]
    s_add_u32 m0, s55, 0
    s_nop 0
    buffer_load_dwordx4 v150, s[16:19], s56 offen offset:0 lds
    buffer_load_dwordx4 v151, s[16:19], s56 offen offset:1024 lds
    s_waitcnt lgkmcnt(11)
    v_mfma_f32_32x32x16_bf16 v[80:95], v[168:171], v[120:123], v[80:95]
    buffer_load_dwordx4 v152, s[16:19], s56 offen offset:2048 lds
    buffer_load_dwordx4 v153, s[16:19], s56 offen offset:3072 lds
    s_add_u32 s56, s56, 128
    s_waitcnt vmcnt(10)
    s_waitcnt lgkmcnt(0)
    s_barrier
    v_mfma_f32_32x32x16_bf16 v[16:31], v[172:175], v[124:127], v[16:31]
    ds_read_b128 v[176:179], v144 offset:16384
    ds_read_b128 v[180:183], v145 offset:16384
    ds_read_b64_tr_b16 v[104:105], v148 offset:18432
    ds_read_b64_tr_b16 v[106:107], v148 offset:18720
    ds_read_b64_tr_b16 v[108:109], v148 offset:18496
    v_mfma_f32_32x32x16_bf16 v[32:47], v[172:175], v[128:131], v[32:47]
    ds_read_b64_tr_b16 v[110:111], v148 offset:18784
    ds_read_b64_tr_b16 v[112:113], v148 offset:18560
    ds_read_b64_tr_b16 v[114:115], v148 offset:18848
    ds_read_b64_tr_b16 v[116:117], v148 offset:18624
    v_mfma_f32_32x32x16_bf16 v[48:63], v[172:175], v[132:135], v[48:63]
    ds_read_b64_tr_b16 v[118:119], v148 offset:18912
    ds_read_b64_tr_b16 v[120:121], v148 offset:18688
    ds_read_b64_tr_b16 v[122:123], v148 offset:18976
    s_mov_b64 exec, s[60:61]
    ds_read_b128 v[120:123], v149 offset:128
    s_mov_b64 exec, -1
    v_mfma_f32_32x32x16_bf16 v[64:79], v[172:175], v[136:139], v[64:79]
    s_add_u32 m0, s54, 41984
    s_nop 0
    buffer_load_dwordx4 v154, s[20:23], s57 offen offset:0 lds
    buffer_load_dwordx4 v155, s[20:23], s57 offen offset:1024 lds
    v_mfma_f32_32x32x16_bf16 v[80:95], v[172:175], v[140:143], v[80:95]
    s_mov_b64 exec, s[52:53]
    buffer_load_dwordx4 v156, s[20:23], s57 offen offset:2048 lds
    s_mov_b64 exec, -1
    s_add_u32 s57, s57, 110592
    s_waitcnt lgkmcnt(9)
    v_mfma_f32_32x32x16_bf16 v[16:31], v[176:179], v[104:107], v[16:31]
    ds_read_b128 v[184:187], v146 offset:16384
    ds_read_b128 v[188:191], v147 offset:16384
    ds_read_b64_tr_b16 v[124:125], v148 offset:23040
    ds_read_b64_tr_b16 v[126:127], v148 offset:23328
    ds_read_b64_tr_b16 v[128:129], v148 offset:23104
    s_waitcnt lgkmcnt(12)
    v_mfma_f32_32x32x16_bf16 v[32:47], v[176:179], v[108:111], v[32:47]
    ds_read_b64_tr_b16 v[130:131], v148 offset:23392
    ds_read_b64_tr_b16 v[132:133], v148 offset:23168
    ds_read_b64_tr_b16 v[134:135], v148 offset:23456
    s_waitcnt lgkmcnt(14)
    ds_read_b64_tr_b16 v[136:137], v148 offset:23232
    s_waitcnt lgkmcnt(14)
    v_mfma_f32_32x32x16_bf16 v[48:63], v[176:179], v[112:115], v[48:63]
    ds_read_b64_tr_b16 v[138:139], v148 offset:23520
    s_waitcnt lgkmcnt(14)
    ds_read_b64_tr_b16 v[140:141], v148 offset:23296
    s_waitcnt lgkmcnt(14)
    ds_read_b64_tr_b16 v[142:143], v148 offset:23584
    s_mov_b64 exec, s[60:61]
    s_waitcnt lgkmcnt(14)
    ds_read_b128 v[140:143], v149 offset:160
    s_mov_b64 exec, -1
    v_mfma_f32_32x32x16_bf16 v[64:79], v[176:179], v[116:119], v[64:79]
    s_waitcnt lgkmcnt(13)
    v_mfma_f32_32x32x16_bf16 v[80:95], v[176:179], v[120:123], v[80:95]
    s_waitcnt vmcnt(10)
    s_waitcnt lgkmcnt(0)
    s_barrier
    v_mfma_f32_32x32x16_bf16 v[16:31], v[180:183], v[124:127], v[16:31]
    ds_read_b64_tr_b16 v[104:105], v148 offset:27648
    ds_read_b64_tr_b16 v[106:107], v148 offset:27936
    ds_read_b64_tr_b16 v[108:109], v148 offset:27712
    ds_read_b64_tr_b16 v[110:111], v148 offset:28000
    v_mfma_f32_32x32x16_bf16 v[32:47], v[180:183], v[128:131], v[32:47]
    ds_read_b64_tr_b16 v[112:113], v148 offset:27776
    ds_read_b64_tr_b16 v[114:115], v148 offset:28064
    ds_read_b64_tr_b16 v[116:117], v148 offset:27840
    ds_read_b64_tr_b16 v[118:119], v148 offset:28128
    v_mfma_f32_32x32x16_bf16 v[48:63], v[180:183], v[132:135], v[48:63]
    ds_read_b64_tr_b16 v[120:121], v148 offset:27904
    ds_read_b64_tr_b16 v[122:123], v148 offset:28192
    s_mov_b64 exec, s[60:61]
    ds_read_b128 v[120:123], v149 offset:192
    s_mov_b64 exec, -1
    v_mfma_f32_32x32x16_bf16 v[64:79], v[180:183], v[136:139], v[64:79]
    s_add_u32 m0, s54, 51200
    s_nop 0
    buffer_load_dwordx4 v154, s[20:23], s57 offen offset:0 lds
    buffer_load_dwordx4 v155, s[20:23], s57 offen offset:1024 lds
    v_mfma_f32_32x32x16_bf16 v[80:95], v[180:183], v[140:143], v[80:95]
    s_mov_b64 exec, s[52:53]
    buffer_load_dwordx4 v156, s[20:23], s57 offen offset:2048 lds
    s_mov_b64 exec, -1
    s_add_u32 s57, s57, 110592
    s_waitcnt lgkmcnt(9)
    v_mfma_f32_32x32x16_bf16 v[16:31], v[184:187], v[104:107], v[16:31]
    ds_read_b64_tr_b16 v[124:125], v148 offset:32256
    ds_read_b64_tr_b16 v[126:127], v148 offset:32544
    ds_read_b64_tr_b16 v[128:129], v148 offset:32320
    ds_read_b64_tr_b16 v[130:131], v148 offset:32608
    s_waitcnt lgkmcnt(11)
    v_mfma_f32_32x32x16_bf16 v[32:47], v[184:187], v[108:111], v[32:47]
    ds_read_b64_tr_b16 v[132:133], v148 offset:32384
    ds_read_b64_tr_b16 v[134:135], v148 offset:32672
    ds_read_b64_tr_b16 v[136:137], v148 offset:32448
    ds_read_b64_tr_b16 v[138:139], v148 offset:32736
    s_waitcnt lgkmcnt(13)
    v_mfma_f32_32x32x16_bf16 v[48:63], v[184:187], v[112:115], v[48:63]
    ds_read_b64_tr_b16 v[140:141], v148 offset:32512
    ds_read_b64_tr_b16 v[142:143], v148 offset:32800
    s_mov_b64 exec, s[60:61]
    s_waitcnt lgkmcnt(14)
    ds_read_b128 v[140:143], v149 offset:224
    s_mov_b64 exec, -1
    v_add_u32 v149, 256, v149
    s_waitcnt lgkmcnt(14)
    v_mfma_f32_32x32x16_bf16 v[64:79], v[184:187], v[116:119], v[64:79]
    s_add_u32 m0, s55, 16384
    s_nop 0
    buffer_load_dwordx4 v150, s[16:19], s56 offen offset:0 lds
    buffer_load_dwordx4 v151, s[16:19], s56 offen offset:1024 lds
    s_waitcnt lgkmcnt(11)
    v_mfma_f32_32x32x16_bf16 v[80:95], v[184:187], v[120:123], v[80:95]
    buffer_load_dwordx4 v152, s[16:19], s56 offen offset:2048 lds
    buffer_load_dwordx4 v153, s[16:19], s56 offen offset:3072 lds
    s_add_u32 s56, s56, 128
    s_waitcnt vmcnt(14)
    s_waitcnt vmcnt(10)
    s_waitcnt lgkmcnt(0)
    s_barrier
    v_mfma_f32_32x32x16_bf16 v[16:31], v[188:191], v[124:127], v[16:31]
    ds_read_b128 v[160:163], v144 offset:0
    ds_read_b128 v[164:167], v145 offset:0
    ds_read_b64_tr_b16 v[104:105], v148 offset:0
    ds_read_b64_tr_b16 v[106:107], v148 offset:288
    ds_read_b64_tr_b16 v[108:109], v148 offset:64
    v_mfma_f32_32x32x16_bf16 v[32:47], v[188:191], v[128:131], v[32:47]
    ds_read_b64_tr_b16 v[110:111], v148 offset:352
    ds_read_b64_tr_b16 v[112:113], v148 offset:128
    ds_read_b64_tr_b16 v[114:115], v148 offset:416
    ds_read_b64_tr_b16 v[116:117], v148 offset:192
    v_mfma_f32_32x32x16_bf16 v[48:63], v[188:191], v[132:135], v[48:63]
    ds_read_b64_tr_b16 v[118:119], v148 offset:480
    ds_read_b64_tr_b16 v[120:121], v148 offset:256
    ds_read_b64_tr_b16 v[122:123], v148 offset:544
    s_mov_b64 exec, s[60:61]
    ds_read_b128 v[120:123], v149 offset:0
    s_mov_b64 exec, -1
    v_mfma_f32_32x32x16_bf16 v[64:79], v[188:191], v[136:139], v[64:79]
    s_add_u32 m0, s54, 60416
    s_nop 0
    buffer_load_dwordx4 v154, s[20:23], s57 offen offset:0 lds
    buffer_load_dwordx4 v155, s[20:23], s57 offen offset:1024 lds
    v_mfma_f32_32x32x16_bf16 v[80:95], v[188:191], v[140:143], v[80:95]
    s_mov_b64 exec, s[52:53]
    buffer_load_dwordx4 v156, s[20:23], s57 offen offset:2048 lds
    s_mov_b64 exec, -1
    s_add_u32 s57, s57, 110592
    s_waitcnt lgkmcnt(9)
    v_mfma_f32_32x32x16_bf16 v[16:31], v[160:163], v[104:107], v[16:31]
    ds_read_b128 v[168:171], v146 offset:0
    ds_read_b128 v[172:175], v147 offset:0
    ds_read_b64_tr_b16 v[124:125], v148 offset:4608
    ds_read_b64_tr_b16 v[126:127], v148 offset:4896
    ds_read_b64_tr_b16 v[128:129], v148 offset:4672
    s_waitcnt lgkmcnt(12)
    v_mfma_f32_32x32x16_bf16 v[32:47], v[160:163], v[108:111], v[32:47]
    ds_read_b64_tr_b16 v[130:131], v148 offset:4960
    ds_read_b64_tr_b16 v[132:133], v148 offset:4736
    ds_read_b64_tr_b16 v[134:135], v148 offset:5024
    s_waitcnt lgkmcnt(14)
    ds_read_b64_tr_b16 v[136:137], v148 offset:4800
    s_waitcnt lgkmcnt(14)
    v_mfma_f32_32x32x16_bf16 v[48:63], v[160:163], v[112:115], v[48:63]
    ds_read_b64_tr_b16 v[138:139], v148 offset:5088
    s_waitcnt lgkmcnt(14)
    ds_read_b64_tr_b16 v[140:141], v148 offset:4864
    s_waitcnt lgkmcnt(14)
    ds_read_b64_tr_b16 v[142:143], v148 offset:5152
    s_mov_b64 exec, s[60:61]
    s_waitcnt lgkmcnt(14)
    ds_read_b128 v[140:143], v149 offset:32
    s_mov_b64 exec, -1
    v_mfma_f32_32x32x16_bf16 v[64:79], v[160:163], v[116:119], v[64:79]
    s_waitcnt lgkmcnt(13)
    v_mfma_f32_32x32x16_bf16 v[80:95], v[160:163], v[120:123], v[80:95]
    s_mov_b32 s65, 2
.p2align 6
gated_mix__mha_block__mixer_gmlp__prompt_kernel_v_l:
    s_waitcnt vmcnt(10)
    s_waitcnt lgkmcnt(0)
    s_barrier
    v_mfma_f32_32x32x16_bf16 v[16:31], v[164:167], v[124:127], v[16:31]
    ds_read_b64_tr_b16 v[104:105], v148 offset:9216
    ds_read_b64_tr_b16 v[106:107], v148 offset:9504
    ds_read_b64_tr_b16 v[108:109], v148 offset:9280
    ds_read_b64_tr_b16 v[110:111], v148 offset:9568
    v_mfma_f32_32x32x16_bf16 v[32:47], v[164:167], v[128:131], v[32:47]
    ds_read_b64_tr_b16 v[112:113], v148 offset:9344
    ds_read_b64_tr_b16 v[114:115], v148 offset:9632
    ds_read_b64_tr_b16 v[116:117], v148 offset:9408
    ds_read_b64_tr_b16 v[118:119], v148 offset:9696
    v_mfma_f32_32x32x16_bf16 v[48:63], v[164:167], v[132:135], v[48:63]
    ds_read_b64_tr_b16 v[120:121], v148 offset:9472
    ds_read_b64_tr_b16 v[122:123], v148 offset:9760
    s_mov_b64 exec, s[60:61]
    ds_read_b128 v[120:123], v149 offset:64
    s_mov_b64 exec, -1
    v_mfma_f32_32x32x16_bf16 v[64:79], v[164:167], v[136:139], v[64:79]
    s_add_u32 m0, s54, 32768
    s_nop 0
    buffer_load_dwordx4 v154, s[20:23], s57 offen offset:0 lds
    buffer_load_dwordx4 v155, s[20:23], s57 offen offset:1024 lds
    v_mfma_f32_32x32x16_bf16 v[80:95], v[164:167], v[140:143], v[80:95]
    s_mov_b64 exec, s[52:53]
    buffer_load_dwordx4 v156, s[20:23], s57 offen offset:2048 lds
    s_mov_b64 exec, -1
    s_add_u32 s57, s57, 110592
    s_waitcnt lgkmcnt(9)
    v_mfma_f32_32x32x16_bf16 v[16:31], v[168:171], v[104:107], v[16:31]
    ds_read_b64_tr_b16 v[124:125], v148 offset:13824
    ds_read_b64_tr_b16 v[126:127], v148 offset:14112
    ds_read_b64_tr_b16 v[128:129], v148 offset:13888
    ds_read_b64_tr_b16 v[130:131], v148 offset:14176
    s_waitcnt lgkmcnt(11)
    v_mfma_f32_32x32x16_bf16 v[32:47], v[168:171], v[108:111], v[32:47]
    ds_read_b64_tr_b16 v[132:133], v148 offset:13952
    ds_read_b64_tr_b16 v[134:135], v148 offset:14240
    ds_read_b64_tr_b16 v[136:137], v148 offset:14016
    ds_read_b64_tr_b16 v[138:139], v148 offset:14304
    s_waitcnt lgkmcnt(13)
    v_mfma_f32_32x32x16_bf16 v[48:63], v[168:171], v[112:115], v[48:63]
    ds_read_b64_tr_b16 v[140:141], v148 offset:14080
    ds_read_b64_tr_b16 v[142:143], v148 offset:14368
    s_mov_b64 exec, s[60:61]
    s_waitcnt lgkmcnt(14)
    ds_read_b128 v[140:143], v149 offset:96
    s_mov_b64 exec, -1
    s_waitcnt lgkmcnt(14)
    v_mfma_f32_32x32x16_bf16 v[64:79], v[168:171], v[116:119], v[64:79]
    s_add_u32 m0, s55, 0
    s_nop 0
    buffer_load_dwordx4 v150, s[16:19], s56 offen offset:0 lds
    buffer_load_dwordx4 v151, s[16:19], s56 offen offset:1024 lds
    s_waitcnt lgkmcnt(11)
    v_mfma_f32_32x32x16_bf16 v[80:95], v[168:171], v[120:123], v[80:95]
    buffer_load_dwordx4 v152, s[16:19], s56 offen offset:2048 lds
    buffer_load_dwordx4 v153, s[16:19], s56 offen offset:3072 lds
    s_add_u32 s56, s56, 128
    s_waitcnt vmcnt(14)
    s_waitcnt vmcnt(10)
    s_waitcnt lgkmcnt(0)
    s_barrier
    v_mfma_f32_32x32x16_bf16 v[16:31], v[172:175], v[124:127], v[16:31]
    ds_read_b128 v[176:179], v144 offset:16384
    ds_read_b128 v[180:183], v145 offset:16384
    ds_read_b64_tr_b16 v[104:105], v148 offset:18432
    ds_read_b64_tr_b16 v[106:107], v148 offset:18720
    ds_read_b64_tr_b16 v[108:109], v148 offset:18496
    v_mfma_f32_32x32x16_bf16 v[32:47], v[172:175], v[128:131], v[32:47]
    ds_read_b64_tr_b16 v[110:111], v148 offset:18784
    ds_read_b64_tr_b16 v[112:113], v148 offset:18560
    ds_read_b64_tr_b16 v[114:115], v148 offset:18848
    ds_read_b64_tr_b16 v[116:117], v148 offset:18624
    v_mfma_f32_32x32x16_bf16 v[48:63], v[172:175], v[132:135], v[48:63]
    ds_read_b64_tr_b16 v[118:119], v148 offset:18912
    ds_read_b64_tr_b16 v[120:121], v148 offset:18688
    ds_read_b64_tr_b16 v[122:123], v148 offset:18976
    s_mov_b64 exec, s[60:61]
    ds_read_b128 v[120:123], v149 offset:128
    s_mov_b64 exec, -1
    v_mfma_f32_32x32x16_bf16 v[64:79], v[172:175], v[136:139], v[64:79]
    s_add_u32 m0, s54, 41984
    s_nop 0
    buffer_load_dwordx4 v154, s[20:23], s57 offen offset:0 lds
    buffer_load_dwordx4 v155, s[20:23], s57 offen offset:1024 lds
    v_mfma_f32_32x32x16_bf16 v[80:95], v[172:175], v[140:143], v[80:95]
    s_mov_b64 exec, s[52:53]
    buffer_load_dwordx4 v156, s[20:23], s57 offen offset:2048 lds
    s_mov_b64 exec, -1
    s_add_u32 s57, s57, 110592
    s_waitcnt lgkmcnt(9)
    v_mfma_f32_32x32x16_bf16 v[16:31], v[176:179], v[104:107], v[16:31]
    ds_read_b128 v[184:187], v146 offset:16384
    ds_read_b128 v[188:191], v147 offset:16384
    ds_read_b64_tr_b16 v[124:125], v148 offset:23040
    ds_read_b64_tr_b16 v[126:127], v148 offset:23328
    ds_read_b64_tr_b16 v[128:129], v148 offset:23104
    s_waitcnt lgkmcnt(12)
    v_mfma_f32_32x32x16_bf16 v[32:47], v[176:179], v[108:111], v[32:47]
    ds_read_b64_tr_b16 v[130:131], v148 offset:23392
    ds_read_b64_tr_b16 v[132:133], v148 offset:23168
    ds_read_b64_tr_b16 v[134:135], v148 offset:23456
    s_waitcnt lgkmcnt(14)
    ds_read_b64_tr_b16 v[136:137], v148 offset:23232
    s_waitcnt lgkmcnt(14)
    v_mfma_f32_32x32x16_bf16 v[48:63], v[176:179], v[112:115], v[48:63]
    ds_read_b64_tr_b16 v[138:139], v148 offset:23520
    s_waitcnt lgkmcnt(14)
    ds_read_b64_tr_b16 v[140:141], v148 offset:23296
    s_waitcnt lgkmcnt(14)
    ds_read_b64_tr_b16 v[142:143], v148 offset:23584
    s_mov_b64 exec, s[60:61]
    s_waitcnt lgkmcnt(14)
    ds_read_b128 v[140:143], v149 offset:160
    s_mov_b64 exec, -1
    v_mfma_f32_32x32x16_bf16 v[64:79], v[176:179], v[116:119], v[64:79]
    s_waitcnt lgkmcnt(13)
    v_mfma_f32_32x32x16_bf16 v[80:95], v[176:179], v[120:123], v[80:95]
    s_waitcnt vmcnt(10)
    s_waitcnt lgkmcnt(0)
    s_barrier
    v_mfma_f32_32x32x16_bf16 v[16:31], v[180:183], v[124:127], v[16:31]
    ds_read_b64_tr_b16 v[104:105], v148 offset:27648
    ds_read_b64_tr_b16 v[106:107], v148 offset:27936
    ds_read_b64_tr_b16 v[108:109], v148 offset:27712
    ds_read_b64_tr_b16 v[110:111], v148 offset:28000
    v_mfma_f32_32x32x16_bf16 v[32:47], v[180:183], v[128:131], v[32:47]
    ds_read_b64_tr_b16 v[112:113], v148 offset:27776
    ds_read_b64_tr_b16 v[114:115], v148 offset:28064
    ds_read_b64_tr_b16 v[116:117], v148 offset:27840
    ds_read_b64_tr_b16 v[118:119], v148 offset:28128
    v_mfma_f32_32x32x16_bf16 v[48:63], v[180:183], v[132:135], v[48:63]
    ds_read_b64_tr_b16 v[120:121], v148 offset:27904
    ds_read_b64_tr_b16 v[122:123], v148 offset:28192
    s_mov_b64 exec, s[60:61]
    ds_read_b128 v[120:123], v149 offset:192
    s_mov_b64 exec, -1
    v_mfma_f32_32x32x16_bf16 v[64:79], v[180:183], v[136:139], v[64:79]
    s_add_u32 m0, s54, 51200
    s_nop 0
    buffer_load_dwordx4 v154, s[20:23], s57 offen offset:0 lds
    buffer_load_dwordx4 v155, s[20:23], s57 offen offset:1024 lds
    v_mfma_f32_32x32x16_bf16 v[80:95], v[180:183], v[140:143], v[80:95]
    s_mov_b64 exec, s[52:53]
    buffer_load_dwordx4 v156, s[20:23], s57 offen offset:2048 lds
    s_mov_b64 exec, -1
    s_add_u32 s57, s57, 110592
    s_waitcnt lgkmcnt(9)
    v_mfma_f32_32x32x16_bf16 v[16:31], v[184:187], v[104:107], v[16:31]
    ds_read_b64_tr_b16 v[124:125], v148 offset:32256
    ds_read_b64_tr_b16 v[126:127], v148 offset:32544
    ds_read_b64_tr_b16 v[128:129], v148 offset:32320
    ds_read_b64_tr_b16 v[130:131], v148 offset:32608
    s_waitcnt lgkmcnt(11)
    v_mfma_f32_32x32x16_bf16 v[32:47], v[184:187], v[108:111], v[32:47]
    ds_read_b64_tr_b16 v[132:133], v148 offset:32384
    ds_read_b64_tr_b16 v[134:135], v148 offset:32672
    ds_read_b64_tr_b16 v[136:137], v148 offset:32448
    ds_read_b64_tr_b16 v[138:139], v148 offset:32736
    s_waitcnt lgkmcnt(13)
    v_mfma_f32_32x32x16_bf16 v[48:63], v[184:187], v[112:115], v[48:63]
    ds_read_b64_tr_b16 v[140:141], v148 offset:32512
    ds_read_b64_tr_b16 v[142:143], v148 offset:32800
    s_mov_b64 exec, s[60:61]
    s_waitcnt lgkmcnt(14)
    ds_read_b128 v[140:143], v149 offset:224
    s_mov_b64 exec, -1
    v_add_u32 v149, 256, v149
    s_waitcnt lgkmcnt(14)
    v_mfma_f32_32x32x16_bf16 v[64:79], v[184:187], v[116:119], v[64:79]
    s_add_u32 m0, s55, 16384
    s_nop 0
    buffer_load_dwordx4 v150, s[16:19], s56 offen offset:0 lds
    buffer_load_dwordx4 v151, s[16:19], s56 offen offset:1024 lds
    s_waitcnt lgkmcnt(11)
    v_mfma_f32_32x32x16_bf16 v[80:95], v[184:187], v[120:123], v[80:95]
    buffer_load_dwordx4 v152, s[16:19], s56 offen offset:2048 lds
    buffer_load_dwordx4 v153, s[16:19], s56 offen offset:3072 lds
    s_add_u32 s56, s56, 128
    s_waitcnt vmcnt(14)
    s_waitcnt vmcnt(10)
    s_waitcnt lgkmcnt(0)
    s_barrier
    v_mfma_f32_32x32x16_bf16 v[16:31], v[188:191], v[124:127], v[16:31]
    ds_read_b128 v[160:163], v144 offset:0
    ds_read_b128 v[164:167], v145 offset:0
    ds_read_b64_tr_b16 v[104:105], v148 offset:0
    ds_read_b64_tr_b16 v[106:107], v148 offset:288
    ds_read_b64_tr_b16 v[108:109], v148 offset:64
    v_mfma_f32_32x32x16_bf16 v[32:47], v[188:191], v[128:131], v[32:47]
    ds_read_b64_tr_b16 v[110:111], v148 offset:352
    ds_read_b64_tr_b16 v[112:113], v148 offset:128
    ds_read_b64_tr_b16 v[114:115], v148 offset:416
    ds_read_b64_tr_b16 v[116:117], v148 offset:192
    v_mfma_f32_32x32x16_bf16 v[48:63], v[188:191], v[132:135], v[48:63]
    ds_read_b64_tr_b16 v[118:119], v148 offset:480
    ds_read_b64_tr_b16 v[120:121], v148 offset:256
    ds_read_b64_tr_b16 v[122:123], v148 offset:544
    s_mov_b64 exec, s[60:61]
    ds_read_b128 v[120:123], v149 offset:0
    s_mov_b64 exec, -1
    v_mfma_f32_32x32x16_bf16 v[64:79], v[188:191], v[136:139], v[64:79]
    s_add_u32 m0, s54, 60416
    s_nop 0
    buffer_load_dwordx4 v154, s[20:23], s57 offen offset:0 lds
    buffer_load_dwordx4 v155, s[20:23], s57 offen offset:1024 lds
    v_mfma_f32_32x32x16_bf16 v[80:95], v[188:191], v[140:143], v[80:95]
    s_mov_b64 exec, s[52:53]
    buffer_load_dwordx4 v156, s[20:23], s57 offen offset:2048 lds
    s_mov_b64 exec, -1
    s_add_u32 s57, s57, 110592
    s_waitcnt lgkmcnt(9)
    v_mfma_f32_32x32x16_bf16 v[16:31], v[160:163], v[104:107], v[16:31]
    ds_read_b128 v[168:171], v146 offset:0
    ds_read_b128 v[172:175], v147 offset:0
    ds_read_b64_tr_b16 v[124:125], v148 offset:4608
    ds_read_b64_tr_b16 v[126:127], v148 offset:4896
    ds_read_b64_tr_b16 v[128:129], v148 offset:4672
    s_waitcnt lgkmcnt(12)
    v_mfma_f32_32x32x16_bf16 v[32:47], v[160:163], v[108:111], v[32:47]
    ds_read_b64_tr_b16 v[130:131], v148 offset:4960
    ds_read_b64_tr_b16 v[132:133], v148 offset:4736
    ds_read_b64_tr_b16 v[134:135], v148 offset:5024
    s_waitcnt lgkmcnt(14)
    ds_read_b64_tr_b16 v[136:137], v148 offset:4800
    s_waitcnt lgkmcnt(14)
    v_mfma_f32_32x32x16_bf16 v[48:63], v[160:163], v[112:115], v[48:63]
    ds_read_b64_tr_b16 v[138:139], v148 offset:5088
    s_waitcnt lgkmcnt(14)
    ds_read_b64_tr_b16 v[140:141], v148 offset:4864
    s_waitcnt lgkmcnt(14)
    ds_read_b64_tr_b16 v[142:143], v148 offset:5152
    s_mov_b64 exec, s[60:61]
    s_waitcnt lgkmcnt(14)
    ds_read_b128 v[140:143], v149 offset:32
    s_mov_b64 exec, -1
    v_mfma_f32_32x32x16_bf16 v[64:79], v[160:163], v[116:119], v[64:79]
    s_waitcnt lgkmcnt(13)
    v_mfma_f32_32x32x16_bf16 v[80:95], v[160:163], v[120:123], v[80:95]
    s_sub_u32 s65, s65, 1
    s_cmp_lg_u32 s65, 0
    s_cbranch_scc1 gated_mix__mha_block__mixer_gmlp__prompt_kernel_v_l
    s_waitcnt vmcnt(10)
    s_waitcnt lgkmcnt(0)
    s_barrier
    v_mfma_f32_32x32x16_bf16 v[16:31], v[164:167], v[124:127], v[16:31]
    ds_read_b64_tr_b16 v[104:105], v148 offset:9216
    ds_read_b64_tr_b16 v[106:107], v148 offset:9504
    ds_read_b64_tr_b16 v[108:109], v148 offset:9280
    ds_read_b64_tr_b16 v[110:111], v148 offset:9568
    v_mfma_f32_32x32x16_bf16 v[32:47], v[164:167], v[128:131], v[32:47]
    ds_read_b64_tr_b16 v[112:113], v148 offset:9344
    ds_read_b64_tr_b16 v[114:115], v148 offset:9632
    ds_read_b64_tr_b16 v[116:117], v148 offset:9408
    ds_read_b64_tr_b16 v[118:119], v148 offset:9696
    v_mfma_f32_32x32x16_bf16 v[48:63], v[164:167], v[132:135], v[48:63]
    ds_read_b64_tr_b16 v[120:121], v148 offset:9472
    ds_read_b64_tr_b16 v[122:123], v148 offset:9760
    s_mov_b64 exec, s[60:61]
    ds_read_b128 v[120:123], v149 offset:64
    s_mov_b64 exec, -1
    v_mfma_f32_32x32x16_bf16 v[64:79], v[164:167], v[136:139], v[64:79]
    s_add_u32 m0, s54, 32768
    s_nop 0
    buffer_load_dwordx4 v154, s[20:23], s57 offen offset:0 lds
    buffer_load_dwordx4 v155, s[20:23], s57 offen offset:1024 lds
    v_mfma_f32_32x32x16_bf16 v[80:95], v[164:167], v[140:143], v[80:95]
    s_mov_b64 exec, s[52:53]
    buffer_load_dwordx4 v156, s[20:23], s57 offen offset:2048 lds
    s_mov_b64 exec, -1
    s_add_u32 s57, s57, 110592
    s_waitcnt lgkmcnt(9)
    v_mfma_f32_32x32x16_bf16 v[16:31], v[168:171], v[104:107], v[16:31]
    ds_read_b64_tr_b16 v[124:125], v148 offset:13824
    ds_read_b64_tr_b16 v[126:127], v148 offset:14112
    ds_read_b64_tr_b16 v[128:129], v148 offset:13888
    ds_read_b64_tr_b16 v[130:131], v148 offset:14176
    s_waitcnt lgkmcnt(11)
    v_mfma_f32_32x32x16_bf16 v[32:47], v[168:171], v[108:111], v[32:47]
    ds_read_b64_tr_b16 v[132:133], v148 offset:13952
    ds_read_b64_tr_b16 v[134:135], v148 offset:14240
    ds_read_b64_tr_b16 v[136:137], v148 offset:14016
    ds_read_b64_tr_b16 v[138:139], v148 offset:14304
    s_waitcnt lgkmcnt(13)
    v_mfma_f32_32x32x16_bf16 v[48:63], v[168:171], v[112:115], v[48:63]
    ds_read_b64_tr_b16 v[140:141], v148 offset:14080
    ds_read_b64_tr_b16 v[142:143], v148 offset:14368
    s_mov_b64 exec, s[60:61]
    s_waitcnt lgkmcnt(14)
    ds_read_b128 v[140:143], v149 offset:96
    s_mov_b64 exec, -1
    s_waitcnt lgkmcnt(14)
    v_mfma_f32_32x32x16_bf16 v[64:79], v[168:171], v[116:119], v[64:79]
    s_add_u32 m0, s55, 0
    s_nop 0
    buffer_load_dwordx4 v150, s[16:19], s56 offen offset:0 lds
    buffer_load_dwordx4 v151, s[16:19], s56 offen offset:1024 lds
    s_waitcnt lgkmcnt(11)
    v_mfma_f32_32x32x16_bf16 v[80:95], v[168:171], v[120:123], v[80:95]
    buffer_load_dwordx4 v152, s[16:19], s56 offen offset:2048 lds
    buffer_load_dwordx4 v153, s[16:19], s56 offen offset:3072 lds
    s_add_u32 s56, s56, 128
    s_waitcnt vmcnt(14)
    s_waitcnt vmcnt(10)
    s_waitcnt lgkmcnt(0)
    s_barrier
    v_mfma_f32_32x32x16_bf16 v[16:31], v[172:175], v[124:127], v[16:31]
    ds_read_b128 v[176:179], v144 offset:16384
    ds_read_b128 v[180:183], v145 offset:16384
    ds_read_b64_tr_b16 v[104:105], v148 offset:18432
    ds_read_b64_tr_b16 v[106:107], v148 offset:18720
    ds_read_b64_tr_b16 v[108:109], v148 offset:18496
    v_mfma_f32_32x32x16_bf16 v[32:47], v[172:175], v[128:131], v[32:47]
    ds_read_b64_tr_b16 v[110:111], v148 offset:18784
    ds_read_b64_tr_b16 v[112:113], v148 offset:18560
    ds_read_b64_tr_b16 v[114:115], v148 offset:18848
    ds_read_b64_tr_b16 v[116:117], v148 offset:18624
    v_mfma_f32_32x32x16_bf16 v[48:63], v[172:175], v[132:135], v[48:63]
    ds_read_b64_tr_b16 v[118:119], v148 offset:18912
    ds_read_b64_tr_b16 v[120:121], v148 offset:18688
    ds_read_b64_tr_b16 v[122:123], v148 offset:18976
    s_mov_b64 exec, s[60:61]
    ds_read_b128 v[120:123], v149 offset:128
    s_mov_b64 exec, -1
    v_mfma_f32_32x32x16_bf16 v[64:79], v[172:175], v[136:139], v[64:79]
    s_add_u32 m0, s54, 41984
    s_nop 0
    buffer_load_dwordx4 v154, s[20:23], s57 offen offset:0 lds
    buffer_load_dwordx4 v155, s[20:23], s57 offen offset:1024 lds
    v_mfma_f32_32x32x16_bf16 v[80:95], v[172:175], v[140:143], v[80:95]
    s_mov_b64 exec, s[52:53]
    buffer_load_dwordx4 v156, s[20:23], s57 offen offset:2048 lds
    s_mov_b64 exec, -1
    s_add_u32 s57, s57, 110592
    s_waitcnt lgkmcnt(9)
    v_mfma_f32_32x32x16_bf16 v[16:31], v[176:179], v[104:107], v[16:31]
    ds_read_b128 v[184:187], v146 offset:16384
    ds_read_b128 v[188:191], v147 offset:16384
    ds_read_b64_tr_b16 v[124:125], v148 offset:23040
    ds_read_b64_tr_b16 v[126:127], v148 offset:23328
    ds_read_b64_tr_b16 v[128:129], v148 offset:23104
    s_waitcnt lgkmcnt(12)
    v_mfma_f32_32x32x16_bf16 v[32:47], v[176:179], v[108:111], v[32:47]
    ds_read_b64_tr_b16 v[130:131], v148 offset:23392
    ds_read_b64_tr_b16 v[132:133], v148 offset:23168
    ds_read_b64_tr_b16 v[134:135], v148 offset:23456
    s_waitcnt lgkmcnt(14)
    ds_read_b64_tr_b16 v[136:137], v148 offset:23232
    s_waitcnt lgkmcnt(14)
    v_mfma_f32_32x32x16_bf16 v[48:63], v[176:179], v[112:115], v[48:63]
    ds_read_b64_tr_b16 v[138:139], v148 offset:23520
    s_waitcnt lgkmcnt(14)
    ds_read_b64_tr_b16 v[140:141], v148 offset:23296
    s_waitcnt lgkmcnt(14)
    ds_read_b64_tr_b16 v[142:143], v148 offset:23584
    s_mov_b64 exec, s[60:61]
    s_waitcnt lgkmcnt(14)
    ds_read_b128 v[140:143], v149 offset:160
    s_mov_b64 exec, -1
    v_mfma_f32_32x32x16_bf16 v[64:79], v[176:179], v[116:119], v[64:79]
    s_waitcnt lgkmcnt(13)
    v_mfma_f32_32x32x16_bf16 v[80:95], v[176:179], v[120:123], v[80:95]
    s_waitcnt vmcnt(10)
    s_waitcnt lgkmcnt(0)
    s_barrier
    v_mfma_f32_32x32x16_bf16 v[16:31], v[180:183], v[124:127], v[16:31]
    ds_read_b64_tr_b16 v[104:105], v148 offset:27648
    ds_read_b64_tr_b16 v[106:107], v148 offset:27936
    ds_read_b64_tr_b16 v[108:109], v148 offset:27712
    ds_read_b64_tr_b16 v[110:111], v148 offset:28000
    v_mfma_f32_32x32x16_bf16 v[32:47], v[180:183], v[128:131], v[32:47]
    ds_read_b64_tr_b16 v[112:113], v148 offset:27776
    ds_read_b64_tr_b16 v[114:115], v148 offset:28064
    ds_read_b64_tr_b16 v[116:117], v148 offset:27840
    ds_read_b64_tr_b16 v[118:119], v148 offset:28128
    v_mfma_f32_32x32x16_bf16 v[48:63], v[180:183], v[132:135], v[48:63]
    ds_read_b64_tr_b16 v[120:121], v148 offset:27904
    ds_read_b64_tr_b16 v[122:123], v148 offset:28192
    s_mov_b64 exec, s[60:61]
    ds_read_b128 v[120:123], v149 offset:192
    s_mov_b64 exec, -1
    v_mfma_f32_32x32x16_bf16 v[64:79], v[180:183], v[136:139], v[64:79]
    v_mfma_f32_32x32x16_bf16 v[80:95], v[180:183], v[140:143], v[80:95]
    s_waitcnt lgkmcnt(9)
    v_mfma_f32_32x32x16_bf16 v[16:31], v[184:187], v[104:107], v[16:31]
    ds_read_b64_tr_b16 v[124:125], v148 offset:32256
    ds_read_b64_tr_b16 v[126:127], v148 offset:32544
    ds_read_b64_tr_b16 v[128:129], v148 offset:32320
    ds_read_b64_tr_b16 v[130:131], v148 offset:32608
    s_waitcnt lgkmcnt(11)
    v_mfma_f32_32x32x16_bf16 v[32:47], v[184:187], v[108:111], v[32:47]
    ds_read_b64_tr_b16 v[132:133], v148 offset:32384
    ds_read_b64_tr_b16 v[134:135], v148 offset:32672
    ds_read_b64_tr_b16 v[136:137], v148 offset:32448
    ds_read_b64_tr_b16 v[138:139], v148 offset:32736
    s_waitcnt lgkmcnt(13)
    v_mfma_f32_32x32x16_bf16 v[48:63], v[184:187], v[112:115], v[48:63]
    ds_read_b64_tr_b16 v[140:141], v148 offset:32512
    ds_read_b64_tr_b16 v[142:143], v148 offset:32800
    s_mov_b64 exec, s[60:61]
    s_waitcnt lgkmcnt(14)
    ds_read_b128 v[140:143], v149 offset:224
    s_mov_b64 exec, -1
    v_add_u32 v149, 256, v149
    s_waitcnt lgkmcnt(14)
    v_mfma_f32_32x32x16_bf16 v[64:79], v[184:187], v[116:119], v[64:79]
    s_waitcnt lgkmcnt(11)
    v_mfma_f32_32x32x16_bf16 v[80:95], v[184:187], v[120:123], v[80:95]
    s_waitcnt vmcnt(7)
    s_waitcnt vmcnt(3)
    s_waitcnt lgkmcnt(0)
    s_barrier
    v_mfma_f32_32x32x16_bf16 v[16:31], v[188:191], v[124:127], v[16:31]
    ds_read_b128 v[160:163], v144 offset:0
    ds_read_b128 v[164:167], v145 offset:0
    ds_read_b64_tr_b16 v[104:105], v148 offset:0
    ds_read_b64_tr_b16 v[106:107], v148 offset:288
    ds_read_b64_tr_b16 v[108:109], v148 offset:64
    v_mfma_f32_32x32x16_bf16 v[32:47], v[188:191], v[128:131], v[32:47]
    ds_read_b64_tr_b16 v[110:111], v148 offset:352
    ds_read_b64_tr_b16 v[112:113], v148 offset:128
    ds_read_b64_tr_b16 v[114:115], v148 offset:416
    ds_read_b64_tr_b16 v[116:117], v148 offset:192
    v_mfma_f32_32x32x16_bf16 v[48:63], v[188:191], v[132:135], v[48:63]
    ds_read_b64_tr_b16 v[118:119], v148 offset:480
    ds_read_b64_tr_b16 v[120:121], v148 offset:256
    ds_read_b64_tr_b16 v[122:123], v148 offset:544
    s_mov_b64 exec, s[60:61]
    ds_read_b128 v[120:123], v149 offset:0
    s_mov_b64 exec, -1
    v_mfma_f32_32x32x16_bf16 v[64:79], v[188:191], v[136:139], v[64:79]
    v_mfma_f32_32x32x16_bf16 v[80:95], v[188:191], v[140:143], v[80:95]
    s_waitcnt lgkmcnt(9)
    v_mfma_f32_32x32x16_bf16 v[16:31], v[160:163], v[104:107], v[16:31]
    ds_read_b128 v[168:171], v146 offset:0
    ds_read_b128 v[172:175], v147 offset:0
    ds_read_b64_tr_b16 v[124:125], v148 offset:4608
    ds_read_b64_tr_b16 v[126:127], v148 offset:4896
    ds_read_b64_tr_b16 v[128:129], v148 offset:4672
    s_waitcnt lgkmcnt(12)
    v_mfma_f32_32x32x16_bf16 v[32:47], v[160:163], v[108:111], v[32:47]
    ds_read_b64_tr_b16 v[130:131], v148 offset:4960
    ds_read_b64_tr_b16 v[132:133], v148 offset:4736
    ds_read_b64_tr_b16 v[134:135], v148 offset:5024
    s_waitcnt lgkmcnt(14)
    ds_read_b64_tr_b16 v[136:137], v148 offset:4800
    s_waitcnt lgkmcnt(14)
    v_mfma_f32_32x32x16_bf16 v[48:63], v[160:163], v[112:115], v[48:63]
    ds_read_b64_tr_b16 v[138:139], v148 offset:5088
    s_waitcnt lgkmcnt(14)
    ds_read_b64_tr_b16 v[140:141], v148 offset:4864
    s_waitcnt lgkmcnt(14)
    ds_read_b64_tr_b16 v[142:143], v148 offset:5152
    s_mov_b64 exec, s[60:61]
    s_waitcnt lgkmcnt(14)
    ds_read_b128 v[140:143], v149 offset:32
    s_mov_b64 exec, -1
    v_mfma_f32_32x32x16_bf16 v[64:79], v[160:163], v[116:119], v[64:79]
    s_waitcnt lgkmcnt(13)
    v_mfma_f32_32x32x16_bf16 v[80:95], v[160:163], v[120:123], v[80:95]
    s_waitcnt vmcnt(0)
    s_waitcnt lgkmcnt(0)
    s_barrier
    v_mfma_f32_32x32x16_bf16 v[16:31], v[164:167], v[124:127], v[16:31]
    ds_read_b64_tr_b16 v[104:105], v148 offset:9216
    ds_read_b64_tr_b16 v[106:107], v148 offset:9504
    ds_read_b64_tr_b16 v[108:109], v148 offset:9280
    ds_read_b64_tr_b16 v[110:111], v148 offset:9568
    v_mfma_f32_32x32x16_bf16 v[32:47], v[164:167], v[128:131], v[32:47]
    ds_read_b64_tr_b16 v[112:113], v148 offset:9344
    ds_read_b64_tr_b16 v[114:115], v148 offset:9632
    ds_read_b64_tr_b16 v[116:117], v148 offset:9408
    ds_read_b64_tr_b16 v[118:119], v148 offset:9696
    v_mfma_f32_32x32x16_bf16 v[48:63], v[164:167], v[132:135], v[48:63]
    ds_read_b64_tr_b16 v[120:121], v148 offset:9472
    ds_read_b64_tr_b16 v[122:123], v148 offset:9760
    s_mov_b64 exec, s[60:61]
    ds_read_b128 v[120:123], v149 offset:64
    s_mov_b64 exec, -1
    v_mfma_f32_32x32x16_bf16 v[64:79], v[164:167], v[136:139], v[64:79]
    v_mfma_f32_32x32x16_bf16 v[80:95], v[164:167], v[140:143], v[80:95]
    s_waitcnt lgkmcnt(9)
    v_mfma_f32_32x32x16_bf16 v[16:31], v[168:171], v[104:107], v[16:31]
    ds_read_b64_tr_b16 v[124:125], v148 offset:13824
    ds_read_b64_tr_b16 v[126:127], v148 offset:14112
    ds_read_b64_tr_b16 v[128:129], v148 offset:13888
    ds_read_b64_tr_b16 v[130:131], v148 offset:14176
    s_waitcnt lgkmcnt(11)
    v_mfma_f32_32x32x16_bf16 v[32:47], v[168:171], v[108:111], v[32:47]
    ds_read_b64_tr_b16 v[132:133], v148 offset:13952
    ds_read_b64_tr_b16 v[134:135], v148 offset:14240
    ds_read_b64_tr_b16 v[136:137], v148 offset:14016
    ds_read_b64_tr_b16 v[138:139], v148 offset:14304
    s_waitcnt lgkmcnt(13)
    v_mfma_f32_32x32x16_bf16 v[48:63], v[168:171], v[112:115], v[48:63]
    ds_read_b64_tr_b16 v[140:141], v148 offset:14080
    ds_read_b64_tr_b16 v[142:143], v148 offset:14368
    s_mov_b64 exec, s[60:61]
    s_waitcnt lgkmcnt(14)
    ds_read_b128 v[140:143], v149 offset:96
    s_mov_b64 exec, -1
    s_waitcnt lgkmcnt(14)
    v_mfma_f32_32x32x16_bf16 v[64:79], v[168:171], v[116:119], v[64:79]
    s_waitcnt lgkmcnt(11)
    v_mfma_f32_32x32x16_bf16 v[80:95], v[168:171], v[120:123], v[80:95]
    s_waitcnt lgkmcnt(9)
    v_mfma_f32_32x32x16_bf16 v[16:31], v[172:175], v[124:127], v[16:31]
    s_waitcnt lgkmcnt(7)
    v_mfma_f32_32x32x16_bf16 v[32:47], v[172:175], v[128:131], v[32:47]
    s_waitcnt lgkmcnt(5)
    v_mfma_f32_32x32x16_bf16 v[48:63], v[172:175], v[132:135], v[48:63]
    s_waitcnt lgkmcnt(3)
    v_mfma_f32_32x32x16_bf16 v[64:79], v[172:175], v[136:139], v[64:79]
    s_waitcnt lgkmcnt(0)
    v_mfma_f32_32x32x16_bf16 v[80:95], v[172:175], v[140:143], v[80:95]
    v_mov_b32 v252, 0
    s_mov_b32 s70, 0x7ff00000
    s_lshl_b32 s71, s5, 4
    s_add_u32 s71, s71, s7
    s_add_u32 s71, s71, 524
    s_setprio 1
    v_cvt_pk_bf16_f32 v104, v16, v17
    v_cvt_pk_bf16_f32 v105, v18, v19
    v_cvt_pk_bf16_f32 v106, v20, v21
    v_cvt_pk_bf16_f32 v107, v22, v23
    v_cvt_pk_bf16_f32 v108, v24, v25
    v_cvt_pk_bf16_f32 v109, v26, v27
    v_cvt_pk_bf16_f32 v110, v28, v29
    v_cvt_pk_bf16_f32 v111, v30, v31
    ds_write_b128 v200, v[104:107] offset:0
    ds_write_b128 v200, v[108:111] offset:640
    v_cvt_pk_bf16_f32 v112, v32, v33
    v_cvt_pk_bf16_f32 v113, v34, v35
    v_cvt_pk_bf16_f32 v114, v36, v37
    v_cvt_pk_bf16_f32 v115, v38, v39
    v_cvt_pk_bf16_f32 v116, v40, v41
    v_cvt_pk_bf16_f32 v117, v42, v43
    v_cvt_pk_bf16_f32 v118, v44, v45
    v_cvt_pk_bf16_f32 v119, v46, v47
    ds_write_b128 v201, v[112:115] offset:0
    ds_write_b128 v201, v[116:119] offset:640
    v_cvt_pk_bf16_f32 v120, v48, v49
    v_cvt_pk_bf16_f32 v121, v50, v51
    v_cvt_pk_bf16_f32 v122, v52, v53
    v_cvt_pk_bf16_f32 v123, v54, v55
    v_cvt_pk_bf16_f32 v124, v56, v57
    v_cvt_pk_bf16_f32 v125, v58, v59
    v_cvt_pk_bf16_f32 v126, v60, v61
    v_cvt_pk_bf16_f32 v127, v62, v63
    ds_write_b128 v202, v[120:123] offset:0
    ds_write_b128 v202, v[124:127] offset:640
    v_cvt_pk_bf16_f32 v128, v64, v65
    v_cvt_pk_bf16_f32 v129, v66, v67
    v_cvt_pk_bf16_f32 v130, v68, v69
    v_cvt_pk_bf16_f32 v131, v70, v71
    v_cvt_pk_bf16_f32 v132, v72, v73
    v_cvt_pk_bf16_f32 v133, v74, v75
    v_cvt_pk_bf16_f32 v134, v76, v77
    v_cvt_pk_bf16_f32 v135, v78, v79
    ds_write_b128 v203, v[128:131] offset:0
    ds_write_b128 v203, v[132:135] offset:640
    v_cvt_pk_bf16_f32 v104, v80, v81
    v_cvt_pk_bf16_f32 v105, v82, v83
    v_cvt_pk_bf16_f32 v106, v84, v85
    v_cvt_pk_bf16_f32 v107, v86, v87
    v_cvt_pk_bf16_f32 v108, v88, v89
    v_cvt_pk_bf16_f32 v109, v90, v91
    v_cvt_pk_bf16_f32 v110, v92, v93
    v_cvt_pk_bf16_f32 v111, v94, v95
    v_cndmask_b32 v104, v104, v205, s[62:63]
    v_cndmask_b32 v105, v105, v205, s[62:63]
    v_cndmask_b32 v106, v106, v205, s[62:63]
    v_cndmask_b32 v107, v107, v205, s[62:63]
    v_cndmask_b32 v108, v108, v205, s[62:63]
    v_cndmask_b32 v109, v109, v205, s[62:63]
    v_cndmask_b32 v110, v110, v205, s[62:63]
    v_cndmask_b32 v111, v111, v205, s[62:63]
    ds_write_b128 v204, v[104:107] offset:0
    ds_write_b128 v204, v[108:111] offset:640
    s_mov_b32 s60, 0x10000
    s_mov_b32 s61, 0x10000
    s_mov_b64 exec, s[60:61]
    ds_write_b128 v206, v[80:83] offset:10240
    ds_write_b128 v206, v[84:87] offset:10256
    ds_write_b128 v206, v[88:91] offset:10304
    ds_write_b128 v206, v[92:95] offset:10320
    s_mov_b64 exec, -1
    s_waitcnt lgkmcnt(0)
    ds_read_b32 v96, v208 offset:10240
    ds_read_b128 v[16:19], v207 offset:0
    ds_read_b128 v[20:23], v207 offset:1024
    ds_read_b128 v[24:27], v207 offset:2048
    ds_read_b128 v[28:31], v207 offset:3072
    ds_read_b128 v[32:35], v207 offset:4096
    ds_read_b128 v[36:39], v207 offset:5120
    ds_read_b128 v[40:43], v207 offset:6144
    ds_read_b128 v[44:47], v207 offset:7168
    ds_read_b128 v[48:51], v207 offset:8192
    ds_read_b128 v[52:55], v207 offset:9216
    s_waitcnt lgkmcnt(10)
    v_mul_f32 v96, 0xbfb8aa3b, v96
    v_exp_f32 v96, v96
    s_nop 0
    v_add_f32 v96, 1.0, v96
    v_rcp_f32 v96, v96
    s_waitcnt lgkmcnt(9)
    buffer_store_dwordx4 v[16:19], v210, s[44:47], s35 offen sc0 sc1
    s_waitcnt lgkmcnt(8)
    buffer_store_dwordx4 v[20:23], v211, s[44:47], s35 offen sc0 sc1
    s_waitcnt lgkmcnt(7)
    buffer_store_dwordx4 v[24:27], v212, s[44:47], s35 offen sc0 sc1
    s_waitcnt lgkmcnt(6)
    buffer_store_dwordx4 v[28:31], v213, s[44:47], s35 offen sc0 sc1
    s_waitcnt lgkmcnt(5)
    buffer_store_dwordx4 v[32:35], v214, s[44:47], s35 offen sc0 sc1
    s_waitcnt lgkmcnt(4)
    buffer_store_dwordx4 v[36:39], v215, s[44:47], s35 offen sc0 sc1
    s_waitcnt lgkmcnt(3)
    buffer_store_dwordx4 v[40:43], v216, s[44:47], s35 offen sc0 sc1
    s_waitcnt lgkmcnt(2)
    buffer_store_dwordx4 v[44:47], v217, s[44:47], s35 offen sc0 sc1
    s_waitcnt lgkmcnt(1)
    buffer_store_dwordx4 v[48:51], v218, s[44:47], s35 offen sc0 sc1
    s_waitcnt lgkmcnt(0)
    buffer_store_dwordx4 v[52:55], v219, s[44:47], s35 offen sc0 sc1
    buffer_store_dword v96, v209, s[40:43], s37 offen sc0 sc1
    s_lshl_b32 s36, s7, 4
    s_add_u32 s36, s36, s5
    s_add_u32 s36, s36, 832
    s_lshl_b32 s39, s36, 7
    s_lshl_b32 s38, s6, 6
    v_add_lshl_u32 v10, v0, s38, 20
    v_mov_b32 v12, s76
    v_mov_b32 v13, s77
    s_waitcnt vmcnt(0)
    s_barrier
    buffer_store_dwordx2 v[12:13], v10, s[72:75], s39 offen sc0 sc1
    s_setprio 0
    s_branch gated_mix__mha_block__mixer_gmlp__prompt_kernel_att
gated_mix__mha_block__mixer_gmlp__prompt_kernel_att:
    s_nop 1
    s_load_dwordx2 s[8:9], s[0:1], 40
    s_load_dwordx2 s[66:67], s[0:1], 16
    s_load_dwordx2 s[68:69], s[0:1], 56
    s_lshl_b32 s24, s3, 2
    s_lshr_b32 s25, s4, 3
    s_add_u32 s24, s24, s25
    s_and_b32 s25, s4, 7
    s_add_u32 s16, s14, 3145728
    s_addc_u32 s17, s15, 0
    s_mov_b32 s18, 5242880
    s_mov_b32 s19, 0x00020000
    s_add_u32 s20, s14, 0
    s_addc_u32 s21, s15, 0
    s_mov_b32 s22, 2424832
    s_mov_b32 s23, 0x00020000
    s_add_u32 s40, s14, 27262976
    s_addc_u32 s41, s15, 0
    s_mov_b32 s42, 11796480
    s_mov_b32 s43, 0x00020000
    s_add_u32 s60, s14, 8388608
    s_addc_u32 s61, s15, 0
    s_mov_b32 s62, 9437184
    s_mov_b32 s63, 0x00020000
    s_mul_i32 s26, s24, 163840
    s_mul_i32 s27, s6, 5120
    s_add_u32 s26, s26, s27
    v_lshlrev_b32 v4, 4, v0
    s_mov_b32 s28, s27
    s_lshr_b32 s29, s24, 3
    s_lshl_b32 s29, s29, 4
    s_add_u32 s29, s29, 768
    v_and_b32 v5, 15, v0
    v_and_b32 v6, 16, v0
    v_lshl_add_u32 v5, v6, 2, v5
    v_add_lshl_u32 v14, v5, s29, 7
    v_mov_b32 v33, 0
    v_mov_b32 v34, 0
    v_mov_b32 v35, 0
    v_mov_b32 v128, 0
    v_mov_b32 v129, 0
    v_mov_b32 v130, 0
    v_mov_b32 v131, 0
    v_mov_b32 v132, 0
    v_mov_b32 v133, 0
    v_mov_b32 v134, 0
    v_mov_b32 v135, 0
    v_mov_b32 v136, 0
    v_mov_b32 v137, 0
    v_mov_b32 v138, 0
    v_mov_b32 v139, 0
    v_mov_b32 v140, 0
    v_mov_b32 v141, 0
    v_mov_b32 v142, 0
    v_mov_b32 v143, 0
    v_mov_b32 v37, 0
    v_mov_b32 v38, 0
    v_mov_b32 v39, 0
    v_mov_b32 v144, 0
    v_mov_b32 v145, 0
    v_mov_b32 v146, 0
    v_mov_b32 v147, 0
    v_mov_b32 v148, 0
    v_mov_b32 v149, 0
    v_mov_b32 v150, 0
    v_mov_b32 v151, 0
    v_mov_b32 v152, 0
    v_mov_b32 v153, 0
    v_mov_b32 v154, 0
    v_mov_b32 v155, 0
    v_mov_b32 v156, 0
    v_mov_b32 v157, 0
    v_mov_b32 v158, 0
    v_mov_b32 v159, 0
    v_mov_b32 v41, 0
    v_mov_b32 v42, 0
    v_mov_b32 v43, 0
    v_mov_b32 v160, 0
    v_mov_b32 v161, 0
    v_mov_b32 v162, 0
    v_mov_b32 v163, 0
    v_mov_b32 v164, 0
    v_mov_b32 v165, 0
    v_mov_b32 v166, 0
    v_mov_b32 v167, 0
    v_mov_b32 v168, 0
    v_mov_b32 v169, 0
    v_mov_b32 v170, 0
    v_mov_b32 v171, 0
    v_mov_b32 v172, 0
    v_mov_b32 v173, 0
    v_mov_b32 v174, 0
    v_mov_b32 v175, 0
    v_mov_b32 v45, 0
    v_mov_b32 v46, 0
    v_mov_b32 v47, 0
    v_mov_b32 v176, 0
    v_mov_b32 v177, 0
    v_mov_b32 v178, 0
    v_mov_b32 v179, 0
    v_mov_b32 v180, 0
    v_mov_b32 v181, 0
    v_mov_b32 v182, 0
    v_mov_b32 v183, 0
    v_mov_b32 v184, 0
    v_mov_b32 v185, 0
    v_mov_b32 v186, 0
    v_mov_b32 v187, 0
    v_mov_b32 v188, 0
    v_mov_b32 v189, 0
    v_mov_b32 v190, 0
    v_mov_b32 v191, 0
    v_mov_b32 v57, 0x3f803f80
    v_mov_b32 v58, 0
    v_mov_b32 v59, 0
    v_mov_b32 v61, 0x3f803f80
    v_mov_b32 v62, 0
    v_mov_b32 v63, 0
    s_lshl_b32 s30, s25, 3
    s_lshl_b32 s31, s6, 1
    s_add_u32 s30, s30, s31
    s_xor_b32 s31, s30, 2
    s_lshl_b32 s32, s24, 6
    s_add_u32 s33, s32, s31
    s_add_u32 s32, s32, s30
    v_and_b32 v5, 31, v0
    v_lshlrev_b32 v6, 2, v5
    v_lshrrev_b32 v7, 5, v0
    v_lshl_add_u32 v8, v7, 30, v6
    s_and_b32 s35, s6, 1
    s_mul_i32 s35, s35, 2560
    v_add_u32 v1, s35, v4
    v_add_u32 v2, 2304, v6
    v_mov_b32 v10, 1328
    v_cmp_lt_u32 vcc, 31, v0
    s_nop 1
    v_cndmask_b32 v2, v2, v10, vcc
    v_cndmask_b32_e64 v57, v57, 0, vcc
    v_cndmask_b32_e64 v61, v61, 0, vcc
    v_add_u32 v2, s35, v2
    v_and_b32 v9, 0x33, v5
    v_and_b32 v10, 4, v5
    v_lshl_or_b32 v9, v10, 1, v9
    v_and_b32 v10, 8, v5
    v_lshrrev_b32 v10, 1, v10
    v_or_b32 v9, v9, v10
    v_cmp_lt_u32 vcc, 18, v5
    v_mov_b32 v11, 19
    s_nop 0
    v_cndmask_b32 v9, v9, v11, vcc
    v_mul_u32_u24 v10, 320, v7
    v_lshl_add_u32 v9, v9, 4, v10
    v_add_u32 v9, 1024, v9
    v_add_u32 v3, s35, v9
    s_mov_b32 s34, 0
    s_mov_b32 s36, 20480
    s_waitcnt lgkmcnt(0)
    s_add_u32 s48, s68, 0
    s_addc_u32 s49, s69, 0
    s_mov_b32 s50, 2654208
    s_mov_b32 s51, 0x00020000
    s_add_u32 s52, s66, 0
    s_addc_u32 s53, s67, 0
    s_mov_b32 s54, 663552
    s_mov_b32 s55, 0x00020000
    s_and_b32 s56, s2, 255
    s_lshl_b32 s56, s56, 2
    s_add_u32 s56, s56, s6
    s_mul_i32 s57, s56, 2592
    s_mul_i32 s58, s56, 648
    s_and_b32 s57, s57, 0xfffffff0
    s_and_b32 s58, s58, 0xfffffff0
    s_lshl_b32 s59, s56, 13
    s_add_u32 s64, s59, 4096
    s_add_u32 s44, s8, 0
    s_addc_u32 s45, s9, 0
    s_mov_b32 s46, 8388608
    s_mov_b32 s47, 0x00020000
    s_cmp_lg_u32 s6, 0
    s_cbranch_scc1 gated_mix__mha_block__mixer_gmlp__prompt_kernel_a_pk_ok
    s_mov_b32 s38, 0x40000
gated_mix__mha_block__mixer_gmlp__prompt_kernel_a_pk:
    buffer_load_dwordx2 v[12:13], v14, s[72:75], 0 offen sc0 sc1
    s_waitcnt vmcnt(0)
    v_cmp_ne_u64 vcc, s[76:77], v[12:13]
    s_sub_u32 s38, s38, 1
    s_nop 2
    s_cbranch_vccz gated_mix__mha_block__mixer_gmlp__prompt_kernel_a_pk_ok
    s_cmp_eq_u32 s38, 0
    s_cbranch_scc1 gated_mix__mha_block__mixer_gmlp__prompt_kernel_a_pk_ok
    s_sleep 2
    s_branch gated_mix__mha_block__mixer_gmlp__prompt_kernel_a_pk
gated_mix__mha_block__mixer_gmlp__prompt_kernel_a_pk_ok:
    s_barrier
    s_setprio 3
    s_mov_b32 m0, s28
    s_nop 0
    buffer_load_dwordx4 v4, s[16:19], s26 offen offset:0 sc0 sc1 lds
    buffer_load_dwordx4 v4, s[16:19], s26 offen offset:1024 sc0 sc1 lds
    buffer_load_dwordx4 v4, s[16:19], s26 offen offset:2048 sc0 sc1 lds
    buffer_load_dwordx4 v4, s[16:19], s26 offen offset:3072 sc0 sc1 lds
    s_add_u32 m0, s28, 4096
    s_add_u32 s29, s26, 4096
    buffer_load_dwordx4 v4, s[16:19], s29 offen sc0 sc1 lds
    s_add_u32 s26, s26, 20480
    s_add_u32 s28, s28, 20480
    s_sub_u32 s29, s28, 61440
    s_cmp_ge_u32 s28, 61440
    s_cselect_b32 s28, s29, s28
    s_lshl_b32 s37, s32, 10
    s_lshl_b32 s38, s32, 7
    s_add_u32 s38, s38, 2097152
    buffer_load_dwordx4 v[16:19], v4, s[20:23], s37 offen offset:0 sc0 sc1
    buffer_load_dword v32, v8, s[20:23], s38 offen offset:0 sc0 sc1
    buffer_load_dwordx4 v[20:23], v4, s[20:23], s37 offen offset:1024 sc0 sc1
    buffer_load_dword v36, v8, s[20:23], s38 offen offset:128 sc0 sc1
    s_lshl_b32 s37, s33, 10
    s_lshl_b32 s38, s33, 7
    s_add_u32 s38, s38, 2097152
    buffer_load_dwordx4 v[24:27], v4, s[20:23], s37 offen offset:0 sc0 sc1
    buffer_load_dword v40, v8, s[20:23], s38 offen offset:0 sc0 sc1
    buffer_load_dwordx4 v[28:31], v4, s[20:23], s37 offen offset:1024 sc0 sc1
    buffer_load_dword v44, v8, s[20:23], s38 offen offset:128 sc0 sc1
    s_lshr_b32 s37, s24, 3
    s_lshl_b32 s37, s37, 13
    s_lshl_b32 s38, s30, 7
    s_add_u32 s37, s37, s38
    s_add_u32 s37, s37, 2359296
    buffer_load_dword v14, v6, s[20:23], s37 offen offset:0 sc0 sc1
    buffer_load_dword v15, v6, s[20:23], s37 offen offset:128 sc0 sc1
    s_mov_b32 m0, s28
    s_nop 0
    buffer_load_dwordx4 v4, s[16:19], s26 offen offset:0 sc0 sc1 lds
    buffer_load_dwordx4 v4, s[16:19], s26 offen offset:1024 sc0 sc1 lds
    buffer_load_dwordx4 v4, s[16:19], s26 offen offset:2048 sc0 sc1 lds
    buffer_load_dwordx4 v4, s[16:19], s26 offen offset:3072 sc0 sc1 lds
    s_add_u32 m0, s28, 4096
    s_add_u32 s29, s26, 4096
    buffer_load_dwordx4 v4, s[16:19], s29 offen sc0 sc1 lds
    s_add_u32 s26, s26, 20480
    s_add_u32 s28, s28, 20480
    s_sub_u32 s29, s28, 61440
    s_cmp_ge_u32 s28, 61440
    s_cselect_b32 s28, s29, s28
    s_waitcnt vmcnt(15)
    s_barrier
    ds_read_b128 v[52:55], v4
    ds_read_b32 v60, v6 offset:2304
    ds_read_b128 v[48:51], v1 offset:0
    ds_read_b32 v56, v2 offset:0
    ds_read_b128 v[64:67], v3 offset:0
    ds_read_b128 v[68:71], v3 offset:640
    s_waitcnt vmcnt(14) lgkmcnt(5)
    v_mfma_f32_32x32x16_bf16 v[80:95], v[52:55], v[16:19], 0
    s_waitcnt vmcnt(13) lgkmcnt(4)
    v_mfma_f32_32x32x16_bf16 v[80:95], v[60:63], v[32:35], v[80:95]
    s_nop 11
    v_max3_f32 v10, v80, v81, v82
    v_max3_f32 v10, v83, v84, v10
    v_max3_f32 v10, v85, v86, v10
    v_max3_f32 v10, v87, v88, v10
    v_max3_f32 v10, v89, v90, v10
    v_max3_f32 v10, v91, v92, v10
    v_max3_f32 v10, v93, v94, v10
    v_max_f32 v10, v95, v10
    v_mov_b32 v11, v10
    s_nop 1
    v_permlane32_swap_b32 v10, v11
    v_max_f32 v10, v10, v11
    v_sub_f32 v10, 0, v10
    v_and_b32 v11, 0xffff0000, v10
    v_sub_f32 v12, v10, v11
    v_cvt_pk_bf16_f32 v12, v11, v12
    v_cmp_gt_u32 vcc, 32, v0
    v_mov_b32 v11, 0
    s_nop 0
    v_cndmask_b32 v33, v11, v12, vcc
    s_waitcnt vmcnt(12)
    v_mfma_f32_32x32x16_bf16 v[96:111], v[52:55], v[20:23], 0
    s_waitcnt vmcnt(11)
    v_mfma_f32_32x32x16_bf16 v[96:111], v[60:63], v[36:39], v[96:111]
    s_nop 11
    v_max3_f32 v10, v96, v97, v98
    v_max3_f32 v10, v99, v100, v10
    v_max3_f32 v10, v101, v102, v10
    v_max3_f32 v10, v103, v104, v10
    v_max3_f32 v10, v105, v106, v10
    v_max3_f32 v10, v107, v108, v10
    v_max3_f32 v10, v109, v110, v10
    v_max_f32 v10, v111, v10
    v_mov_b32 v11, v10
    s_nop 1
    v_permlane32_swap_b32 v10, v11
    v_max_f32 v10, v10, v11
    v_sub_f32 v10, 0, v10
    v_and_b32 v11, 0xffff0000, v10
    v_sub_f32 v12, v10, v11
    v_cvt_pk_bf16_f32 v12, v11, v12
    v_cmp_gt_u32 vcc, 32, v0
    v_mov_b32 v11, 0
    s_nop 0
    v_cndmask_b32 v37, v11, v12, vcc
    s_waitcnt vmcnt(10)
    v_mfma_f32_32x32x16_bf16 v[80:95], v[52:55], v[24:27], 0
    s_waitcnt vmcnt(9)
    v_mfma_f32_32x32x16_bf16 v[80:95], v[60:63], v[40:43], v[80:95]
    s_nop 11
    v_max3_f32 v10, v80, v81, v82
    v_max3_f32 v10, v83, v84, v10
    v_max3_f32 v10, v85, v86, v10
    v_max3_f32 v10, v87, v88, v10
    v_max3_f32 v10, v89, v90, v10
    v_max3_f32 v10, v91, v92, v10
    v_max3_f32 v10, v93, v94, v10
    v_max_f32 v10, v95, v10
    v_mov_b32 v11, v10
    s_nop 1
    v_permlane32_swap_b32 v10, v11
    v_max_f32 v10, v10, v11
    v_sub_f32 v10, 0, v10
    v_and_b32 v11, 0xffff0000, v10
    v_sub_f32 v12, v10, v11
    v_cvt_pk_bf16_f32 v12, v11, v12
    v_cmp_gt_u32 vcc, 32, v0
    v_mov_b32 v11, 0
    s_nop 0
    v_cndmask_b32 v41, v11, v12, vcc
    s_waitcnt vmcnt(8)
    v_mfma_f32_32x32x16_bf16 v[96:111], v[52:55], v[28:31], 0
    s_waitcnt vmcnt(7)
    v_mfma_f32_32x32x16_bf16 v[96:111], v[60:63], v[44:47], v[96:111]
    s_nop 11
    v_max3_f32 v10, v96, v97, v98
    v_max3_f32 v10, v99, v100, v10
    v_max3_f32 v10, v101, v102, v10
    v_max3_f32 v10, v103, v104, v10
    v_max3_f32 v10, v105, v106, v10
    v_max3_f32 v10, v107, v108, v10
    v_max3_f32 v10, v109, v110, v10
    v_max_f32 v10, v111, v10
    v_mov_b32 v11, v10
    s_nop 1
    v_permlane32_swap_b32 v10, v11
    v_max_f32 v10, v10, v11
    v_sub_f32 v10, 0, v10
    v_and_b32 v11, 0xffff0000, v10
    v_sub_f32 v12, v10, v11
    v_cvt_pk_bf16_f32 v12, v11, v12
    v_cmp_gt_u32 vcc, 32, v0
    v_mov_b32 v11, 0
    s_nop 0
    v_cndmask_b32 v45, v11, v12, vcc
    s_waitcnt lgkmcnt(3)
    v_mfma_f32_32x32x16_bf16 v[80:95], v[48:51], v[16:19], 0
    s_waitcnt lgkmcnt(2)
    v_mfma_f32_32x32x16_bf16 v[80:95], v[56:59], v[32:35], v[80:95]
    s_setprio 1
    s_nop 10
    v_exp_f32 v80, v80
    v_exp_f32 v81, v81
    v_exp_f32 v82, v82
    v_exp_f32 v83, v83
    v_mfma_f32_32x32x16_bf16 v[96:111], v[48:51], v[20:23], 0
    v_exp_f32 v84, v84
    v_exp_f32 v85, v85
    v_cvt_pk_bf16_f32 v112, v80, v81
    v_exp_f32 v86, v86
    v_exp_f32 v87, v87
    v_cvt_pk_bf16_f32 v113, v82, v83
    v_mfma_f32_32x32x16_bf16 v[96:111], v[56:59], v[36:39], v[96:111]
    v_exp_f32 v88, v88
    v_exp_f32 v89, v89
    v_cvt_pk_bf16_f32 v114, v84, v85
    v_exp_f32 v90, v90
    v_exp_f32 v91, v91
    v_cvt_pk_bf16_f32 v115, v86, v87
    v_exp_f32 v92, v92
    v_exp_f32 v93, v93
    v_cvt_pk_bf16_f32 v116, v88, v89
    v_exp_f32 v94, v94
    v_exp_f32 v95, v95
    v_cvt_pk_bf16_f32 v117, v90, v91
    s_waitcnt lgkmcnt(1)
    v_mfma_f32_32x32x16_bf16 v[128:143], v[64:67], v[112:115], v[128:143]
    ds_read_b128 v[52:55], v1 offset:5120
    ds_read_b32 v60, v2 offset:5120
    ds_read_b128 v[72:75], v3 offset:5120
    ds_read_b128 v[76:79], v3 offset:5760
    v_exp_f32 v96, v96
    v_exp_f32 v97, v97
    v_cvt_pk_bf16_f32 v118, v92, v93
    v_exp_f32 v98, v98
    v_exp_f32 v99, v99
    v_cvt_pk_bf16_f32 v119, v94, v95
    v_mfma_f32_32x32x16_bf16 v[80:95], v[48:51], v[24:27], 0
    buffer_load_dwordx4 v[192:195], v4, s[44:47], s59 offen offset:1024
    v_exp_f32 v100, v100
    v_exp_f32 v101, v101
    v_cvt_pk_bf16_f32 v120, v96, v97
    v_exp_f32 v102, v102
    v_exp_f32 v103, v103
    v_cvt_pk_bf16_f32 v121, v98, v99
    v_mfma_f32_32x32x16_bf16 v[80:95], v[56:59], v[40:43], v[80:95]
    v_exp_f32 v104, v104
    v_exp_f32 v105, v105
    v_cvt_pk_bf16_f32 v122, v100, v101
    v_exp_f32 v106, v106
    v_exp_f32 v107, v107
    v_cvt_pk_bf16_f32 v123, v102, v103
    s_waitcnt lgkmcnt(4)
    v_mfma_f32_32x32x16_bf16 v[128:143], v[68:71], v[116:119], v[128:143]
    v_exp_f32 v108, v108
    v_exp_f32 v109, v109
    v_cvt_pk_bf16_f32 v124, v104, v105
    v_exp_f32 v110, v110
    v_exp_f32 v111, v111
    v_cvt_pk_bf16_f32 v125, v106, v107
    v_mfma_f32_32x32x16_bf16 v[144:159], v[64:67], v[120:123], v[144:159]
    v_exp_f32 v80, v80
    v_exp_f32 v81, v81
    v_cvt_pk_bf16_f32 v126, v108, v109
    v_exp_f32 v82, v82
    v_exp_f32 v83, v83
    v_cvt_pk_bf16_f32 v127, v110, v111
    v_mfma_f32_32x32x16_bf16 v[96:111], v[48:51], v[28:31], 0
    v_exp_f32 v84, v84
    v_exp_f32 v85, v85
    v_cvt_pk_bf16_f32 v112, v80, v81
    v_exp_f32 v86, v86
    buffer_load_dwordx4 v[196:199], v4, s[44:47], s64 offen offset:1024
    v_exp_f32 v87, v87
    v_cvt_pk_bf16_f32 v113, v82, v83
    v_mfma_f32_32x32x16_bf16 v[96:111], v[56:59], v[44:47], v[96:111]
    v_exp_f32 v88, v88
    v_exp_f32 v89, v89
    v_cvt_pk_bf16_f32 v114, v84, v85
    v_exp_f32 v90, v90
    v_exp_f32 v91, v91
    v_cvt_pk_bf16_f32 v115, v86, v87
    v_mfma_f32_32x32x16_bf16 v[144:159], v[68:71], v[124:127], v[144:159]
    v_exp_f32 v92, v92
    v_exp_f32 v93, v93
    v_cvt_pk_bf16_f32 v116, v88, v89
    v_exp_f32 v94, v94
    v_exp_f32 v95, v95
    v_cvt_pk_bf16_f32 v117, v90, v91
    s_waitcnt lgkmcnt(0)
    v_mfma_f32_32x32x16_bf16 v[160:175], v[64:67], v[112:115], v[160:175]
    v_exp_f32 v96, v96
    v_exp_f32 v97, v97
    v_cvt_pk_bf16_f32 v118, v92, v93
    v_exp_f32 v98, v98
    v_exp_f32 v99, v99
    v_cvt_pk_bf16_f32 v119, v94, v95
    v_mfma_f32_32x32x16_bf16 v[80:95], v[52:55], v[16:19], 0
    v_exp_f32 v100, v100
    v_exp_f32 v101, v101
    v_cvt_pk_bf16_f32 v120, v96, v97
    buffer_load_dwordx4 v[192:195], v4, s[44:47], s59 offen offset:2048
    v_exp_f32 v102, v102
    v_exp_f32 v103, v103
    v_cvt_pk_bf16_f32 v121, v98, v99
    v_mfma_f32_32x32x16_bf16 v[80:95], v[60:63], v[32:35], v[80:95]
    v_exp_f32 v104, v104
    v_exp_f32 v105, v105
    v_cvt_pk_bf16_f32 v122, v100, v101
    v_exp_f32 v106, v106
    v_exp_f32 v107, v107
    v_cvt_pk_bf16_f32 v123, v102, v103
    v_mfma_f32_32x32x16_bf16 v[160:175], v[68:71], v[116:119], v[160:175]
    v_exp_f32 v108, v108
    v_exp_f32 v109, v109
    v_cvt_pk_bf16_f32 v124, v104, v105
    v_exp_f32 v110, v110
    v_exp_f32 v111, v111
    v_cvt_pk_bf16_f32 v125, v106, v107
    v_mfma_f32_32x32x16_bf16 v[176:191], v[64:67], v[120:123], v[176:191]
    v_exp_f32 v80, v80
    v_exp_f32 v81, v81
    v_cvt_pk_bf16_f32 v126, v108, v109
    v_exp_f32 v82, v82
    v_exp_f32 v83, v83
    v_cvt_pk_bf16_f32 v127, v110, v111
    v_mfma_f32_32x32x16_bf16 v[96:111], v[52:55], v[20:23], 0
    v_exp_f32 v84, v84
    v_exp_f32 v85, v85
    v_cvt_pk_bf16_f32 v112, v80, v81
    v_exp_f32 v86, v86
    buffer_load_dwordx4 v[196:199], v4, s[44:47], s64 offen offset:2048
    v_exp_f32 v87, v87
    v_cvt_pk_bf16_f32 v113, v82, v83
    v_mfma_f32_32x32x16_bf16 v[96:111], v[60:63], v[36:39], v[96:111]
    v_exp_f32 v88, v88
    v_exp_f32 v89, v89
    v_cvt_pk_bf16_f32 v114, v84, v85
    v_exp_f32 v90, v90
    v_exp_f32 v91, v91
    v_cvt_pk_bf16_f32 v115, v86, v87
    v_mfma_f32_32x32x16_bf16 v[176:191], v[68:71], v[124:127], v[176:191]
    v_exp_f32 v92, v92
    v_exp_f32 v93, v93
    v_cvt_pk_bf16_f32 v116, v88, v89
    v_exp_f32 v94, v94
    v_exp_f32 v95, v95
    v_cvt_pk_bf16_f32 v117, v90, v91
    v_mfma_f32_32x32x16_bf16 v[128:143], v[72:75], v[112:115], v[128:143]
    ds_read_b128 v[48:51], v1 offset:10240
    ds_read_b32 v56, v2 offset:10240
    ds_read_b128 v[64:67], v3 offset:10240
    ds_read_b128 v[68:71], v3 offset:10880
    v_exp_f32 v96, v96
    v_exp_f32 v97, v97
    v_cvt_pk_bf16_f32 v118, v92, v93
    v_exp_f32 v98, v98
    v_exp_f32 v99, v99
    v_cvt_pk_bf16_f32 v119, v94, v95
    v_mfma_f32_32x32x16_bf16 v[80:95], v[52:55], v[24:27], 0
    buffer_load_dwordx4 v[192:195], v4, s[44:47], s59 offen offset:3072
    v_exp_f32 v100, v100
    v_exp_f32 v101, v101
    v_cvt_pk_bf16_f32 v120, v96, v97
    v_exp_f32 v102, v102
    v_exp_f32 v103, v103
    v_cvt_pk_bf16_f32 v121, v98, v99
    v_mfma_f32_32x32x16_bf16 v[80:95], v[60:63], v[40:43], v[80:95]
    v_exp_f32 v104, v104
    v_exp_f32 v105, v105
    v_cvt_pk_bf16_f32 v122, v100, v101
    v_exp_f32 v106, v106
    v_exp_f32 v107, v107
    v_cvt_pk_bf16_f32 v123, v102, v103
    v_mfma_f32_32x32x16_bf16 v[128:143], v[76:79], v[116:119], v[128:143]
    v_exp_f32 v108, v108
    v_exp_f32 v109, v109
    v_cvt_pk_bf16_f32 v124, v104, v105
    v_exp_f32 v110, v110
    v_exp_f32 v111, v111
    v_cvt_pk_bf16_f32 v125, v106, v107
    v_mfma_f32_32x32x16_bf16 v[144:159], v[72:75], v[120:123], v[144:159]
    v_exp_f32 v80, v80
    v_exp_f32 v81, v81
    v_cvt_pk_bf16_f32 v126, v108, v109
    v_exp_f32 v82, v82
    v_exp_f32 v83, v83
    v_cvt_pk_bf16_f32 v127, v110, v111
    v_mfma_f32_32x32x16_bf16 v[96:111], v[52:55], v[28:31], 0
    s_add_u32 s39, s70, 0
    buffer_store_dwordx4 v[200:203], v252, s[60:63], s39 offen sc0 sc1
    v_exp_f32 v84, v84
    v_exp_f32 v85, v85
    buffer_load_dwordx4 v[196:199], v4, s[44:47], s64 offen offset:3072
    v_cvt_pk_bf16_f32 v112, v80, v81
    v_exp_f32 v86, v86
    v_exp_f32 v87, v87
    v_cvt_pk_bf16_f32 v113, v82, v83
    v_mfma_f32_32x32x16_bf16 v[96:111], v[60:63], v[44:47], v[96:111]
    v_exp_f32 v88, v88
    buffer_store_dwordx4 v[204:207], v252, s[60:63], s39 offen offset:1024 sc0 sc1
    v_exp_f32 v89, v89
    v_cvt_pk_bf16_f32 v114, v84, v85
    v_exp_f32 v90, v90
    v_exp_f32 v91, v91
    v_cvt_pk_bf16_f32 v115, v86, v87
    v_mfma_f32_32x32x16_bf16 v[144:159], v[76:79], v[124:127], v[144:159]
    v_exp_f32 v92, v92
    v_exp_f32 v93, v93
    v_cvt_pk_bf16_f32 v116, v88, v89
    v_exp_f32 v94, v94
    v_exp_f32 v95, v95
    v_cvt_pk_bf16_f32 v117, v90, v91
    s_waitcnt lgkmcnt(0)
    v_mfma_f32_32x32x16_bf16 v[160:175], v[72:75], v[112:115], v[160:175]
    v_exp_f32 v96, v96
    v_exp_f32 v97, v97
    v_cvt_pk_bf16_f32 v118, v92, v93
    v_exp_f32 v98, v98
    v_exp_f32 v99, v99
    v_cvt_pk_bf16_f32 v119, v94, v95
    s_add_u32 s39, s70, 2048
    buffer_store_dwordx4 v[208:211], v252, s[60:63], s39 offen sc0 sc1
    v_mfma_f32_32x32x16_bf16 v[80:95], v[48:51], v[16:19], 0
    v_exp_f32 v100, v100
    v_exp_f32 v101, v101
    v_cvt_pk_bf16_f32 v120, v96, v97
    v_exp_f32 v102, v102
    v_exp_f32 v103, v103
    v_cvt_pk_bf16_f32 v121, v98, v99
    v_mfma_f32_32x32x16_bf16 v[80:95], v[56:59], v[32:35], v[80:95]
    buffer_store_dwordx4 v[212:215], v252, s[60:63], s39 offen offset:1024 sc0 sc1
    v_exp_f32 v104, v104
    v_exp_f32 v105, v105
    v_cvt_pk_bf16_f32 v122, v100, v101
    v_exp_f32 v106, v106
    v_exp_f32 v107, v107
    v_cvt_pk_bf16_f32 v123, v102, v103
    v_mfma_f32_32x32x16_bf16 v[160:175], v[76:79], v[116:119], v[160:175]
    v_exp_f32 v108, v108
    v_exp_f32 v109, v109
    v_cvt_pk_bf16_f32 v124, v104, v105
    v_exp_f32 v110, v110
    v_exp_f32 v111, v111
    v_cvt_pk_bf16_f32 v125, v106, v107
    v_mfma_f32_32x32x16_bf16 v[176:191], v[72:75], v[120:123], v[176:191]
    v_exp_f32 v80, v80
    v_exp_f32 v81, v81
    v_cvt_pk_bf16_f32 v126, v108, v109
    v_exp_f32 v82, v82
    v_exp_f32 v83, v83
    v_cvt_pk_bf16_f32 v127, v110, v111
    v_mfma_f32_32x32x16_bf16 v[96:111], v[48:51], v[20:23], 0
    s_add_u32 s39, s70, 4096
    buffer_store_dwordx4 v[216:219], v252, s[60:63], s39 offen sc0 sc1
    v_exp_f32 v84, v84
    v_exp_f32 v85, v85
    v_cvt_pk_bf16_f32 v112, v80, v81
    v_exp_f32 v86, v86
    v_exp_f32 v87, v87
    v_cvt_pk_bf16_f32 v113, v82, v83
    v_mfma_f32_32x32x16_bf16 v[96:111], v[56:59], v[36:39], v[96:111]
    v_exp_f32 v88, v88
    buffer_store_dwordx4 v[220:223], v252, s[60:63], s39 offen offset:1024 sc0 sc1
    v_exp_f32 v89, v89
    v_cvt_pk_bf16_f32 v114, v84, v85
    v_exp_f32 v90, v90
    v_exp_f32 v91, v91
    v_cvt_pk_bf16_f32 v115, v86, v87
    v_mfma_f32_32x32x16_bf16 v[176:191], v[76:79], v[124:127], v[176:191]
    v_exp_f32 v92, v92
    v_exp_f32 v93, v93
    v_cvt_pk_bf16_f32 v116, v88, v89
    v_exp_f32 v94, v94
    v_exp_f32 v95, v95
    v_cvt_pk_bf16_f32 v117, v90, v91
    v_mfma_f32_32x32x16_bf16 v[128:143], v[64:67], v[112:115], v[128:143]
    ds_read_b128 v[52:55], v1 offset:15360
    ds_read_b32 v60, v2 offset:15360
    ds_read_b128 v[72:75], v3 offset:15360
    ds_read_b128 v[76:79], v3 offset:16000
    v_exp_f32 v96, v96
    v_exp_f32 v97, v97
    v_cvt_pk_bf16_f32 v118, v92, v93
    s_add_u32 s39, s70, 147456
    buffer_store_dwordx4 v[224:227], v252, s[60:63], s39 offen sc0 sc1
    v_exp_f32 v98, v98
    v_exp_f32 v99, v99
    v_cvt_pk_bf16_f32 v119, v94, v95
    v_mfma_f32_32x32x16_bf16 v[80:95], v[48:51], v[24:27], 0
    v_exp_f32 v100, v100
    v_exp_f32 v101, v101
    v_cvt_pk_bf16_f32 v120, v96, v97
    v_exp_f32 v102, v102
    buffer_store_dwordx4 v[228:231], v252, s[60:63], s39 offen offset:1024 sc0 sc1
    v_exp_f32 v103, v103
    v_cvt_pk_bf16_f32 v121, v98, v99
    v_mfma_f32_32x32x16_bf16 v[80:95], v[56:59], v[40:43], v[80:95]
    v_exp_f32 v104, v104
    v_exp_f32 v105, v105
    v_cvt_pk_bf16_f32 v122, v100, v101
    v_exp_f32 v106, v106
    v_exp_f32 v107, v107
    v_cvt_pk_bf16_f32 v123, v102, v103
    v_mfma_f32_32x32x16_bf16 v[128:143], v[68:71], v[116:119], v[128:143]
    v_exp_f32 v108, v108
    v_exp_f32 v109, v109
    v_cvt_pk_bf16_f32 v124, v104, v105
    v_exp_f32 v110, v110
    v_exp_f32 v111, v111
    v_cvt_pk_bf16_f32 v125, v106, v107
    v_mfma_f32_32x32x16_bf16 v[144:159], v[64:67], v[120:123], v[144:159]
    v_exp_f32 v80, v80
    v_exp_f32 v81, v81
    v_cvt_pk_bf16_f32 v126, v108, v109
    v_exp_f32 v82, v82
    v_exp_f32 v83, v83
    v_cvt_pk_bf16_f32 v127, v110, v111
    v_mfma_f32_32x32x16_bf16 v[96:111], v[48:51], v[28:31], 0
    s_add_u32 s39, s70, 149504
    buffer_store_dwordx4 v[232:235], v252, s[60:63], s39 offen sc0 sc1
    v_exp_f32 v84, v84
    v_exp_f32 v85, v85
    v_cvt_pk_bf16_f32 v112, v80, v81
    v_exp_f32 v86, v86
    v_exp_f32 v87, v87
    v_cvt_pk_bf16_f32 v113, v82, v83
    v_mfma_f32_32x32x16_bf16 v[96:111], v[56:59], v[44:47], v[96:111]
    v_exp_f32 v88, v88
    buffer_store_dwordx4 v[236:239], v252, s[60:63], s39 offen offset:1024 sc0 sc1
    v_exp_f32 v89, v89
    v_cvt_pk_bf16_f32 v114, v84, v85
    v_exp_f32 v90, v90
    v_exp_f32 v91, v91
    v_cvt_pk_bf16_f32 v115, v86, v87
    v_mfma_f32_32x32x16_bf16 v[144:159], v[68:71], v[124:127], v[144:159]
    v_exp_f32 v92, v92
    v_exp_f32 v93, v93
    v_cvt_pk_bf16_f32 v116, v88, v89
    v_exp_f32 v94, v94
    v_exp_f32 v95, v95
    v_cvt_pk_bf16_f32 v117, v90, v91
    s_waitcnt lgkmcnt(0)
    v_mfma_f32_32x32x16_bf16 v[160:175], v[64:67], v[112:115], v[160:175]
    v_exp_f32 v96, v96
    v_exp_f32 v97, v97
    v_cvt_pk_bf16_f32 v118, v92, v93
    v_exp_f32 v98, v98
    v_exp_f32 v99, v99
    v_cvt_pk_bf16_f32 v119, v94, v95
    s_add_u32 s39, s70, 151552
    buffer_store_dwordx4 v[240:243], v252, s[60:63], s39 offen sc0 sc1
    v_mfma_f32_32x32x16_bf16 v[80:95], v[52:55], v[16:19], 0
    v_exp_f32 v100, v100
    v_exp_f32 v101, v101
    v_cvt_pk_bf16_f32 v120, v96, v97
    v_exp_f32 v102, v102
    v_exp_f32 v103, v103
    v_cvt_pk_bf16_f32 v121, v98, v99
    v_mfma_f32_32x32x16_bf16 v[80:95], v[60:63], v[32:35], v[80:95]
    buffer_store_dwordx4 v[244:247], v252, s[60:63], s39 offen offset:1024 sc0 sc1
    v_exp_f32 v104, v104
    v_exp_f32 v105, v105
    v_cvt_pk_bf16_f32 v122, v100, v101
    v_exp_f32 v106, v106
    v_exp_f32 v107, v107
    v_cvt_pk_bf16_f32 v123, v102, v103
    v_mfma_f32_32x32x16_bf16 v[160:175], v[68:71], v[116:119], v[160:175]
    v_exp_f32 v108, v108
    v_exp_f32 v109, v109
    v_cvt_pk_bf16_f32 v124, v104, v105
    v_exp_f32 v110, v110
    v_exp_f32 v111, v111
    v_cvt_pk_bf16_f32 v125, v106, v107
    v_mfma_f32_32x32x16_bf16 v[176:191], v[64:67], v[120:123], v[176:191]
    v_exp_f32 v80, v80
    v_exp_f32 v81, v81
    v_cvt_pk_bf16_f32 v126, v108, v109
    v_exp_f32 v82, v82
    v_exp_f32 v83, v83
    v_cvt_pk_bf16_f32 v127, v110, v111
    v_mfma_f32_32x32x16_bf16 v[96:111], v[52:55], v[20:23], 0
    v_exp_f32 v84, v84
    v_exp_f32 v85, v85
    v_cvt_pk_bf16_f32 v112, v80, v81
    v_exp_f32 v86, v86
    v_exp_f32 v87, v87
    v_cvt_pk_bf16_f32 v113, v82, v83
    v_mfma_f32_32x32x16_bf16 v[96:111], v[60:63], v[36:39], v[96:111]
    v_exp_f32 v88, v88
    v_exp_f32 v89, v89
    v_cvt_pk_bf16_f32 v114, v84, v85
    v_exp_f32 v90, v90
    v_exp_f32 v91, v91
    v_cvt_pk_bf16_f32 v115, v86, v87
    v_mfma_f32_32x32x16_bf16 v[176:191], v[68:71], v[124:127], v[176:191]
    v_exp_f32 v92, v92
    v_exp_f32 v93, v93
    v_cvt_pk_bf16_f32 v116, v88, v89
    v_exp_f32 v94, v94
    v_exp_f32 v95, v95
    v_cvt_pk_bf16_f32 v117, v90, v91
    s_waitcnt vmcnt(18)
    s_barrier
    s_add_u32 s34, s34, 1
    s_cmp_eq_u32 s34, 3
    s_cselect_b32 s37, -40960, s36
    s_cselect_b32 s34, 0, s34
    v_add_u32 v1, s37, v1
    v_add_u32 v2, s37, v2
    v_add_u32 v3, s37, v3
    v_mfma_f32_32x32x16_bf16 v[128:143], v[72:75], v[112:115], v[128:143]
    ds_read_b128 v[48:51], v1 offset:0
    ds_read_b32 v56, v2 offset:0
    ds_read_b128 v[64:67], v3 offset:0
    ds_read_b128 v[68:71], v3 offset:640
    v_exp_f32 v96, v96
    v_exp_f32 v97, v97
    v_cvt_pk_bf16_f32 v118, v92, v93
    v_exp_f32 v98, v98
    s_mov_b32 m0, s28
    v_exp_f32 v99, v99
    v_cvt_pk_bf16_f32 v119, v94, v95
    buffer_load_dwordx4 v4, s[16:19], s26 offen offset:0 sc0 sc1 lds
    v_mfma_f32_32x32x16_bf16 v[80:95], v[52:55], v[24:27], 0
    v_exp_f32 v100, v100
    buffer_load_dwordx4 v4, s[16:19], s26 offen offset:1024 sc0 sc1 lds
    v_exp_f32 v101, v101
    v_cvt_pk_bf16_f32 v120, v96, v97
    buffer_load_dwordx4 v4, s[16:19], s26 offen offset:2048 sc0 sc1 lds
    v_exp_f32 v102, v102
    buffer_load_dwordx4 v4, s[16:19], s26 offen offset:3072 sc0 sc1 lds
    v_exp_f32 v103, v103
    v_cvt_pk_bf16_f32 v121, v98, v99
    s_add_u32 m0, s28, 4096
    v_mfma_f32_32x32x16_bf16 v[80:95], v[60:63], v[40:43], v[80:95]
    v_exp_f32 v104, v104
    s_add_u32 s29, s26, 4096
    v_exp_f32 v105, v105
    v_cvt_pk_bf16_f32 v122, v100, v101
    buffer_load_dwordx4 v4, s[16:19], s29 offen sc0 sc1 lds
    v_exp_f32 v106, v106
    s_add_u32 s26, s26, 20480
    v_exp_f32 v107, v107
    v_cvt_pk_bf16_f32 v123, v102, v103
    s_add_u32 s28, s28, 20480
    v_mfma_f32_32x32x16_bf16 v[128:143], v[76:79], v[116:119], v[128:143]
    v_exp_f32 v108, v108
    s_sub_u32 s29, s28, 61440
    v_exp_f32 v109, v109
    v_cvt_pk_bf16_f32 v124, v104, v105
    s_cmp_ge_u32 s28, 61440
    v_exp_f32 v110, v110
    s_cselect_b32 s28, s29, s28
    v_exp_f32 v111, v111
    v_cvt_pk_bf16_f32 v125, v106, v107
    v_mfma_f32_32x32x16_bf16 v[144:159], v[72:75], v[120:123], v[144:159]
    v_exp_f32 v80, v80
    v_exp_f32 v81, v81
    v_cvt_pk_bf16_f32 v126, v108, v109
    v_exp_f32 v82, v82
    v_exp_f32 v83, v83
    v_cvt_pk_bf16_f32 v127, v110, v111
    v_mfma_f32_32x32x16_bf16 v[96:111], v[52:55], v[28:31], 0
    v_exp_f32 v84, v84
    v_exp_f32 v85, v85
    v_cvt_pk_bf16_f32 v112, v80, v81
    v_exp_f32 v86, v86
    v_exp_f32 v87, v87
    v_cvt_pk_bf16_f32 v113, v82, v83
    v_mfma_f32_32x32x16_bf16 v[96:111], v[60:63], v[44:47], v[96:111]
    v_exp_f32 v88, v88
    v_exp_f32 v89, v89
    v_cvt_pk_bf16_f32 v114, v84, v85
    v_exp_f32 v90, v90
    v_exp_f32 v91, v91
    v_cvt_pk_bf16_f32 v115, v86, v87
    v_mfma_f32_32x32x16_bf16 v[144:159], v[76:79], v[124:127], v[144:159]
    v_exp_f32 v92, v92
    v_exp_f32 v93, v93
    v_cvt_pk_bf16_f32 v116, v88, v89
    v_exp_f32 v94, v94
    v_exp_f32 v95, v95
    v_cvt_pk_bf16_f32 v117, v90, v91
    s_waitcnt lgkmcnt(0)
    v_mfma_f32_32x32x16_bf16 v[160:175], v[72:75], v[112:115], v[160:175]
    v_exp_f32 v96, v96
    v_exp_f32 v97, v97
    v_cvt_pk_bf16_f32 v118, v92, v93
    v_exp_f32 v98, v98
    v_exp_f32 v99, v99
    v_cvt_pk_bf16_f32 v119, v94, v95
    v_mfma_f32_32x32x16_bf16 v[80:95], v[48:51], v[16:19], 0
    v_exp_f32 v100, v100
    v_exp_f32 v101, v101
    v_cvt_pk_bf16_f32 v120, v96, v97
    v_exp_f32 v102, v102
    v_exp_f32 v103, v103
    v_cvt_pk_bf16_f32 v121, v98, v99
    v_mfma_f32_32x32x16_bf16 v[80:95], v[56:59], v[32:35], v[80:95]
    v_exp_f32 v104, v104
    v_exp_f32 v105, v105
    v_cvt_pk_bf16_f32 v122, v100, v101
    v_exp_f32 v106, v106
    v_exp_f32 v107, v107
    v_cvt_pk_bf16_f32 v123, v102, v103
    v_mfma_f32_32x32x16_bf16 v[160:175], v[76:79], v[116:119], v[160:175]
    v_exp_f32 v108, v108
    v_exp_f32 v109, v109
    v_cvt_pk_bf16_f32 v124, v104, v105
    v_exp_f32 v110, v110
    v_exp_f32 v111, v111
    v_cvt_pk_bf16_f32 v125, v106, v107
    v_mfma_f32_32x32x16_bf16 v[176:191], v[72:75], v[120:123], v[176:191]
    v_exp_f32 v80, v80
    v_exp_f32 v81, v81
    v_cvt_pk_bf16_f32 v126, v108, v109
    v_exp_f32 v82, v82
    v_exp_f32 v83, v83
    v_cvt_pk_bf16_f32 v127, v110, v111
    v_mfma_f32_32x32x16_bf16 v[96:111], v[48:51], v[20:23], 0
    v_exp_f32 v84, v84
    v_exp_f32 v85, v85
    v_cvt_pk_bf16_f32 v112, v80, v81
    v_exp_f32 v86, v86
    v_exp_f32 v87, v87
    v_cvt_pk_bf16_f32 v113, v82, v83
    v_mfma_f32_32x32x16_bf16 v[96:111], v[56:59], v[36:39], v[96:111]
    v_exp_f32 v88, v88
    v_exp_f32 v89, v89
    v_cvt_pk_bf16_f32 v114, v84, v85
    v_exp_f32 v90, v90
    v_exp_f32 v91, v91
    v_cvt_pk_bf16_f32 v115, v86, v87
    v_mfma_f32_32x32x16_bf16 v[176:191], v[76:79], v[124:127], v[176:191]
    v_exp_f32 v92, v92
    v_exp_f32 v93, v93
    v_cvt_pk_bf16_f32 v116, v88, v89
    v_exp_f32 v94, v94
    v_exp_f32 v95, v95
    v_cvt_pk_bf16_f32 v117, v90, v91
    v_mfma_f32_32x32x16_bf16 v[128:143], v[64:67], v[112:115], v[128:143]
    ds_read_b128 v[52:55], v1 offset:5120
    ds_read_b32 v60, v2 offset:5120
    ds_read_b128 v[72:75], v3 offset:5120
    ds_read_b128 v[76:79], v3 offset:5760
    v_exp_f32 v96, v96
    v_exp_f32 v97, v97
    v_cvt_pk_bf16_f32 v118, v92, v93
    v_exp_f32 v98, v98
    v_exp_f32 v99, v99
    v_cvt_pk_bf16_f32 v119, v94, v95
    v_mfma_f32_32x32x16_bf16 v[80:95], v[48:51], v[24:27], 0
    v_exp_f32 v100, v100
    v_exp_f32 v101, v101
    v_cvt_pk_bf16_f32 v120, v96, v97
    v_exp_f32 v102, v102
    v_exp_f32 v103, v103
    v_cvt_pk_bf16_f32 v121, v98, v99
    v_mfma_f32_32x32x16_bf16 v[80:95], v[56:59], v[40:43], v[80:95]
    v_exp_f32 v104, v104
    v_exp_f32 v105, v105
    v_cvt_pk_bf16_f32 v122, v100, v101
    v_exp_f32 v106, v106
    v_exp_f32 v107, v107
    v_cvt_pk_bf16_f32 v123, v102, v103
    v_mfma_f32_32x32x16_bf16 v[128:143], v[68:71], v[116:119], v[128:143]
    v_exp_f32 v108, v108
    v_exp_f32 v109, v109
    v_cvt_pk_bf16_f32 v124, v104, v105
    v_exp_f32 v110, v110
    v_exp_f32 v111, v111
    v_cvt_pk_bf16_f32 v125, v106, v107
    v_mfma_f32_32x32x16_bf16 v[144:159], v[64:67], v[120:123], v[144:159]
    v_exp_f32 v80, v80
    v_exp_f32 v81, v81
    v_cvt_pk_bf16_f32 v126, v108, v109
    v_exp_f32 v82, v82
    v_exp_f32 v83, v83
    v_cvt_pk_bf16_f32 v127, v110, v111
    v_mfma_f32_32x32x16_bf16 v[96:111], v[48:51], v[28:31], 0
    v_exp_f32 v84, v84
    v_exp_f32 v85, v85
    v_cvt_pk_bf16_f32 v112, v80, v81
    v_exp_f32 v86, v86
    v_exp_f32 v87, v87
    v_cvt_pk_bf16_f32 v113, v82, v83
    v_mfma_f32_32x32x16_bf16 v[96:111], v[56:59], v[44:47], v[96:111]
    v_exp_f32 v88, v88
    v_exp_f32 v89, v89
    v_cvt_pk_bf16_f32 v114, v84, v85
    v_exp_f32 v90, v90
    v_exp_f32 v91, v91
    v_cvt_pk_bf16_f32 v115, v86, v87
    v_mfma_f32_32x32x16_bf16 v[144:159], v[68:71], v[124:127], v[144:159]
    v_exp_f32 v92, v92
    v_exp_f32 v93, v93
    v_cvt_pk_bf16_f32 v116, v88, v89
    v_exp_f32 v94, v94
    v_exp_f32 v95, v95
    v_cvt_pk_bf16_f32 v117, v90, v91
    s_waitcnt lgkmcnt(0)
    v_mfma_f32_32x32x16_bf16 v[160:175], v[64:67], v[112:115], v[160:175]
    v_exp_f32 v96, v96
    v_exp_f32 v97, v97
    v_cvt_pk_bf16_f32 v118, v92, v93
    v_exp_f32 v98, v98
    v_exp_f32 v99, v99
    v_cvt_pk_bf16_f32 v119, v94, v95
    v_mfma_f32_32x32x16_bf16 v[80:95], v[52:55], v[16:19], 0
    v_exp_f32 v100, v100
    v_exp_f32 v101, v101
    v_cvt_pk_bf16_f32 v120, v96, v97
    v_exp_f32 v102, v102
    v_exp_f32 v103, v103
    v_cvt_pk_bf16_f32 v121, v98, v99
    v_mfma_f32_32x32x16_bf16 v[80:95], v[60:63], v[32:35], v[80:95]
    v_exp_f32 v104, v104
    v_exp_f32 v105, v105
    v_cvt_pk_bf16_f32 v122, v100, v101
    v_exp_f32 v106, v106
    v_exp_f32 v107, v107
    v_cvt_pk_bf16_f32 v123, v102, v103
    v_mfma_f32_32x32x16_bf16 v[160:175], v[68:71], v[116:119], v[160:175]
    v_exp_f32 v108, v108
    v_exp_f32 v109, v109
    v_cvt_pk_bf16_f32 v124, v104, v105
    v_exp_f32 v110, v110
    v_exp_f32 v111, v111
    v_cvt_pk_bf16_f32 v125, v106, v107
    s_lshl_b32 s39, s71, 7
    s_lshl_b32 s38, s6, 6
    v_add_lshl_u32 v10, v0, s38, 20
    v_mov_b32 v12, s76
    v_mov_b32 v13, s77
    s_waitcnt vmcnt(5)
    s_barrier
    buffer_store_dwordx2 v[12:13], v10, s[72:75], s39 offen sc0 sc1
    v_mfma_f32_32x32x16_bf16 v[176:191], v[64:67], v[120:123], v[176:191]
    v_exp_f32 v80, v80
    v_exp_f32 v81, v81
    v_cvt_pk_bf16_f32 v126, v108, v109
    v_exp_f32 v82, v82
    v_exp_f32 v83, v83
    v_cvt_pk_bf16_f32 v127, v110, v111
    v_mfma_f32_32x32x16_bf16 v[96:111], v[52:55], v[20:23], 0
    v_exp_f32 v84, v84
    v_exp_f32 v85, v85
    v_cvt_pk_bf16_f32 v112, v80, v81
    v_exp_f32 v86, v86
    v_exp_f32 v87, v87
    v_cvt_pk_bf16_f32 v113, v82, v83
    v_mfma_f32_32x32x16_bf16 v[96:111], v[60:63], v[36:39], v[96:111]
    v_exp_f32 v88, v88
    v_exp_f32 v89, v89
    v_cvt_pk_bf16_f32 v114, v84, v85
    v_exp_f32 v90, v90
    v_exp_f32 v91, v91
    v_cvt_pk_bf16_f32 v115, v86, v87
    v_mfma_f32_32x32x16_bf16 v[176:191], v[68:71], v[124:127], v[176:191]
    v_exp_f32 v92, v92
    v_exp_f32 v93, v93
    v_cvt_pk_bf16_f32 v116, v88, v89
    v_exp_f32 v94, v94
    v_exp_f32 v95, v95
    v_cvt_pk_bf16_f32 v117, v90, v91
    v_mfma_f32_32x32x16_bf16 v[128:143], v[72:75], v[112:115], v[128:143]
    ds_read_b128 v[48:51], v1 offset:10240
    ds_read_b32 v56, v2 offset:10240
    ds_read_b128 v[64:67], v3 offset:10240
    ds_read_b128 v[68:71], v3 offset:10880
    v_exp_f32 v96, v96
    v_exp_f32 v97, v97
    v_cvt_pk_bf16_f32 v118, v92, v93
    v_exp_f32 v98, v98
    v_exp_f32 v99, v99
    v_cvt_pk_bf16_f32 v119, v94, v95
    v_mfma_f32_32x32x16_bf16 v[80:95], v[52:55], v[24:27], 0
    v_exp_f32 v100, v100
    v_exp_f32 v101, v101
    v_cvt_pk_bf16_f32 v120, v96, v97
    v_exp_f32 v102, v102
    v_exp_f32 v103, v103
    v_cvt_pk_bf16_f32 v121, v98, v99
    v_mfma_f32_32x32x16_bf16 v[80:95], v[60:63], v[40:43], v[80:95]
    v_exp_f32 v104, v104
    v_exp_f32 v105, v105
    v_cvt_pk_bf16_f32 v122, v100, v101
    v_exp_f32 v106, v106
    v_exp_f32 v107, v107
    v_cvt_pk_bf16_f32 v123, v102, v103
    v_mfma_f32_32x32x16_bf16 v[128:143], v[76:79], v[116:119], v[128:143]
    v_exp_f32 v108, v108
    v_exp_f32 v109, v109
    v_cvt_pk_bf16_f32 v124, v104, v105
    v_exp_f32 v110, v110
    v_exp_f32 v111, v111
    v_cvt_pk_bf16_f32 v125, v106, v107
    v_mfma_f32_32x32x16_bf16 v[144:159], v[72:75], v[120:123], v[144:159]
    v_exp_f32 v80, v80
    v_exp_f32 v81, v81
    v_cvt_pk_bf16_f32 v126, v108, v109
    v_exp_f32 v82, v82
    v_exp_f32 v83, v83
    v_cvt_pk_bf16_f32 v127, v110, v111
    v_mfma_f32_32x32x16_bf16 v[96:111], v[52:55], v[28:31], 0
    v_exp_f32 v84, v84
    buffer_load_dwordx4 v[192:195], v4, s[48:51], s57 offen offset:0
    v_exp_f32 v85, v85
    v_cvt_pk_bf16_f32 v112, v80, v81
    v_exp_f32 v86, v86
    v_exp_f32 v87, v87
    v_cvt_pk_bf16_f32 v113, v82, v83
    v_mfma_f32_32x32x16_bf16 v[96:111], v[60:63], v[44:47], v[96:111]
    v_exp_f32 v88, v88
    v_exp_f32 v89, v89
    v_cvt_pk_bf16_f32 v114, v84, v85
    v_exp_f32 v90, v90
    v_exp_f32 v91, v91
    v_cvt_pk_bf16_f32 v115, v86, v87
    v_mfma_f32_32x32x16_bf16 v[144:159], v[76:79], v[124:127], v[144:159]
    v_exp_f32 v92, v92
    v_exp_f32 v93, v93
    v_cvt_pk_bf16_f32 v116, v88, v89
    v_exp_f32 v94, v94
    v_exp_f32 v95, v95
    v_cvt_pk_bf16_f32 v117, v90, v91
    s_waitcnt lgkmcnt(0)
    v_mfma_f32_32x32x16_bf16 v[160:175], v[72:75], v[112:115], v[160:175]
    v_exp_f32 v96, v96
    v_exp_f32 v97, v97
    v_cvt_pk_bf16_f32 v118, v92, v93
    v_exp_f32 v98, v98
    v_exp_f32 v99, v99
    v_cvt_pk_bf16_f32 v119, v94, v95
    v_mfma_f32_32x32x16_bf16 v[80:95], v[48:51], v[16:19], 0
    buffer_load_dwordx4 v[196:199], v4, s[48:51], s57 offen offset:1024
    v_exp_f32 v100, v100
    v_exp_f32 v101, v101
    v_cvt_pk_bf16_f32 v120, v96, v97
    v_exp_f32 v102, v102
    v_exp_f32 v103, v103
    v_cvt_pk_bf16_f32 v121, v98, v99
    v_mfma_f32_32x32x16_bf16 v[80:95], v[56:59], v[32:35], v[80:95]
    v_exp_f32 v104, v104
    v_exp_f32 v105, v105
    v_cvt_pk_bf16_f32 v122, v100, v101
    v_exp_f32 v106, v106
    v_exp_f32 v107, v107
    v_cvt_pk_bf16_f32 v123, v102, v103
    v_mfma_f32_32x32x16_bf16 v[160:175], v[76:79], v[116:119], v[160:175]
    v_exp_f32 v108, v108
    v_exp_f32 v109, v109
    v_cvt_pk_bf16_f32 v124, v104, v105
    v_exp_f32 v110, v110
    v_exp_f32 v111, v111
    v_cvt_pk_bf16_f32 v125, v106, v107
    v_mfma_f32_32x32x16_bf16 v[176:191], v[72:75], v[120:123], v[176:191]
    v_exp_f32 v80, v80
    v_exp_f32 v81, v81
    v_cvt_pk_bf16_f32 v126, v108, v109
    v_exp_f32 v82, v82
    v_exp_f32 v83, v83
    v_cvt_pk_bf16_f32 v127, v110, v111
    v_mfma_f32_32x32x16_bf16 v[96:111], v[48:51], v[20:23], 0
    v_exp_f32 v84, v84
    buffer_load_dwordx4 v[192:195], v4, s[48:51], s57 offen offset:2048
    v_exp_f32 v85, v85
    v_cvt_pk_bf16_f32 v112, v80, v81
    v_exp_f32 v86, v86
    v_exp_f32 v87, v87
    v_cvt_pk_bf16_f32 v113, v82, v83
    v_mfma_f32_32x32x16_bf16 v[96:111], v[56:59], v[36:39], v[96:111]
    v_exp_f32 v88, v88
    v_exp_f32 v89, v89
    v_cvt_pk_bf16_f32 v114, v84, v85
    v_exp_f32 v90, v90
    v_exp_f32 v91, v91
    v_cvt_pk_bf16_f32 v115, v86, v87
    v_mfma_f32_32x32x16_bf16 v[176:191], v[76:79], v[124:127], v[176:191]
    v_exp_f32 v92, v92
    v_exp_f32 v93, v93
    v_cvt_pk_bf16_f32 v116, v88, v89
    v_exp_f32 v94, v94
    v_exp_f32 v95, v95
    v_cvt_pk_bf16_f32 v117, v90, v91
    v_mfma_f32_32x32x16_bf16 v[128:143], v[64:67], v[112:115], v[128:143]
    ds_read_b128 v[52:55], v1 offset:15360
    ds_read_b32 v60, v2 offset:15360
    ds_read_b128 v[72:75], v3 offset:15360
    ds_read_b128 v[76:79], v3 offset:16000
    v_exp_f32 v96, v96
    v_exp_f32 v97, v97
    v_cvt_pk_bf16_f32 v118, v92, v93
    v_exp_f32 v98, v98
    buffer_load_dwordx4 v[196:199], v4, s[52:55], s58 offen
    v_exp_f32 v99, v99
    v_cvt_pk_bf16_f32 v119, v94, v95
    v_mfma_f32_32x32x16_bf16 v[80:95], v[48:51], v[24:27], 0
    v_exp_f32 v100, v100
    v_exp_f32 v101, v101
    v_cvt_pk_bf16_f32 v120, v96, v97
    v_exp_f32 v102, v102
    v_exp_f32 v103, v103
    v_cvt_pk_bf16_f32 v121, v98, v99
    v_mfma_f32_32x32x16_bf16 v[80:95], v[56:59], v[40:43], v[80:95]
    v_exp_f32 v104, v104
    v_exp_f32 v105, v105
    v_cvt_pk_bf16_f32 v122, v100, v101
    v_exp_f32 v106, v106
    v_exp_f32 v107, v107
    v_cvt_pk_bf16_f32 v123, v102, v103
    v_mfma_f32_32x32x16_bf16 v[128:143], v[68:71], v[116:119], v[128:143]
    v_exp_f32 v108, v108
    v_exp_f32 v109, v109
    v_cvt_pk_bf16_f32 v124, v104, v105
    v_exp_f32 v110, v110
    v_exp_f32 v111, v111
    v_cvt_pk_bf16_f32 v125, v106, v107
    v_mfma_f32_32x32x16_bf16 v[144:159], v[64:67], v[120:123], v[144:159]
    v_exp_f32 v80, v80
    v_exp_f32 v81, v81
    v_cvt_pk_bf16_f32 v126, v108, v109
    v_exp_f32 v82, v82
    v_exp_f32 v83, v83
    v_cvt_pk_bf16_f32 v127, v110, v111
    v_mfma_f32_32x32x16_bf16 v[96:111], v[48:51], v[28:31], 0
    v_exp_f32 v84, v84
    v_exp_f32 v85, v85
    v_cvt_pk_bf16_f32 v112, v80, v81
    v_exp_f32 v86, v86
    v_exp_f32 v87, v87
    v_cvt_pk_bf16_f32 v113, v82, v83
    v_mfma_f32_32x32x16_bf16 v[96:111], v[56:59], v[44:47], v[96:111]
    v_exp_f32 v88, v88
    v_exp_f32 v89, v89
    v_cvt_pk_bf16_f32 v114, v84, v85
    v_exp_f32 v90, v90
    v_exp_f32 v91, v91
    v_cvt_pk_bf16_f32 v115, v86, v87
    v_mfma_f32_32x32x16_bf16 v[144:159], v[68:71], v[124:127], v[144:159]
    v_exp_f32 v92, v92
    v_exp_f32 v93, v93
    v_cvt_pk_bf16_f32 v116, v88, v89
    v_exp_f32 v94, v94
    v_exp_f32 v95, v95
    v_cvt_pk_bf16_f32 v117, v90, v91
    s_waitcnt lgkmcnt(0)
    v_mfma_f32_32x32x16_bf16 v[160:175], v[64:67], v[112:115], v[160:175]
    v_exp_f32 v96, v96
    v_exp_f32 v97, v97
    v_cvt_pk_bf16_f32 v118, v92, v93
    v_exp_f32 v98, v98
    v_exp_f32 v99, v99
    v_cvt_pk_bf16_f32 v119, v94, v95
    v_mfma_f32_32x32x16_bf16 v[80:95], v[52:55], v[16:19], 0
    v_exp_f32 v100, v100
    v_exp_f32 v101, v101
    v_cvt_pk_bf16_f32 v120, v96, v97
    v_exp_f32 v102, v102
    v_exp_f32 v103, v103
    v_cvt_pk_bf16_f32 v121, v98, v99
    v_mfma_f32_32x32x16_bf16 v[80:95], v[60:63], v[32:35], v[80:95]
    v_exp_f32 v104, v104
    v_exp_f32 v105, v105
    v_cvt_pk_bf16_f32 v122, v100, v101
    v_exp_f32 v106, v106
    v_exp_f32 v107, v107
    v_cvt_pk_bf16_f32 v123, v102, v103
    v_mfma_f32_32x32x16_bf16 v[160:175], v[68:71], v[116:119], v[160:175]
    v_exp_f32 v108, v108
    v_exp_f32 v109, v109
    v_cvt_pk_bf16_f32 v124, v104, v105
    v_exp_f32 v110, v110
    v_exp_f32 v111, v111
    v_cvt_pk_bf16_f32 v125, v106, v107
    v_mfma_f32_32x32x16_bf16 v[176:191], v[64:67], v[120:123], v[176:191]
    v_exp_f32 v80, v80
    v_exp_f32 v81, v81
    v_cvt_pk_bf16_f32 v126, v108, v109
    v_exp_f32 v82, v82
    v_exp_f32 v83, v83
    v_cvt_pk_bf16_f32 v127, v110, v111
    v_mfma_f32_32x32x16_bf16 v[96:111], v[52:55], v[20:23], 0
    v_exp_f32 v84, v84
    v_exp_f32 v85, v85
    v_cvt_pk_bf16_f32 v112, v80, v81
    v_exp_f32 v86, v86
    v_exp_f32 v87, v87
    v_cvt_pk_bf16_f32 v113, v82, v83
    v_mfma_f32_32x32x16_bf16 v[96:111], v[60:63], v[36:39], v[96:111]
    v_exp_f32 v88, v88
    v_exp_f32 v89, v89
    v_cvt_pk_bf16_f32 v114, v84, v85
    v_exp_f32 v90, v90
    v_exp_f32 v91, v91
    v_cvt_pk_bf16_f32 v115, v86, v87
    v_mfma_f32_32x32x16_bf16 v[176:191], v[68:71], v[124:127], v[176:191]
    v_exp_f32 v92, v92
    v_exp_f32 v93, v93
    v_cvt_pk_bf16_f32 v116, v88, v89
    v_exp_f32 v94, v94
    v_exp_f32 v95, v95
    v_cvt_pk_bf16_f32 v117, v90, v91
    s_waitcnt vmcnt(5)
    s_barrier
    s_add_u32 s34, s34, 1
    s_cmp_eq_u32 s34, 3
    s_cselect_b32 s37, -40960, s36
    s_cselect_b32 s34, 0, s34
    v_add_u32 v1, s37, v1
    v_add_u32 v2, s37, v2
    v_add_u32 v3, s37, v3
    v_mfma_f32_32x32x16_bf16 v[128:143], v[72:75], v[112:115], v[128:143]
    ds_read_b128 v[48:51], v1 offset:0
    ds_read_b32 v56, v2 offset:0
    ds_read_b128 v[64:67], v3 offset:0
    ds_read_b128 v[68:71], v3 offset:640
    v_exp_f32 v96, v96
    v_exp_f32 v97, v97
    v_cvt_pk_bf16_f32 v118, v92, v93
    v_exp_f32 v98, v98
    s_mov_b32 m0, s28
    v_exp_f32 v99, v99
    v_cvt_pk_bf16_f32 v119, v94, v95
    buffer_load_dwordx4 v4, s[16:19], s26 offen offset:0 sc0 sc1 lds
    v_mfma_f32_32x32x16_bf16 v[80:95], v[52:55], v[24:27], 0
    v_exp_f32 v100, v100
    buffer_load_dwordx4 v4, s[16:19], s26 offen offset:1024 sc0 sc1 lds
    v_exp_f32 v101, v101
    v_cvt_pk_bf16_f32 v120, v96, v97
    buffer_load_dwordx4 v4, s[16:19], s26 offen offset:2048 sc0 sc1 lds
    v_exp_f32 v102, v102
    buffer_load_dwordx4 v4, s[16:19], s26 offen offset:3072 sc0 sc1 lds
    v_exp_f32 v103, v103
    v_cvt_pk_bf16_f32 v121, v98, v99
    s_add_u32 m0, s28, 4096
    v_mfma_f32_32x32x16_bf16 v[80:95], v[60:63], v[40:43], v[80:95]
    v_exp_f32 v104, v104
    s_add_u32 s29, s26, 4096
    v_exp_f32 v105, v105
    v_cvt_pk_bf16_f32 v122, v100, v101
    buffer_load_dwordx4 v4, s[16:19], s29 offen sc0 sc1 lds
    v_exp_f32 v106, v106
    s_add_u32 s26, s26, 20480
    v_exp_f32 v107, v107
    v_cvt_pk_bf16_f32 v123, v102, v103
    s_add_u32 s28, s28, 20480
    v_mfma_f32_32x32x16_bf16 v[128:143], v[76:79], v[116:119], v[128:143]
    v_exp_f32 v108, v108
    s_sub_u32 s29, s28, 61440
    v_exp_f32 v109, v109
    v_cvt_pk_bf16_f32 v124, v104, v105
    s_cmp_ge_u32 s28, 61440
    v_exp_f32 v110, v110
    s_cselect_b32 s28, s29, s28
    v_exp_f32 v111, v111
    v_cvt_pk_bf16_f32 v125, v106, v107
    v_mfma_f32_32x32x16_bf16 v[144:159], v[72:75], v[120:123], v[144:159]
    v_exp_f32 v80, v80
    v_exp_f32 v81, v81
    v_cvt_pk_bf16_f32 v126, v108, v109
    v_exp_f32 v82, v82
    v_exp_f32 v83, v83
    v_cvt_pk_bf16_f32 v127, v110, v111
    v_mfma_f32_32x32x16_bf16 v[96:111], v[52:55], v[28:31], 0
    v_exp_f32 v84, v84
    v_exp_f32 v85, v85
    v_cvt_pk_bf16_f32 v112, v80, v81
    v_exp_f32 v86, v86
    v_exp_f32 v87, v87
    v_cvt_pk_bf16_f32 v113, v82, v83
    v_mfma_f32_32x32x16_bf16 v[96:111], v[60:63], v[44:47], v[96:111]
    v_exp_f32 v88, v88
    v_exp_f32 v89, v89
    v_cvt_pk_bf16_f32 v114, v84, v85
    v_exp_f32 v90, v90
    v_exp_f32 v91, v91
    v_cvt_pk_bf16_f32 v115, v86, v87
    v_mfma_f32_32x32x16_bf16 v[144:159], v[76:79], v[124:127], v[144:159]
    v_exp_f32 v92, v92
    v_exp_f32 v93, v93
    v_cvt_pk_bf16_f32 v116, v88, v89
    v_exp_f32 v94, v94
    v_exp_f32 v95, v95
    v_cvt_pk_bf16_f32 v117, v90, v91
    s_waitcnt lgkmcnt(0)
    v_mfma_f32_32x32x16_bf16 v[160:175], v[72:75], v[112:115], v[160:175]
    v_exp_f32 v96, v96
    v_exp_f32 v97, v97
    v_cvt_pk_bf16_f32 v118, v92, v93
    v_exp_f32 v98, v98
    v_exp_f32 v99, v99
    v_cvt_pk_bf16_f32 v119, v94, v95
    v_mfma_f32_32x32x16_bf16 v[80:95], v[48:51], v[16:19], 0
    v_exp_f32 v100, v100
    v_exp_f32 v101, v101
    v_cvt_pk_bf16_f32 v120, v96, v97
    v_exp_f32 v102, v102
    v_exp_f32 v103, v103
    v_cvt_pk_bf16_f32 v121, v98, v99
    v_mfma_f32_32x32x16_bf16 v[80:95], v[56:59], v[32:35], v[80:95]
    v_exp_f32 v104, v104
    v_exp_f32 v105, v105
    v_cvt_pk_bf16_f32 v122, v100, v101
    v_exp_f32 v106, v106
    v_exp_f32 v107, v107
    v_cvt_pk_bf16_f32 v123, v102, v103
    v_mfma_f32_32x32x16_bf16 v[160:175], v[76:79], v[116:119], v[160:175]
    v_exp_f32 v108, v108
    v_exp_f32 v109, v109
    v_cvt_pk_bf16_f32 v124, v104, v105
    v_exp_f32 v110, v110
    v_exp_f32 v111, v111
    v_cvt_pk_bf16_f32 v125, v106, v107
    s_mov_b32 s65, 4
.p2align 6
gated_mix__mha_block__mixer_gmlp__prompt_kernel_a_al:
    v_mfma_f32_32x32x16_bf16 v[176:191], v[72:75], v[120:123], v[176:191]
    v_exp_f32 v80, v80
    v_exp_f32 v81, v81
    v_cvt_pk_bf16_f32 v126, v108, v109
    v_exp_f32 v82, v82
    v_exp_f32 v83, v83
    v_cvt_pk_bf16_f32 v127, v110, v111
    v_mfma_f32_32x32x16_bf16 v[96:111], v[48:51], v[20:23], 0
    v_exp_f32 v84, v84
    v_exp_f32 v85, v85
    v_cvt_pk_bf16_f32 v112, v80, v81
    v_exp_f32 v86, v86
    v_exp_f32 v87, v87
    v_cvt_pk_bf16_f32 v113, v82, v83
    v_mfma_f32_32x32x16_bf16 v[96:111], v[56:59], v[36:39], v[96:111]
    v_exp_f32 v88, v88
    v_exp_f32 v89, v89
    v_cvt_pk_bf16_f32 v114, v84, v85
    v_exp_f32 v90, v90
    v_exp_f32 v91, v91
    v_cvt_pk_bf16_f32 v115, v86, v87
    v_mfma_f32_32x32x16_bf16 v[176:191], v[76:79], v[124:127], v[176:191]
    v_exp_f32 v92, v92
    v_exp_f32 v93, v93
    v_cvt_pk_bf16_f32 v116, v88, v89
    v_exp_f32 v94, v94
    v_exp_f32 v95, v95
    v_cvt_pk_bf16_f32 v117, v90, v91
    v_mfma_f32_32x32x16_bf16 v[128:143], v[64:67], v[112:115], v[128:143]
    ds_read_b128 v[52:55], v1 offset:5120
    ds_read_b32 v60, v2 offset:5120
    ds_read_b128 v[72:75], v3 offset:5120
    ds_read_b128 v[76:79], v3 offset:5760
    v_exp_f32 v96, v96
    v_exp_f32 v97, v97
    v_cvt_pk_bf16_f32 v118, v92, v93
    v_exp_f32 v98, v98
    v_exp_f32 v99, v99
    v_cvt_pk_bf16_f32 v119, v94, v95
    v_mfma_f32_32x32x16_bf16 v[80:95], v[48:51], v[24:27], 0
    v_exp_f32 v100, v100
    v_exp_f32 v101, v101
    v_cvt_pk_bf16_f32 v120, v96, v97
    v_exp_f32 v102, v102
    v_exp_f32 v103, v103
    v_cvt_pk_bf16_f32 v121, v98, v99
    v_mfma_f32_32x32x16_bf16 v[80:95], v[56:59], v[40:43], v[80:95]
    v_exp_f32 v104, v104
    v_exp_f32 v105, v105
    v_cvt_pk_bf16_f32 v122, v100, v101
    v_exp_f32 v106, v106
    v_exp_f32 v107, v107
    v_cvt_pk_bf16_f32 v123, v102, v103
    v_mfma_f32_32x32x16_bf16 v[128:143], v[68:71], v[116:119], v[128:143]
    v_exp_f32 v108, v108
    v_exp_f32 v109, v109
    v_cvt_pk_bf16_f32 v124, v104, v105
    v_exp_f32 v110, v110
    v_exp_f32 v111, v111
    v_cvt_pk_bf16_f32 v125, v106, v107
    v_mfma_f32_32x32x16_bf16 v[144:159], v[64:67], v[120:123], v[144:159]
    v_exp_f32 v80, v80
    v_exp_f32 v81, v81
    v_cvt_pk_bf16_f32 v126, v108, v109
    v_exp_f32 v82, v82
    v_exp_f32 v83, v83
    v_cvt_pk_bf16_f32 v127, v110, v111
    v_mfma_f32_32x32x16_bf16 v[96:111], v[48:51], v[28:31], 0
    v_exp_f32 v84, v84
    v_exp_f32 v85, v85
    v_cvt_pk_bf16_f32 v112, v80, v81
    v_exp_f32 v86, v86
    v_exp_f32 v87, v87
    v_cvt_pk_bf16_f32 v113, v82, v83
    v_mfma_f32_32x32x16_bf16 v[96:111], v[56:59], v[44:47], v[96:111]
    v_exp_f32 v88, v88
    v_exp_f32 v89, v89
    v_cvt_pk_bf16_f32 v114, v84, v85
    v_exp_f32 v90, v90
    v_exp_f32 v91, v91
    v_cvt_pk_bf16_f32 v115, v86, v87
    v_mfma_f32_32x32x16_bf16 v[144:159], v[68:71], v[124:127], v[144:159]
    v_exp_f32 v92, v92
    v_exp_f32 v93, v93
    v_cvt_pk_bf16_f32 v116, v88, v89
    v_exp_f32 v94, v94
    v_exp_f32 v95, v95
    v_cvt_pk_bf16_f32 v117, v90, v91
    s_waitcnt lgkmcnt(0)
    v_mfma_f32_32x32x16_bf16 v[160:175], v[64:67], v[112:115], v[160:175]
    v_exp_f32 v96, v96
    v_exp_f32 v97, v97
    v_cvt_pk_bf16_f32 v118, v92, v93
    v_exp_f32 v98, v98
    v_exp_f32 v99, v99
    v_cvt_pk_bf16_f32 v119, v94, v95
    v_mfma_f32_32x32x16_bf16 v[80:95], v[52:55], v[16:19], 0
    v_exp_f32 v100, v100
    v_exp_f32 v101, v101
    v_cvt_pk_bf16_f32 v120, v96, v97
    v_exp_f32 v102, v102
    v_exp_f32 v103, v103
    v_cvt_pk_bf16_f32 v121, v98, v99
    v_mfma_f32_32x32x16_bf16 v[80:95], v[60:63], v[32:35], v[80:95]
    v_exp_f32 v104, v104
    v_exp_f32 v105, v105
    v_cvt_pk_bf16_f32 v122, v100, v101
    v_exp_f32 v106, v106
    v_exp_f32 v107, v107
    v_cvt_pk_bf16_f32 v123, v102, v103
    v_mfma_f32_32x32x16_bf16 v[160:175], v[68:71], v[116:119], v[160:175]
    v_exp_f32 v108, v108
    v_exp_f32 v109, v109
    v_cvt_pk_bf16_f32 v124, v104, v105
    v_exp_f32 v110, v110
    v_exp_f32 v111, v111
    v_cvt_pk_bf16_f32 v125, v106, v107
    v_mfma_f32_32x32x16_bf16 v[176:191], v[64:67], v[120:123], v[176:191]
    v_exp_f32 v80, v80
    v_exp_f32 v81, v81
    v_cvt_pk_bf16_f32 v126, v108, v109
    v_exp_f32 v82, v82
    v_exp_f32 v83, v83
    v_cvt_pk_bf16_f32 v127, v110, v111
    v_mfma_f32_32x32x16_bf16 v[96:111], v[52:55], v[20:23], 0
    v_exp_f32 v84, v84
    v_exp_f32 v85, v85
    v_cvt_pk_bf16_f32 v112, v80, v81
    v_exp_f32 v86, v86
    v_exp_f32 v87, v87
    v_cvt_pk_bf16_f32 v113, v82, v83
    v_mfma_f32_32x32x16_bf16 v[96:111], v[60:63], v[36:39], v[96:111]
    v_exp_f32 v88, v88
    v_exp_f32 v89, v89
    v_cvt_pk_bf16_f32 v114, v84, v85
    v_exp_f32 v90, v90
    v_exp_f32 v91, v91
    v_cvt_pk_bf16_f32 v115, v86, v87
    v_mfma_f32_32x32x16_bf16 v[176:191], v[68:71], v[124:127], v[176:191]
    v_exp_f32 v92, v92
    v_exp_f32 v93, v93
    v_cvt_pk_bf16_f32 v116, v88, v89
    v_exp_f32 v94, v94
    v_exp_f32 v95, v95
    v_cvt_pk_bf16_f32 v117, v90, v91
    v_mfma_f32_32x32x16_bf16 v[128:143], v[72:75], v[112:115], v[128:143]
    ds_read_b128 v[48:51], v1 offset:10240
    ds_read_b32 v56, v2 offset:10240
    ds_read_b128 v[64:67], v3 offset:10240
    ds_read_b128 v[68:71], v3 offset:10880
    v_exp_f32 v96, v96
    v_exp_f32 v97, v97
    v_cvt_pk_bf16_f32 v118, v92, v93
    v_exp_f32 v98, v98
    v_exp_f32 v99, v99
    v_cvt_pk_bf16_f32 v119, v94, v95
    v_mfma_f32_32x32x16_bf16 v[80:95], v[52:55], v[24:27], 0
    v_exp_f32 v100, v100
    v_exp_f32 v101, v101
    v_cvt_pk_bf16_f32 v120, v96, v97
    v_exp_f32 v102, v102
    v_exp_f32 v103, v103
    v_cvt_pk_bf16_f32 v121, v98, v99
    v_mfma_f32_32x32x16_bf16 v[80:95], v[60:63], v[40:43], v[80:95]
    v_exp_f32 v104, v104
    v_exp_f32 v105, v105
    v_cvt_pk_bf16_f32 v122, v100, v101
    v_exp_f32 v106, v106
    v_exp_f32 v107, v107
    v_cvt_pk_bf16_f32 v123, v102, v103
    v_mfma_f32_32x32x16_bf16 v[128:143], v[76:79], v[116:119], v[128:143]
    v_exp_f32 v108, v108
    v_exp_f32 v109, v109
    v_cvt_pk_bf16_f32 v124, v104, v105
    v_exp_f32 v110, v110
    v_exp_f32 v111, v111
    v_cvt_pk_bf16_f32 v125, v106, v107
    v_mfma_f32_32x32x16_bf16 v[144:159], v[72:75], v[120:123], v[144:159]
    v_exp_f32 v80, v80
    v_exp_f32 v81, v81
    v_cvt_pk_bf16_f32 v126, v108, v109
    v_exp_f32 v82, v82
    v_exp_f32 v83, v83
    v_cvt_pk_bf16_f32 v127, v110, v111
    v_mfma_f32_32x32x16_bf16 v[96:111], v[52:55], v[28:31], 0
    v_exp_f32 v84, v84
    v_exp_f32 v85, v85
    v_cvt_pk_bf16_f32 v112, v80, v81
    v_exp_f32 v86, v86
    v_exp_f32 v87, v87
    v_cvt_pk_bf16_f32 v113, v82, v83
    v_mfma_f32_32x32x16_bf16 v[96:111], v[60:63], v[44:47], v[96:111]
    v_exp_f32 v88, v88
    v_exp_f32 v89, v89
    v_cvt_pk_bf16_f32 v114, v84, v85
    v_exp_f32 v90, v90
    v_exp_f32 v91, v91
    v_cvt_pk_bf16_f32 v115, v86, v87
    v_mfma_f32_32x32x16_bf16 v[144:159], v[76:79], v[124:127], v[144:159]
    v_exp_f32 v92, v92
    v_exp_f32 v93, v93
    v_cvt_pk_bf16_f32 v116, v88, v89
    v_exp_f32 v94, v94
    v_exp_f32 v95, v95
    v_cvt_pk_bf16_f32 v117, v90, v91
    s_waitcnt lgkmcnt(0)
    v_mfma_f32_32x32x16_bf16 v[160:175], v[72:75], v[112:115], v[160:175]
    v_exp_f32 v96, v96
    v_exp_f32 v97, v97
    v_cvt_pk_bf16_f32 v118, v92, v93
    v_exp_f32 v98, v98
    v_exp_f32 v99, v99
    v_cvt_pk_bf16_f32 v119, v94, v95
    v_mfma_f32_32x32x16_bf16 v[80:95], v[48:51], v[16:19], 0
    v_exp_f32 v100, v100
    v_exp_f32 v101, v101
    v_cvt_pk_bf16_f32 v120, v96, v97
    v_exp_f32 v102, v102
    v_exp_f32 v103, v103
    v_cvt_pk_bf16_f32 v121, v98, v99
    v_mfma_f32_32x32x16_bf16 v[80:95], v[56:59], v[32:35], v[80:95]
    v_exp_f32 v104, v104
    v_exp_f32 v105, v105
    v_cvt_pk_bf16_f32 v122, v100, v101
    v_exp_f32 v106, v106
    v_exp_f32 v107, v107
    v_cvt_pk_bf16_f32 v123, v102, v103
    v_mfma_f32_32x32x16_bf16 v[160:175], v[76:79], v[116:119], v[160:175]
    v_exp_f32 v108, v108
    v_exp_f32 v109, v109
    v_cvt_pk_bf16_f32 v124, v104, v105
    v_exp_f32 v110, v110
    v_exp_f32 v111, v111
    v_cvt_pk_bf16_f32 v125, v106, v107
    v_mfma_f32_32x32x16_bf16 v[176:191], v[72:75], v[120:123], v[176:191]
    v_exp_f32 v80, v80
    v_exp_f32 v81, v81
    v_cvt_pk_bf16_f32 v126, v108, v109
    v_exp_f32 v82, v82
    v_exp_f32 v83, v83
    v_cvt_pk_bf16_f32 v127, v110, v111
    v_mfma_f32_32x32x16_bf16 v[96:111], v[48:51], v[20:23], 0
    v_exp_f32 v84, v84
    v_exp_f32 v85, v85
    v_cvt_pk_bf16_f32 v112, v80, v81
    v_exp_f32 v86, v86
    v_exp_f32 v87, v87
    v_cvt_pk_bf16_f32 v113, v82, v83
    v_mfma_f32_32x32x16_bf16 v[96:111], v[56:59], v[36:39], v[96:111]
    v_exp_f32 v88, v88
    v_exp_f32 v89, v89
    v_cvt_pk_bf16_f32 v114, v84, v85
    v_exp_f32 v90, v90
    v_exp_f32 v91, v91
    v_cvt_pk_bf16_f32 v115, v86, v87
    v_mfma_f32_32x32x16_bf16 v[176:191], v[76:79], v[124:127], v[176:191]
    v_exp_f32 v92, v92
    v_exp_f32 v93, v93
    v_cvt_pk_bf16_f32 v116, v88, v89
    v_exp_f32 v94, v94
    v_exp_f32 v95, v95
    v_cvt_pk_bf16_f32 v117, v90, v91
    v_mfma_f32_32x32x16_bf16 v[128:143], v[64:67], v[112:115], v[128:143]
    ds_read_b128 v[52:55], v1 offset:15360
    ds_read_b32 v60, v2 offset:15360
    ds_read_b128 v[72:75], v3 offset:15360
    ds_read_b128 v[76:79], v3 offset:16000
    v_exp_f32 v96, v96
    v_exp_f32 v97, v97
    v_cvt_pk_bf16_f32 v118, v92, v93
    v_exp_f32 v98, v98
    v_exp_f32 v99, v99
    v_cvt_pk_bf16_f32 v119, v94, v95
    v_mfma_f32_32x32x16_bf16 v[80:95], v[48:51], v[24:27], 0
    v_exp_f32 v100, v100
    v_exp_f32 v101, v101
    v_cvt_pk_bf16_f32 v120, v96, v97
    v_exp_f32 v102, v102
    v_exp_f32 v103, v103
    v_cvt_pk_bf16_f32 v121, v98, v99
    v_mfma_f32_32x32x16_bf16 v[80:95], v[56:59], v[40:43], v[80:95]
    v_exp_f32 v104, v104
    v_exp_f32 v105, v105
    v_cvt_pk_bf16_f32 v122, v100, v101
    v_exp_f32 v106, v106
    v_exp_f32 v107, v107
    v_cvt_pk_bf16_f32 v123, v102, v103
    v_mfma_f32_32x32x16_bf16 v[128:143], v[68:71], v[116:119], v[128:143]
    v_exp_f32 v108, v108
    v_exp_f32 v109, v109
    v_cvt_pk_bf16_f32 v124, v104, v105
    v_exp_f32 v110, v110
    v_exp_f32 v111, v111
    v_cvt_pk_bf16_f32 v125, v106, v107
    v_mfma_f32_32x32x16_bf16 v[144:159], v[64:67], v[120:123], v[144:159]
    v_exp_f32 v80, v80
    v_exp_f32 v81, v81
    v_cvt_pk_bf16_f32 v126, v108, v109
    v_exp_f32 v82, v82
    v_exp_f32 v83, v83
    v_cvt_pk_bf16_f32 v127, v110, v111
    v_mfma_f32_32x32x16_bf16 v[96:111], v[48:51], v[28:31], 0
    v_exp_f32 v84, v84
    v_exp_f32 v85, v85
    v_cvt_pk_bf16_f32 v112, v80, v81
    v_exp_f32 v86, v86
    v_exp_f32 v87, v87
    v_cvt_pk_bf16_f32 v113, v82, v83
    v_mfma_f32_32x32x16_bf16 v[96:111], v[56:59], v[44:47], v[96:111]
    v_exp_f32 v88, v88
    v_exp_f32 v89, v89
    v_cvt_pk_bf16_f32 v114, v84, v85
    v_exp_f32 v90, v90
    v_exp_f32 v91, v91
    v_cvt_pk_bf16_f32 v115, v86, v87
    v_mfma_f32_32x32x16_bf16 v[144:159], v[68:71], v[124:127], v[144:159]
    v_exp_f32 v92, v92
    v_exp_f32 v93, v93
    v_cvt_pk_bf16_f32 v116, v88, v89
    v_exp_f32 v94, v94
    v_exp_f32 v95, v95
    v_cvt_pk_bf16_f32 v117, v90, v91
    s_waitcnt lgkmcnt(0)
    v_mfma_f32_32x32x16_bf16 v[160:175], v[64:67], v[112:115], v[160:175]
    v_exp_f32 v96, v96
    v_exp_f32 v97, v97
    v_cvt_pk_bf16_f32 v118, v92, v93
    v_exp_f32 v98, v98
    v_exp_f32 v99, v99
    v_cvt_pk_bf16_f32 v119, v94, v95
    v_mfma_f32_32x32x16_bf16 v[80:95], v[52:55], v[16:19], 0
    v_exp_f32 v100, v100
    v_exp_f32 v101, v101
    v_cvt_pk_bf16_f32 v120, v96, v97
    v_exp_f32 v102, v102
    v_exp_f32 v103, v103
    v_cvt_pk_bf16_f32 v121, v98, v99
    v_mfma_f32_32x32x16_bf16 v[80:95], v[60:63], v[32:35], v[80:95]
    v_exp_f32 v104, v104
    v_exp_f32 v105, v105
    v_cvt_pk_bf16_f32 v122, v100, v101
    v_exp_f32 v106, v106
    v_exp_f32 v107, v107
    v_cvt_pk_bf16_f32 v123, v102, v103
    v_mfma_f32_32x32x16_bf16 v[160:175], v[68:71], v[116:119], v[160:175]
    v_exp_f32 v108, v108
    v_exp_f32 v109, v109
    v_cvt_pk_bf16_f32 v124, v104, v105
    v_exp_f32 v110, v110
    v_exp_f32 v111, v111
    v_cvt_pk_bf16_f32 v125, v106, v107
    v_mfma_f32_32x32x16_bf16 v[176:191], v[64:67], v[120:123], v[176:191]
    v_exp_f32 v80, v80
    v_exp_f32 v81, v81
    v_cvt_pk_bf16_f32 v126, v108, v109
    v_exp_f32 v82, v82
    v_exp_f32 v83, v83
    v_cvt_pk_bf16_f32 v127, v110, v111
    v_mfma_f32_32x32x16_bf16 v[96:111], v[52:55], v[20:23], 0
    v_exp_f32 v84, v84
    v_exp_f32 v85, v85
    v_cvt_pk_bf16_f32 v112, v80, v81
    v_exp_f32 v86, v86
    v_exp_f32 v87, v87
    v_cvt_pk_bf16_f32 v113, v82, v83
    v_mfma_f32_32x32x16_bf16 v[96:111], v[60:63], v[36:39], v[96:111]
    v_exp_f32 v88, v88
    v_exp_f32 v89, v89
    v_cvt_pk_bf16_f32 v114, v84, v85
    v_exp_f32 v90, v90
    v_exp_f32 v91, v91
    v_cvt_pk_bf16_f32 v115, v86, v87
    v_mfma_f32_32x32x16_bf16 v[176:191], v[68:71], v[124:127], v[176:191]
    v_exp_f32 v92, v92
    v_exp_f32 v93, v93
    v_cvt_pk_bf16_f32 v116, v88, v89
    v_exp_f32 v94, v94
    v_exp_f32 v95, v95
    v_cvt_pk_bf16_f32 v117, v90, v91
    s_waitcnt vmcnt(0)
    s_barrier
    s_add_u32 s34, s34, 1
    s_cmp_eq_u32 s34, 3
    s_cselect_b32 s37, -40960, s36
    s_cselect_b32 s34, 0, s34
    v_add_u32 v1, s37, v1
    v_add_u32 v2, s37, v2
    v_add_u32 v3, s37, v3
    v_mfma_f32_32x32x16_bf16 v[128:143], v[72:75], v[112:115], v[128:143]
    ds_read_b128 v[48:51], v1 offset:0
    ds_read_b32 v56, v2 offset:0
    ds_read_b128 v[64:67], v3 offset:0
    ds_read_b128 v[68:71], v3 offset:640
    v_exp_f32 v96, v96
    v_exp_f32 v97, v97
    v_cvt_pk_bf16_f32 v118, v92, v93
    v_exp_f32 v98, v98
    s_mov_b32 m0, s28
    v_exp_f32 v99, v99
    v_cvt_pk_bf16_f32 v119, v94, v95
    buffer_load_dwordx4 v4, s[16:19], s26 offen offset:0 sc0 sc1 lds
    v_mfma_f32_32x32x16_bf16 v[80:95], v[52:55], v[24:27], 0
    v_exp_f32 v100, v100
    buffer_load_dwordx4 v4, s[16:19], s26 offen offset:1024 sc0 sc1 lds
    v_exp_f32 v101, v101
    v_cvt_pk_bf16_f32 v120, v96, v97
    buffer_load_dwordx4 v4, s[16:19], s26 offen offset:2048 sc0 sc1 lds
    v_exp_f32 v102, v102
    buffer_load_dwordx4 v4, s[16:19], s26 offen offset:3072 sc0 sc1 lds
    v_exp_f32 v103, v103
    v_cvt_pk_bf16_f32 v121, v98, v99
    s_add_u32 m0, s28, 4096
    v_mfma_f32_32x32x16_bf16 v[80:95], v[60:63], v[40:43], v[80:95]
    v_exp_f32 v104, v104
    s_add_u32 s29, s26, 4096
    v_exp_f32 v105, v105
    v_cvt_pk_bf16_f32 v122, v100, v101
    buffer_load_dwordx4 v4, s[16:19], s29 offen sc0 sc1 lds
    v_exp_f32 v106, v106
    s_add_u32 s26, s26, 20480
    v_exp_f32 v107, v107
    v_cvt_pk_bf16_f32 v123, v102, v103
    s_add_u32 s28, s28, 20480
    v_mfma_f32_32x32x16_bf16 v[128:143], v[76:79], v[116:119], v[128:143]
    v_exp_f32 v108, v108
    s_sub_u32 s29, s28, 61440
    v_exp_f32 v109, v109
    v_cvt_pk_bf16_f32 v124, v104, v105
    s_cmp_ge_u32 s28, 61440
    v_exp_f32 v110, v110
    s_cselect_b32 s28, s29, s28
    v_exp_f32 v111, v111
    v_cvt_pk_bf16_f32 v125, v106, v107
    v_mfma_f32_32x32x16_bf16 v[144:159], v[72:75], v[120:123], v[144:159]
    v_exp_f32 v80, v80
    v_exp_f32 v81, v81
    v_cvt_pk_bf16_f32 v126, v108, v109
    v_exp_f32 v82, v82
    v_exp_f32 v83, v83
    v_cvt_pk_bf16_f32 v127, v110, v111
    v_mfma_f32_32x32x16_bf16 v[96:111], v[52:55], v[28:31], 0
    v_exp_f32 v84, v84
    v_exp_f32 v85, v85
    v_cvt_pk_bf16_f32 v112, v80, v81
    v_exp_f32 v86, v86
    v_exp_f32 v87, v87
    v_cvt_pk_bf16_f32 v113, v82, v83
    v_mfma_f32_32x32x16_bf16 v[96:111], v[60:63], v[44:47], v[96:111]
    v_exp_f32 v88, v88
    v_exp_f32 v89, v89
    v_cvt_pk_bf16_f32 v114, v84, v85
    v_exp_f32 v90, v90
    v_exp_f32 v91, v91
    v_cvt_pk_bf16_f32 v115, v86, v87
    v_mfma_f32_32x32x16_bf16 v[144:159], v[76:79], v[124:127], v[144:159]
    v_exp_f32 v92, v92
    v_exp_f32 v93, v93
    v_cvt_pk_bf16_f32 v116, v88, v89
    v_exp_f32 v94, v94
    v_exp_f32 v95, v95
    v_cvt_pk_bf16_f32 v117, v90, v91
    s_waitcnt lgkmcnt(0)
    v_mfma_f32_32x32x16_bf16 v[160:175], v[72:75], v[112:115], v[160:175]
    v_exp_f32 v96, v96
    v_exp_f32 v97, v97
    v_cvt_pk_bf16_f32 v118, v92, v93
    v_exp_f32 v98, v98
    v_exp_f32 v99, v99
    v_cvt_pk_bf16_f32 v119, v94, v95
    v_mfma_f32_32x32x16_bf16 v[80:95], v[48:51], v[16:19], 0
    v_exp_f32 v100, v100
    v_exp_f32 v101, v101
    v_cvt_pk_bf16_f32 v120, v96, v97
    v_exp_f32 v102, v102
    v_exp_f32 v103, v103
    v_cvt_pk_bf16_f32 v121, v98, v99
    v_mfma_f32_32x32x16_bf16 v[80:95], v[56:59], v[32:35], v[80:95]
    v_exp_f32 v104, v104
    v_exp_f32 v105, v105
    v_cvt_pk_bf16_f32 v122, v100, v101
    v_exp_f32 v106, v106
    v_exp_f32 v107, v107
    v_cvt_pk_bf16_f32 v123, v102, v103
    v_mfma_f32_32x32x16_bf16 v[160:175], v[76:79], v[116:119], v[160:175]
    v_exp_f32 v108, v108
    v_exp_f32 v109, v109
    v_cvt_pk_bf16_f32 v124, v104, v105
    v_exp_f32 v110, v110
    v_exp_f32 v111, v111
    v_cvt_pk_bf16_f32 v125, v106, v107
    s_sub_u32 s65, s65, 1
    s_cmp_lg_u32 s65, 0
    s_cbranch_scc1 gated_mix__mha_block__mixer_gmlp__prompt_kernel_a_al
    v_mfma_f32_32x32x16_bf16 v[176:191], v[72:75], v[120:123], v[176:191]
    v_exp_f32 v80, v80
    v_exp_f32 v81, v81
    v_cvt_pk_bf16_f32 v126, v108, v109
    v_exp_f32 v82, v82
    v_exp_f32 v83, v83
    v_cvt_pk_bf16_f32 v127, v110, v111
    v_mfma_f32_32x32x16_bf16 v[96:111], v[48:51], v[20:23], 0
    v_exp_f32 v84, v84
    v_exp_f32 v85, v85
    v_cvt_pk_bf16_f32 v112, v80, v81
    v_exp_f32 v86, v86
    v_exp_f32 v87, v87
    v_cvt_pk_bf16_f32 v113, v82, v83
    v_mfma_f32_32x32x16_bf16 v[96:111], v[56:59], v[36:39], v[96:111]
    v_exp_f32 v88, v88
    v_exp_f32 v89, v89
    v_cvt_pk_bf16_f32 v114, v84, v85
    v_exp_f32 v90, v90
    v_exp_f32 v91, v91
    v_cvt_pk_bf16_f32 v115, v86, v87
    v_mfma_f32_32x32x16_bf16 v[176:191], v[76:79], v[124:127], v[176:191]
    v_exp_f32 v92, v92
    v_exp_f32 v93, v93
    v_cvt_pk_bf16_f32 v116, v88, v89
    v_exp_f32 v94, v94
    v_exp_f32 v95, v95
    v_cvt_pk_bf16_f32 v117, v90, v91
    v_mfma_f32_32x32x16_bf16 v[128:143], v[64:67], v[112:115], v[128:143]
    ds_read_b128 v[52:55], v1 offset:5120
    ds_read_b32 v60, v2 offset:5120
    ds_read_b128 v[72:75], v3 offset:5120
    ds_read_b128 v[76:79], v3 offset:5760
    v_exp_f32 v96, v96
    v_exp_f32 v97, v97
    v_cvt_pk_bf16_f32 v118, v92, v93
    v_exp_f32 v98, v98
    v_exp_f32 v99, v99
    v_cvt_pk_bf16_f32 v119, v94, v95
    v_mfma_f32_32x32x16_bf16 v[80:95], v[48:51], v[24:27], 0
    v_exp_f32 v100, v100
    v_exp_f32 v101, v101
    v_cvt_pk_bf16_f32 v120, v96, v97
    v_exp_f32 v102, v102
    v_exp_f32 v103, v103
    v_cvt_pk_bf16_f32 v121, v98, v99
    v_mfma_f32_32x32x16_bf16 v[80:95], v[56:59], v[40:43], v[80:95]
    v_exp_f32 v104, v104
    v_exp_f32 v105, v105
    v_cvt_pk_bf16_f32 v122, v100, v101
    v_exp_f32 v106, v106
    v_exp_f32 v107, v107
    v_cvt_pk_bf16_f32 v123, v102, v103
    v_mfma_f32_32x32x16_bf16 v[128:143], v[68:71], v[116:119], v[128:143]
    v_exp_f32 v108, v108
    v_exp_f32 v109, v109
    v_cvt_pk_bf16_f32 v124, v104, v105
    v_exp_f32 v110, v110
    v_exp_f32 v111, v111
    v_cvt_pk_bf16_f32 v125, v106, v107
    v_mfma_f32_32x32x16_bf16 v[144:159], v[64:67], v[120:123], v[144:159]
    v_exp_f32 v80, v80
    v_exp_f32 v81, v81
    v_cvt_pk_bf16_f32 v126, v108, v109
    v_exp_f32 v82, v82
    v_exp_f32 v83, v83
    v_cvt_pk_bf16_f32 v127, v110, v111
    v_mfma_f32_32x32x16_bf16 v[96:111], v[48:51], v[28:31], 0
    v_exp_f32 v84, v84
    v_exp_f32 v85, v85
    v_cvt_pk_bf16_f32 v112, v80, v81
    v_exp_f32 v86, v86
    v_exp_f32 v87, v87
    v_cvt_pk_bf16_f32 v113, v82, v83
    v_mfma_f32_32x32x16_bf16 v[96:111], v[56:59], v[44:47], v[96:111]
    v_exp_f32 v88, v88
    v_exp_f32 v89, v89
    v_cvt_pk_bf16_f32 v114, v84, v85
    v_exp_f32 v90, v90
    v_exp_f32 v91, v91
    v_cvt_pk_bf16_f32 v115, v86, v87
    v_mfma_f32_32x32x16_bf16 v[144:159], v[68:71], v[124:127], v[144:159]
    v_exp_f32 v92, v92
    v_exp_f32 v93, v93
    v_cvt_pk_bf16_f32 v116, v88, v89
    v_exp_f32 v94, v94
    v_exp_f32 v95, v95
    v_cvt_pk_bf16_f32 v117, v90, v91
    s_waitcnt lgkmcnt(0)
    v_mfma_f32_32x32x16_bf16 v[160:175], v[64:67], v[112:115], v[160:175]
    v_exp_f32 v96, v96
    v_exp_f32 v97, v97
    v_cvt_pk_bf16_f32 v118, v92, v93
    v_exp_f32 v98, v98
    v_exp_f32 v99, v99
    v_cvt_pk_bf16_f32 v119, v94, v95
    v_mfma_f32_32x32x16_bf16 v[80:95], v[52:55], v[16:19], 0
    v_exp_f32 v100, v100
    v_exp_f32 v101, v101
    v_cvt_pk_bf16_f32 v120, v96, v97
    v_exp_f32 v102, v102
    v_exp_f32 v103, v103
    v_cvt_pk_bf16_f32 v121, v98, v99
    v_mfma_f32_32x32x16_bf16 v[80:95], v[60:63], v[32:35], v[80:95]
    v_exp_f32 v104, v104
    v_exp_f32 v105, v105
    v_cvt_pk_bf16_f32 v122, v100, v101
    v_exp_f32 v106, v106
    v_exp_f32 v107, v107
    v_cvt_pk_bf16_f32 v123, v102, v103
    v_mfma_f32_32x32x16_bf16 v[160:175], v[68:71], v[116:119], v[160:175]
    v_exp_f32 v108, v108
    v_exp_f32 v109, v109
    v_cvt_pk_bf16_f32 v124, v104, v105
    v_exp_f32 v110, v110
    v_exp_f32 v111, v111
    v_cvt_pk_bf16_f32 v125, v106, v107
    v_mfma_f32_32x32x16_bf16 v[176:191], v[64:67], v[120:123], v[176:191]
    v_exp_f32 v80, v80
    v_exp_f32 v81, v81
    v_cvt_pk_bf16_f32 v126, v108, v109
    v_exp_f32 v82, v82
    v_exp_f32 v83, v83
    v_cvt_pk_bf16_f32 v127, v110, v111
    v_mfma_f32_32x32x16_bf16 v[96:111], v[52:55], v[20:23], 0
    v_exp_f32 v84, v84
    v_exp_f32 v85, v85
    v_cvt_pk_bf16_f32 v112, v80, v81
    v_exp_f32 v86, v86
    v_exp_f32 v87, v87
    v_cvt_pk_bf16_f32 v113, v82, v83
    v_mfma_f32_32x32x16_bf16 v[96:111], v[60:63], v[36:39], v[96:111]
    v_exp_f32 v88, v88
    v_exp_f32 v89, v89
    v_cvt_pk_bf16_f32 v114, v84, v85
    v_exp_f32 v90, v90
    v_exp_f32 v91, v91
    v_cvt_pk_bf16_f32 v115, v86, v87
    v_mfma_f32_32x32x16_bf16 v[176:191], v[68:71], v[124:127], v[176:191]
    v_exp_f32 v92, v92
    v_exp_f32 v93, v93
    v_cvt_pk_bf16_f32 v116, v88, v89
    v_exp_f32 v94, v94
    v_exp_f32 v95, v95
    v_cvt_pk_bf16_f32 v117, v90, v91
    v_mfma_f32_32x32x16_bf16 v[128:143], v[72:75], v[112:115], v[128:143]
    ds_read_b128 v[48:51], v1 offset:10240
    ds_read_b32 v56, v2 offset:10240
    ds_read_b128 v[64:67], v3 offset:10240
    ds_read_b128 v[68:71], v3 offset:10880
    v_exp_f32 v96, v96
    v_exp_f32 v97, v97
    v_cvt_pk_bf16_f32 v118, v92, v93
    v_exp_f32 v98, v98
    v_exp_f32 v99, v99
    v_cvt_pk_bf16_f32 v119, v94, v95
    v_mfma_f32_32x32x16_bf16 v[80:95], v[52:55], v[24:27], 0
    v_exp_f32 v100, v100
    v_exp_f32 v101, v101
    v_cvt_pk_bf16_f32 v120, v96, v97
    v_exp_f32 v102, v102
    v_exp_f32 v103, v103
    v_cvt_pk_bf16_f32 v121, v98, v99
    v_mfma_f32_32x32x16_bf16 v[80:95], v[60:63], v[40:43], v[80:95]
    v_exp_f32 v104, v104
    v_exp_f32 v105, v105
    v_cvt_pk_bf16_f32 v122, v100, v101
    v_exp_f32 v106, v106
    v_exp_f32 v107, v107
    v_cvt_pk_bf16_f32 v123, v102, v103
    v_mfma_f32_32x32x16_bf16 v[128:143], v[76:79], v[116:119], v[128:143]
    v_exp_f32 v108, v108
    v_exp_f32 v109, v109
    v_cvt_pk_bf16_f32 v124, v104, v105
    v_exp_f32 v110, v110
    v_exp_f32 v111, v111
    v_cvt_pk_bf16_f32 v125, v106, v107
    v_mfma_f32_32x32x16_bf16 v[144:159], v[72:75], v[120:123], v[144:159]
    v_exp_f32 v80, v80
    v_exp_f32 v81, v81
    v_cvt_pk_bf16_f32 v126, v108, v109
    v_exp_f32 v82, v82
    v_exp_f32 v83, v83
    v_cvt_pk_bf16_f32 v127, v110, v111
    v_mfma_f32_32x32x16_bf16 v[96:111], v[52:55], v[28:31], 0
    v_exp_f32 v84, v84
    v_exp_f32 v85, v85
    v_cvt_pk_bf16_f32 v112, v80, v81
    v_exp_f32 v86, v86
    v_exp_f32 v87, v87
    v_cvt_pk_bf16_f32 v113, v82, v83
    v_mfma_f32_32x32x16_bf16 v[96:111], v[60:63], v[44:47], v[96:111]
    v_exp_f32 v88, v88
    v_exp_f32 v89, v89
    v_cvt_pk_bf16_f32 v114, v84, v85
    v_exp_f32 v90, v90
    v_exp_f32 v91, v91
    v_cvt_pk_bf16_f32 v115, v86, v87
    v_mfma_f32_32x32x16_bf16 v[144:159], v[76:79], v[124:127], v[144:159]
    v_exp_f32 v92, v92
    v_exp_f32 v93, v93
    v_cvt_pk_bf16_f32 v116, v88, v89
    v_exp_f32 v94, v94
    v_exp_f32 v95, v95
    v_cvt_pk_bf16_f32 v117, v90, v91
    s_waitcnt lgkmcnt(0)
    v_mfma_f32_32x32x16_bf16 v[160:175], v[72:75], v[112:115], v[160:175]
    v_exp_f32 v96, v96
    v_exp_f32 v97, v97
    v_cvt_pk_bf16_f32 v118, v92, v93
    v_exp_f32 v98, v98
    v_exp_f32 v99, v99
    v_cvt_pk_bf16_f32 v119, v94, v95
    v_mfma_f32_32x32x16_bf16 v[80:95], v[48:51], v[16:19], 0
    v_exp_f32 v100, v100
    v_exp_f32 v101, v101
    v_cvt_pk_bf16_f32 v120, v96, v97
    v_exp_f32 v102, v102
    v_exp_f32 v103, v103
    v_cvt_pk_bf16_f32 v121, v98, v99
    v_mfma_f32_32x32x16_bf16 v[80:95], v[56:59], v[32:35], v[80:95]
    v_exp_f32 v104, v104
    v_exp_f32 v105, v105
    v_cvt_pk_bf16_f32 v122, v100, v101
    v_exp_f32 v106, v106
    v_exp_f32 v107, v107
    v_cvt_pk_bf16_f32 v123, v102, v103
    v_mfma_f32_32x32x16_bf16 v[160:175], v[76:79], v[116:119], v[160:175]
    v_exp_f32 v108, v108
    v_exp_f32 v109, v109
    v_cvt_pk_bf16_f32 v124, v104, v105
    v_exp_f32 v110, v110
    v_exp_f32 v111, v111
    v_cvt_pk_bf16_f32 v125, v106, v107
    v_mfma_f32_32x32x16_bf16 v[176:191], v[72:75], v[120:123], v[176:191]
    v_exp_f32 v80, v80
    v_exp_f32 v81, v81
    v_cvt_pk_bf16_f32 v126, v108, v109
    v_exp_f32 v82, v82
    v_exp_f32 v83, v83
    v_cvt_pk_bf16_f32 v127, v110, v111
    v_mfma_f32_32x32x16_bf16 v[96:111], v[48:51], v[20:23], 0
    v_exp_f32 v84, v84
    v_exp_f32 v85, v85
    v_cvt_pk_bf16_f32 v112, v80, v81
    v_exp_f32 v86, v86
    v_exp_f32 v87, v87
    v_cvt_pk_bf16_f32 v113, v82, v83
    v_mfma_f32_32x32x16_bf16 v[96:111], v[56:59], v[36:39], v[96:111]
    v_exp_f32 v88, v88
    v_exp_f32 v89, v89
    v_cvt_pk_bf16_f32 v114, v84, v85
    v_exp_f32 v90, v90
    v_exp_f32 v91, v91
    v_cvt_pk_bf16_f32 v115, v86, v87
    v_mfma_f32_32x32x16_bf16 v[176:191], v[76:79], v[124:127], v[176:191]
    v_exp_f32 v92, v92
    v_exp_f32 v93, v93
    v_cvt_pk_bf16_f32 v116, v88, v89
    v_exp_f32 v94, v94
    v_exp_f32 v95, v95
    v_cvt_pk_bf16_f32 v117, v90, v91
    v_mfma_f32_32x32x16_bf16 v[128:143], v[64:67], v[112:115], v[128:143]
    ds_read_b128 v[52:55], v1 offset:15360
    ds_read_b32 v60, v2 offset:15360
    ds_read_b128 v[72:75], v3 offset:15360
    ds_read_b128 v[76:79], v3 offset:16000
    v_exp_f32 v96, v96
    v_exp_f32 v97, v97
    v_cvt_pk_bf16_f32 v118, v92, v93
    v_exp_f32 v98, v98
    v_exp_f32 v99, v99
    v_cvt_pk_bf16_f32 v119, v94, v95
    v_mfma_f32_32x32x16_bf16 v[80:95], v[48:51], v[24:27], 0
    v_exp_f32 v100, v100
    v_exp_f32 v101, v101
    v_cvt_pk_bf16_f32 v120, v96, v97
    v_exp_f32 v102, v102
    v_exp_f32 v103, v103
    v_cvt_pk_bf16_f32 v121, v98, v99
    v_mfma_f32_32x32x16_bf16 v[80:95], v[56:59], v[40:43], v[80:95]
    v_exp_f32 v104, v104
    v_exp_f32 v105, v105
    v_cvt_pk_bf16_f32 v122, v100, v101
    v_exp_f32 v106, v106
    v_exp_f32 v107, v107
    v_cvt_pk_bf16_f32 v123, v102, v103
    v_mfma_f32_32x32x16_bf16 v[128:143], v[68:71], v[116:119], v[128:143]
    v_exp_f32 v108, v108
    v_exp_f32 v109, v109
    v_cvt_pk_bf16_f32 v124, v104, v105
    v_exp_f32 v110, v110
    v_exp_f32 v111, v111
    v_cvt_pk_bf16_f32 v125, v106, v107
    v_mfma_f32_32x32x16_bf16 v[144:159], v[64:67], v[120:123], v[144:159]
    v_exp_f32 v80, v80
    v_exp_f32 v81, v81
    v_cvt_pk_bf16_f32 v126, v108, v109
    v_exp_f32 v82, v82
    v_exp_f32 v83, v83
    v_cvt_pk_bf16_f32 v127, v110, v111
    v_mfma_f32_32x32x16_bf16 v[96:111], v[48:51], v[28:31], 0
    v_exp_f32 v84, v84
    v_exp_f32 v85, v85
    v_cvt_pk_bf16_f32 v112, v80, v81
    v_exp_f32 v86, v86
    v_exp_f32 v87, v87
    v_cvt_pk_bf16_f32 v113, v82, v83
    v_mfma_f32_32x32x16_bf16 v[96:111], v[56:59], v[44:47], v[96:111]
    v_exp_f32 v88, v88
    v_exp_f32 v89, v89
    v_cvt_pk_bf16_f32 v114, v84, v85
    v_exp_f32 v90, v90
    v_exp_f32 v91, v91
    v_cvt_pk_bf16_f32 v115, v86, v87
    v_mfma_f32_32x32x16_bf16 v[144:159], v[68:71], v[124:127], v[144:159]
    v_exp_f32 v92, v92
    v_exp_f32 v93, v93
    v_cvt_pk_bf16_f32 v116, v88, v89
    v_exp_f32 v94, v94
    v_exp_f32 v95, v95
    v_cvt_pk_bf16_f32 v117, v90, v91
    s_waitcnt lgkmcnt(0)
    v_mfma_f32_32x32x16_bf16 v[160:175], v[64:67], v[112:115], v[160:175]
    v_exp_f32 v96, v96
    v_exp_f32 v97, v97
    v_cvt_pk_bf16_f32 v118, v92, v93
    v_exp_f32 v98, v98
    v_exp_f32 v99, v99
    v_cvt_pk_bf16_f32 v119, v94, v95
    v_mfma_f32_32x32x16_bf16 v[80:95], v[52:55], v[16:19], 0
    v_exp_f32 v100, v100
    v_exp_f32 v101, v101
    v_cvt_pk_bf16_f32 v120, v96, v97
    v_exp_f32 v102, v102
    v_exp_f32 v103, v103
    v_cvt_pk_bf16_f32 v121, v98, v99
    v_mfma_f32_32x32x16_bf16 v[80:95], v[60:63], v[32:35], v[80:95]
    v_exp_f32 v104, v104
    v_exp_f32 v105, v105
    v_cvt_pk_bf16_f32 v122, v100, v101
    v_exp_f32 v106, v106
    v_exp_f32 v107, v107
    v_cvt_pk_bf16_f32 v123, v102, v103
    v_mfma_f32_32x32x16_bf16 v[160:175], v[68:71], v[116:119], v[160:175]
    v_exp_f32 v108, v108
    v_exp_f32 v109, v109
    v_cvt_pk_bf16_f32 v124, v104, v105
    v_exp_f32 v110, v110
    v_exp_f32 v111, v111
    v_cvt_pk_bf16_f32 v125, v106, v107
    v_mfma_f32_32x32x16_bf16 v[176:191], v[64:67], v[120:123], v[176:191]
    v_exp_f32 v80, v80
    v_exp_f32 v81, v81
    v_cvt_pk_bf16_f32 v126, v108, v109
    v_exp_f32 v82, v82
    v_exp_f32 v83, v83
    v_cvt_pk_bf16_f32 v127, v110, v111
    v_mfma_f32_32x32x16_bf16 v[96:111], v[52:55], v[20:23], 0
    v_exp_f32 v84, v84
    v_exp_f32 v85, v85
    v_cvt_pk_bf16_f32 v112, v80, v81
    v_exp_f32 v86, v86
    v_exp_f32 v87, v87
    v_cvt_pk_bf16_f32 v113, v82, v83
    v_mfma_f32_32x32x16_bf16 v[96:111], v[60:63], v[36:39], v[96:111]
    v_exp_f32 v88, v88
    v_exp_f32 v89, v89
    v_cvt_pk_bf16_f32 v114, v84, v85
    v_exp_f32 v90, v90
    v_exp_f32 v91, v91
    v_cvt_pk_bf16_f32 v115, v86, v87
    v_mfma_f32_32x32x16_bf16 v[176:191], v[68:71], v[124:127], v[176:191]
    v_exp_f32 v92, v92
    v_exp_f32 v93, v93
    v_cvt_pk_bf16_f32 v116, v88, v89
    v_exp_f32 v94, v94
    v_exp_f32 v95, v95
    v_cvt_pk_bf16_f32 v117, v90, v91
    s_waitcnt vmcnt(0)
    s_barrier
    s_add_u32 s34, s34, 1
    s_cmp_eq_u32 s34, 3
    s_cselect_b32 s37, -40960, s36
    s_cselect_b32 s34, 0, s34
    v_add_u32 v1, s37, v1
    v_add_u32 v2, s37, v2
    v_add_u32 v3, s37, v3
    v_mfma_f32_32x32x16_bf16 v[128:143], v[72:75], v[112:115], v[128:143]
    ds_read_b128 v[48:51], v1 offset:0
    ds_read_b32 v56, v2 offset:0
    ds_read_b128 v[64:67], v3 offset:0
    ds_read_b128 v[68:71], v3 offset:640
    v_exp_f32 v96, v96
    v_exp_f32 v97, v97
    v_cvt_pk_bf16_f32 v118, v92, v93
    v_exp_f32 v98, v98
    v_exp_f32 v99, v99
    v_cvt_pk_bf16_f32 v119, v94, v95
    v_mfma_f32_32x32x16_bf16 v[80:95], v[52:55], v[24:27], 0
    v_exp_f32 v100, v100
    v_exp_f32 v101, v101
    v_cvt_pk_bf16_f32 v120, v96, v97
    v_exp_f32 v102, v102
    v_exp_f32 v103, v103
    v_cvt_pk_bf16_f32 v121, v98, v99
    v_mfma_f32_32x32x16_bf16 v[80:95], v[60:63], v[40:43], v[80:95]
    v_exp_f32 v104, v104
    v_exp_f32 v105, v105
    v_cvt_pk_bf16_f32 v122, v100, v101
    v_exp_f32 v106, v106
    v_exp_f32 v107, v107
    v_cvt_pk_bf16_f32 v123, v102, v103
    v_mfma_f32_32x32x16_bf16 v[128:143], v[76:79], v[116:119], v[128:143]
    v_exp_f32 v108, v108
    v_exp_f32 v109, v109
    v_cvt_pk_bf16_f32 v124, v104, v105
    v_exp_f32 v110, v110
    v_exp_f32 v111, v111
    v_cvt_pk_bf16_f32 v125, v106, v107
    v_mfma_f32_32x32x16_bf16 v[144:159], v[72:75], v[120:123], v[144:159]
    v_exp_f32 v80, v80
    v_exp_f32 v81, v81
    v_cvt_pk_bf16_f32 v126, v108, v109
    v_exp_f32 v82, v82
    v_exp_f32 v83, v83
    v_cvt_pk_bf16_f32 v127, v110, v111
    v_mfma_f32_32x32x16_bf16 v[96:111], v[52:55], v[28:31], 0
    v_exp_f32 v84, v84
    v_exp_f32 v85, v85
    v_cvt_pk_bf16_f32 v112, v80, v81
    v_exp_f32 v86, v86
    v_exp_f32 v87, v87
    v_cvt_pk_bf16_f32 v113, v82, v83
    v_mfma_f32_32x32x16_bf16 v[96:111], v[60:63], v[44:47], v[96:111]
    v_exp_f32 v88, v88
    v_exp_f32 v89, v89
    v_cvt_pk_bf16_f32 v114, v84, v85
    v_exp_f32 v90, v90
    v_exp_f32 v91, v91
    v_cvt_pk_bf16_f32 v115, v86, v87
    v_mfma_f32_32x32x16_bf16 v[144:159], v[76:79], v[124:127], v[144:159]
    v_exp_f32 v92, v92
    v_exp_f32 v93, v93
    v_cvt_pk_bf16_f32 v116, v88, v89
    v_exp_f32 v94, v94
    v_exp_f32 v95, v95
    v_cvt_pk_bf16_f32 v117, v90, v91
    s_waitcnt lgkmcnt(0)
    v_mfma_f32_32x32x16_bf16 v[160:175], v[72:75], v[112:115], v[160:175]
    v_exp_f32 v96, v96
    v_exp_f32 v97, v97
    v_cvt_pk_bf16_f32 v118, v92, v93
    v_exp_f32 v98, v98
    v_exp_f32 v99, v99
    v_cvt_pk_bf16_f32 v119, v94, v95
    v_mfma_f32_32x32x16_bf16 v[80:95], v[48:51], v[16:19], 0
    v_exp_f32 v100, v100
    v_exp_f32 v101, v101
    v_cvt_pk_bf16_f32 v120, v96, v97
    v_exp_f32 v102, v102
    v_exp_f32 v103, v103
    v_cvt_pk_bf16_f32 v121, v98, v99
    v_mfma_f32_32x32x16_bf16 v[80:95], v[56:59], v[32:35], v[80:95]
    v_exp_f32 v104, v104
    v_exp_f32 v105, v105
    v_cvt_pk_bf16_f32 v122, v100, v101
    v_exp_f32 v106, v106
    v_exp_f32 v107, v107
    v_cvt_pk_bf16_f32 v123, v102, v103
    v_mfma_f32_32x32x16_bf16 v[160:175], v[76:79], v[116:119], v[160:175]
    v_exp_f32 v108, v108
    v_exp_f32 v109, v109
    v_cvt_pk_bf16_f32 v124, v104, v105
    v_exp_f32 v110, v110
    v_exp_f32 v111, v111
    v_cvt_pk_bf16_f32 v125, v106, v107
    v_mfma_f32_32x32x16_bf16 v[176:191], v[72:75], v[120:123], v[176:191]
    v_exp_f32 v80, v80
    v_exp_f32 v81, v81
    v_cvt_pk_bf16_f32 v126, v108, v109
    v_exp_f32 v82, v82
    v_exp_f32 v83, v83
    v_cvt_pk_bf16_f32 v127, v110, v111
    v_mfma_f32_32x32x16_bf16 v[96:111], v[48:51], v[20:23], 0
    v_exp_f32 v84, v84
    v_exp_f32 v85, v85
    v_cvt_pk_bf16_f32 v112, v80, v81
    v_exp_f32 v86, v86
    v_exp_f32 v87, v87
    v_cvt_pk_bf16_f32 v113, v82, v83
    v_mfma_f32_32x32x16_bf16 v[96:111], v[56:59], v[36:39], v[96:111]
    v_exp_f32 v88, v88
    v_exp_f32 v89, v89
    v_cvt_pk_bf16_f32 v114, v84, v85
    v_exp_f32 v90, v90
    v_exp_f32 v91, v91
    v_cvt_pk_bf16_f32 v115, v86, v87
    v_mfma_f32_32x32x16_bf16 v[176:191], v[76:79], v[124:127], v[176:191]
    v_exp_f32 v92, v92
    v_exp_f32 v93, v93
    v_cvt_pk_bf16_f32 v116, v88, v89
    v_exp_f32 v94, v94
    v_exp_f32 v95, v95
    v_cvt_pk_bf16_f32 v117, v90, v91
    v_mfma_f32_32x32x16_bf16 v[128:143], v[64:67], v[112:115], v[128:143]
    ds_read_b128 v[52:55], v1 offset:5120
    ds_read_b32 v60, v2 offset:5120
    ds_read_b128 v[72:75], v3 offset:5120
    ds_read_b128 v[76:79], v3 offset:5760
    v_exp_f32 v96, v96
    v_exp_f32 v97, v97
    v_cvt_pk_bf16_f32 v118, v92, v93
    v_exp_f32 v98, v98
    v_exp_f32 v99, v99
    v_cvt_pk_bf16_f32 v119, v94, v95
    v_mfma_f32_32x32x16_bf16 v[80:95], v[48:51], v[24:27], 0
    v_exp_f32 v100, v100
    v_exp_f32 v101, v101
    v_cvt_pk_bf16_f32 v120, v96, v97
    v_exp_f32 v102, v102
    v_exp_f32 v103, v103
    v_cvt_pk_bf16_f32 v121, v98, v99
    v_mfma_f32_32x32x16_bf16 v[80:95], v[56:59], v[40:43], v[80:95]
    v_exp_f32 v104, v104
    v_exp_f32 v105, v105
    v_cvt_pk_bf16_f32 v122, v100, v101
    v_exp_f32 v106, v106
    v_exp_f32 v107, v107
    v_cvt_pk_bf16_f32 v123, v102, v103
    v_mfma_f32_32x32x16_bf16 v[128:143], v[68:71], v[116:119], v[128:143]
    v_exp_f32 v108, v108
    v_exp_f32 v109, v109
    v_cvt_pk_bf16_f32 v124, v104, v105
    v_exp_f32 v110, v110
    v_exp_f32 v111, v111
    v_cvt_pk_bf16_f32 v125, v106, v107
    v_mfma_f32_32x32x16_bf16 v[144:159], v[64:67], v[120:123], v[144:159]
    v_exp_f32 v80, v80
    v_exp_f32 v81, v81
    v_cvt_pk_bf16_f32 v126, v108, v109
    v_exp_f32 v82, v82
    v_exp_f32 v83, v83
    v_cvt_pk_bf16_f32 v127, v110, v111
    v_mfma_f32_32x32x16_bf16 v[96:111], v[48:51], v[28:31], 0
    v_exp_f32 v84, v84
    v_exp_f32 v85, v85
    v_cvt_pk_bf16_f32 v112, v80, v81
    v_exp_f32 v86, v86
    v_exp_f32 v87, v87
    v_cvt_pk_bf16_f32 v113, v82, v83
    v_mfma_f32_32x32x16_bf16 v[96:111], v[56:59], v[44:47], v[96:111]
    v_exp_f32 v88, v88
    v_exp_f32 v89, v89
    v_cvt_pk_bf16_f32 v114, v84, v85
    v_exp_f32 v90, v90
    v_exp_f32 v91, v91
    v_cvt_pk_bf16_f32 v115, v86, v87
    v_mfma_f32_32x32x16_bf16 v[144:159], v[68:71], v[124:127], v[144:159]
    v_exp_f32 v92, v92
    v_exp_f32 v93, v93
    v_cvt_pk_bf16_f32 v116, v88, v89
    v_exp_f32 v94, v94
    v_exp_f32 v95, v95
    v_cvt_pk_bf16_f32 v117, v90, v91
    s_waitcnt lgkmcnt(0)
    v_mfma_f32_32x32x16_bf16 v[160:175], v[64:67], v[112:115], v[160:175]
    v_exp_f32 v96, v96
    v_exp_f32 v97, v97
    v_cvt_pk_bf16_f32 v118, v92, v93
    v_exp_f32 v98, v98
    v_exp_f32 v99, v99
    v_cvt_pk_bf16_f32 v119, v94, v95
    v_mfma_f32_32x32x16_bf16 v[80:95], v[52:55], v[16:19], 0
    v_exp_f32 v100, v100
    v_exp_f32 v101, v101
    v_cvt_pk_bf16_f32 v120, v96, v97
    v_exp_f32 v102, v102
    v_exp_f32 v103, v103
    v_cvt_pk_bf16_f32 v121, v98, v99
    v_mfma_f32_32x32x16_bf16 v[80:95], v[60:63], v[32:35], v[80:95]
    v_exp_f32 v104, v104
    v_exp_f32 v105, v105
    v_cvt_pk_bf16_f32 v122, v100, v101
    v_exp_f32 v106, v106
    v_exp_f32 v107, v107
    v_cvt_pk_bf16_f32 v123, v102, v103
    v_mfma_f32_32x32x16_bf16 v[160:175], v[68:71], v[116:119], v[160:175]
    v_exp_f32 v108, v108
    v_exp_f32 v109, v109
    v_cvt_pk_bf16_f32 v124, v104, v105
    v_exp_f32 v110, v110
    v_exp_f32 v111, v111
    v_cvt_pk_bf16_f32 v125, v106, v107
    v_mfma_f32_32x32x16_bf16 v[176:191], v[64:67], v[120:123], v[176:191]
    v_exp_f32 v80, v80
    v_exp_f32 v81, v81
    v_cvt_pk_bf16_f32 v126, v108, v109
    v_exp_f32 v82, v82
    v_exp_f32 v83, v83
    v_cvt_pk_bf16_f32 v127, v110, v111
    v_mfma_f32_32x32x16_bf16 v[96:111], v[52:55], v[20:23], 0
    v_exp_f32 v84, v84
    v_exp_f32 v85, v85
    v_cvt_pk_bf16_f32 v112, v80, v81
    v_exp_f32 v86, v86
    v_exp_f32 v87, v87
    v_cvt_pk_bf16_f32 v113, v82, v83
    v_mfma_f32_32x32x16_bf16 v[96:111], v[60:63], v[36:39], v[96:111]
    v_exp_f32 v88, v88
    v_exp_f32 v89, v89
    v_cvt_pk_bf16_f32 v114, v84, v85
    v_exp_f32 v90, v90
    v_exp_f32 v91, v91
    v_cvt_pk_bf16_f32 v115, v86, v87
    v_mfma_f32_32x32x16_bf16 v[176:191], v[68:71], v[124:127], v[176:191]
    v_exp_f32 v92, v92
    v_exp_f32 v93, v93
    v_cvt_pk_bf16_f32 v116, v88, v89
    v_exp_f32 v94, v94
    v_exp_f32 v95, v95
    v_cvt_pk_bf16_f32 v117, v90, v91
    v_mfma_f32_32x32x16_bf16 v[128:143], v[72:75], v[112:115], v[128:143]
    ds_read_b128 v[48:51], v1 offset:10240
    ds_read_b32 v56, v2 offset:10240
    ds_read_b128 v[64:67], v3 offset:10240
    ds_read_b128 v[68:71], v3 offset:10880
    v_exp_f32 v96, v96
    v_exp_f32 v97, v97
    v_cvt_pk_bf16_f32 v118, v92, v93
    v_exp_f32 v98, v98
    v_exp_f32 v99, v99
    v_cvt_pk_bf16_f32 v119, v94, v95
    v_mfma_f32_32x32x16_bf16 v[80:95], v[52:55], v[24:27], 0
    v_exp_f32 v100, v100
    v_exp_f32 v101, v101
    v_cvt_pk_bf16_f32 v120, v96, v97
    v_exp_f32 v102, v102
    v_exp_f32 v103, v103
    v_cvt_pk_bf16_f32 v121, v98, v99
    v_mfma_f32_32x32x16_bf16 v[80:95], v[60:63], v[40:43], v[80:95]
    v_exp_f32 v104, v104
    v_exp_f32 v105, v105
    v_cvt_pk_bf16_f32 v122, v100, v101
    v_exp_f32 v106, v106
    v_exp_f32 v107, v107
    v_cvt_pk_bf16_f32 v123, v102, v103
    v_mfma_f32_32x32x16_bf16 v[128:143], v[76:79], v[116:119], v[128:143]
    v_exp_f32 v108, v108
    v_exp_f32 v109, v109
    v_cvt_pk_bf16_f32 v124, v104, v105
    v_exp_f32 v110, v110
    v_exp_f32 v111, v111
    v_cvt_pk_bf16_f32 v125, v106, v107
    v_mfma_f32_32x32x16_bf16 v[144:159], v[72:75], v[120:123], v[144:159]
    v_exp_f32 v80, v80
    v_exp_f32 v81, v81
    v_cvt_pk_bf16_f32 v126, v108, v109
    v_exp_f32 v82, v82
    v_exp_f32 v83, v83
    v_cvt_pk_bf16_f32 v127, v110, v111
    v_mfma_f32_32x32x16_bf16 v[96:111], v[52:55], v[28:31], 0
    v_exp_f32 v84, v84
    v_exp_f32 v85, v85
    v_cvt_pk_bf16_f32 v112, v80, v81
    v_exp_f32 v86, v86
    v_exp_f32 v87, v87
    v_cvt_pk_bf16_f32 v113, v82, v83
    v_mfma_f32_32x32x16_bf16 v[96:111], v[60:63], v[44:47], v[96:111]
    v_exp_f32 v88, v88
    v_exp_f32 v89, v89
    v_cvt_pk_bf16_f32 v114, v84, v85
    v_exp_f32 v90, v90
    v_exp_f32 v91, v91
    v_cvt_pk_bf16_f32 v115, v86, v87
    v_mfma_f32_32x32x16_bf16 v[144:159], v[76:79], v[124:127], v[144:159]
    v_exp_f32 v92, v92
    v_exp_f32 v93, v93
    v_cvt_pk_bf16_f32 v116, v88, v89
    v_exp_f32 v94, v94
    v_exp_f32 v95, v95
    v_cvt_pk_bf16_f32 v117, v90, v91
    s_waitcnt lgkmcnt(0)
    v_mfma_f32_32x32x16_bf16 v[160:175], v[72:75], v[112:115], v[160:175]
    v_exp_f32 v96, v96
    v_exp_f32 v97, v97
    v_cvt_pk_bf16_f32 v118, v92, v93
    v_exp_f32 v98, v98
    v_exp_f32 v99, v99
    v_cvt_pk_bf16_f32 v119, v94, v95
    v_mfma_f32_32x32x16_bf16 v[80:95], v[48:51], v[16:19], 0
    v_exp_f32 v100, v100
    v_exp_f32 v101, v101
    v_cvt_pk_bf16_f32 v120, v96, v97
    v_exp_f32 v102, v102
    v_exp_f32 v103, v103
    v_cvt_pk_bf16_f32 v121, v98, v99
    v_mfma_f32_32x32x16_bf16 v[80:95], v[56:59], v[32:35], v[80:95]
    v_exp_f32 v104, v104
    v_exp_f32 v105, v105
    v_cvt_pk_bf16_f32 v122, v100, v101
    v_exp_f32 v106, v106
    v_exp_f32 v107, v107
    v_cvt_pk_bf16_f32 v123, v102, v103
    v_mfma_f32_32x32x16_bf16 v[160:175], v[76:79], v[116:119], v[160:175]
    v_exp_f32 v108, v108
    v_exp_f32 v109, v109
    v_cvt_pk_bf16_f32 v124, v104, v105
    v_exp_f32 v110, v110
    v_exp_f32 v111, v111
    v_cvt_pk_bf16_f32 v125, v106, v107
    v_mfma_f32_32x32x16_bf16 v[176:191], v[72:75], v[120:123], v[176:191]
    v_exp_f32 v80, v80
    v_exp_f32 v81, v81
    v_cvt_pk_bf16_f32 v126, v108, v109
    v_exp_f32 v82, v82
    v_exp_f32 v83, v83
    v_cvt_pk_bf16_f32 v127, v110, v111
    v_mfma_f32_32x32x16_bf16 v[96:111], v[48:51], v[20:23], 0
    v_exp_f32 v84, v84
    v_exp_f32 v85, v85
    v_cvt_pk_bf16_f32 v112, v80, v81
    v_exp_f32 v86, v86
    v_exp_f32 v87, v87
    v_cvt_pk_bf16_f32 v113, v82, v83
    v_mfma_f32_32x32x16_bf16 v[96:111], v[56:59], v[36:39], v[96:111]
    v_exp_f32 v88, v88
    v_exp_f32 v89, v89
    v_cvt_pk_bf16_f32 v114, v84, v85
    v_exp_f32 v90, v90
    v_exp_f32 v91, v91
    v_cvt_pk_bf16_f32 v115, v86, v87
    v_mfma_f32_32x32x16_bf16 v[176:191], v[76:79], v[124:127], v[176:191]
    v_exp_f32 v92, v92
    v_exp_f32 v93, v93
    v_cvt_pk_bf16_f32 v116, v88, v89
    v_exp_f32 v94, v94
    v_exp_f32 v95, v95
    v_cvt_pk_bf16_f32 v117, v90, v91
    v_mfma_f32_32x32x16_bf16 v[128:143], v[64:67], v[112:115], v[128:143]
    ds_read_b128 v[52:55], v1 offset:15360
    ds_read_b32 v60, v2 offset:15360
    ds_read_b128 v[72:75], v3 offset:15360
    ds_read_b128 v[76:79], v3 offset:16000
    v_exp_f32 v96, v96
    v_exp_f32 v97, v97
    v_cvt_pk_bf16_f32 v118, v92, v93
    v_exp_f32 v98, v98
    v_exp_f32 v99, v99
    v_cvt_pk_bf16_f32 v119, v94, v95
    v_mfma_f32_32x32x16_bf16 v[80:95], v[48:51], v[24:27], 0
    v_exp_f32 v100, v100
    v_exp_f32 v101, v101
    v_cvt_pk_bf16_f32 v120, v96, v97
    v_exp_f32 v102, v102
    v_exp_f32 v103, v103
    v_cvt_pk_bf16_f32 v121, v98, v99
    v_mfma_f32_32x32x16_bf16 v[80:95], v[56:59], v[40:43], v[80:95]
    v_exp_f32 v104, v104
    v_exp_f32 v105, v105
    v_cvt_pk_bf16_f32 v122, v100, v101
    v_exp_f32 v106, v106
    v_exp_f32 v107, v107
    v_cvt_pk_bf16_f32 v123, v102, v103
    v_mfma_f32_32x32x16_bf16 v[128:143], v[68:71], v[116:119], v[128:143]
    v_exp_f32 v108, v108
    v_exp_f32 v109, v109
    v_cvt_pk_bf16_f32 v124, v104, v105
    v_exp_f32 v110, v110
    v_exp_f32 v111, v111
    v_cvt_pk_bf16_f32 v125, v106, v107
    v_mfma_f32_32x32x16_bf16 v[144:159], v[64:67], v[120:123], v[144:159]
    v_exp_f32 v80, v80
    v_exp_f32 v81, v81
    v_cvt_pk_bf16_f32 v126, v108, v109
    v_exp_f32 v82, v82
    v_exp_f32 v83, v83
    v_cvt_pk_bf16_f32 v127, v110, v111
    v_mfma_f32_32x32x16_bf16 v[96:111], v[48:51], v[28:31], 0
    v_exp_f32 v84, v84
    v_exp_f32 v85, v85
    v_cvt_pk_bf16_f32 v112, v80, v81
    v_exp_f32 v86, v86
    v_exp_f32 v87, v87
    v_cvt_pk_bf16_f32 v113, v82, v83
    v_mfma_f32_32x32x16_bf16 v[96:111], v[56:59], v[44:47], v[96:111]
    v_exp_f32 v88, v88
    v_exp_f32 v89, v89
    v_cvt_pk_bf16_f32 v114, v84, v85
    v_exp_f32 v90, v90
    v_exp_f32 v91, v91
    v_cvt_pk_bf16_f32 v115, v86, v87
    v_mfma_f32_32x32x16_bf16 v[144:159], v[68:71], v[124:127], v[144:159]
    v_exp_f32 v92, v92
    v_exp_f32 v93, v93
    v_cvt_pk_bf16_f32 v116, v88, v89
    v_exp_f32 v94, v94
    v_exp_f32 v95, v95
    v_cvt_pk_bf16_f32 v117, v90, v91
    s_waitcnt lgkmcnt(0)
    v_mfma_f32_32x32x16_bf16 v[160:175], v[64:67], v[112:115], v[160:175]
    v_exp_f32 v96, v96
    v_exp_f32 v97, v97
    v_cvt_pk_bf16_f32 v118, v92, v93
    v_exp_f32 v98, v98
    v_exp_f32 v99, v99
    v_cvt_pk_bf16_f32 v119, v94, v95
    v_mfma_f32_32x32x16_bf16 v[80:95], v[52:55], v[16:19], 0
    v_exp_f32 v100, v100
    v_exp_f32 v101, v101
    v_cvt_pk_bf16_f32 v120, v96, v97
    v_exp_f32 v102, v102
    v_exp_f32 v103, v103
    v_cvt_pk_bf16_f32 v121, v98, v99
    v_mfma_f32_32x32x16_bf16 v[80:95], v[60:63], v[32:35], v[80:95]
    v_exp_f32 v104, v104
    v_exp_f32 v105, v105
    v_cvt_pk_bf16_f32 v122, v100, v101
    v_exp_f32 v106, v106
    v_exp_f32 v107, v107
    v_cvt_pk_bf16_f32 v123, v102, v103
    v_mfma_f32_32x32x16_bf16 v[160:175], v[68:71], v[116:119], v[160:175]
    v_exp_f32 v108, v108
    v_exp_f32 v109, v109
    v_cvt_pk_bf16_f32 v124, v104, v105
    v_exp_f32 v110, v110
    v_exp_f32 v111, v111
    v_cvt_pk_bf16_f32 v125, v106, v107
    v_mfma_f32_32x32x16_bf16 v[176:191], v[64:67], v[120:123], v[176:191]
    v_exp_f32 v80, v80
    v_exp_f32 v81, v81
    v_cvt_pk_bf16_f32 v126, v108, v109
    v_exp_f32 v82, v82
    v_exp_f32 v83, v83
    v_cvt_pk_bf16_f32 v127, v110, v111
    v_mfma_f32_32x32x16_bf16 v[96:111], v[52:55], v[20:23], 0
    v_exp_f32 v84, v84
    v_exp_f32 v85, v85
    v_cvt_pk_bf16_f32 v112, v80, v81
    v_exp_f32 v86, v86
    v_exp_f32 v87, v87
    v_cvt_pk_bf16_f32 v113, v82, v83
    v_mfma_f32_32x32x16_bf16 v[96:111], v[60:63], v[36:39], v[96:111]
    v_exp_f32 v88, v88
    v_exp_f32 v89, v89
    v_cvt_pk_bf16_f32 v114, v84, v85
    v_exp_f32 v90, v90
    v_exp_f32 v91, v91
    v_cvt_pk_bf16_f32 v115, v86, v87
    v_mfma_f32_32x32x16_bf16 v[176:191], v[68:71], v[124:127], v[176:191]
    v_exp_f32 v92, v92
    v_exp_f32 v93, v93
    v_cvt_pk_bf16_f32 v116, v88, v89
    v_exp_f32 v94, v94
    v_exp_f32 v95, v95
    v_cvt_pk_bf16_f32 v117, v90, v91
    v_mfma_f32_32x32x16_bf16 v[128:143], v[72:75], v[112:115], v[128:143]
    v_exp_f32 v96, v96
    v_exp_f32 v97, v97
    v_cvt_pk_bf16_f32 v118, v92, v93
    v_exp_f32 v98, v98
    v_exp_f32 v99, v99
    v_cvt_pk_bf16_f32 v119, v94, v95
    v_mfma_f32_32x32x16_bf16 v[80:95], v[52:55], v[24:27], 0
    v_exp_f32 v100, v100
    v_exp_f32 v101, v101
    v_cvt_pk_bf16_f32 v120, v96, v97
    v_exp_f32 v102, v102
    v_exp_f32 v103, v103
    v_cvt_pk_bf16_f32 v121, v98, v99
    v_mfma_f32_32x32x16_bf16 v[80:95], v[60:63], v[40:43], v[80:95]
    v_exp_f32 v104, v104
    v_exp_f32 v105, v105
    v_cvt_pk_bf16_f32 v122, v100, v101
    v_exp_f32 v106, v106
    v_exp_f32 v107, v107
    v_cvt_pk_bf16_f32 v123, v102, v103
    v_mfma_f32_32x32x16_bf16 v[128:143], v[76:79], v[116:119], v[128:143]
    v_exp_f32 v108, v108
    v_exp_f32 v109, v109
    v_cvt_pk_bf16_f32 v124, v104, v105
    v_exp_f32 v110, v110
    v_exp_f32 v111, v111
    v_cvt_pk_bf16_f32 v125, v106, v107
    v_mfma_f32_32x32x16_bf16 v[144:159], v[72:75], v[120:123], v[144:159]
    v_exp_f32 v80, v80
    v_exp_f32 v81, v81
    v_cvt_pk_bf16_f32 v126, v108, v109
    v_exp_f32 v82, v82
    v_exp_f32 v83, v83
    v_cvt_pk_bf16_f32 v127, v110, v111
    v_mfma_f32_32x32x16_bf16 v[96:111], v[52:55], v[28:31], 0
    v_exp_f32 v84, v84
    v_exp_f32 v85, v85
    v_cvt_pk_bf16_f32 v112, v80, v81
    v_exp_f32 v86, v86
    v_exp_f32 v87, v87
    v_cvt_pk_bf16_f32 v113, v82, v83
    v_mfma_f32_32x32x16_bf16 v[96:111], v[60:63], v[44:47], v[96:111]
    v_exp_f32 v88, v88
    v_exp_f32 v89, v89
    v_cvt_pk_bf16_f32 v114, v84, v85
    v_exp_f32 v90, v90
    v_exp_f32 v91, v91
    v_cvt_pk_bf16_f32 v115, v86, v87
    v_mfma_f32_32x32x16_bf16 v[144:159], v[76:79], v[124:127], v[144:159]
    v_exp_f32 v92, v92
    v_exp_f32 v93, v93
    v_cvt_pk_bf16_f32 v116, v88, v89
    v_exp_f32 v94, v94
    v_exp_f32 v95, v95
    v_cvt_pk_bf16_f32 v117, v90, v91
    v_mfma_f32_32x32x16_bf16 v[160:175], v[72:75], v[112:115], v[160:175]
    v_exp_f32 v96, v96
    v_exp_f32 v97, v97
    v_cvt_pk_bf16_f32 v118, v92, v93
    v_exp_f32 v98, v98
    v_exp_f32 v99, v99
    v_cvt_pk_bf16_f32 v119, v94, v95
    v_exp_f32 v100, v100
    v_exp_f32 v101, v101
    v_cvt_pk_bf16_f32 v120, v96, v97
    v_exp_f32 v102, v102
    v_exp_f32 v103, v103
    v_cvt_pk_bf16_f32 v121, v98, v99
    v_exp_f32 v104, v104
    v_exp_f32 v105, v105
    v_cvt_pk_bf16_f32 v122, v100, v101
    v_exp_f32 v106, v106
    v_exp_f32 v107, v107
    v_cvt_pk_bf16_f32 v123, v102, v103
    v_mfma_f32_32x32x16_bf16 v[160:175], v[76:79], v[116:119], v[160:175]
    v_exp_f32 v108, v108
    v_exp_f32 v109, v109
    v_cvt_pk_bf16_f32 v124, v104, v105
    v_exp_f32 v110, v110
    v_exp_f32 v111, v111
    v_cvt_pk_bf16_f32 v125, v106, v107
    v_cvt_pk_bf16_f32 v126, v108, v109
    v_cvt_pk_bf16_f32 v127, v110, v111
    v_mfma_f32_32x32x16_bf16 v[176:191], v[72:75], v[120:123], v[176:191]
    s_nop 0
    v_mfma_f32_32x32x16_bf16 v[176:191], v[76:79], v[124:127], v[176:191]
    s_setprio 3
    s_lshl_b32 s37, s6, 12
    s_xor_b32 s38, s37, 4096
    v_lshlrev_b32 v10, 4, v0
    v_add_u32 v10, 61440, v10
    v_add_u32 v11, s37, v10
    v_add_u32 v10, s38, v10
    s_lshl_b32 s37, s6, 10
    s_xor_b32 s38, s37, 1024
    v_lshlrev_b32 v12, 4, v5
    v_add_u32 v12, 77824, v12
    v_add_u32 v13, s37, v12
    v_add_u32 v12, s38, v12
    s_mov_b32 exec_hi, 0
    ds_write_b128 v12, v[168:171]
    ds_write_b128 v12, v[184:187] offset:512
    s_mov_b64 exec, -1
    ds_write_b128 v10, v[160:163] offset:0
    ds_write_b128 v10, v[164:167] offset:1024
    ds_write_b128 v10, v[176:179] offset:2048
    ds_write_b128 v10, v[180:183] offset:3072
    s_waitcnt lgkmcnt(0)
    s_barrier
    ds_read_b128 v[80:83], v11 offset:0
    ds_read_b128 v[84:87], v11 offset:1024
    ds_read_b128 v[88:91], v13 offset:0
    ds_read_b128 v[96:99], v11 offset:2048
    ds_read_b128 v[100:103], v11 offset:3072
    ds_read_b128 v[104:107], v13 offset:512
    s_waitcnt lgkmcnt(5)
    v_add_f32 v128, v128, v80
    v_add_f32 v129, v129, v81
    v_add_f32 v130, v130, v82
    v_add_f32 v131, v131, v83
    s_waitcnt lgkmcnt(4)
    v_add_f32 v132, v132, v84
    v_add_f32 v133, v133, v85
    v_add_f32 v134, v134, v86
    v_add_f32 v135, v135, v87
    s_waitcnt lgkmcnt(3)
    v_add_f32 v136, v136, v88
    v_add_f32 v137, v137, v89
    v_add_f32 v138, v138, v90
    s_waitcnt lgkmcnt(2)
    v_add_f32 v144, v144, v96
    v_add_f32 v145, v145, v97
    v_add_f32 v146, v146, v98
    v_add_f32 v147, v147, v99
    s_waitcnt lgkmcnt(1)
    v_add_f32 v148, v148, v100
    v_add_f32 v149, v149, v101
    v_add_f32 v150, v150, v102
    v_add_f32 v151, v151, v103
    s_waitcnt lgkmcnt(0)
    v_add_f32 v152, v152, v104
    v_add_f32 v153, v153, v105
    v_add_f32 v154, v154, v106
    v_mov_b32 v10, 0
    v_mov_b32 v12, v138
    v_mov_b32 v13, v138
    s_nop 1
    v_permlane32_swap_b32 v12, v13
    v_rcp_f32 v13, v12
    v_mul_f32 v11, 0x4d800000, v12
    v_mul_f32 v13, 0x6b000000, v13
    v_fma_f32 v10, v11, 0, v10
    v_fma_f32 v10, v13, 0, v10
    v_fma_f32 v10, v128, 0, v10
    v_fma_f32 v10, v129, 0, v10
    v_fma_f32 v10, v130, 0, v10
    v_fma_f32 v10, v131, 0, v10
    v_fma_f32 v10, v132, 0, v10
    v_fma_f32 v10, v133, 0, v10
    v_fma_f32 v10, v134, 0, v10
    v_fma_f32 v10, v135, 0, v10
    v_fma_f32 v10, v136, 0, v10
    v_fma_f32 v10, v137, 0, v10
    v_mov_b32 v12, v154
    v_mov_b32 v13, v154
    s_nop 1
    v_permlane32_swap_b32 v12, v13
    v_rcp_f32 v13, v12
    v_mul_f32 v11, 0x4d800000, v12
    v_mul_f32 v13, 0x6b000000, v13
    v_fma_f32 v10, v11, 0, v10
    v_fma_f32 v10, v13, 0, v10
    v_fma_f32 v10, v144, 0, v10
    v_fma_f32 v10, v145, 0, v10
    v_fma_f32 v10, v146, 0, v10
    v_fma_f32 v10, v147, 0, v10
    v_fma_f32 v10, v148, 0, v10
    v_fma_f32 v10, v149, 0, v10
    v_fma_f32 v10, v150, 0, v10
    v_fma_f32 v10, v151, 0, v10
    v_fma_f32 v10, v152, 0, v10
    v_fma_f32 v10, v153, 0, v10
    v_cmp_u_f32 vcc, v10, v10
    s_nop 3
    s_cbranch_vccnz gated_mix__mha_block__mixer_gmlp__prompt_kernel_a_fb
gated_mix__mha_block__mixer_gmlp__prompt_kernel_a_fin:
    s_waitcnt vmcnt(0) lgkmcnt(0)
    s_nop 15
    s_add_u32 s44, s14, 40108032
    s_addc_u32 s45, s15, 0
    s_mov_b32 s46, 262144
    s_mov_b32 s47, 0x00020000
    s_mul_i32 s33, s30, 184320
    s_lshl_b32 s34, s24, 10
    s_add_u32 s33, s33, s34
    s_lshl_b32 s34, s32, 7
    v_mov_b32 v10, v138
    v_mov_b32 v11, v138
    s_nop 1
    v_permlane32_swap_b32 v10, v11
    v_rcp_f32 v10, v10
    s_nop 0
    v_mul_f32 v10, v14, v10
    v_mul_f32 v128, v10, v128
    v_mul_f32 v129, v10, v129
    v_mul_f32 v130, v10, v130
    v_mul_f32 v131, v10, v131
    v_mul_f32 v132, v10, v132
    v_mul_f32 v133, v10, v133
    v_mul_f32 v134, v10, v134
    v_mul_f32 v135, v10, v135
    v_mul_f32 v136, v10, v136
    v_mul_f32 v137, v10, v137
    v_cvt_pk_bf16_f32 v112, v128, v129
    v_cvt_pk_bf16_f32 v113, v130, v131
    v_cvt_pk_bf16_f32 v114, v132, v133
    v_cvt_pk_bf16_f32 v115, v134, v135
    v_cvt_pk_bf16_f32 v116, v136, v137
    buffer_store_dwordx4 v[112:115], v4, s[40:43], s33 offen sc0 sc1
    buffer_store_dword v116, v8, s[44:47], s34 offen offset:0 sc0 sc1
    s_add_u32 s33, s33, 184320
    v_mov_b32 v10, v154
    v_mov_b32 v11, v154
    s_nop 1
    v_permlane32_swap_b32 v10, v11
    v_rcp_f32 v10, v10
    s_nop 0
    v_mul_f32 v10, v15, v10
    v_mul_f32 v144, v10, v144
    v_mul_f32 v145, v10, v145
    v_mul_f32 v146, v10, v146
    v_mul_f32 v147, v10, v147
    v_mul_f32 v148, v10, v148
    v_mul_f32 v149, v10, v149
    v_mul_f32 v150, v10, v150
    v_mul_f32 v151, v10, v151
    v_mul_f32 v152, v10, v152
    v_mul_f32 v153, v10, v153
    v_cvt_pk_bf16_f32 v120, v144, v145
    v_cvt_pk_bf16_f32 v121, v146, v147
    v_cvt_pk_bf16_f32 v122, v148, v149
    v_cvt_pk_bf16_f32 v123, v150, v151
    v_cvt_pk_bf16_f32 v124, v152, v153
    buffer_store_dwordx4 v[120:123], v4, s[40:43], s33 offen sc0 sc1
    buffer_store_dword v124, v8, s[44:47], s34 offen offset:128 sc0 sc1
    s_lshl_b32 s36, s25, 5
    s_add_u32 s36, s36, s24
    s_add_u32 s36, s36, 1280
    s_lshl_b32 s39, s36, 7
    s_lshl_b32 s38, s6, 6
    v_add_lshl_u32 v10, v0, s38, 20
    v_mov_b32 v12, s76
    v_mov_b32 v13, s77
    s_waitcnt vmcnt(0)
    s_barrier
    buffer_store_dwordx2 v[12:13], v10, s[72:75], s39 offen sc0 sc1
    s_endpgm
gated_mix__mha_block__mixer_gmlp__prompt_kernel_a_fb:
    s_waitcnt vmcnt(0) lgkmcnt(0)
    s_nop 15
    s_mul_i32 s26, s24, 163840
    v_add_u32 v2, 2304, v6
    v_mov_b32 v33, 0
    v_mov_b32 v37, 0
    v_mov_b32 v12, 0xff800000
    v_mov_b32 v13, 0xff800000
    s_mov_b32 s29, s26
    s_mov_b32 s38, 64
gated_mix__mha_block__mixer_gmlp__prompt_kernel_a_fb1:
    buffer_load_dwordx4 v[48:51], v4, s[16:19], s29 offen sc0 sc1
    buffer_load_dword v56, v2, s[16:19], s29 offen sc0 sc1
    s_waitcnt vmcnt(1)
    v_mfma_f32_32x32x16_bf16 v[80:95], v[48:51], v[16:19], 0
    s_waitcnt vmcnt(0)
    v_mfma_f32_32x32x16_bf16 v[80:95], v[56:59], v[32:35], v[80:95]
    v_mfma_f32_32x32x16_bf16 v[96:111], v[48:51], v[20:23], 0
    v_mfma_f32_32x32x16_bf16 v[96:111], v[56:59], v[36:39], v[96:111]
    s_nop 9
    v_max3_f32 v12, v80, v81, v12
    v_max3_f32 v12, v82, v83, v12
    v_max3_f32 v12, v84, v85, v12
    v_max3_f32 v12, v86, v87, v12
    v_max3_f32 v12, v88, v89, v12
    v_max3_f32 v12, v90, v91, v12
    v_max3_f32 v12, v92, v93, v12
    v_max3_f32 v12, v94, v95, v12
    v_max3_f32 v13, v96, v97, v13
    v_max3_f32 v13, v98, v99, v13
    v_max3_f32 v13, v100, v101, v13
    v_max3_f32 v13, v102, v103, v13
    v_max3_f32 v13, v104, v105, v13
    v_max3_f32 v13, v106, v107, v13
    v_max3_f32 v13, v108, v109, v13
    v_max3_f32 v13, v110, v111, v13
    s_add_u32 s29, s29, 2560
    s_sub_u32 s38, s38, 1
    s_cmp_lg_u32 s38, 0
    s_waitcnt vmcnt(0) lgkmcnt(0)
    s_nop 15
    s_cbranch_scc1 gated_mix__mha_block__mixer_gmlp__prompt_kernel_a_fb1
    v_mov_b32 v11, v12
    s_nop 1
    v_permlane32_swap_b32 v12, v11
    v_max_f32 v12, v12, v11
    v_mov_b32 v128, 0
    v_mov_b32 v129, 0
    v_mov_b32 v130, 0
    v_mov_b32 v131, 0
    v_mov_b32 v132, 0
    v_mov_b32 v133, 0
    v_mov_b32 v134, 0
    v_mov_b32 v135, 0
    v_mov_b32 v136, 0
    v_mov_b32 v137, 0
    v_mov_b32 v138, 0
    v_mov_b32 v139, 0
    v_mov_b32 v140, 0
    v_mov_b32 v141, 0
    v_mov_b32 v142, 0
    v_mov_b32 v143, 0
    v_mov_b32 v11, v13
    s_nop 1
    v_permlane32_swap_b32 v13, v11
    v_max_f32 v13, v13, v11
    v_mov_b32 v144, 0
    v_mov_b32 v145, 0
    v_mov_b32 v146, 0
    v_mov_b32 v147, 0
    v_mov_b32 v148, 0
    v_mov_b32 v149, 0
    v_mov_b32 v150, 0
    v_mov_b32 v151, 0
    v_mov_b32 v152, 0
    v_mov_b32 v153, 0
    v_mov_b32 v154, 0
    v_mov_b32 v155, 0
    v_mov_b32 v156, 0
    v_mov_b32 v157, 0
    v_mov_b32 v158, 0
    v_mov_b32 v159, 0
    s_mov_b32 s29, s26
    s_mov_b32 s38, 64
    s_waitcnt vmcnt(0) lgkmcnt(0)
    s_nop 15
gated_mix__mha_block__mixer_gmlp__prompt_kernel_a_fb2:
    buffer_load_dwordx4 v[48:51], v4, s[16:19], s29 offen sc0 sc1
    buffer_load_dword v56, v2, s[16:19], s29 offen sc0 sc1
    buffer_load_dwordx4 v[64:67], v9, s[16:19], s29 offen sc0 sc1
    buffer_load_dwordx4 v[68:71], v9, s[16:19], s29 offen offset:640 sc0 sc1
    s_waitcnt vmcnt(3)
    v_mfma_f32_32x32x16_bf16 v[80:95], v[48:51], v[16:19], 0
    s_waitcnt vmcnt(2)
    v_mfma_f32_32x32x16_bf16 v[80:95], v[56:59], v[32:35], v[80:95]
    v_mfma_f32_32x32x16_bf16 v[96:111], v[48:51], v[20:23], 0
    v_mfma_f32_32x32x16_bf16 v[96:111], v[56:59], v[36:39], v[96:111]
    s_nop 9
    v_sub_f32 v80, v80, v12
    v_sub_f32 v81, v81, v12
    v_sub_f32 v82, v82, v12
    v_sub_f32 v83, v83, v12
    v_sub_f32 v84, v84, v12
    v_sub_f32 v85, v85, v12
    v_sub_f32 v86, v86, v12
    v_sub_f32 v87, v87, v12
    v_sub_f32 v88, v88, v12
    v_sub_f32 v89, v89, v12
    v_sub_f32 v90, v90, v12
    v_sub_f32 v91, v91, v12
    v_sub_f32 v92, v92, v12
    v_sub_f32 v93, v93, v12
    v_sub_f32 v94, v94, v12
    v_sub_f32 v95, v95, v12
    v_exp_f32 v80, v80
    v_exp_f32 v81, v81
    v_exp_f32 v82, v82
    v_exp_f32 v83, v83
    v_exp_f32 v84, v84
    v_exp_f32 v85, v85
    v_exp_f32 v86, v86
    v_exp_f32 v87, v87
    v_exp_f32 v88, v88
    v_exp_f32 v89, v89
    v_exp_f32 v90, v90
    v_exp_f32 v91, v91
    v_exp_f32 v92, v92
    v_exp_f32 v93, v93
    v_exp_f32 v94, v94
    v_exp_f32 v95, v95
    v_cvt_pk_bf16_f32 v112, v80, v81
    v_cvt_pk_bf16_f32 v113, v82, v83
    v_cvt_pk_bf16_f32 v114, v84, v85
    v_cvt_pk_bf16_f32 v115, v86, v87
    v_cvt_pk_bf16_f32 v116, v88, v89
    v_cvt_pk_bf16_f32 v117, v90, v91
    v_cvt_pk_bf16_f32 v118, v92, v93
    v_cvt_pk_bf16_f32 v119, v94, v95
    s_waitcnt vmcnt(1)
    v_mfma_f32_32x32x16_bf16 v[128:143], v[64:67], v[112:115], v[128:143]
    s_waitcnt vmcnt(0)
    v_mfma_f32_32x32x16_bf16 v[128:143], v[68:71], v[116:119], v[128:143]
    v_sub_f32 v96, v96, v13
    v_sub_f32 v97, v97, v13
    v_sub_f32 v98, v98, v13
    v_sub_f32 v99, v99, v13
    v_sub_f32 v100, v100, v13
    v_sub_f32 v101, v101, v13
    v_sub_f32 v102, v102, v13
    v_sub_f32 v103, v103, v13
    v_sub_f32 v104, v104, v13
    v_sub_f32 v105, v105, v13
    v_sub_f32 v106, v106, v13
    v_sub_f32 v107, v107, v13
    v_sub_f32 v108, v108, v13
    v_sub_f32 v109, v109, v13
    v_sub_f32 v110, v110, v13
    v_sub_f32 v111, v111, v13
    v_exp_f32 v96, v96
    v_exp_f32 v97, v97
    v_exp_f32 v98, v98
    v_exp_f32 v99, v99
    v_exp_f32 v100, v100
    v_exp_f32 v101, v101
    v_exp_f32 v102, v102
    v_exp_f32 v103, v103
    v_exp_f32 v104, v104
    v_exp_f32 v105, v105
    v_exp_f32 v106, v106
    v_exp_f32 v107, v107
    v_exp_f32 v108, v108
    v_exp_f32 v109, v109
    v_exp_f32 v110, v110
    v_exp_f32 v111, v111
    v_cvt_pk_bf16_f32 v120, v96, v97
    v_cvt_pk_bf16_f32 v121, v98, v99
    v_cvt_pk_bf16_f32 v122, v100, v101
    v_cvt_pk_bf16_f32 v123, v102, v103
    v_cvt_pk_bf16_f32 v124, v104, v105
    v_cvt_pk_bf16_f32 v125, v106, v107
    v_cvt_pk_bf16_f32 v126, v108, v109
    v_cvt_pk_bf16_f32 v127, v110, v111
    v_mfma_f32_32x32x16_bf16 v[144:159], v[64:67], v[120:123], v[144:159]
    s_nop 0
    v_mfma_f32_32x32x16_bf16 v[144:159], v[68:71], v[124:127], v[144:159]
    s_add_u32 s29, s29, 2560
    s_sub_u32 s38, s38, 1
    s_cmp_lg_u32 s38, 0
    s_waitcnt vmcnt(0) lgkmcnt(0)
    s_nop 15
    s_cbranch_scc1 gated_mix__mha_block__mixer_gmlp__prompt_kernel_a_fb2
    s_branch gated_mix__mha_block__mixer_gmlp__prompt_kernel_a_fin
gated_mix__mha_block__mixer_gmlp__prompt_kernel_G:
    s_nop 1
    s_setprio 2
    s_cmp_eq_u32 s24, 3
    s_cbranch_scc1 gated_mix__mha_block__mixer_gmlp__prompt_kernel_qk
    s_mul_i32 s7, s7, 3
    s_add_u32 s7, s7, s24
    s_mul_i32 s64, s7, 3
    s_lshl_b32 s26, s5, 7
    s_lshl_b32 s27, s6, 5
    s_add_u32 s26, s26, s27
    v_lshrrev_b32 v4, 3, v0
    v_and_b32 v5, 7, v0
    v_add_u32 v6, s26, v4
    v_lshrrev_b32 v7, 1, v4
    v_mul_u32_u24 v6, 1152, v6
    v_xor_b32 v7, v7, v5
    s_lshl_b32 s55, s6, 12
    s_mov_b32 s56, 0
    v_lshl_add_u32 v224, v7, 4, v6
    v_xor_b32 v7, 4, v7
    v_lshl_add_u32 v225, v7, 4, v6
    v_add_u32 v226, 16384, v224
    v_add_u32 v227, 24576, v225
    v_add_u32 v225, 8192, v225
    s_add_u32 s16, s8, 0
    s_addc_u32 s17, s9, 0
    s_mov_b32 s18, 2359296
    s_mov_b32 s19, 0x00020000
    s_add_u32 m0, s55, 0
    s_nop 0
    buffer_load_dwordx4 v224, s[16:19], s56 offen offset:0 lds
    buffer_load_dwordx4 v225, s[16:19], s56 offen offset:1024 lds
    buffer_load_dwordx4 v226, s[16:19], s56 offen offset:2048 lds
    buffer_load_dwordx4 v227, s[16:19], s56 offen offset:3072 lds
    s_add_u32 s56, s56, 128
    s_add_u32 s20, s12, 0
    s_addc_u32 s21, s13, 0
    s_mov_b32 s22, 5308416
    s_mov_b32 s23, 0x00020000
    s_lshl_b32 s26, s64, 7
    s_add_u32 s26, s26, 4608
    s_lshl_b32 s27, s6, 3
    s_movk_i32 s28, 9216
    v_lshlrev_b32 v6, 1, v4
    v_and_b32 v6, 4, v6
    v_xor_b32 v6, v6, v5
    v_lshlrev_b32 v6, 4, v6
    v_add_u32 v6, s26, v6
    v_add_u32 v7, s27, v4
    v_mul_lo_u32 v7, v7, s28
    v_add_u32 v228, v7, v6
    s_lshl_b32 s54, s6, 10
    s_add_u32 s54, s54, 32768
    s_mov_b32 s57, 0
    s_add_u32 m0, s54, 0
    s_nop 0
    buffer_load_dwordx4 v228, s[20:23], s57 offen offset:0 lds
    s_add_u32 m0, s54, 3968
    s_nop 0
    buffer_load_dwordx4 v228, s[20:23], s57 offen offset:128 lds
    s_add_u32 m0, s54, 7936
    s_nop 0
    buffer_load_dwordx4 v228, s[20:23], s57 offen offset:256 lds
    s_add_u32 s57, s57, 294912
    s_add_u32 m0, s54, 12288
    s_nop 0
    buffer_load_dwordx4 v228, s[20:23], s57 offen offset:0 lds
    s_add_u32 m0, s54, 16256
    s_nop 0
    buffer_load_dwordx4 v228, s[20:23], s57 offen offset:128 lds
    s_add_u32 m0, s54, 20224
    s_nop 0
    buffer_load_dwordx4 v228, s[20:23], s57 offen offset:256 lds
    s_add_u32 s57, s57, 294912
    s_add_u32 m0, s55, 16384
    s_nop 0
    buffer_load_dwordx4 v224, s[16:19], s56 offen offset:0 lds
    buffer_load_dwordx4 v225, s[16:19], s56 offen offset:1024 lds
    buffer_load_dwordx4 v226, s[16:19], s56 offen offset:2048 lds
    buffer_load_dwordx4 v227, s[16:19], s56 offen offset:3072 lds
    s_add_u32 s56, s56, 128
    s_add_u32 m0, s54, 24576
    s_nop 0
    buffer_load_dwordx4 v228, s[20:23], s57 offen offset:0 lds
    s_add_u32 m0, s54, 28544
    s_nop 0
    buffer_load_dwordx4 v228, s[20:23], s57 offen offset:128 lds
    s_add_u32 m0, s54, 32512
    s_nop 0
    buffer_load_dwordx4 v228, s[20:23], s57 offen offset:256 lds
    s_add_u32 s57, s57, 294912
    s_add_u32 m0, s54, 36864
    s_nop 0
    buffer_load_dwordx4 v228, s[20:23], s57 offen offset:0 lds
    s_add_u32 m0, s54, 40832
    s_nop 0
    buffer_load_dwordx4 v228, s[20:23], s57 offen offset:128 lds
    s_add_u32 m0, s54, 44800
    s_nop 0
    buffer_load_dwordx4 v228, s[20:23], s57 offen offset:256 lds
    s_add_u32 s57, s57, 294912
    s_add_u32 s48, s68, 0
    s_addc_u32 s49, s69, 0
    s_mov_b32 s50, 256
    s_mov_b32 s51, 0x00020000
    v_mov_b32 v234, 0
    buffer_load_dwordx2 v[232:233], v234, s[48:51], 0 offen sc0 sc1
    s_add_u32 s40, s12, 0
    s_addc_u32 s41, s13, 0
    s_mov_b32 s42, 5308416
    s_mov_b32 s43, 0x00020000
    s_add_u32 s44, s10, 0
    s_addc_u32 s45, s11, 0
    s_mov_b32 s46, 1990656
    s_mov_b32 s47, 0x00020000
    s_lshl_b32 s25, s2, 2
    s_add_u32 s25, s25, s6
    s_lshl_b32 s25, s25, 10
    s_add_u32 s26, s25, 2097152
    s_add_u32 s27, s25, 4194304
    v_lshlrev_b32 v3, 4, v0
    buffer_load_dwordx4 v[252:255], v3, s[16:19], s25 offen
    buffer_load_dwordx4 v[252:255], v3, s[40:43], s25 offen
    buffer_load_dwordx4 v[252:255], v3, s[44:47], s25 offen
    buffer_load_dwordx4 v[252:255], v3, s[40:43], s26 offen
    buffer_load_dwordx4 v[252:255], v3, s[16:19], s26 offen
    buffer_load_dwordx4 v[252:255], v3, s[40:43], s27 offen
    s_and_b32 s29, s6, 1
    s_lshl_b32 s29, s29, 13
    v_and_b32 v8, 31, v0
    v_and_b32 v9, 0x33, v8
    v_and_b32 v10, 4, v8
    v_lshl_or_b32 v9, v10, 1, v9
    v_and_b32 v10, 8, v8
    v_lshrrev_b32 v10, 1, v10
    v_or_b32 v9, v9, v10
    v_lshrrev_b32 v10, 5, v0
    v_bfe_u32 v11, v9, 1, 3
    v_xor_b32 v11, v11, v10
    v_lshlrev_b32 v11, 4, v11
    v_lshl_add_u32 v11, v9, 7, v11
    v_add_u32 v216, s29, v11
    v_xor_b32 v217, 32, v216
    v_xor_b32 v218, 64, v216
    v_xor_b32 v219, 96, v216
    v_mov_b32 v15, v10
    v_bfe_u32 v12, v0, 2, 2
    v_lshl_add_u32 v13, v10, 3, v12
    v_lshlrev_b32 v13, 7, v13
    v_and_b32 v14, 2, v12
    v_lshl_add_u32 v13, v14, 5, v13
    v_and_b32 v14, 16, v0
    v_lshl_add_u32 v13, v14, 1, v13
    v_and_b32 v14, 1, v0
    v_lshl_add_u32 v13, v14, 4, v13
    v_and_b32 v14, 2, v0
    v_lshl_add_u32 v13, v14, 2, v13
    s_lshr_b32 s30, s6, 1
    s_mul_i32 s31, s30, 3
    s_add_u32 s32, s31, 0
    s_and_b32 s33, s32, 1
    s_lshl_b32 s33, s33, 6
    s_lshr_b32 s32, s32, 1
    s_lshl_b32 s32, s32, 12
    s_add_u32 s32, s32, 32768
    v_xor_b32 v14, s33, v13
    v_add_u32 v220, s32, v14
    s_add_u32 s32, s31, 1
    s_and_b32 s33, s32, 1
    s_lshl_b32 s33, s33, 6
    s_lshr_b32 s32, s32, 1
    s_lshl_b32 s32, s32, 12
    s_add_u32 s32, s32, 32768
    v_xor_b32 v14, s33, v13
    v_add_u32 v221, s32, v14
    s_add_u32 s32, s31, 2
    s_and_b32 s33, s32, 1
    s_lshl_b32 s33, s33, 6
    s_lshr_b32 s32, s32, 1
    s_lshl_b32 s32, s32, 12
    s_add_u32 s32, s32, 32768
    v_xor_b32 v14, s33, v13
    v_add_u32 v222, s32, v14
    s_waitcnt vmcnt(20)
    s_waitcnt lgkmcnt(0)
    s_barrier
    ds_read_b128 v[112:115], v216 offset:0
    ds_read_b128 v[116:119], v216 offset:4096
    ds_read_b64_tr_b16 v[176:177], v220 offset:0
    ds_read_b64_tr_b16 v[178:179], v220 offset:512
    ds_read_b64_tr_b16 v[180:181], v221 offset:0
    ds_read_b64_tr_b16 v[182:183], v221 offset:512
    ds_read_b64_tr_b16 v[184:185], v222 offset:0
    ds_read_b64_tr_b16 v[186:187], v222 offset:512
    ds_read_b128 v[120:123], v217 offset:0
    ds_read_b128 v[124:127], v217 offset:4096
    s_waitcnt lgkmcnt(6)
    v_mfma_f32_32x32x16_bf16 v[16:31], v[112:115], v[176:179], 0
    ds_read_b64_tr_b16 v[188:189], v220 offset:2048
    ds_read_b64_tr_b16 v[190:191], v220 offset:2560
    ds_read_b64_tr_b16 v[192:193], v221 offset:2048
    ds_read_b64_tr_b16 v[194:195], v221 offset:2560
    v_mfma_f32_32x32x16_bf16 v[64:79], v[116:119], v[176:179], 0
    ds_read_b64_tr_b16 v[196:197], v222 offset:2048
    ds_read_b64_tr_b16 v[198:199], v222 offset:2560
    ds_read_b128 v[128:131], v218 offset:0
    s_waitcnt lgkmcnt(11)
    v_mfma_f32_32x32x16_bf16 v[32:47], v[112:115], v[180:183], 0
    ds_read_b128 v[132:135], v218 offset:4096
    ds_read_b128 v[136:139], v219 offset:0
    ds_read_b128 v[140:143], v219 offset:4096
    v_mfma_f32_32x32x16_bf16 v[80:95], v[116:119], v[180:183], 0
    s_waitcnt lgkmcnt(12)
    v_mfma_f32_32x32x16_bf16 v[48:63], v[112:115], v[184:187], 0
    v_mfma_f32_32x32x16_bf16 v[96:111], v[116:119], v[184:187], 0
    s_waitcnt vmcnt(17)
    s_waitcnt lgkmcnt(0)
    s_barrier
    v_mfma_f32_32x32x16_bf16 v[16:31], v[120:123], v[188:191], v[16:31]
    ds_read_b64_tr_b16 v[176:177], v220 offset:12288
    ds_read_b64_tr_b16 v[178:179], v220 offset:12800
    v_mfma_f32_32x32x16_bf16 v[64:79], v[124:127], v[188:191], v[64:79]
    ds_read_b64_tr_b16 v[180:181], v221 offset:12288
    ds_read_b64_tr_b16 v[182:183], v221 offset:12800
    v_mfma_f32_32x32x16_bf16 v[32:47], v[120:123], v[192:195], v[32:47]
    ds_read_b64_tr_b16 v[184:185], v222 offset:12288
    ds_read_b64_tr_b16 v[186:187], v222 offset:12800
    v_mfma_f32_32x32x16_bf16 v[80:95], v[124:127], v[192:195], v[80:95]
    s_add_u32 m0, s54, 0
    s_nop 0
    buffer_load_dwordx4 v228, s[20:23], s57 offen offset:0 lds
    v_mfma_f32_32x32x16_bf16 v[48:63], v[120:123], v[196:199], v[48:63]
    s_add_u32 m0, s54, 3968
    s_nop 0
    buffer_load_dwordx4 v228, s[20:23], s57 offen offset:128 lds
    v_mfma_f32_32x32x16_bf16 v[96:111], v[124:127], v[196:199], v[96:111]
    s_add_u32 m0, s54, 7936
    s_nop 0
    buffer_load_dwordx4 v228, s[20:23], s57 offen offset:256 lds
    s_add_u32 s57, s57, 294912
    s_waitcnt lgkmcnt(4)
    v_mfma_f32_32x32x16_bf16 v[16:31], v[128:131], v[176:179], v[16:31]
    ds_read_b64_tr_b16 v[188:189], v220 offset:14336
    ds_read_b64_tr_b16 v[190:191], v220 offset:14848
    v_mfma_f32_32x32x16_bf16 v[64:79], v[132:135], v[176:179], v[64:79]
    ds_read_b64_tr_b16 v[192:193], v221 offset:14336
    ds_read_b64_tr_b16 v[194:195], v221 offset:14848
    s_waitcnt lgkmcnt(6)
    v_mfma_f32_32x32x16_bf16 v[32:47], v[128:131], v[180:183], v[32:47]
    ds_read_b64_tr_b16 v[196:197], v222 offset:14336
    ds_read_b64_tr_b16 v[198:199], v222 offset:14848
    v_mfma_f32_32x32x16_bf16 v[80:95], v[132:135], v[180:183], v[80:95]
    s_add_u32 m0, s55, 0
    s_nop 0
    buffer_load_dwordx4 v224, s[16:19], s56 offen offset:0 lds
    buffer_load_dwordx4 v225, s[16:19], s56 offen offset:1024 lds
    s_waitcnt lgkmcnt(6)
    v_mfma_f32_32x32x16_bf16 v[48:63], v[128:131], v[184:187], v[48:63]
    buffer_load_dwordx4 v226, s[16:19], s56 offen offset:2048 lds
    v_mfma_f32_32x32x16_bf16 v[96:111], v[132:135], v[184:187], v[96:111]
    buffer_load_dwordx4 v227, s[16:19], s56 offen offset:3072 lds
    s_add_u32 s56, s56, 128
    s_waitcnt vmcnt(17)
    s_waitcnt lgkmcnt(0)
    s_barrier
    v_mfma_f32_32x32x16_bf16 v[16:31], v[136:139], v[188:191], v[16:31]
    ds_read_b128 v[144:147], v216 offset:16384
    ds_read_b128 v[148:151], v216 offset:20480
    ds_read_b64_tr_b16 v[176:177], v220 offset:24576
    ds_read_b64_tr_b16 v[178:179], v220 offset:25088
    v_mfma_f32_32x32x16_bf16 v[64:79], v[140:143], v[188:191], v[64:79]
    ds_read_b64_tr_b16 v[180:181], v221 offset:24576
    ds_read_b64_tr_b16 v[182:183], v221 offset:25088
    ds_read_b64_tr_b16 v[184:185], v222 offset:24576
    v_mfma_f32_32x32x16_bf16 v[32:47], v[136:139], v[192:195], v[32:47]
    ds_read_b64_tr_b16 v[186:187], v222 offset:25088
    ds_read_b128 v[152:155], v217 offset:16384
    ds_read_b128 v[156:159], v217 offset:20480
    v_mfma_f32_32x32x16_bf16 v[80:95], v[140:143], v[192:195], v[80:95]
    s_add_u32 m0, s54, 12288
    s_nop 0
    buffer_load_dwordx4 v228, s[20:23], s57 offen offset:0 lds
    v_mfma_f32_32x32x16_bf16 v[48:63], v[136:139], v[196:199], v[48:63]
    s_add_u32 m0, s54, 16256
    s_nop 0
    buffer_load_dwordx4 v228, s[20:23], s57 offen offset:128 lds
    v_mfma_f32_32x32x16_bf16 v[96:111], v[140:143], v[196:199], v[96:111]
    s_add_u32 m0, s54, 20224
    s_nop 0
    buffer_load_dwordx4 v228, s[20:23], s57 offen offset:256 lds
    s_add_u32 s57, s57, 294912
    s_waitcnt lgkmcnt(6)
    v_mfma_f32_32x32x16_bf16 v[16:31], v[144:147], v[176:179], v[16:31]
    ds_read_b64_tr_b16 v[188:189], v220 offset:26624
    ds_read_b64_tr_b16 v[190:191], v220 offset:27136
    ds_read_b64_tr_b16 v[192:193], v221 offset:26624
    ds_read_b64_tr_b16 v[194:195], v221 offset:27136
    v_mfma_f32_32x32x16_bf16 v[64:79], v[148:151], v[176:179], v[64:79]
    ds_read_b64_tr_b16 v[196:197], v222 offset:26624
    ds_read_b64_tr_b16 v[198:199], v222 offset:27136
    ds_read_b128 v[160:163], v218 offset:16384
    s_waitcnt lgkmcnt(11)
    v_mfma_f32_32x32x16_bf16 v[32:47], v[144:147], v[180:183], v[32:47]
    ds_read_b128 v[164:167], v218 offset:20480
    ds_read_b128 v[168:171], v219 offset:16384
    ds_read_b128 v[172:175], v219 offset:20480
    v_mfma_f32_32x32x16_bf16 v[80:95], v[148:151], v[180:183], v[80:95]
    s_waitcnt lgkmcnt(12)
    v_mfma_f32_32x32x16_bf16 v[48:63], v[144:147], v[184:187], v[48:63]
    v_mfma_f32_32x32x16_bf16 v[96:111], v[148:151], v[184:187], v[96:111]
    s_waitcnt vmcnt(17)
    s_waitcnt lgkmcnt(0)
    s_barrier
    v_mfma_f32_32x32x16_bf16 v[16:31], v[152:155], v[188:191], v[16:31]
    ds_read_b64_tr_b16 v[176:177], v220 offset:36864
    ds_read_b64_tr_b16 v[178:179], v220 offset:37376
    v_mfma_f32_32x32x16_bf16 v[64:79], v[156:159], v[188:191], v[64:79]
    ds_read_b64_tr_b16 v[180:181], v221 offset:36864
    ds_read_b64_tr_b16 v[182:183], v221 offset:37376
    v_mfma_f32_32x32x16_bf16 v[32:47], v[152:155], v[192:195], v[32:47]
    ds_read_b64_tr_b16 v[184:185], v222 offset:36864
    ds_read_b64_tr_b16 v[186:187], v222 offset:37376
    v_mfma_f32_32x32x16_bf16 v[80:95], v[156:159], v[192:195], v[80:95]
    s_add_u32 m0, s54, 24576
    s_nop 0
    buffer_load_dwordx4 v228, s[20:23], s57 offen offset:0 lds
    v_mfma_f32_32x32x16_bf16 v[48:63], v[152:155], v[196:199], v[48:63]
    s_add_u32 m0, s54, 28544
    s_nop 0
    buffer_load_dwordx4 v228, s[20:23], s57 offen offset:128 lds
    v_mfma_f32_32x32x16_bf16 v[96:111], v[156:159], v[196:199], v[96:111]
    s_add_u32 m0, s54, 32512
    s_nop 0
    buffer_load_dwordx4 v228, s[20:23], s57 offen offset:256 lds
    s_add_u32 s57, s57, 294912
    s_waitcnt lgkmcnt(4)
    v_mfma_f32_32x32x16_bf16 v[16:31], v[160:163], v[176:179], v[16:31]
    ds_read_b64_tr_b16 v[188:189], v220 offset:38912
    ds_read_b64_tr_b16 v[190:191], v220 offset:39424
    v_mfma_f32_32x32x16_bf16 v[64:79], v[164:167], v[176:179], v[64:79]
    ds_read_b64_tr_b16 v[192:193], v221 offset:38912
    ds_read_b64_tr_b16 v[194:195], v221 offset:39424
    s_waitcnt lgkmcnt(6)
    v_mfma_f32_32x32x16_bf16 v[32:47], v[160:163], v[180:183], v[32:47]
    ds_read_b64_tr_b16 v[196:197], v222 offset:38912
    ds_read_b64_tr_b16 v[198:199], v222 offset:39424
    v_mfma_f32_32x32x16_bf16 v[80:95], v[164:167], v[180:183], v[80:95]
    s_add_u32 m0, s55, 16384
    s_nop 0
    buffer_load_dwordx4 v224, s[16:19], s56 offen offset:0 lds
    buffer_load_dwordx4 v225, s[16:19], s56 offen offset:1024 lds
    s_waitcnt lgkmcnt(6)
    v_mfma_f32_32x32x16_bf16 v[48:63], v[160:163], v[184:187], v[48:63]
    buffer_load_dwordx4 v226, s[16:19], s56 offen offset:2048 lds
    v_mfma_f32_32x32x16_bf16 v[96:111], v[164:167], v[184:187], v[96:111]
    buffer_load_dwordx4 v227, s[16:19], s56 offen offset:3072 lds
    s_add_u32 s56, s56, 128
    s_waitcnt vmcnt(14)
    s_waitcnt vmcnt(10)
    s_waitcnt lgkmcnt(0)
    s_barrier
    v_mfma_f32_32x32x16_bf16 v[16:31], v[168:171], v[188:191], v[16:31]
    ds_read_b128 v[112:115], v216 offset:0
    ds_read_b128 v[116:119], v216 offset:4096
    ds_read_b64_tr_b16 v[176:177], v220 offset:0
    ds_read_b64_tr_b16 v[178:179], v220 offset:512
    v_mfma_f32_32x32x16_bf16 v[64:79], v[172:175], v[188:191], v[64:79]
    ds_read_b64_tr_b16 v[180:181], v221 offset:0
    ds_read_b64_tr_b16 v[182:183], v221 offset:512
    ds_read_b64_tr_b16 v[184:185], v222 offset:0
    v_mfma_f32_32x32x16_bf16 v[32:47], v[168:171], v[192:195], v[32:47]
    ds_read_b64_tr_b16 v[186:187], v222 offset:512
    ds_read_b128 v[120:123], v217 offset:0
    ds_read_b128 v[124:127], v217 offset:4096
    v_mfma_f32_32x32x16_bf16 v[80:95], v[172:175], v[192:195], v[80:95]
    s_add_u32 m0, s54, 36864
    s_nop 0
    buffer_load_dwordx4 v228, s[20:23], s57 offen offset:0 lds
    v_mfma_f32_32x32x16_bf16 v[48:63], v[168:171], v[196:199], v[48:63]
    s_add_u32 m0, s54, 40832
    s_nop 0
    buffer_load_dwordx4 v228, s[20:23], s57 offen offset:128 lds
    v_mfma_f32_32x32x16_bf16 v[96:111], v[172:175], v[196:199], v[96:111]
    s_add_u32 m0, s54, 44800
    s_nop 0
    buffer_load_dwordx4 v228, s[20:23], s57 offen offset:256 lds
    s_add_u32 s57, s57, 294912
    v_readfirstlane_b32 s76, v232
    v_readfirstlane_b32 s77, v233
    s_mov_b32 s38, 0x40000
gated_mix__mha_block__mixer_gmlp__prompt_kernel_z2_n:
    s_nop 1
    s_cmp_eq_u32 s76, 0
    s_cbranch_scc1 gated_mix__mha_block__mixer_gmlp__prompt_kernel_z2_n_r
    s_sub_u32 s39, s76, s78
    s_add_u32 s39, s39, 2000
    s_cmp_ge_i32 s39, 0
    s_cbranch_scc1 gated_mix__mha_block__mixer_gmlp__prompt_kernel_z2_n_ok
    s_cmp_lt_u32 s38, 262080
    s_cbranch_scc1 gated_mix__mha_block__mixer_gmlp__prompt_kernel_z2_n_ok
gated_mix__mha_block__mixer_gmlp__prompt_kernel_z2_n_r:
    buffer_load_dwordx2 v[232:233], v234, s[48:51], 0 offen sc0 sc1
    s_waitcnt vmcnt(0)
    v_readfirstlane_b32 s76, v232
    v_readfirstlane_b32 s77, v233
    s_sub_u32 s38, s38, 1
    s_cmp_lg_u32 s38, 0
    s_nop 3
    s_cbranch_scc1 gated_mix__mha_block__mixer_gmlp__prompt_kernel_z2_n
gated_mix__mha_block__mixer_gmlp__prompt_kernel_z2_n_ok:
    s_nop 1
    s_waitcnt lgkmcnt(6)
    v_mfma_f32_32x32x16_bf16 v[16:31], v[112:115], v[176:179], v[16:31]
    ds_read_b64_tr_b16 v[188:189], v220 offset:2048
    ds_read_b64_tr_b16 v[190:191], v220 offset:2560
    ds_read_b64_tr_b16 v[192:193], v221 offset:2048
    ds_read_b64_tr_b16 v[194:195], v221 offset:2560
    v_mfma_f32_32x32x16_bf16 v[64:79], v[116:119], v[176:179], v[64:79]
    ds_read_b64_tr_b16 v[196:197], v222 offset:2048
    ds_read_b64_tr_b16 v[198:199], v222 offset:2560
    ds_read_b128 v[128:131], v218 offset:0
    s_waitcnt lgkmcnt(11)
    v_mfma_f32_32x32x16_bf16 v[32:47], v[112:115], v[180:183], v[32:47]
    ds_read_b128 v[132:135], v218 offset:4096
    ds_read_b128 v[136:139], v219 offset:0
    ds_read_b128 v[140:143], v219 offset:4096
    v_mfma_f32_32x32x16_bf16 v[80:95], v[116:119], v[180:183], v[80:95]
    s_and_b32 s39, s2, 255
    s_lshl_b32 s39, s39, 7
    s_lshl_b32 s38, s6, 6
    v_add_lshl_u32 v10, v0, s38, 20
    v_mov_b32 v12, s76
    s_waitcnt lgkmcnt(12)
    v_mfma_f32_32x32x16_bf16 v[48:63], v[112:115], v[184:187], v[48:63]
    v_mov_b32 v13, s77
    v_mfma_f32_32x32x16_bf16 v[96:111], v[116:119], v[184:187], v[96:111]
    buffer_store_dwordx2 v[12:13], v10, s[72:75], s39 offen sc0 sc1
    s_waitcnt vmcnt(11)
    s_waitcnt lgkmcnt(0)
    s_barrier
    v_mfma_f32_32x32x16_bf16 v[16:31], v[120:123], v[188:191], v[16:31]
    ds_read_b64_tr_b16 v[176:177], v220 offset:12288
    ds_read_b64_tr_b16 v[178:179], v220 offset:12800
    v_mfma_f32_32x32x16_bf16 v[64:79], v[124:127], v[188:191], v[64:79]
    ds_read_b64_tr_b16 v[180:181], v221 offset:12288
    ds_read_b64_tr_b16 v[182:183], v221 offset:12800
    v_mfma_f32_32x32x16_bf16 v[32:47], v[120:123], v[192:195], v[32:47]
    ds_read_b64_tr_b16 v[184:185], v222 offset:12288
    ds_read_b64_tr_b16 v[186:187], v222 offset:12800
    v_mfma_f32_32x32x16_bf16 v[80:95], v[124:127], v[192:195], v[80:95]
    s_add_u32 m0, s54, 0
    s_nop 0
    buffer_load_dwordx4 v228, s[20:23], s57 offen offset:0 lds
    v_mfma_f32_32x32x16_bf16 v[48:63], v[120:123], v[196:199], v[48:63]
    s_add_u32 m0, s54, 3968
    s_nop 0
    buffer_load_dwordx4 v228, s[20:23], s57 offen offset:128 lds
    v_mfma_f32_32x32x16_bf16 v[96:111], v[124:127], v[196:199], v[96:111]
    s_add_u32 m0, s54, 7936
    s_nop 0
    buffer_load_dwordx4 v228, s[20:23], s57 offen offset:256 lds
    s_add_u32 s57, s57, 294912
    s_waitcnt lgkmcnt(4)
    v_mfma_f32_32x32x16_bf16 v[16:31], v[128:131], v[176:179], v[16:31]
    ds_read_b64_tr_b16 v[188:189], v220 offset:14336
    ds_read_b64_tr_b16 v[190:191], v220 offset:14848
    v_mfma_f32_32x32x16_bf16 v[64:79], v[132:135], v[176:179], v[64:79]
    ds_read_b64_tr_b16 v[192:193], v221 offset:14336
    ds_read_b64_tr_b16 v[194:195], v221 offset:14848
    s_waitcnt lgkmcnt(6)
    v_mfma_f32_32x32x16_bf16 v[32:47], v[128:131], v[180:183], v[32:47]
    ds_read_b64_tr_b16 v[196:197], v222 offset:14336
    ds_read_b64_tr_b16 v[198:199], v222 offset:14848
    v_mfma_f32_32x32x16_bf16 v[80:95], v[132:135], v[180:183], v[80:95]
    s_add_u32 m0, s55, 0
    s_nop 0
    buffer_load_dwordx4 v224, s[16:19], s56 offen offset:0 lds
    buffer_load_dwordx4 v225, s[16:19], s56 offen offset:1024 lds
    s_waitcnt lgkmcnt(6)
    v_mfma_f32_32x32x16_bf16 v[48:63], v[128:131], v[184:187], v[48:63]
    buffer_load_dwordx4 v226, s[16:19], s56 offen offset:2048 lds
    v_mfma_f32_32x32x16_bf16 v[96:111], v[132:135], v[184:187], v[96:111]
    buffer_load_dwordx4 v227, s[16:19], s56 offen offset:3072 lds
    s_add_u32 s56, s56, 128
    s_waitcnt vmcnt(15)
    s_waitcnt vmcnt(11)
    s_waitcnt lgkmcnt(0)
    s_barrier
    v_mfma_f32_32x32x16_bf16 v[16:31], v[136:139], v[188:191], v[16:31]
    ds_read_b128 v[144:147], v216 offset:16384
    ds_read_b128 v[148:151], v216 offset:20480
    ds_read_b64_tr_b16 v[176:177], v220 offset:24576
    ds_read_b64_tr_b16 v[178:179], v220 offset:25088
    v_mfma_f32_32x32x16_bf16 v[64:79], v[140:143], v[188:191], v[64:79]
    ds_read_b64_tr_b16 v[180:181], v221 offset:24576
    ds_read_b64_tr_b16 v[182:183], v221 offset:25088
    ds_read_b64_tr_b16 v[184:185], v222 offset:24576
    v_mfma_f32_32x32x16_bf16 v[32:47], v[136:139], v[192:195], v[32:47]
    ds_read_b64_tr_b16 v[186:187], v222 offset:25088
    ds_read_b128 v[152:155], v217 offset:16384
    ds_read_b128 v[156:159], v217 offset:20480
    v_mfma_f32_32x32x16_bf16 v[80:95], v[140:143], v[192:195], v[80:95]
    s_add_u32 m0, s54, 12288
    s_nop 0
    buffer_load_dwordx4 v228, s[20:23], s57 offen offset:0 lds
    v_mfma_f32_32x32x16_bf16 v[48:63], v[136:139], v[196:199], v[48:63]
    s_add_u32 m0, s54, 16256
    s_nop 0
    buffer_load_dwordx4 v228, s[20:23], s57 offen offset:128 lds
    v_mfma_f32_32x32x16_bf16 v[96:111], v[140:143], v[196:199], v[96:111]
    s_add_u32 m0, s54, 20224
    s_nop 0
    buffer_load_dwordx4 v228, s[20:23], s57 offen offset:256 lds
    s_add_u32 s57, s57, 294912
    s_waitcnt lgkmcnt(6)
    v_mfma_f32_32x32x16_bf16 v[16:31], v[144:147], v[176:179], v[16:31]
    ds_read_b64_tr_b16 v[188:189], v220 offset:26624
    ds_read_b64_tr_b16 v[190:191], v220 offset:27136
    ds_read_b64_tr_b16 v[192:193], v221 offset:26624
    ds_read_b64_tr_b16 v[194:195], v221 offset:27136
    v_mfma_f32_32x32x16_bf16 v[64:79], v[148:151], v[176:179], v[64:79]
    ds_read_b64_tr_b16 v[196:197], v222 offset:26624
    ds_read_b64_tr_b16 v[198:199], v222 offset:27136
    ds_read_b128 v[160:163], v218 offset:16384
    s_waitcnt lgkmcnt(11)
    v_mfma_f32_32x32x16_bf16 v[32:47], v[144:147], v[180:183], v[32:47]
    ds_read_b128 v[164:167], v218 offset:20480
    ds_read_b128 v[168:171], v219 offset:16384
    ds_read_b128 v[172:175], v219 offset:20480
    v_mfma_f32_32x32x16_bf16 v[80:95], v[148:151], v[180:183], v[80:95]
    s_waitcnt lgkmcnt(12)
    v_mfma_f32_32x32x16_bf16 v[48:63], v[144:147], v[184:187], v[48:63]
    v_mfma_f32_32x32x16_bf16 v[96:111], v[148:151], v[184:187], v[96:111]
    s_waitcnt vmcnt(11)
    s_waitcnt lgkmcnt(0)
    s_barrier
    v_mfma_f32_32x32x16_bf16 v[16:31], v[152:155], v[188:191], v[16:31]
    ds_read_b64_tr_b16 v[176:177], v220 offset:36864
    ds_read_b64_tr_b16 v[178:179], v220 offset:37376
    v_mfma_f32_32x32x16_bf16 v[64:79], v[156:159], v[188:191], v[64:79]
    ds_read_b64_tr_b16 v[180:181], v221 offset:36864
    ds_read_b64_tr_b16 v[182:183], v221 offset:37376
    v_mfma_f32_32x32x16_bf16 v[32:47], v[152:155], v[192:195], v[32:47]
    ds_read_b64_tr_b16 v[184:185], v222 offset:36864
    ds_read_b64_tr_b16 v[186:187], v222 offset:37376
    v_mfma_f32_32x32x16_bf16 v[80:95], v[156:159], v[192:195], v[80:95]
    s_add_u32 m0, s54, 24576
    s_nop 0
    buffer_load_dwordx4 v228, s[20:23], s57 offen offset:0 lds
    v_mfma_f32_32x32x16_bf16 v[48:63], v[152:155], v[196:199], v[48:63]
    s_add_u32 m0, s54, 28544
    s_nop 0
    buffer_load_dwordx4 v228, s[20:23], s57 offen offset:128 lds
    v_mfma_f32_32x32x16_bf16 v[96:111], v[156:159], v[196:199], v[96:111]
    s_add_u32 m0, s54, 32512
    s_nop 0
    buffer_load_dwordx4 v228, s[20:23], s57 offen offset:256 lds
    s_add_u32 s57, s57, 294912
    s_waitcnt lgkmcnt(4)
    v_mfma_f32_32x32x16_bf16 v[16:31], v[160:163], v[176:179], v[16:31]
    ds_read_b64_tr_b16 v[188:189], v220 offset:38912
    ds_read_b64_tr_b16 v[190:191], v220 offset:39424
    v_mfma_f32_32x32x16_bf16 v[64:79], v[164:167], v[176:179], v[64:79]
    ds_read_b64_tr_b16 v[192:193], v221 offset:38912
    ds_read_b64_tr_b16 v[194:195], v221 offset:39424
    s_waitcnt lgkmcnt(6)
    v_mfma_f32_32x32x16_bf16 v[32:47], v[160:163], v[180:183], v[32:47]
    ds_read_b64_tr_b16 v[196:197], v222 offset:38912
    ds_read_b64_tr_b16 v[198:199], v222 offset:39424
    v_mfma_f32_32x32x16_bf16 v[80:95], v[164:167], v[180:183], v[80:95]
    s_add_u32 m0, s55, 16384
    s_nop 0
    buffer_load_dwordx4 v224, s[16:19], s56 offen offset:0 lds
    buffer_load_dwordx4 v225, s[16:19], s56 offen offset:1024 lds
    s_waitcnt lgkmcnt(6)
    v_mfma_f32_32x32x16_bf16 v[48:63], v[160:163], v[184:187], v[48:63]
    buffer_load_dwordx4 v226, s[16:19], s56 offen offset:2048 lds
    v_mfma_f32_32x32x16_bf16 v[96:111], v[164:167], v[184:187], v[96:111]
    buffer_load_dwordx4 v227, s[16:19], s56 offen offset:3072 lds
    s_add_u32 s56, s56, 128
    s_waitcnt vmcnt(14)
    s_waitcnt vmcnt(10)
    s_waitcnt lgkmcnt(0)
    s_barrier
    v_mfma_f32_32x32x16_bf16 v[16:31], v[168:171], v[188:191], v[16:31]
    ds_read_b128 v[112:115], v216 offset:0
    ds_read_b128 v[116:119], v216 offset:4096
    ds_read_b64_tr_b16 v[176:177], v220 offset:0
    ds_read_b64_tr_b16 v[178:179], v220 offset:512
    v_mfma_f32_32x32x16_bf16 v[64:79], v[172:175], v[188:191], v[64:79]
    ds_read_b64_tr_b16 v[180:181], v221 offset:0
    ds_read_b64_tr_b16 v[182:183], v221 offset:512
    ds_read_b64_tr_b16 v[184:185], v222 offset:0
    v_mfma_f32_32x32x16_bf16 v[32:47], v[168:171], v[192:195], v[32:47]
    ds_read_b64_tr_b16 v[186:187], v222 offset:512
    ds_read_b128 v[120:123], v217 offset:0
    ds_read_b128 v[124:127], v217 offset:4096
    v_mfma_f32_32x32x16_bf16 v[80:95], v[172:175], v[192:195], v[80:95]
    s_add_u32 m0, s54, 36864
    s_nop 0
    buffer_load_dwordx4 v228, s[20:23], s57 offen offset:0 lds
    v_mfma_f32_32x32x16_bf16 v[48:63], v[168:171], v[196:199], v[48:63]
    s_add_u32 m0, s54, 40832
    s_nop 0
    buffer_load_dwordx4 v228, s[20:23], s57 offen offset:128 lds
    v_mfma_f32_32x32x16_bf16 v[96:111], v[172:175], v[196:199], v[96:111]
    s_add_u32 m0, s54, 44800
    s_nop 0
    buffer_load_dwordx4 v228, s[20:23], s57 offen offset:256 lds
    s_add_u32 s57, s57, 294912
    s_waitcnt lgkmcnt(6)
    v_mfma_f32_32x32x16_bf16 v[16:31], v[112:115], v[176:179], v[16:31]
    ds_read_b64_tr_b16 v[188:189], v220 offset:2048
    ds_read_b64_tr_b16 v[190:191], v220 offset:2560
    ds_read_b64_tr_b16 v[192:193], v221 offset:2048
    ds_read_b64_tr_b16 v[194:195], v221 offset:2560
    v_mfma_f32_32x32x16_bf16 v[64:79], v[116:119], v[176:179], v[64:79]
    ds_read_b64_tr_b16 v[196:197], v222 offset:2048
    ds_read_b64_tr_b16 v[198:199], v222 offset:2560
    ds_read_b128 v[128:131], v218 offset:0
    s_waitcnt lgkmcnt(11)
    v_mfma_f32_32x32x16_bf16 v[32:47], v[112:115], v[180:183], v[32:47]
    ds_read_b128 v[132:135], v218 offset:4096
    ds_read_b128 v[136:139], v219 offset:0
    ds_read_b128 v[140:143], v219 offset:4096
    v_mfma_f32_32x32x16_bf16 v[80:95], v[116:119], v[180:183], v[80:95]
    s_waitcnt lgkmcnt(12)
    v_mfma_f32_32x32x16_bf16 v[48:63], v[112:115], v[184:187], v[48:63]
    v_mfma_f32_32x32x16_bf16 v[96:111], v[116:119], v[184:187], v[96:111]
    s_waitcnt vmcnt(10)
    s_waitcnt lgkmcnt(0)
    s_barrier
    v_mfma_f32_32x32x16_bf16 v[16:31], v[120:123], v[188:191], v[16:31]
    ds_read_b64_tr_b16 v[176:177], v220 offset:12288
    ds_read_b64_tr_b16 v[178:179], v220 offset:12800
    v_mfma_f32_32x32x16_bf16 v[64:79], v[124:127], v[188:191], v[64:79]
    ds_read_b64_tr_b16 v[180:181], v221 offset:12288
    ds_read_b64_tr_b16 v[182:183], v221 offset:12800
    v_mfma_f32_32x32x16_bf16 v[32:47], v[120:123], v[192:195], v[32:47]
    ds_read_b64_tr_b16 v[184:185], v222 offset:12288
    ds_read_b64_tr_b16 v[186:187], v222 offset:12800
    v_mfma_f32_32x32x16_bf16 v[80:95], v[124:127], v[192:195], v[80:95]
    s_add_u32 m0, s54, 0
    s_nop 0
    buffer_load_dwordx4 v228, s[20:23], s57 offen offset:0 lds
    v_mfma_f32_32x32x16_bf16 v[48:63], v[120:123], v[196:199], v[48:63]
    s_add_u32 m0, s54, 3968
    s_nop 0
    buffer_load_dwordx4 v228, s[20:23], s57 offen offset:128 lds
    v_mfma_f32_32x32x16_bf16 v[96:111], v[124:127], v[196:199], v[96:111]
    s_add_u32 m0, s54, 7936
    s_nop 0
    buffer_load_dwordx4 v228, s[20:23], s57 offen offset:256 lds
    s_add_u32 s57, s57, 294912
    s_waitcnt lgkmcnt(4)
    v_mfma_f32_32x32x16_bf16 v[16:31], v[128:131], v[176:179], v[16:31]
    ds_read_b64_tr_b16 v[188:189], v220 offset:14336
    ds_read_b64_tr_b16 v[190:191], v220 offset:14848
    v_mfma_f32_32x32x16_bf16 v[64:79], v[132:135], v[176:179], v[64:79]
    ds_read_b64_tr_b16 v[192:193], v221 offset:14336
    ds_read_b64_tr_b16 v[194:195], v221 offset:14848
    s_waitcnt lgkmcnt(6)
    v_mfma_f32_32x32x16_bf16 v[32:47], v[128:131], v[180:183], v[32:47]
    ds_read_b64_tr_b16 v[196:197], v222 offset:14336
    ds_read_b64_tr_b16 v[198:199], v222 offset:14848
    v_mfma_f32_32x32x16_bf16 v[80:95], v[132:135], v[180:183], v[80:95]
    s_add_u32 m0, s55, 0
    s_nop 0
    buffer_load_dwordx4 v224, s[16:19], s56 offen offset:0 lds
    buffer_load_dwordx4 v225, s[16:19], s56 offen offset:1024 lds
    s_waitcnt lgkmcnt(6)
    v_mfma_f32_32x32x16_bf16 v[48:63], v[128:131], v[184:187], v[48:63]
    buffer_load_dwordx4 v226, s[16:19], s56 offen offset:2048 lds
    v_mfma_f32_32x32x16_bf16 v[96:111], v[132:135], v[184:187], v[96:111]
    buffer_load_dwordx4 v227, s[16:19], s56 offen offset:3072 lds
    s_add_u32 s56, s56, 128
    s_waitcnt vmcnt(14)
    s_waitcnt vmcnt(10)
    s_waitcnt lgkmcnt(0)
    s_barrier
    v_mfma_f32_32x32x16_bf16 v[16:31], v[136:139], v[188:191], v[16:31]
    ds_read_b128 v[144:147], v216 offset:16384
    ds_read_b128 v[148:151], v216 offset:20480
    ds_read_b64_tr_b16 v[176:177], v220 offset:24576
    ds_read_b64_tr_b16 v[178:179], v220 offset:25088
    v_mfma_f32_32x32x16_bf16 v[64:79], v[140:143], v[188:191], v[64:79]
    ds_read_b64_tr_b16 v[180:181], v221 offset:24576
    ds_read_b64_tr_b16 v[182:183], v221 offset:25088
    ds_read_b64_tr_b16 v[184:185], v222 offset:24576
    v_mfma_f32_32x32x16_bf16 v[32:47], v[136:139], v[192:195], v[32:47]
    ds_read_b64_tr_b16 v[186:187], v222 offset:25088
    ds_read_b128 v[152:155], v217 offset:16384
    ds_read_b128 v[156:159], v217 offset:20480
    v_mfma_f32_32x32x16_bf16 v[80:95], v[140:143], v[192:195], v[80:95]
    s_add_u32 m0, s54, 12288
    s_nop 0
    buffer_load_dwordx4 v228, s[20:23], s57 offen offset:0 lds
    v_mfma_f32_32x32x16_bf16 v[48:63], v[136:139], v[196:199], v[48:63]
    s_add_u32 m0, s54, 16256
    s_nop 0
    buffer_load_dwordx4 v228, s[20:23], s57 offen offset:128 lds
    v_mfma_f32_32x32x16_bf16 v[96:111], v[140:143], v[196:199], v[96:111]
    s_add_u32 m0, s54, 20224
    s_nop 0
    buffer_load_dwordx4 v228, s[20:23], s57 offen offset:256 lds
    s_add_u32 s57, s57, 294912
    s_waitcnt lgkmcnt(6)
    v_mfma_f32_32x32x16_bf16 v[16:31], v[144:147], v[176:179], v[16:31]
    ds_read_b64_tr_b16 v[188:189], v220 offset:26624
    ds_read_b64_tr_b16 v[190:191], v220 offset:27136
    ds_read_b64_tr_b16 v[192:193], v221 offset:26624
    ds_read_b64_tr_b16 v[194:195], v221 offset:27136
    v_mfma_f32_32x32x16_bf16 v[64:79], v[148:151], v[176:179], v[64:79]
    ds_read_b64_tr_b16 v[196:197], v222 offset:26624
    ds_read_b64_tr_b16 v[198:199], v222 offset:27136
    ds_read_b128 v[160:163], v218 offset:16384
    s_waitcnt lgkmcnt(11)
    v_mfma_f32_32x32x16_bf16 v[32:47], v[144:147], v[180:183], v[32:47]
    ds_read_b128 v[164:167], v218 offset:20480
    ds_read_b128 v[168:171], v219 offset:16384
    ds_read_b128 v[172:175], v219 offset:20480
    v_mfma_f32_32x32x16_bf16 v[80:95], v[148:151], v[180:183], v[80:95]
    s_waitcnt lgkmcnt(12)
    v_mfma_f32_32x32x16_bf16 v[48:63], v[144:147], v[184:187], v[48:63]
    v_mfma_f32_32x32x16_bf16 v[96:111], v[148:151], v[184:187], v[96:111]
    s_waitcnt vmcnt(10)
    s_waitcnt lgkmcnt(0)
    s_barrier
    v_mfma_f32_32x32x16_bf16 v[16:31], v[152:155], v[188:191], v[16:31]
    ds_read_b64_tr_b16 v[176:177], v220 offset:36864
    ds_read_b64_tr_b16 v[178:179], v220 offset:37376
    v_mfma_f32_32x32x16_bf16 v[64:79], v[156:159], v[188:191], v[64:79]
    ds_read_b64_tr_b16 v[180:181], v221 offset:36864
    ds_read_b64_tr_b16 v[182:183], v221 offset:37376
    v_mfma_f32_32x32x16_bf16 v[32:47], v[152:155], v[192:195], v[32:47]
    ds_read_b64_tr_b16 v[184:185], v222 offset:36864
    ds_read_b64_tr_b16 v[186:187], v222 offset:37376
    v_mfma_f32_32x32x16_bf16 v[80:95], v[156:159], v[192:195], v[80:95]
    s_add_u32 m0, s54, 24576
    s_nop 0
    buffer_load_dwordx4 v228, s[20:23], s57 offen offset:0 lds
    v_mfma_f32_32x32x16_bf16 v[48:63], v[152:155], v[196:199], v[48:63]
    s_add_u32 m0, s54, 28544
    s_nop 0
    buffer_load_dwordx4 v228, s[20:23], s57 offen offset:128 lds
    v_mfma_f32_32x32x16_bf16 v[96:111], v[156:159], v[196:199], v[96:111]
    s_add_u32 m0, s54, 32512
    s_nop 0
    buffer_load_dwordx4 v228, s[20:23], s57 offen offset:256 lds
    s_add_u32 s57, s57, 294912
    s_waitcnt lgkmcnt(4)
    v_mfma_f32_32x32x16_bf16 v[16:31], v[160:163], v[176:179], v[16:31]
    ds_read_b64_tr_b16 v[188:189], v220 offset:38912
    ds_read_b64_tr_b16 v[190:191], v220 offset:39424
    v_mfma_f32_32x32x16_bf16 v[64:79], v[164:167], v[176:179], v[64:79]
    ds_read_b64_tr_b16 v[192:193], v221 offset:38912
    ds_read_b64_tr_b16 v[194:195], v221 offset:39424
    s_waitcnt lgkmcnt(6)
    v_mfma_f32_32x32x16_bf16 v[32:47], v[160:163], v[180:183], v[32:47]
    ds_read_b64_tr_b16 v[196:197], v222 offset:38912
    ds_read_b64_tr_b16 v[198:199], v222 offset:39424
    v_mfma_f32_32x32x16_bf16 v[80:95], v[164:167], v[180:183], v[80:95]
    s_add_u32 m0, s55, 16384
    s_nop 0
    buffer_load_dwordx4 v224, s[16:19], s56 offen offset:0 lds
    buffer_load_dwordx4 v225, s[16:19], s56 offen offset:1024 lds
    s_waitcnt lgkmcnt(6)
    v_mfma_f32_32x32x16_bf16 v[48:63], v[160:163], v[184:187], v[48:63]
    buffer_load_dwordx4 v226, s[16:19], s56 offen offset:2048 lds
    v_mfma_f32_32x32x16_bf16 v[96:111], v[164:167], v[184:187], v[96:111]
    buffer_load_dwordx4 v227, s[16:19], s56 offen offset:3072 lds
    s_add_u32 s56, s56, 128
    s_waitcnt vmcnt(14)
    s_waitcnt vmcnt(10)
    s_waitcnt lgkmcnt(0)
    s_barrier
    v_mfma_f32_32x32x16_bf16 v[16:31], v[168:171], v[188:191], v[16:31]
    ds_read_b128 v[112:115], v216 offset:0
    ds_read_b128 v[116:119], v216 offset:4096
    ds_read_b64_tr_b16 v[176:177], v220 offset:0
    ds_read_b64_tr_b16 v[178:179], v220 offset:512
    v_mfma_f32_32x32x16_bf16 v[64:79], v[172:175], v[188:191], v[64:79]
    ds_read_b64_tr_b16 v[180:181], v221 offset:0
    ds_read_b64_tr_b16 v[182:183], v221 offset:512
    ds_read_b64_tr_b16 v[184:185], v222 offset:0
    v_mfma_f32_32x32x16_bf16 v[32:47], v[168:171], v[192:195], v[32:47]
    ds_read_b64_tr_b16 v[186:187], v222 offset:512
    ds_read_b128 v[120:123], v217 offset:0
    ds_read_b128 v[124:127], v217 offset:4096
    v_mfma_f32_32x32x16_bf16 v[80:95], v[172:175], v[192:195], v[80:95]
    s_add_u32 m0, s54, 36864
    s_nop 0
    buffer_load_dwordx4 v228, s[20:23], s57 offen offset:0 lds
    v_mfma_f32_32x32x16_bf16 v[48:63], v[168:171], v[196:199], v[48:63]
    s_add_u32 m0, s54, 40832
    s_nop 0
    buffer_load_dwordx4 v228, s[20:23], s57 offen offset:128 lds
    v_mfma_f32_32x32x16_bf16 v[96:111], v[172:175], v[196:199], v[96:111]
    s_add_u32 m0, s54, 44800
    s_nop 0
    buffer_load_dwordx4 v228, s[20:23], s57 offen offset:256 lds
    s_add_u32 s57, s57, 294912
    s_waitcnt lgkmcnt(6)
    v_mfma_f32_32x32x16_bf16 v[16:31], v[112:115], v[176:179], v[16:31]
    ds_read_b64_tr_b16 v[188:189], v220 offset:2048
    ds_read_b64_tr_b16 v[190:191], v220 offset:2560
    ds_read_b64_tr_b16 v[192:193], v221 offset:2048
    ds_read_b64_tr_b16 v[194:195], v221 offset:2560
    v_mfma_f32_32x32x16_bf16 v[64:79], v[116:119], v[176:179], v[64:79]
    ds_read_b64_tr_b16 v[196:197], v222 offset:2048
    ds_read_b64_tr_b16 v[198:199], v222 offset:2560
    ds_read_b128 v[128:131], v218 offset:0
    s_waitcnt lgkmcnt(11)
    v_mfma_f32_32x32x16_bf16 v[32:47], v[112:115], v[180:183], v[32:47]
    ds_read_b128 v[132:135], v218 offset:4096
    ds_read_b128 v[136:139], v219 offset:0
    ds_read_b128 v[140:143], v219 offset:4096
    v_mfma_f32_32x32x16_bf16 v[80:95], v[116:119], v[180:183], v[80:95]
    s_waitcnt lgkmcnt(12)
    v_mfma_f32_32x32x16_bf16 v[48:63], v[112:115], v[184:187], v[48:63]
    v_mfma_f32_32x32x16_bf16 v[96:111], v[116:119], v[184:187], v[96:111]
    s_waitcnt vmcnt(10)
    s_waitcnt lgkmcnt(0)
    s_barrier
    v_mfma_f32_32x32x16_bf16 v[16:31], v[120:123], v[188:191], v[16:31]
    ds_read_b64_tr_b16 v[176:177], v220 offset:12288
    ds_read_b64_tr_b16 v[178:179], v220 offset:12800
    v_mfma_f32_32x32x16_bf16 v[64:79], v[124:127], v[188:191], v[64:79]
    ds_read_b64_tr_b16 v[180:181], v221 offset:12288
    ds_read_b64_tr_b16 v[182:183], v221 offset:12800
    v_mfma_f32_32x32x16_bf16 v[32:47], v[120:123], v[192:195], v[32:47]
    ds_read_b64_tr_b16 v[184:185], v222 offset:12288
    ds_read_b64_tr_b16 v[186:187], v222 offset:12800
    v_mfma_f32_32x32x16_bf16 v[80:95], v[124:127], v[192:195], v[80:95]
    s_add_u32 m0, s54, 0
    s_nop 0
    buffer_load_dwordx4 v228, s[20:23], s57 offen offset:0 lds
    v_mfma_f32_32x32x16_bf16 v[48:63], v[120:123], v[196:199], v[48:63]
    s_add_u32 m0, s54, 3968
    s_nop 0
    buffer_load_dwordx4 v228, s[20:23], s57 offen offset:128 lds
    v_mfma_f32_32x32x16_bf16 v[96:111], v[124:127], v[196:199], v[96:111]
    s_add_u32 m0, s54, 7936
    s_nop 0
    buffer_load_dwordx4 v228, s[20:23], s57 offen offset:256 lds
    s_add_u32 s57, s57, 294912
    s_waitcnt lgkmcnt(4)
    v_mfma_f32_32x32x16_bf16 v[16:31], v[128:131], v[176:179], v[16:31]
    ds_read_b64_tr_b16 v[188:189], v220 offset:14336
    ds_read_b64_tr_b16 v[190:191], v220 offset:14848
    v_mfma_f32_32x32x16_bf16 v[64:79], v[132:135], v[176:179], v[64:79]
    ds_read_b64_tr_b16 v[192:193], v221 offset:14336
    ds_read_b64_tr_b16 v[194:195], v221 offset:14848
    s_waitcnt lgkmcnt(6)
    v_mfma_f32_32x32x16_bf16 v[32:47], v[128:131], v[180:183], v[32:47]
    ds_read_b64_tr_b16 v[196:197], v222 offset:14336
    ds_read_b64_tr_b16 v[198:199], v222 offset:14848
    v_mfma_f32_32x32x16_bf16 v[80:95], v[132:135], v[180:183], v[80:95]
    s_add_u32 m0, s55, 0
    s_nop 0
    buffer_load_dwordx4 v224, s[16:19], s56 offen offset:0 lds
    buffer_load_dwordx4 v225, s[16:19], s56 offen offset:1024 lds
    s_waitcnt lgkmcnt(6)
    v_mfma_f32_32x32x16_bf16 v[48:63], v[128:131], v[184:187], v[48:63]
    buffer_load_dwordx4 v226, s[16:19], s56 offen offset:2048 lds
    v_mfma_f32_32x32x16_bf16 v[96:111], v[132:135], v[184:187], v[96:111]
    buffer_load_dwordx4 v227, s[16:19], s56 offen offset:3072 lds
    s_add_u32 s56, s56, 128
    s_waitcnt vmcnt(14)
    s_waitcnt vmcnt(10)
    s_waitcnt lgkmcnt(0)
    s_barrier
    v_mfma_f32_32x32x16_bf16 v[16:31], v[136:139], v[188:191], v[16:31]
    ds_read_b128 v[144:147], v216 offset:16384
    ds_read_b128 v[148:151], v216 offset:20480
    ds_read_b64_tr_b16 v[176:177], v220 offset:24576
    ds_read_b64_tr_b16 v[178:179], v220 offset:25088
    v_mfma_f32_32x32x16_bf16 v[64:79], v[140:143], v[188:191], v[64:79]
    ds_read_b64_tr_b16 v[180:181], v221 offset:24576
    ds_read_b64_tr_b16 v[182:183], v221 offset:25088
    ds_read_b64_tr_b16 v[184:185], v222 offset:24576
    v_mfma_f32_32x32x16_bf16 v[32:47], v[136:139], v[192:195], v[32:47]
    ds_read_b64_tr_b16 v[186:187], v222 offset:25088
    ds_read_b128 v[152:155], v217 offset:16384
    ds_read_b128 v[156:159], v217 offset:20480
    v_mfma_f32_32x32x16_bf16 v[80:95], v[140:143], v[192:195], v[80:95]
    s_add_u32 m0, s54, 12288
    s_nop 0
    buffer_load_dwordx4 v228, s[20:23], s57 offen offset:0 lds
    v_mfma_f32_32x32x16_bf16 v[48:63], v[136:139], v[196:199], v[48:63]
    s_add_u32 m0, s54, 16256
    s_nop 0
    buffer_load_dwordx4 v228, s[20:23], s57 offen offset:128 lds
    v_mfma_f32_32x32x16_bf16 v[96:111], v[140:143], v[196:199], v[96:111]
    s_add_u32 m0, s54, 20224
    s_nop 0
    buffer_load_dwordx4 v228, s[20:23], s57 offen offset:256 lds
    s_add_u32 s57, s57, 294912
    s_waitcnt lgkmcnt(6)
    v_mfma_f32_32x32x16_bf16 v[16:31], v[144:147], v[176:179], v[16:31]
    ds_read_b64_tr_b16 v[188:189], v220 offset:26624
    ds_read_b64_tr_b16 v[190:191], v220 offset:27136
    ds_read_b64_tr_b16 v[192:193], v221 offset:26624
    ds_read_b64_tr_b16 v[194:195], v221 offset:27136
    v_mfma_f32_32x32x16_bf16 v[64:79], v[148:151], v[176:179], v[64:79]
    ds_read_b64_tr_b16 v[196:197], v222 offset:26624
    ds_read_b64_tr_b16 v[198:199], v222 offset:27136
    ds_read_b128 v[160:163], v218 offset:16384
    s_waitcnt lgkmcnt(11)
    v_mfma_f32_32x32x16_bf16 v[32:47], v[144:147], v[180:183], v[32:47]
    ds_read_b128 v[164:167], v218 offset:20480
    ds_read_b128 v[168:171], v219 offset:16384
    ds_read_b128 v[172:175], v219 offset:20480
    v_mfma_f32_32x32x16_bf16 v[80:95], v[148:151], v[180:183], v[80:95]
    s_waitcnt lgkmcnt(12)
    v_mfma_f32_32x32x16_bf16 v[48:63], v[144:147], v[184:187], v[48:63]
    v_mfma_f32_32x32x16_bf16 v[96:111], v[148:151], v[184:187], v[96:111]
    s_waitcnt vmcnt(10)
    s_waitcnt lgkmcnt(0)
    s_barrier
    v_mfma_f32_32x32x16_bf16 v[16:31], v[152:155], v[188:191], v[16:31]
    ds_read_b64_tr_b16 v[176:177], v220 offset:36864
    ds_read_b64_tr_b16 v[178:179], v220 offset:37376
    v_mfma_f32_32x32x16_bf16 v[64:79], v[156:159], v[188:191], v[64:79]
    ds_read_b64_tr_b16 v[180:181], v221 offset:36864
    ds_read_b64_tr_b16 v[182:183], v221 offset:37376
    v_mfma_f32_32x32x16_bf16 v[32:47], v[152:155], v[192:195], v[32:47]
    ds_read_b64_tr_b16 v[184:185], v222 offset:36864
    ds_read_b64_tr_b16 v[186:187], v222 offset:37376
    v_mfma_f32_32x32x16_bf16 v[80:95], v[156:159], v[192:195], v[80:95]
    v_mfma_f32_32x32x16_bf16 v[48:63], v[152:155], v[196:199], v[48:63]
    v_mfma_f32_32x32x16_bf16 v[96:111], v[156:159], v[196:199], v[96:111]
    s_waitcnt lgkmcnt(4)
    v_mfma_f32_32x32x16_bf16 v[16:31], v[160:163], v[176:179], v[16:31]
    ds_read_b64_tr_b16 v[188:189], v220 offset:38912
    ds_read_b64_tr_b16 v[190:191], v220 offset:39424
    v_mfma_f32_32x32x16_bf16 v[64:79], v[164:167], v[176:179], v[64:79]
    ds_read_b64_tr_b16 v[192:193], v221 offset:38912
    ds_read_b64_tr_b16 v[194:195], v221 offset:39424
    s_waitcnt lgkmcnt(6)
    v_mfma_f32_32x32x16_bf16 v[32:47], v[160:163], v[180:183], v[32:47]
    ds_read_b64_tr_b16 v[196:197], v222 offset:38912
    ds_read_b64_tr_b16 v[198:199], v222 offset:39424
    v_mfma_f32_32x32x16_bf16 v[80:95], v[164:167], v[180:183], v[80:95]
    s_waitcnt lgkmcnt(6)
    v_mfma_f32_32x32x16_bf16 v[48:63], v[160:163], v[184:187], v[48:63]
    v_mfma_f32_32x32x16_bf16 v[96:111], v[164:167], v[184:187], v[96:111]
    s_waitcnt vmcnt(7)
    s_waitcnt vmcnt(3)
    s_waitcnt lgkmcnt(0)
    s_barrier
    v_mfma_f32_32x32x16_bf16 v[16:31], v[168:171], v[188:191], v[16:31]
    ds_read_b128 v[112:115], v216 offset:0
    ds_read_b128 v[116:119], v216 offset:4096
    ds_read_b64_tr_b16 v[176:177], v220 offset:0
    ds_read_b64_tr_b16 v[178:179], v220 offset:512
    v_mfma_f32_32x32x16_bf16 v[64:79], v[172:175], v[188:191], v[64:79]
    ds_read_b64_tr_b16 v[180:181], v221 offset:0
    ds_read_b64_tr_b16 v[182:183], v221 offset:512
    ds_read_b64_tr_b16 v[184:185], v222 offset:0
    v_mfma_f32_32x32x16_bf16 v[32:47], v[168:171], v[192:195], v[32:47]
    ds_read_b64_tr_b16 v[186:187], v222 offset:512
    ds_read_b128 v[120:123], v217 offset:0
    ds_read_b128 v[124:127], v217 offset:4096
    v_mfma_f32_32x32x16_bf16 v[80:95], v[172:175], v[192:195], v[80:95]
    v_mfma_f32_32x32x16_bf16 v[48:63], v[168:171], v[196:199], v[48:63]
    v_mfma_f32_32x32x16_bf16 v[96:111], v[172:175], v[196:199], v[96:111]
    s_waitcnt lgkmcnt(6)
    v_mfma_f32_32x32x16_bf16 v[16:31], v[112:115], v[176:179], v[16:31]
    ds_read_b64_tr_b16 v[188:189], v220 offset:2048
    ds_read_b64_tr_b16 v[190:191], v220 offset:2560
    ds_read_b64_tr_b16 v[192:193], v221 offset:2048
    ds_read_b64_tr_b16 v[194:195], v221 offset:2560
    v_mfma_f32_32x32x16_bf16 v[64:79], v[116:119], v[176:179], v[64:79]
    ds_read_b64_tr_b16 v[196:197], v222 offset:2048
    ds_read_b64_tr_b16 v[198:199], v222 offset:2560
    ds_read_b128 v[128:131], v218 offset:0
    s_waitcnt lgkmcnt(11)
    v_mfma_f32_32x32x16_bf16 v[32:47], v[112:115], v[180:183], v[32:47]
    ds_read_b128 v[132:135], v218 offset:4096
    ds_read_b128 v[136:139], v219 offset:0
    ds_read_b128 v[140:143], v219 offset:4096
    v_mfma_f32_32x32x16_bf16 v[80:95], v[116:119], v[180:183], v[80:95]
    s_waitcnt lgkmcnt(12)
    v_mfma_f32_32x32x16_bf16 v[48:63], v[112:115], v[184:187], v[48:63]
    v_mfma_f32_32x32x16_bf16 v[96:111], v[116:119], v[184:187], v[96:111]
    s_waitcnt vmcnt(0)
    s_waitcnt lgkmcnt(0)
    s_barrier
    v_mfma_f32_32x32x16_bf16 v[16:31], v[120:123], v[188:191], v[16:31]
    ds_read_b64_tr_b16 v[176:177], v220 offset:12288
    ds_read_b64_tr_b16 v[178:179], v220 offset:12800
    v_mfma_f32_32x32x16_bf16 v[64:79], v[124:127], v[188:191], v[64:79]
    ds_read_b64_tr_b16 v[180:181], v221 offset:12288
    ds_read_b64_tr_b16 v[182:183], v221 offset:12800
    v_mfma_f32_32x32x16_bf16 v[32:47], v[120:123], v[192:195], v[32:47]
    ds_read_b64_tr_b16 v[184:185], v222 offset:12288
    ds_read_b64_tr_b16 v[186:187], v222 offset:12800
    v_mfma_f32_32x32x16_bf16 v[80:95], v[124:127], v[192:195], v[80:95]
    v_mfma_f32_32x32x16_bf16 v[48:63], v[120:123], v[196:199], v[48:63]
    v_mfma_f32_32x32x16_bf16 v[96:111], v[124:127], v[196:199], v[96:111]
    s_waitcnt lgkmcnt(4)
    v_mfma_f32_32x32x16_bf16 v[16:31], v[128:131], v[176:179], v[16:31]
    ds_read_b64_tr_b16 v[188:189], v220 offset:14336
    ds_read_b64_tr_b16 v[190:191], v220 offset:14848
    v_mfma_f32_32x32x16_bf16 v[64:79], v[132:135], v[176:179], v[64:79]
    ds_read_b64_tr_b16 v[192:193], v221 offset:14336
    ds_read_b64_tr_b16 v[194:195], v221 offset:14848
    s_waitcnt lgkmcnt(6)
    v_mfma_f32_32x32x16_bf16 v[32:47], v[128:131], v[180:183], v[32:47]
    ds_read_b64_tr_b16 v[196:197], v222 offset:14336
    ds_read_b64_tr_b16 v[198:199], v222 offset:14848
    v_mfma_f32_32x32x16_bf16 v[80:95], v[132:135], v[180:183], v[80:95]
    s_waitcnt lgkmcnt(6)
    v_mfma_f32_32x32x16_bf16 v[48:63], v[128:131], v[184:187], v[48:63]
    v_mfma_f32_32x32x16_bf16 v[96:111], v[132:135], v[184:187], v[96:111]
    s_waitcnt lgkmcnt(4)
    v_mfma_f32_32x32x16_bf16 v[16:31], v[136:139], v[188:191], v[16:31]
    v_mfma_f32_32x32x16_bf16 v[64:79], v[140:143], v[188:191], v[64:79]
    s_waitcnt lgkmcnt(2)
    v_mfma_f32_32x32x16_bf16 v[32:47], v[136:139], v[192:195], v[32:47]
    v_mfma_f32_32x32x16_bf16 v[80:95], v[140:143], v[192:195], v[80:95]
    s_waitcnt lgkmcnt(0)
    v_mfma_f32_32x32x16_bf16 v[48:63], v[136:139], v[196:199], v[48:63]
    v_mfma_f32_32x32x16_bf16 v[96:111], v[140:143], v[196:199], v[96:111]
    s_and_b32 s29, s6, 1
    s_lshl_b32 s32, s5, 2
    s_lshl_b32 s33, s29, 1
    s_add_u32 s32, s32, s33
    s_lshl_b32 s33, s64, 1
    s_add_u32 s33, s33, s31
    s_nop 7
    v_mov_b32 v168, 0xbdd2d3e8
    s_add_u32 s44, s14, 2424832
    s_addc_u32 s45, s15, 0
    s_mov_b32 s46, 393216
    s_mov_b32 s47, 0x00020000
    v_bfe_u32 v1, v0, 4, 1
    v_lshlrev_b32 v1, 9, v1
    v_lshl_add_u32 v1, v15, 5, v1
    v_bfe_u32 v2, v0, 3, 1
    v_lshl_add_u32 v1, v2, 6, v1
    v_bfe_u32 v2, v0, 2, 1
    v_lshl_add_u32 v1, v2, 4, v1
    s_lshl_b32 s35, s30, 10
    s_lshl_b32 s36, s29, 8
    s_add_u32 s35, s35, s36
    s_add_u32 s35, s35, 73728
    v_add_u32 v1, s35, v1
    s_setprio 0
    v_mul_f32 v160, v16, v16
    v_mul_f32 v161, v17, v17
    v_mul_f32 v162, v18, v18
    v_mul_f32 v163, v19, v19
    v_mul_f32 v164, v20, v20
    v_mul_f32 v165, v21, v21
    v_mul_f32 v166, v22, v22
    v_mul_f32 v167, v23, v23
    v_fmaak_f32 v160, v160, v168, 0xc0135761
    v_fmaak_f32 v161, v161, v168, 0xc0135761
    v_fmaak_f32 v162, v162, v168, 0xc0135761
    v_fmaak_f32 v163, v163, v168, 0xc0135761
    v_fmaak_f32 v164, v164, v168, 0xc0135761
    v_fmaak_f32 v165, v165, v168, 0xc0135761
    v_fmaak_f32 v166, v166, v168, 0xc0135761
    v_fmaak_f32 v167, v167, v168, 0xc0135761
    v_mul_f32 v160, v160, v16
    v_mul_f32 v161, v161, v17
    v_mul_f32 v162, v162, v18
    v_mul_f32 v163, v163, v19
    v_mul_f32 v164, v164, v20
    v_mul_f32 v165, v165, v21
    v_mul_f32 v166, v166, v22
    v_mul_f32 v167, v167, v23
    v_exp_f32 v160, v160
    v_exp_f32 v161, v161
    v_exp_f32 v162, v162
    v_exp_f32 v163, v163
    v_exp_f32 v164, v164
    v_exp_f32 v165, v165
    v_exp_f32 v166, v166
    v_exp_f32 v167, v167
    v_add_f32 v160, 1.0, v160
    v_add_f32 v161, 1.0, v161
    v_add_f32 v162, 1.0, v162
    v_add_f32 v163, 1.0, v163
    v_add_f32 v164, 1.0, v164
    v_add_f32 v165, 1.0, v165
    v_add_f32 v166, 1.0, v166
    v_add_f32 v167, 1.0, v167
    v_rcp_f32 v160, v160
    v_rcp_f32 v161, v161
    v_rcp_f32 v162, v162
    v_rcp_f32 v163, v163
    v_rcp_f32 v164, v164
    v_rcp_f32 v165, v165
    v_rcp_f32 v166, v166
    v_rcp_f32 v167, v167
    v_mul_f32 v16, v16, v160
    v_mul_f32 v17, v17, v161
    v_mul_f32 v18, v18, v162
    v_mul_f32 v19, v19, v163
    v_mul_f32 v20, v20, v164
    v_mul_f32 v21, v21, v165
    v_mul_f32 v22, v22, v166
    v_mul_f32 v23, v23, v167
    v_mul_f32 v160, v24, v24
    v_mul_f32 v161, v25, v25
    v_mul_f32 v162, v26, v26
    v_mul_f32 v163, v27, v27
    v_mul_f32 v164, v28, v28
    v_mul_f32 v165, v29, v29
    v_mul_f32 v166, v30, v30
    v_mul_f32 v167, v31, v31
    v_fmaak_f32 v160, v160, v168, 0xc0135761
    v_fmaak_f32 v161, v161, v168, 0xc0135761
    v_fmaak_f32 v162, v162, v168, 0xc0135761
    v_fmaak_f32 v163, v163, v168, 0xc0135761
    v_fmaak_f32 v164, v164, v168, 0xc0135761
    v_fmaak_f32 v165, v165, v168, 0xc0135761
    v_fmaak_f32 v166, v166, v168, 0xc0135761
    v_fmaak_f32 v167, v167, v168, 0xc0135761
    v_mul_f32 v160, v160, v24
    v_mul_f32 v161, v161, v25
    v_mul_f32 v162, v162, v26
    v_mul_f32 v163, v163, v27
    v_mul_f32 v164, v164, v28
    v_mul_f32 v165, v165, v29
    v_mul_f32 v166, v166, v30
    v_mul_f32 v167, v167, v31
    v_exp_f32 v160, v160
    v_exp_f32 v161, v161
    v_exp_f32 v162, v162
    v_exp_f32 v163, v163
    v_exp_f32 v164, v164
    v_exp_f32 v165, v165
    v_exp_f32 v166, v166
    v_exp_f32 v167, v167
    v_add_f32 v160, 1.0, v160
    v_add_f32 v161, 1.0, v161
    v_add_f32 v162, 1.0, v162
    v_add_f32 v163, 1.0, v163
    v_add_f32 v164, 1.0, v164
    v_add_f32 v165, 1.0, v165
    v_add_f32 v166, 1.0, v166
    v_add_f32 v167, 1.0, v167
    v_rcp_f32 v160, v160
    v_rcp_f32 v161, v161
    v_rcp_f32 v162, v162
    v_rcp_f32 v163, v163
    v_rcp_f32 v164, v164
    v_rcp_f32 v165, v165
    v_rcp_f32 v166, v166
    v_rcp_f32 v167, v167
    v_mul_f32 v24, v24, v160
    v_mul_f32 v25, v25, v161
    v_mul_f32 v26, v26, v162
    v_mul_f32 v27, v27, v163
    v_mul_f32 v28, v28, v164
    v_mul_f32 v29, v29, v165
    v_mul_f32 v30, v30, v166
    v_mul_f32 v31, v31, v167
    v_mul_f32 v192, v16, v16
    v_mul_f32 v193, v17, v17
    v_mul_f32 v194, v18, v18
    v_mul_f32 v195, v19, v19
    v_mul_f32 v196, v20, v20
    v_mul_f32 v197, v21, v21
    v_mul_f32 v198, v22, v22
    v_mul_f32 v199, v23, v23
    v_mul_f32 v200, v24, v24
    v_mul_f32 v201, v25, v25
    v_mul_f32 v202, v26, v26
    v_mul_f32 v203, v27, v27
    v_mul_f32 v204, v28, v28
    v_mul_f32 v205, v29, v29
    v_mul_f32 v206, v30, v30
    v_mul_f32 v207, v31, v31
    v_mul_f32 v160, v32, v32
    v_mul_f32 v161, v33, v33
    v_mul_f32 v162, v34, v34
    v_mul_f32 v163, v35, v35
    v_mul_f32 v164, v36, v36
    v_mul_f32 v165, v37, v37
    v_mul_f32 v166, v38, v38
    v_mul_f32 v167, v39, v39
    v_fmaak_f32 v160, v160, v168, 0xc0135761
    v_fmaak_f32 v161, v161, v168, 0xc0135761
    v_fmaak_f32 v162, v162, v168, 0xc0135761
    v_fmaak_f32 v163, v163, v168, 0xc0135761
    v_fmaak_f32 v164, v164, v168, 0xc0135761
    v_fmaak_f32 v165, v165, v168, 0xc0135761
    v_fmaak_f32 v166, v166, v168, 0xc0135761
    v_fmaak_f32 v167, v167, v168, 0xc0135761
    v_mul_f32 v160, v160, v32
    v_mul_f32 v161, v161, v33
    v_mul_f32 v162, v162, v34
    v_mul_f32 v163, v163, v35
    v_mul_f32 v164, v164, v36
    v_mul_f32 v165, v165, v37
    v_mul_f32 v166, v166, v38
    v_mul_f32 v167, v167, v39
    v_exp_f32 v160, v160
    v_exp_f32 v161, v161
    v_exp_f32 v162, v162
    v_exp_f32 v163, v163
    v_exp_f32 v164, v164
    v_exp_f32 v165, v165
    v_exp_f32 v166, v166
    v_exp_f32 v167, v167
    v_add_f32 v160, 1.0, v160
    v_add_f32 v161, 1.0, v161
    v_add_f32 v162, 1.0, v162
    v_add_f32 v163, 1.0, v163
    v_add_f32 v164, 1.0, v164
    v_add_f32 v165, 1.0, v165
    v_add_f32 v166, 1.0, v166
    v_add_f32 v167, 1.0, v167
    v_rcp_f32 v160, v160
    v_rcp_f32 v161, v161
    v_rcp_f32 v162, v162
    v_rcp_f32 v163, v163
    v_rcp_f32 v164, v164
    v_rcp_f32 v165, v165
    v_rcp_f32 v166, v166
    v_rcp_f32 v167, v167
    v_mul_f32 v32, v32, v160
    v_mul_f32 v33, v33, v161
    v_mul_f32 v34, v34, v162
    v_mul_f32 v35, v35, v163
    v_mul_f32 v36, v36, v164
    v_mul_f32 v37, v37, v165
    v_mul_f32 v38, v38, v166
    v_mul_f32 v39, v39, v167
    v_mul_f32 v160, v40, v40
    v_mul_f32 v161, v41, v41
    v_mul_f32 v162, v42, v42
    v_mul_f32 v163, v43, v43
    v_mul_f32 v164, v44, v44
    v_mul_f32 v165, v45, v45
    v_mul_f32 v166, v46, v46
    v_mul_f32 v167, v47, v47
    v_fmaak_f32 v160, v160, v168, 0xc0135761
    v_fmaak_f32 v161, v161, v168, 0xc0135761
    v_fmaak_f32 v162, v162, v168, 0xc0135761
    v_fmaak_f32 v163, v163, v168, 0xc0135761
    v_fmaak_f32 v164, v164, v168, 0xc0135761
    v_fmaak_f32 v165, v165, v168, 0xc0135761
    v_fmaak_f32 v166, v166, v168, 0xc0135761
    v_fmaak_f32 v167, v167, v168, 0xc0135761
    v_mul_f32 v160, v160, v40
    v_mul_f32 v161, v161, v41
    v_mul_f32 v162, v162, v42
    v_mul_f32 v163, v163, v43
    v_mul_f32 v164, v164, v44
    v_mul_f32 v165, v165, v45
    v_mul_f32 v166, v166, v46
    v_mul_f32 v167, v167, v47
    v_exp_f32 v160, v160
    v_exp_f32 v161, v161
    v_exp_f32 v162, v162
    v_exp_f32 v163, v163
    v_exp_f32 v164, v164
    v_exp_f32 v165, v165
    v_exp_f32 v166, v166
    v_exp_f32 v167, v167
    v_add_f32 v160, 1.0, v160
    v_add_f32 v161, 1.0, v161
    v_add_f32 v162, 1.0, v162
    v_add_f32 v163, 1.0, v163
    v_add_f32 v164, 1.0, v164
    v_add_f32 v165, 1.0, v165
    v_add_f32 v166, 1.0, v166
    v_add_f32 v167, 1.0, v167
    v_rcp_f32 v160, v160
    v_rcp_f32 v161, v161
    v_rcp_f32 v162, v162
    v_rcp_f32 v163, v163
    v_rcp_f32 v164, v164
    v_rcp_f32 v165, v165
    v_rcp_f32 v166, v166
    v_rcp_f32 v167, v167
    v_mul_f32 v40, v40, v160
    v_mul_f32 v41, v41, v161
    v_mul_f32 v42, v42, v162
    v_mul_f32 v43, v43, v163
    v_mul_f32 v44, v44, v164
    v_mul_f32 v45, v45, v165
    v_mul_f32 v46, v46, v166
    v_mul_f32 v47, v47, v167
    v_fmac_f32 v192, v32, v32
    v_add_f32 v176, v32, v16
    v_fmac_f32 v193, v33, v33
    v_add_f32 v177, v33, v17
    v_fmac_f32 v194, v34, v34
    v_add_f32 v178, v34, v18
    v_fmac_f32 v195, v35, v35
    v_add_f32 v179, v35, v19
    v_fmac_f32 v196, v36, v36
    v_add_f32 v180, v36, v20
    v_fmac_f32 v197, v37, v37
    v_add_f32 v181, v37, v21
    v_fmac_f32 v198, v38, v38
    v_add_f32 v182, v38, v22
    v_fmac_f32 v199, v39, v39
    v_add_f32 v183, v39, v23
    v_fmac_f32 v200, v40, v40
    v_add_f32 v184, v40, v24
    v_fmac_f32 v201, v41, v41
    v_add_f32 v185, v41, v25
    v_fmac_f32 v202, v42, v42
    v_add_f32 v186, v42, v26
    v_fmac_f32 v203, v43, v43
    v_add_f32 v187, v43, v27
    v_fmac_f32 v204, v44, v44
    v_add_f32 v188, v44, v28
    v_fmac_f32 v205, v45, v45
    v_add_f32 v189, v45, v29
    v_fmac_f32 v206, v46, v46
    v_add_f32 v190, v46, v30
    v_fmac_f32 v207, v47, v47
    v_add_f32 v191, v47, v31
    v_mul_f32 v160, v48, v48
    v_mul_f32 v161, v49, v49
    v_mul_f32 v162, v50, v50
    v_mul_f32 v163, v51, v51
    v_mul_f32 v164, v52, v52
    v_mul_f32 v165, v53, v53
    v_mul_f32 v166, v54, v54
    v_mul_f32 v167, v55, v55
    v_fmaak_f32 v160, v160, v168, 0xc0135761
    v_fmaak_f32 v161, v161, v168, 0xc0135761
    v_fmaak_f32 v162, v162, v168, 0xc0135761
    v_fmaak_f32 v163, v163, v168, 0xc0135761
    v_fmaak_f32 v164, v164, v168, 0xc0135761
    v_fmaak_f32 v165, v165, v168, 0xc0135761
    v_fmaak_f32 v166, v166, v168, 0xc0135761
    v_fmaak_f32 v167, v167, v168, 0xc0135761
    v_mul_f32 v160, v160, v48
    v_mul_f32 v161, v161, v49
    v_mul_f32 v162, v162, v50
    v_mul_f32 v163, v163, v51
    v_mul_f32 v164, v164, v52
    v_mul_f32 v165, v165, v53
    v_mul_f32 v166, v166, v54
    v_mul_f32 v167, v167, v55
    v_exp_f32 v160, v160
    v_exp_f32 v161, v161
    v_exp_f32 v162, v162
    v_exp_f32 v163, v163
    v_exp_f32 v164, v164
    v_exp_f32 v165, v165
    v_exp_f32 v166, v166
    v_exp_f32 v167, v167
    v_add_f32 v160, 1.0, v160
    v_add_f32 v161, 1.0, v161
    v_add_f32 v162, 1.0, v162
    v_add_f32 v163, 1.0, v163
    v_add_f32 v164, 1.0, v164
    v_add_f32 v165, 1.0, v165
    v_add_f32 v166, 1.0, v166
    v_add_f32 v167, 1.0, v167
    v_rcp_f32 v160, v160
    v_rcp_f32 v161, v161
    v_rcp_f32 v162, v162
    v_rcp_f32 v163, v163
    v_rcp_f32 v164, v164
    v_rcp_f32 v165, v165
    v_rcp_f32 v166, v166
    v_rcp_f32 v167, v167
    v_mul_f32 v48, v48, v160
    v_mul_f32 v49, v49, v161
    v_mul_f32 v50, v50, v162
    v_mul_f32 v51, v51, v163
    v_mul_f32 v52, v52, v164
    v_mul_f32 v53, v53, v165
    v_mul_f32 v54, v54, v166
    v_mul_f32 v55, v55, v167
    v_mul_f32 v160, v56, v56
    v_mul_f32 v161, v57, v57
    v_mul_f32 v162, v58, v58
    v_mul_f32 v163, v59, v59
    v_mul_f32 v164, v60, v60
    v_mul_f32 v165, v61, v61
    v_mul_f32 v166, v62, v62
    v_mul_f32 v167, v63, v63
    v_fmaak_f32 v160, v160, v168, 0xc0135761
    v_fmaak_f32 v161, v161, v168, 0xc0135761
    v_fmaak_f32 v162, v162, v168, 0xc0135761
    v_fmaak_f32 v163, v163, v168, 0xc0135761
    v_fmaak_f32 v164, v164, v168, 0xc0135761
    v_fmaak_f32 v165, v165, v168, 0xc0135761
    v_fmaak_f32 v166, v166, v168, 0xc0135761
    v_fmaak_f32 v167, v167, v168, 0xc0135761
    v_mul_f32 v160, v160, v56
    v_mul_f32 v161, v161, v57
    v_mul_f32 v162, v162, v58
    v_mul_f32 v163, v163, v59
    v_mul_f32 v164, v164, v60
    v_mul_f32 v165, v165, v61
    v_mul_f32 v166, v166, v62
    v_mul_f32 v167, v167, v63
    v_exp_f32 v160, v160
    v_exp_f32 v161, v161
    v_exp_f32 v162, v162
    v_exp_f32 v163, v163
    v_exp_f32 v164, v164
    v_exp_f32 v165, v165
    v_exp_f32 v166, v166
    v_exp_f32 v167, v167
    v_add_f32 v160, 1.0, v160
    v_add_f32 v161, 1.0, v161
    v_add_f32 v162, 1.0, v162
    v_add_f32 v163, 1.0, v163
    v_add_f32 v164, 1.0, v164
    v_add_f32 v165, 1.0, v165
    v_add_f32 v166, 1.0, v166
    v_add_f32 v167, 1.0, v167
    v_rcp_f32 v160, v160
    v_rcp_f32 v161, v161
    v_rcp_f32 v162, v162
    v_rcp_f32 v163, v163
    v_rcp_f32 v164, v164
    v_rcp_f32 v165, v165
    v_rcp_f32 v166, v166
    v_rcp_f32 v167, v167
    v_mul_f32 v56, v56, v160
    v_mul_f32 v57, v57, v161
    v_mul_f32 v58, v58, v162
    v_mul_f32 v59, v59, v163
    v_mul_f32 v60, v60, v164
    v_mul_f32 v61, v61, v165
    v_mul_f32 v62, v62, v166
    v_mul_f32 v63, v63, v167
    v_fmac_f32 v192, v48, v48
    v_add_f32 v176, v48, v176
    v_fmac_f32 v193, v49, v49
    v_add_f32 v177, v49, v177
    v_fmac_f32 v194, v50, v50
    v_add_f32 v178, v50, v178
    v_fmac_f32 v195, v51, v51
    v_add_f32 v179, v51, v179
    v_fmac_f32 v196, v52, v52
    v_add_f32 v180, v52, v180
    v_fmac_f32 v197, v53, v53
    v_add_f32 v181, v53, v181
    v_fmac_f32 v198, v54, v54
    v_add_f32 v182, v54, v182
    v_fmac_f32 v199, v55, v55
    v_add_f32 v183, v55, v183
    v_fmac_f32 v200, v56, v56
    v_add_f32 v184, v56, v184
    v_fmac_f32 v201, v57, v57
    v_add_f32 v185, v57, v185
    v_fmac_f32 v202, v58, v58
    v_add_f32 v186, v58, v186
    v_fmac_f32 v203, v59, v59
    v_add_f32 v187, v59, v187
    v_fmac_f32 v204, v60, v60
    v_add_f32 v188, v60, v188
    v_fmac_f32 v205, v61, v61
    v_add_f32 v189, v61, v189
    v_fmac_f32 v206, v62, v62
    v_add_f32 v190, v62, v190
    v_fmac_f32 v207, v63, v63
    v_add_f32 v191, v63, v191
    v_permlane16_swap_b32 v176, v192
    v_permlane16_swap_b32 v177, v193
    v_permlane16_swap_b32 v178, v194
    v_permlane16_swap_b32 v179, v195
    v_permlane16_swap_b32 v180, v196
    v_permlane16_swap_b32 v181, v197
    v_permlane16_swap_b32 v182, v198
    v_permlane16_swap_b32 v183, v199
    v_permlane16_swap_b32 v184, v200
    v_permlane16_swap_b32 v185, v201
    v_permlane16_swap_b32 v186, v202
    v_permlane16_swap_b32 v187, v203
    v_permlane16_swap_b32 v188, v204
    v_permlane16_swap_b32 v189, v205
    v_permlane16_swap_b32 v190, v206
    v_permlane16_swap_b32 v191, v207
    v_add_f32 v176, v176, v192
    v_add_f32 v177, v177, v193
    v_add_f32 v178, v178, v194
    v_add_f32 v179, v179, v195
    v_add_f32 v180, v180, v196
    v_add_f32 v181, v181, v197
    v_add_f32 v182, v182, v198
    v_add_f32 v183, v183, v199
    v_add_f32 v184, v184, v200
    v_add_f32 v185, v185, v201
    v_add_f32 v186, v186, v202
    v_add_f32 v187, v187, v203
    v_add_f32 v188, v188, v204
    v_add_f32 v189, v189, v205
    v_add_f32 v190, v190, v206
    v_add_f32 v191, v191, v207
    v_add_f32_dpp v192, v176, v176 row_ror:8 row_mask:0xf bank_mask:0x3
    s_nop 1
    v_add_f32_dpp v192, v184, v184 row_ror:8 row_mask:0xf bank_mask:0xc
    v_add_f32_dpp v193, v177, v177 row_ror:8 row_mask:0xf bank_mask:0x3
    s_nop 1
    v_add_f32_dpp v193, v185, v185 row_ror:8 row_mask:0xf bank_mask:0xc
    v_add_f32_dpp v194, v178, v178 row_ror:8 row_mask:0xf bank_mask:0x3
    s_nop 1
    v_add_f32_dpp v194, v186, v186 row_ror:8 row_mask:0xf bank_mask:0xc
    v_add_f32_dpp v195, v179, v179 row_ror:8 row_mask:0xf bank_mask:0x3
    s_nop 1
    v_add_f32_dpp v195, v187, v187 row_ror:8 row_mask:0xf bank_mask:0xc
    v_add_f32_dpp v196, v180, v180 row_ror:8 row_mask:0xf bank_mask:0x3
    s_nop 1
    v_add_f32_dpp v196, v188, v188 row_ror:8 row_mask:0xf bank_mask:0xc
    v_add_f32_dpp v197, v181, v181 row_ror:8 row_mask:0xf bank_mask:0x3
    s_nop 1
    v_add_f32_dpp v197, v189, v189 row_ror:8 row_mask:0xf bank_mask:0xc
    v_add_f32_dpp v198, v182, v182 row_ror:8 row_mask:0xf bank_mask:0x3
    s_nop 1
    v_add_f32_dpp v198, v190, v190 row_ror:8 row_mask:0xf bank_mask:0xc
    v_add_f32_dpp v199, v183, v183 row_ror:8 row_mask:0xf bank_mask:0x3
    s_nop 1
    v_add_f32_dpp v199, v191, v191 row_ror:8 row_mask:0xf bank_mask:0xc
    v_add_f32_dpp v112, v192, v192 row_half_mirror row_mask:0xf bank_mask:0x5
    s_nop 1
    v_add_f32_dpp v112, v196, v196 row_half_mirror row_mask:0xf bank_mask:0xa
    v_add_f32_dpp v113, v193, v193 row_half_mirror row_mask:0xf bank_mask:0x5
    s_nop 1
    v_add_f32_dpp v113, v197, v197 row_half_mirror row_mask:0xf bank_mask:0xa
    v_add_f32_dpp v114, v194, v194 row_half_mirror row_mask:0xf bank_mask:0x5
    s_nop 1
    v_add_f32_dpp v114, v198, v198 row_half_mirror row_mask:0xf bank_mask:0xa
    v_add_f32_dpp v115, v195, v195 row_half_mirror row_mask:0xf bank_mask:0x5
    s_nop 1
    v_add_f32_dpp v115, v199, v199 row_half_mirror row_mask:0xf bank_mask:0xa
    v_add_f32_dpp v112, v112, v112 quad_perm:[1,0,3,2] row_mask:0xf bank_mask:0xf
    v_add_f32_dpp v113, v113, v113 quad_perm:[1,0,3,2] row_mask:0xf bank_mask:0xf
    v_add_f32_dpp v114, v114, v114 quad_perm:[1,0,3,2] row_mask:0xf bank_mask:0xf
    v_add_f32_dpp v115, v115, v115 quad_perm:[1,0,3,2] row_mask:0xf bank_mask:0xf
    v_add_f32_dpp v112, v112, v112 quad_perm:[2,3,0,1] row_mask:0xf bank_mask:0xf
    v_add_f32_dpp v113, v113, v113 quad_perm:[2,3,0,1] row_mask:0xf bank_mask:0xf
    v_add_f32_dpp v114, v114, v114 quad_perm:[2,3,0,1] row_mask:0xf bank_mask:0xf
    v_add_f32_dpp v115, v115, v115 quad_perm:[2,3,0,1] row_mask:0xf bank_mask:0xf
    ds_write_b128 v1, v[112:115] offset:0
    v_mul_f32 v160, v64, v64
    v_mul_f32 v161, v65, v65
    v_mul_f32 v162, v66, v66
    v_mul_f32 v163, v67, v67
    v_mul_f32 v164, v68, v68
    v_mul_f32 v165, v69, v69
    v_mul_f32 v166, v70, v70
    v_mul_f32 v167, v71, v71
    v_fmaak_f32 v160, v160, v168, 0xc0135761
    v_fmaak_f32 v161, v161, v168, 0xc0135761
    v_fmaak_f32 v162, v162, v168, 0xc0135761
    v_fmaak_f32 v163, v163, v168, 0xc0135761
    v_fmaak_f32 v164, v164, v168, 0xc0135761
    v_fmaak_f32 v165, v165, v168, 0xc0135761
    v_fmaak_f32 v166, v166, v168, 0xc0135761
    v_fmaak_f32 v167, v167, v168, 0xc0135761
    v_mul_f32 v160, v160, v64
    v_mul_f32 v161, v161, v65
    v_mul_f32 v162, v162, v66
    v_mul_f32 v163, v163, v67
    v_mul_f32 v164, v164, v68
    v_mul_f32 v165, v165, v69
    v_mul_f32 v166, v166, v70
    v_mul_f32 v167, v167, v71
    v_exp_f32 v160, v160
    v_exp_f32 v161, v161
    v_exp_f32 v162, v162
    v_exp_f32 v163, v163
    v_exp_f32 v164, v164
    v_exp_f32 v165, v165
    v_exp_f32 v166, v166
    v_exp_f32 v167, v167
    v_add_f32 v160, 1.0, v160
    v_add_f32 v161, 1.0, v161
    v_add_f32 v162, 1.0, v162
    v_add_f32 v163, 1.0, v163
    v_add_f32 v164, 1.0, v164
    v_add_f32 v165, 1.0, v165
    v_add_f32 v166, 1.0, v166
    v_add_f32 v167, 1.0, v167
    v_rcp_f32 v160, v160
    v_rcp_f32 v161, v161
    v_rcp_f32 v162, v162
    v_rcp_f32 v163, v163
    v_rcp_f32 v164, v164
    v_rcp_f32 v165, v165
    v_rcp_f32 v166, v166
    v_rcp_f32 v167, v167
    v_mul_f32 v64, v64, v160
    v_mul_f32 v65, v65, v161
    v_mul_f32 v66, v66, v162
    v_mul_f32 v67, v67, v163
    v_mul_f32 v68, v68, v164
    v_mul_f32 v69, v69, v165
    v_mul_f32 v70, v70, v166
    v_mul_f32 v71, v71, v167
    v_mul_f32 v160, v72, v72
    v_mul_f32 v161, v73, v73
    v_mul_f32 v162, v74, v74
    v_mul_f32 v163, v75, v75
    v_mul_f32 v164, v76, v76
    v_mul_f32 v165, v77, v77
    v_mul_f32 v166, v78, v78
    v_mul_f32 v167, v79, v79
    v_fmaak_f32 v160, v160, v168, 0xc0135761
    v_fmaak_f32 v161, v161, v168, 0xc0135761
    v_fmaak_f32 v162, v162, v168, 0xc0135761
    v_fmaak_f32 v163, v163, v168, 0xc0135761
    v_fmaak_f32 v164, v164, v168, 0xc0135761
    v_fmaak_f32 v165, v165, v168, 0xc0135761
    v_fmaak_f32 v166, v166, v168, 0xc0135761
    v_fmaak_f32 v167, v167, v168, 0xc0135761
    v_mul_f32 v160, v160, v72
    v_mul_f32 v161, v161, v73
    v_mul_f32 v162, v162, v74
    v_mul_f32 v163, v163, v75
    v_mul_f32 v164, v164, v76
    v_mul_f32 v165, v165, v77
    v_mul_f32 v166, v166, v78
    v_mul_f32 v167, v167, v79
    v_exp_f32 v160, v160
    v_exp_f32 v161, v161
    v_exp_f32 v162, v162
    v_exp_f32 v163, v163
    v_exp_f32 v164, v164
    v_exp_f32 v165, v165
    v_exp_f32 v166, v166
    v_exp_f32 v167, v167
    v_add_f32 v160, 1.0, v160
    v_add_f32 v161, 1.0, v161
    v_add_f32 v162, 1.0, v162
    v_add_f32 v163, 1.0, v163
    v_add_f32 v164, 1.0, v164
    v_add_f32 v165, 1.0, v165
    v_add_f32 v166, 1.0, v166
    v_add_f32 v167, 1.0, v167
    v_rcp_f32 v160, v160
    v_rcp_f32 v161, v161
    v_rcp_f32 v162, v162
    v_rcp_f32 v163, v163
    v_rcp_f32 v164, v164
    v_rcp_f32 v165, v165
    v_rcp_f32 v166, v166
    v_rcp_f32 v167, v167
    v_mul_f32 v72, v72, v160
    v_mul_f32 v73, v73, v161
    v_mul_f32 v74, v74, v162
    v_mul_f32 v75, v75, v163
    v_mul_f32 v76, v76, v164
    v_mul_f32 v77, v77, v165
    v_mul_f32 v78, v78, v166
    v_mul_f32 v79, v79, v167
    v_mul_f32 v192, v64, v64
    v_mul_f32 v193, v65, v65
    v_mul_f32 v194, v66, v66
    v_mul_f32 v195, v67, v67
    v_mul_f32 v196, v68, v68
    v_mul_f32 v197, v69, v69
    v_mul_f32 v198, v70, v70
    v_mul_f32 v199, v71, v71
    v_mul_f32 v200, v72, v72
    v_mul_f32 v201, v73, v73
    v_mul_f32 v202, v74, v74
    v_mul_f32 v203, v75, v75
    v_mul_f32 v204, v76, v76
    v_mul_f32 v205, v77, v77
    v_mul_f32 v206, v78, v78
    v_mul_f32 v207, v79, v79
    v_mul_f32 v160, v80, v80
    v_mul_f32 v161, v81, v81
    v_mul_f32 v162, v82, v82
    v_mul_f32 v163, v83, v83
    v_mul_f32 v164, v84, v84
    v_mul_f32 v165, v85, v85
    v_mul_f32 v166, v86, v86
    v_mul_f32 v167, v87, v87
    v_fmaak_f32 v160, v160, v168, 0xc0135761
    v_fmaak_f32 v161, v161, v168, 0xc0135761
    v_fmaak_f32 v162, v162, v168, 0xc0135761
    v_fmaak_f32 v163, v163, v168, 0xc0135761
    v_fmaak_f32 v164, v164, v168, 0xc0135761
    v_fmaak_f32 v165, v165, v168, 0xc0135761
    v_fmaak_f32 v166, v166, v168, 0xc0135761
    v_fmaak_f32 v167, v167, v168, 0xc0135761
    v_mul_f32 v160, v160, v80
    v_mul_f32 v161, v161, v81
    v_mul_f32 v162, v162, v82
    v_mul_f32 v163, v163, v83
    v_mul_f32 v164, v164, v84
    v_mul_f32 v165, v165, v85
    v_mul_f32 v166, v166, v86
    v_mul_f32 v167, v167, v87
    v_exp_f32 v160, v160
    v_exp_f32 v161, v161
    v_exp_f32 v162, v162
    v_exp_f32 v163, v163
    v_exp_f32 v164, v164
    v_exp_f32 v165, v165
    v_exp_f32 v166, v166
    v_exp_f32 v167, v167
    v_add_f32 v160, 1.0, v160
    v_add_f32 v161, 1.0, v161
    v_add_f32 v162, 1.0, v162
    v_add_f32 v163, 1.0, v163
    v_add_f32 v164, 1.0, v164
    v_add_f32 v165, 1.0, v165
    v_add_f32 v166, 1.0, v166
    v_add_f32 v167, 1.0, v167
    v_rcp_f32 v160, v160
    v_rcp_f32 v161, v161
    v_rcp_f32 v162, v162
    v_rcp_f32 v163, v163
    v_rcp_f32 v164, v164
    v_rcp_f32 v165, v165
    v_rcp_f32 v166, v166
    v_rcp_f32 v167, v167
    v_mul_f32 v80, v80, v160
    v_mul_f32 v81, v81, v161
    v_mul_f32 v82, v82, v162
    v_mul_f32 v83, v83, v163
    v_mul_f32 v84, v84, v164
    v_mul_f32 v85, v85, v165
    v_mul_f32 v86, v86, v166
    v_mul_f32 v87, v87, v167
    v_mul_f32 v160, v88, v88
    v_mul_f32 v161, v89, v89
    v_mul_f32 v162, v90, v90
    v_mul_f32 v163, v91, v91
    v_mul_f32 v164, v92, v92
    v_mul_f32 v165, v93, v93
    v_mul_f32 v166, v94, v94
    v_mul_f32 v167, v95, v95
    v_fmaak_f32 v160, v160, v168, 0xc0135761
    v_fmaak_f32 v161, v161, v168, 0xc0135761
    v_fmaak_f32 v162, v162, v168, 0xc0135761
    v_fmaak_f32 v163, v163, v168, 0xc0135761
    v_fmaak_f32 v164, v164, v168, 0xc0135761
    v_fmaak_f32 v165, v165, v168, 0xc0135761
    v_fmaak_f32 v166, v166, v168, 0xc0135761
    v_fmaak_f32 v167, v167, v168, 0xc0135761
    v_mul_f32 v160, v160, v88
    v_mul_f32 v161, v161, v89
    v_mul_f32 v162, v162, v90
    v_mul_f32 v163, v163, v91
    v_mul_f32 v164, v164, v92
    v_mul_f32 v165, v165, v93
    v_mul_f32 v166, v166, v94
    v_mul_f32 v167, v167, v95
    v_exp_f32 v160, v160
    v_exp_f32 v161, v161
    v_exp_f32 v162, v162
    v_exp_f32 v163, v163
    v_exp_f32 v164, v164
    v_exp_f32 v165, v165
    v_exp_f32 v166, v166
    v_exp_f32 v167, v167
    v_add_f32 v160, 1.0, v160
    v_add_f32 v161, 1.0, v161
    v_add_f32 v162, 1.0, v162
    v_add_f32 v163, 1.0, v163
    v_add_f32 v164, 1.0, v164
    v_add_f32 v165, 1.0, v165
    v_add_f32 v166, 1.0, v166
    v_add_f32 v167, 1.0, v167
    v_rcp_f32 v160, v160
    v_rcp_f32 v161, v161
    v_rcp_f32 v162, v162
    v_rcp_f32 v163, v163
    v_rcp_f32 v164, v164
    v_rcp_f32 v165, v165
    v_rcp_f32 v166, v166
    v_rcp_f32 v167, v167
    v_mul_f32 v88, v88, v160
    v_mul_f32 v89, v89, v161
    v_mul_f32 v90, v90, v162
    v_mul_f32 v91, v91, v163
    v_mul_f32 v92, v92, v164
    v_mul_f32 v93, v93, v165
    v_mul_f32 v94, v94, v166
    v_mul_f32 v95, v95, v167
    v_fmac_f32 v192, v80, v80
    v_add_f32 v176, v80, v64
    v_fmac_f32 v193, v81, v81
    v_add_f32 v177, v81, v65
    v_fmac_f32 v194, v82, v82
    v_add_f32 v178, v82, v66
    v_fmac_f32 v195, v83, v83
    v_add_f32 v179, v83, v67
    v_fmac_f32 v196, v84, v84
    v_add_f32 v180, v84, v68
    v_fmac_f32 v197, v85, v85
    v_add_f32 v181, v85, v69
    v_fmac_f32 v198, v86, v86
    v_add_f32 v182, v86, v70
    v_fmac_f32 v199, v87, v87
    v_add_f32 v183, v87, v71
    v_fmac_f32 v200, v88, v88
    v_add_f32 v184, v88, v72
    v_fmac_f32 v201, v89, v89
    v_add_f32 v185, v89, v73
    v_fmac_f32 v202, v90, v90
    v_add_f32 v186, v90, v74
    v_fmac_f32 v203, v91, v91
    v_add_f32 v187, v91, v75
    v_fmac_f32 v204, v92, v92
    v_add_f32 v188, v92, v76
    v_fmac_f32 v205, v93, v93
    v_add_f32 v189, v93, v77
    v_fmac_f32 v206, v94, v94
    v_add_f32 v190, v94, v78
    v_fmac_f32 v207, v95, v95
    v_add_f32 v191, v95, v79
    v_mul_f32 v160, v96, v96
    v_mul_f32 v161, v97, v97
    v_mul_f32 v162, v98, v98
    v_mul_f32 v163, v99, v99
    v_mul_f32 v164, v100, v100
    v_mul_f32 v165, v101, v101
    v_mul_f32 v166, v102, v102
    v_mul_f32 v167, v103, v103
    v_fmaak_f32 v160, v160, v168, 0xc0135761
    v_fmaak_f32 v161, v161, v168, 0xc0135761
    v_fmaak_f32 v162, v162, v168, 0xc0135761
    v_fmaak_f32 v163, v163, v168, 0xc0135761
    v_fmaak_f32 v164, v164, v168, 0xc0135761
    v_fmaak_f32 v165, v165, v168, 0xc0135761
    v_fmaak_f32 v166, v166, v168, 0xc0135761
    v_fmaak_f32 v167, v167, v168, 0xc0135761
    v_mul_f32 v160, v160, v96
    v_mul_f32 v161, v161, v97
    v_mul_f32 v162, v162, v98
    v_mul_f32 v163, v163, v99
    v_mul_f32 v164, v164, v100
    v_mul_f32 v165, v165, v101
    v_mul_f32 v166, v166, v102
    v_mul_f32 v167, v167, v103
    v_exp_f32 v160, v160
    v_exp_f32 v161, v161
    v_exp_f32 v162, v162
    v_exp_f32 v163, v163
    v_exp_f32 v164, v164
    v_exp_f32 v165, v165
    v_exp_f32 v166, v166
    v_exp_f32 v167, v167
    v_add_f32 v160, 1.0, v160
    v_add_f32 v161, 1.0, v161
    v_add_f32 v162, 1.0, v162
    v_add_f32 v163, 1.0, v163
    v_add_f32 v164, 1.0, v164
    v_add_f32 v165, 1.0, v165
    v_add_f32 v166, 1.0, v166
    v_add_f32 v167, 1.0, v167
    v_rcp_f32 v160, v160
    v_rcp_f32 v161, v161
    v_rcp_f32 v162, v162
    v_rcp_f32 v163, v163
    v_rcp_f32 v164, v164
    v_rcp_f32 v165, v165
    v_rcp_f32 v166, v166
    v_rcp_f32 v167, v167
    v_mul_f32 v96, v96, v160
    v_mul_f32 v97, v97, v161
    v_mul_f32 v98, v98, v162
    v_mul_f32 v99, v99, v163
    v_mul_f32 v100, v100, v164
    v_mul_f32 v101, v101, v165
    v_mul_f32 v102, v102, v166
    v_mul_f32 v103, v103, v167
    v_mul_f32 v160, v104, v104
    v_mul_f32 v161, v105, v105
    v_mul_f32 v162, v106, v106
    v_mul_f32 v163, v107, v107
    v_mul_f32 v164, v108, v108
    v_mul_f32 v165, v109, v109
    v_mul_f32 v166, v110, v110
    v_mul_f32 v167, v111, v111
    v_fmaak_f32 v160, v160, v168, 0xc0135761
    v_fmaak_f32 v161, v161, v168, 0xc0135761
    v_fmaak_f32 v162, v162, v168, 0xc0135761
    v_fmaak_f32 v163, v163, v168, 0xc0135761
    v_fmaak_f32 v164, v164, v168, 0xc0135761
    v_fmaak_f32 v165, v165, v168, 0xc0135761
    v_fmaak_f32 v166, v166, v168, 0xc0135761
    v_fmaak_f32 v167, v167, v168, 0xc0135761
    v_mul_f32 v160, v160, v104
    v_mul_f32 v161, v161, v105
    v_mul_f32 v162, v162, v106
    v_mul_f32 v163, v163, v107
    v_mul_f32 v164, v164, v108
    v_mul_f32 v165, v165, v109
    v_mul_f32 v166, v166, v110
    v_mul_f32 v167, v167, v111
    v_exp_f32 v160, v160
    v_exp_f32 v161, v161
    v_exp_f32 v162, v162
    v_exp_f32 v163, v163
    v_exp_f32 v164, v164
    v_exp_f32 v165, v165
    v_exp_f32 v166, v166
    v_exp_f32 v167, v167
    v_add_f32 v160, 1.0, v160
    v_add_f32 v161, 1.0, v161
    v_add_f32 v162, 1.0, v162
    v_add_f32 v163, 1.0, v163
    v_add_f32 v164, 1.0, v164
    v_add_f32 v165, 1.0, v165
    v_add_f32 v166, 1.0, v166
    v_add_f32 v167, 1.0, v167
    v_rcp_f32 v160, v160
    v_rcp_f32 v161, v161
    v_rcp_f32 v162, v162
    v_rcp_f32 v163, v163
    v_rcp_f32 v164, v164
    v_rcp_f32 v165, v165
    v_rcp_f32 v166, v166
    v_rcp_f32 v167, v167
    v_mul_f32 v104, v104, v160
    v_mul_f32 v105, v105, v161
    v_mul_f32 v106, v106, v162
    v_mul_f32 v107, v107, v163
    v_mul_f32 v108, v108, v164
    v_mul_f32 v109, v109, v165
    v_mul_f32 v110, v110, v166
    v_mul_f32 v111, v111, v167
    v_fmac_f32 v192, v96, v96
    v_add_f32 v176, v96, v176
    v_fmac_f32 v193, v97, v97
    v_add_f32 v177, v97, v177
    v_fmac_f32 v194, v98, v98
    v_add_f32 v178, v98, v178
    v_fmac_f32 v195, v99, v99
    v_add_f32 v179, v99, v179
    v_fmac_f32 v196, v100, v100
    v_add_f32 v180, v100, v180
    v_fmac_f32 v197, v101, v101
    v_add_f32 v181, v101, v181
    v_fmac_f32 v198, v102, v102
    v_add_f32 v182, v102, v182
    v_fmac_f32 v199, v103, v103
    v_add_f32 v183, v103, v183
    v_fmac_f32 v200, v104, v104
    v_add_f32 v184, v104, v184
    v_fmac_f32 v201, v105, v105
    v_add_f32 v185, v105, v185
    v_fmac_f32 v202, v106, v106
    v_add_f32 v186, v106, v186
    v_fmac_f32 v203, v107, v107
    v_add_f32 v187, v107, v187
    v_fmac_f32 v204, v108, v108
    v_add_f32 v188, v108, v188
    v_fmac_f32 v205, v109, v109
    v_add_f32 v189, v109, v189
    v_fmac_f32 v206, v110, v110
    v_add_f32 v190, v110, v190
    v_fmac_f32 v207, v111, v111
    v_add_f32 v191, v111, v191
    v_permlane16_swap_b32 v176, v192
    v_permlane16_swap_b32 v177, v193
    v_permlane16_swap_b32 v178, v194
    v_permlane16_swap_b32 v179, v195
    v_permlane16_swap_b32 v180, v196
    v_permlane16_swap_b32 v181, v197
    v_permlane16_swap_b32 v182, v198
    v_permlane16_swap_b32 v183, v199
    v_permlane16_swap_b32 v184, v200
    v_permlane16_swap_b32 v185, v201
    v_permlane16_swap_b32 v186, v202
    v_permlane16_swap_b32 v187, v203
    v_permlane16_swap_b32 v188, v204
    v_permlane16_swap_b32 v189, v205
    v_permlane16_swap_b32 v190, v206
    v_permlane16_swap_b32 v191, v207
    v_add_f32 v176, v176, v192
    v_add_f32 v177, v177, v193
    v_add_f32 v178, v178, v194
    v_add_f32 v179, v179, v195
    v_add_f32 v180, v180, v196
    v_add_f32 v181, v181, v197
    v_add_f32 v182, v182, v198
    v_add_f32 v183, v183, v199
    v_add_f32 v184, v184, v200
    v_add_f32 v185, v185, v201
    v_add_f32 v186, v186, v202
    v_add_f32 v187, v187, v203
    v_add_f32 v188, v188, v204
    v_add_f32 v189, v189, v205
    v_add_f32 v190, v190, v206
    v_add_f32 v191, v191, v207
    v_add_f32_dpp v192, v176, v176 row_ror:8 row_mask:0xf bank_mask:0x3
    s_nop 1
    v_add_f32_dpp v192, v184, v184 row_ror:8 row_mask:0xf bank_mask:0xc
    v_add_f32_dpp v193, v177, v177 row_ror:8 row_mask:0xf bank_mask:0x3
    s_nop 1
    v_add_f32_dpp v193, v185, v185 row_ror:8 row_mask:0xf bank_mask:0xc
    v_add_f32_dpp v194, v178, v178 row_ror:8 row_mask:0xf bank_mask:0x3
    s_nop 1
    v_add_f32_dpp v194, v186, v186 row_ror:8 row_mask:0xf bank_mask:0xc
    v_add_f32_dpp v195, v179, v179 row_ror:8 row_mask:0xf bank_mask:0x3
    s_nop 1
    v_add_f32_dpp v195, v187, v187 row_ror:8 row_mask:0xf bank_mask:0xc
    v_add_f32_dpp v196, v180, v180 row_ror:8 row_mask:0xf bank_mask:0x3
    s_nop 1
    v_add_f32_dpp v196, v188, v188 row_ror:8 row_mask:0xf bank_mask:0xc
    v_add_f32_dpp v197, v181, v181 row_ror:8 row_mask:0xf bank_mask:0x3
    s_nop 1
    v_add_f32_dpp v197, v189, v189 row_ror:8 row_mask:0xf bank_mask:0xc
    v_add_f32_dpp v198, v182, v182 row_ror:8 row_mask:0xf bank_mask:0x3
    s_nop 1
    v_add_f32_dpp v198, v190, v190 row_ror:8 row_mask:0xf bank_mask:0xc
    v_add_f32_dpp v199, v183, v183 row_ror:8 row_mask:0xf bank_mask:0x3
    s_nop 1
    v_add_f32_dpp v199, v191, v191 row_ror:8 row_mask:0xf bank_mask:0xc
    v_add_f32_dpp v116, v192, v192 row_half_mirror row_mask:0xf bank_mask:0x5
    s_nop 1
    v_add_f32_dpp v116, v196, v196 row_half_mirror row_mask:0xf bank_mask:0xa
    v_add_f32_dpp v117, v193, v193 row_half_mirror row_mask:0xf bank_mask:0x5
    s_nop 1
    v_add_f32_dpp v117, v197, v197 row_half_mirror row_mask:0xf bank_mask:0xa
    v_add_f32_dpp v118, v194, v194 row_half_mirror row_mask:0xf bank_mask:0x5
    s_nop 1
    v_add_f32_dpp v118, v198, v198 row_half_mirror row_mask:0xf bank_mask:0xa
    v_add_f32_dpp v119, v195, v195 row_half_mirror row_mask:0xf bank_mask:0x5
    s_nop 1
    v_add_f32_dpp v119, v199, v199 row_half_mirror row_mask:0xf bank_mask:0xa
    v_add_f32_dpp v116, v116, v116 quad_perm:[1,0,3,2] row_mask:0xf bank_mask:0xf
    v_add_f32_dpp v117, v117, v117 quad_perm:[1,0,3,2] row_mask:0xf bank_mask:0xf
    v_add_f32_dpp v118, v118, v118 quad_perm:[1,0,3,2] row_mask:0xf bank_mask:0xf
    v_add_f32_dpp v119, v119, v119 quad_perm:[1,0,3,2] row_mask:0xf bank_mask:0xf
    v_add_f32_dpp v116, v116, v116 quad_perm:[2,3,0,1] row_mask:0xf bank_mask:0xf
    v_add_f32_dpp v117, v117, v117 quad_perm:[2,3,0,1] row_mask:0xf bank_mask:0xf
    v_add_f32_dpp v118, v118, v118 quad_perm:[2,3,0,1] row_mask:0xf bank_mask:0xf
    v_add_f32_dpp v119, v119, v119 quad_perm:[2,3,0,1] row_mask:0xf bank_mask:0xf
    ds_write_b128 v1, v[116:119] offset:128
    s_setprio 2
    s_lshl_b32 s36, s6, 7
    s_add_u32 s36, s36, 73728
    v_lshl_add_u32 v2, v8, 2, s36
    s_mul_i32 s34, s5, 12
    s_add_u32 s35, s34, s7
    s_lshl_b32 s35, s35, 11
    s_lshl_b32 s37, s6, 9
    s_add_u32 s35, s35, s37
    s_lshl_b32 s34, s34, 11
    s_add_u32 s34, s34, s37
    v_lshlrev_b32 v3, 4, v8
    v_lshl_add_u32 v4, v15, 30, v3
    v_lshl_add_u32 v3, v15, 11, v3
    v_mov_b32 v114, s76
    v_mov_b32 v115, s77
    s_waitcnt lgkmcnt(0)
    s_barrier
    ds_read_b32 v112, v2
    ds_read_b32 v113, v2 offset:512
    ds_read_b32 v116, v2 offset:1024
    ds_read_b32 v117, v2 offset:1536
    s_waitcnt lgkmcnt(1)
    v_add_f32 v112, v112, v116
    s_waitcnt lgkmcnt(0)
    v_add_f32 v113, v113, v117
    buffer_store_dwordx4 v[112:115], v4, s[44:47], s35 offen sc0 sc1
    v_mov_b32 v174, v2
    v_mov_b32 v175, v3
    s_load_dwordx4 s[8:11], s[0:1], 40
    s_load_dwordx2 s[66:67], s[0:1], 16
    s_load_dwordx2 s[68:69], s[0:1], 56
    s_load_dwordx2 s[70:71], s[0:1], 72
    s_mov_b32 s24, s5
    s_and_b32 s25, s3, 3
    s_lshl_b32 s25, s25, 2
    s_and_b32 s26, s4, 3
    s_add_u32 s25, s25, s26
    s_lshl_b32 s26, s24, 7
    s_lshl_b32 s27, s6, 5
    s_add_u32 s26, s26, s27
    v_lshrrev_b32 v4, 3, v0
    v_and_b32 v5, 7, v0
    s_lshl_b32 s55, s6, 12
    s_mov_b32 s57, 0
    v_add_u32 v6, 0, v4
    v_bfe_u32 v7, v6, 1, 3
    v_xor_b32 v7, v7, v5
    v_add_u32 v6, s26, v6
    v_lshlrev_b32 v6, 12, v6
    v_lshl_add_u32 v6, v7, 4, v6
    v_subrev_u32 v224, 0, v6
    v_add_u32 v6, 8, v4
    v_bfe_u32 v7, v6, 1, 3
    v_xor_b32 v7, v7, v5
    v_add_u32 v6, s26, v6
    v_lshlrev_b32 v6, 12, v6
    v_lshl_add_u32 v6, v7, 4, v6
    v_subrev_u32 v225, 1024, v6
    v_add_u32 v6, 16, v4
    v_bfe_u32 v7, v6, 1, 3
    v_xor_b32 v7, v7, v5
    v_add_u32 v6, s26, v6
    v_lshlrev_b32 v6, 12, v6
    v_lshl_add_u32 v6, v7, 4, v6
    v_subrev_u32 v226, 2048, v6
    v_add_u32 v6, 24, v4
    v_bfe_u32 v7, v6, 1, 3
    v_xor_b32 v7, v7, v5
    v_add_u32 v6, s26, v6
    v_lshlrev_b32 v6, 12, v6
    v_lshl_add_u32 v6, v7, 4, v6
    v_subrev_u32 v227, 3072, v6
    s_waitcnt lgkmcnt(0)
    s_add_u32 s20, s8, 0
    s_addc_u32 s21, s9, 0
    s_mov_b32 s22, 8388608
    s_mov_b32 s23, 0x00020000
    s_add_u32 m0, s55, 0
    s_nop 0
    buffer_load_dwordx4 v224, s[20:23], s57 offen offset:0 lds
    buffer_load_dwordx4 v225, s[20:23], s57 offen offset:1024 lds
    buffer_load_dwordx4 v226, s[20:23], s57 offen offset:2048 lds
    buffer_load_dwordx4 v227, s[20:23], s57 offen offset:3072 lds
    s_add_u32 s57, s57, 128
    s_add_u32 m0, s55, 18432
    s_nop 0
    buffer_load_dwordx4 v224, s[20:23], s57 offen offset:0 lds
    buffer_load_dwordx4 v225, s[20:23], s57 offen offset:1024 lds
    buffer_load_dwordx4 v226, s[20:23], s57 offen offset:2048 lds
    buffer_load_dwordx4 v227, s[20:23], s57 offen offset:3072 lds
    s_add_u32 s57, s57, 128
    s_add_u32 m0, s55, 36864
    s_nop 0
    buffer_load_dwordx4 v224, s[20:23], s57 offen offset:0 lds
    buffer_load_dwordx4 v225, s[20:23], s57 offen offset:1024 lds
    buffer_load_dwordx4 v226, s[20:23], s57 offen offset:2048 lds
    buffer_load_dwordx4 v227, s[20:23], s57 offen offset:3072 lds
    s_add_u32 s57, s57, 128
    s_add_u32 s16, s14, 17825792
    s_addc_u32 s17, s15, 0
    s_mov_b32 s18, 9437184
    s_mov_b32 s19, 0x00020000
    s_lshl_b32 s26, s25, 2
    s_add_u32 s26, s26, s6
    s_lshl_b32 s26, s26, 17
    v_lshlrev_b32 v1, 4, v0
    v_add_u32 v222, s26, v1
    s_lshr_b32 s26, s25, 1
    s_add_u32 s26, s26, 64
    s_lshl_b32 s26, s26, 17
    s_and_b32 s27, s25, 1
    s_lshl_b32 s27, s27, 8
    s_add_u32 s26, s26, s27
    s_lshl_b32 s27, s6, 10
    s_add_u32 s26, s26, s27
    v_lshrrev_b32 v2, 4, v0
    v_and_b32 v3, 15, v0
    v_lshlrev_b32 v4, 9, v2
    v_lshl_add_u32 v4, v3, 4, v4
    v_add_u32 v223, s26, v4
    s_lshl_b32 s54, s6, 9
    s_add_u32 s54, s54, 16384
    s_mov_b32 s56, 0
    s_mov_b32 s52, -1
    s_mov_b32 s53, 0
    s_lshl_b32 s26, s25, 1
    s_mul_i32 s27, s26, 21846
    s_lshr_b32 s27, s27, 16
    s_add_u32 s26, s26, 1
    s_mul_i32 s28, s26, 21846
    s_lshr_b32 s28, s28, 16
    s_cmp_ge_u32 s25, 4
    s_cselect_b32 s38, 11, 10
    v_mov_b32 v6, s27
    v_mov_b32 v7, s28
    v_cmp_eq_u32 vcc, 1, v2
    s_nop 1
    v_cndmask_b32 v6, v6, v7, vcc
    v_mov_b32 v7, s38
    v_cmp_lt_u32 vcc, 1, v2
    s_nop 1
    v_cndmask_b32 v6, v6, v7, vcc
    v_lshl_add_u32 v7, v6, 4, v3
    v_add_u32 v7, 256, v7
    v_lshlrev_b32 v233, 7, v7
    s_lshl_b32 s26, s25, 1
    v_add_u32 v6, s26, v2
    s_lshr_b32 s27, s25, 2
    s_add_u32 s27, s27, 32
    v_mov_b32 v7, s27
    v_cndmask_b32 v6, v6, v7, vcc
    v_mul_u32_u24 v7, 7282, v6
    v_lshrrev_b32 v7, 16, v7
    v_mul_u32_u24 v11, 9, v7
    v_sub_u32 v6, v6, v11
    v_lshlrev_b32 v6, 4, v6
    v_lshrrev_b32 v6, 6, v6
    v_mul_u32_u24 v7, 3, v7
    v_add_u32 v6, v6, v7
    s_lshl_b32 s26, s24, 4
    s_add_u32 s26, s26, 512
    v_add_u32 v6, s26, v6
    s_add_u32 s26, s24, 832
    v_mov_b32 v7, s26
    v_cmp_eq_u32 vcc, 3, v2
    s_nop 1
    v_cndmask_b32 v6, v6, v7, vcc
    v_lshlrev_b32 v232, 7, v6
    v_and_b32 v6, 0x33, v3
    v_and_b32 v7, 4, v3
    v_lshl_or_b32 v6, v7, 1, v6
    v_and_b32 v7, 8, v3
    v_lshrrev_b32 v7, 1, v7
    v_or_b32 v6, v6, v7
    v_lshlrev_b32 v7, 8, v2
    v_lshl_add_u32 v7, v6, 4, v7
    v_add_u32 v220, 16384, v7
    v_and_b32 v6, 31, v0
    v_lshrrev_b32 v7, 5, v0
    v_bfe_u32 v11, v6, 1, 3
    v_xor_b32 v11, v11, v7
    v_lshlrev_b32 v11, 4, v11
    v_lshl_add_u32 v208, v6, 7, v11
    v_xor_b32 v209, 32, v208
    v_xor_b32 v210, 64, v208
    v_xor_b32 v211, 96, v208
    v_bfe_u32 v11, v3, 1, 3
    v_xor_b32 v11, v11, v2
    v_lshlrev_b32 v11, 4, v11
    v_lshl_add_u32 v11, v3, 7, v11
    v_add_u32 v216, s55, v11
    v_xor_b32 v217, 64, v216
    v_add_u32 v212, 36864, v208
    v_add_u32 v213, 36864, v209
    v_add_u32 v214, 36864, v210
    v_add_u32 v215, 36864, v211
    v_add_u32 v218, 36864, v216
    v_add_u32 v219, 36864, v217
    v_add_u32 v221, 36864, v220
    v_sub_u32 v222, v222, v1
    v_lshl_add_u32 v222, v2, 9, v222
    v_and_b32 v6, 7, v3
    v_lshl_add_u32 v222, v6, 4, v222
    v_and_b32 v6, 8, v3
    v_lshl_add_u32 v222, v6, 5, v222
    s_mul_i32 s12, s3, 30
    s_add_u32 s12, s12, s4
    s_min_u32 s12, s12, 233
    s_mul_i32 s13, s12, 7282
    s_lshr_b32 s13, s13, 16
    s_mul_i32 s78, s13, 9
    s_sub_u32 s78, s12, s78
    s_mul_i32 s58, s13, 80
    s_add_u32 s38, s58, 79
    s_min_u32 s38, s38, 2047
    s_lshr_b32 s59, s58, 7
    s_lshr_b32 s39, s38, 7
    s_sub_u32 s39, s39, s59
    s_lshl_b32 s59, s59, 4
    s_add_u32 s59, s59, 1024
    v_and_b32 v6, 1, v2
    v_mul_u32_u24 v6, s39, v6
    v_lshl_add_u32 v6, v6, 4, v3
    v_add_lshl_u32 v230, v6, s59, 7
    s_lshr_b32 s59, s58, 8
    s_lshr_b32 s39, s38, 8
    s_sub_u32 s39, s39, s59
    s_lshl_b32 s59, s59, 5
    s_add_u32 s59, s59, 1280
    v_lshrrev_b32 v6, 5, v0
    v_mul_u32_u24 v6, s39, v6
    v_and_b32 v7, 31, v0
    v_lshl_add_u32 v6, v6, 5, v7
    v_add_lshl_u32 v231, v6, s59, 7
    s_add_u32 s40, s14, 17825792
    s_addc_u32 s41, s15, 0
    s_mov_b32 s42, 9437184
    s_mov_b32 s43, 0x00020000
    s_mov_b32 s38, 0x40000
gated_mix__mha_block__mixer_gmlp__prompt_kernel_z2_p:
    s_add_u32 s36, s34, 0
    buffer_load_dwordx4 v[120:123], v175, s[44:47], s36 offen sc0 sc1
    s_add_u32 s36, s34, 4096
    buffer_load_dwordx4 v[124:127], v175, s[44:47], s36 offen sc0 sc1
    s_add_u32 s36, s34, 8192
    buffer_load_dwordx4 v[128:131], v175, s[44:47], s36 offen sc0 sc1
    s_add_u32 s36, s34, 12288
    buffer_load_dwordx4 v[132:135], v175, s[44:47], s36 offen sc0 sc1
    s_add_u32 s36, s34, 16384
    buffer_load_dwordx4 v[136:139], v175, s[44:47], s36 offen sc0 sc1
    s_add_u32 s36, s34, 20480
    buffer_load_dwordx4 v[140:143], v175, s[44:47], s36 offen sc0 sc1
    s_mov_b64 s[36:37], 0
    s_waitcnt vmcnt(5)
    v_cmp_ne_u64 vcc, s[76:77], v[122:123]
    s_nop 3
    s_or_b64 s[36:37], s[36:37], vcc
    s_waitcnt vmcnt(4)
    v_cmp_ne_u64 vcc, s[76:77], v[126:127]
    s_nop 3
    s_or_b64 s[36:37], s[36:37], vcc
    s_waitcnt vmcnt(3)
    v_cmp_ne_u64 vcc, s[76:77], v[130:131]
    s_nop 3
    s_or_b64 s[36:37], s[36:37], vcc
    s_waitcnt vmcnt(2)
    v_cmp_ne_u64 vcc, s[76:77], v[134:135]
    s_nop 3
    s_or_b64 s[36:37], s[36:37], vcc
    s_waitcnt vmcnt(1)
    v_cmp_ne_u64 vcc, s[76:77], v[138:139]
    s_nop 3
    s_or_b64 s[36:37], s[36:37], vcc
    s_waitcnt vmcnt(0)
    v_cmp_ne_u64 vcc, s[76:77], v[142:143]
    s_nop 3
    s_or_b64 s[36:37], s[36:37], vcc
    s_cmp_eq_u64 s[36:37], 0
    s_cbranch_scc1 gated_mix__mha_block__mixer_gmlp__prompt_kernel_z2_p_ok
    s_sub_u32 s38, s38, 1
    s_cmp_eq_u32 s38, 0
    s_cbranch_scc1 gated_mix__mha_block__mixer_gmlp__prompt_kernel_z2_p_ok
    s_sleep 2
    s_branch gated_mix__mha_block__mixer_gmlp__prompt_kernel_z2_p
gated_mix__mha_block__mixer_gmlp__prompt_kernel_z2_p_ok:
    v_add_f32 v120, v120, v124
    v_add_f32 v121, v121, v125
    v_add_f32 v120, v120, v128
    v_add_f32 v121, v121, v129
    v_add_f32 v120, v120, v132
    v_add_f32 v121, v121, v133
    v_add_f32 v120, v120, v136
    v_add_f32 v121, v121, v137
    v_add_f32 v120, v120, v140
    v_add_f32 v121, v121, v141
    v_mov_b32 v122, v120
    v_mov_b32 v123, v121
    s_nop 0
    v_permlane32_swap_b32 v120, v122
    v_permlane32_swap_b32 v121, v123
    v_add_f32 v120, v120, v122
    v_add_f32 v121, v121, v123
    v_mul_f32 v120, 0x39e38e39, v120
    v_mul_f32 v121, 0x39e38e39, v121
    v_fma_f32 v121, -v120, v120, v121
    v_max_f32 v121, 0, v121
    v_add_f32 v121, 0x3727c5ac, v121
    v_rsq_f32 v121, v121
    s_nop 0
    v_mul_f32_e64 v120, -v120, v121
    ds_write_b32 v174, v120 offset:2048
    ds_write_b32 v174, v121 offset:2560
    s_and_b32 s36, s6, 1
    s_lshl_b32 s36, s36, 8
    s_add_u32 s36, s36, 75776
    v_lshl_add_u32 v4, v15, 5, s36
    s_lshl_b32 s34, s33, 7
    s_lshl_b32 s35, s32, 1
    s_add_u32 s34, s34, s35
    s_lshl_b32 s34, s34, 10
    s_waitcnt lgkmcnt(0)
    s_barrier
    ds_read_b128 v[176:179], v4 offset:0
    ds_read_b128 v[192:195], v4 offset:512
    ds_read_b128 v[180:183], v4 offset:16
    ds_read_b128 v[196:199], v4 offset:528
    ds_read_b128 v[184:187], v4 offset:64
    ds_read_b128 v[200:203], v4 offset:576
    ds_read_b128 v[188:191], v4 offset:80
    ds_read_b128 v[204:207], v4 offset:592
    ds_read_b128 v[112:115], v4 offset:128
    ds_read_b128 v[128:131], v4 offset:640
    ds_read_b128 v[116:119], v4 offset:144
    ds_read_b128 v[132:135], v4 offset:656
    ds_read_b128 v[120:123], v4 offset:192
    ds_read_b128 v[136:139], v4 offset:704
    ds_read_b128 v[124:127], v4 offset:208
    s_waitcnt lgkmcnt(14)
    ds_read_b128 v[140:143], v4 offset:720
    s_waitcnt lgkmcnt(14)
    v_fma_f32 v16, v16, v192, v176
    v_fma_f32 v17, v17, v193, v177
    v_fma_f32 v18, v18, v194, v178
    v_fma_f32 v19, v19, v195, v179
    s_waitcnt lgkmcnt(12)
    v_fma_f32 v20, v20, v196, v180
    v_fma_f32 v21, v21, v197, v181
    v_fma_f32 v22, v22, v198, v182
    v_fma_f32 v23, v23, v199, v183
    s_waitcnt lgkmcnt(10)
    v_fma_f32 v24, v24, v200, v184
    v_fma_f32 v25, v25, v201, v185
    v_fma_f32 v26, v26, v202, v186
    v_fma_f32 v27, v27, v203, v187
    s_waitcnt lgkmcnt(8)
    v_fma_f32 v28, v28, v204, v188
    v_fma_f32 v29, v29, v205, v189
    v_fma_f32 v30, v30, v206, v190
    v_fma_f32 v31, v31, v207, v191
    v_cvt_pk_bf16_f32 v144, v16, v17
    v_cvt_pk_bf16_f32 v145, v18, v19
    v_cvt_pk_bf16_f32 v146, v20, v21
    v_cvt_pk_bf16_f32 v147, v22, v23
    v_cvt_pk_bf16_f32 v148, v24, v25
    v_cvt_pk_bf16_f32 v149, v26, v27
    v_cvt_pk_bf16_f32 v150, v28, v29
    v_cvt_pk_bf16_f32 v151, v30, v31
    s_add_u32 s35, s34, 0
    buffer_store_dwordx4 v[144:147], v1, s[40:43], s35 offen offset:0 sc0 sc1
    buffer_store_dwordx4 v[148:151], v1, s[40:43], s35 offen offset:1024 sc0 sc1
    v_fma_f32 v32, v32, v192, v176
    v_fma_f32 v33, v33, v193, v177
    v_fma_f32 v34, v34, v194, v178
    v_fma_f32 v35, v35, v195, v179
    v_fma_f32 v36, v36, v196, v180
    v_fma_f32 v37, v37, v197, v181
    v_fma_f32 v38, v38, v198, v182
    v_fma_f32 v39, v39, v199, v183
    v_fma_f32 v40, v40, v200, v184
    v_fma_f32 v41, v41, v201, v185
    v_fma_f32 v42, v42, v202, v186
    v_fma_f32 v43, v43, v203, v187
    v_fma_f32 v44, v44, v204, v188
    v_fma_f32 v45, v45, v205, v189
    v_fma_f32 v46, v46, v206, v190
    v_fma_f32 v47, v47, v207, v191
    v_cvt_pk_bf16_f32 v152, v32, v33
    v_cvt_pk_bf16_f32 v153, v34, v35
    v_cvt_pk_bf16_f32 v154, v36, v37
    v_cvt_pk_bf16_f32 v155, v38, v39
    v_cvt_pk_bf16_f32 v156, v40, v41
    v_cvt_pk_bf16_f32 v157, v42, v43
    v_cvt_pk_bf16_f32 v158, v44, v45
    v_cvt_pk_bf16_f32 v159, v46, v47
    s_add_u32 s35, s34, 131072
    buffer_store_dwordx4 v[152:155], v1, s[40:43], s35 offen offset:0 sc0 sc1
    buffer_store_dwordx4 v[156:159], v1, s[40:43], s35 offen offset:1024 sc0 sc1
    v_fma_f32 v48, v48, v192, v176
    v_fma_f32 v49, v49, v193, v177
    v_fma_f32 v50, v50, v194, v178
    v_fma_f32 v51, v51, v195, v179
    v_fma_f32 v52, v52, v196, v180
    v_fma_f32 v53, v53, v197, v181
    v_fma_f32 v54, v54, v198, v182
    v_fma_f32 v55, v55, v199, v183
    v_fma_f32 v56, v56, v200, v184
    v_fma_f32 v57, v57, v201, v185
    v_fma_f32 v58, v58, v202, v186
    v_fma_f32 v59, v59, v203, v187
    v_fma_f32 v60, v60, v204, v188
    v_fma_f32 v61, v61, v205, v189
    v_fma_f32 v62, v62, v206, v190
    v_fma_f32 v63, v63, v207, v191
    v_cvt_pk_bf16_f32 v160, v48, v49
    v_cvt_pk_bf16_f32 v161, v50, v51
    v_cvt_pk_bf16_f32 v162, v52, v53
    v_cvt_pk_bf16_f32 v163, v54, v55
    v_cvt_pk_bf16_f32 v164, v56, v57
    v_cvt_pk_bf16_f32 v165, v58, v59
    v_cvt_pk_bf16_f32 v166, v60, v61
    v_cvt_pk_bf16_f32 v167, v62, v63
    s_add_u32 s35, s34, 262144
    buffer_store_dwordx4 v[160:163], v1, s[40:43], s35 offen offset:0 sc0 sc1
    buffer_store_dwordx4 v[164:167], v1, s[40:43], s35 offen offset:1024 sc0 sc1
    s_waitcnt lgkmcnt(6)
    v_fma_f32 v64, v64, v128, v112
    v_fma_f32 v65, v65, v129, v113
    v_fma_f32 v66, v66, v130, v114
    v_fma_f32 v67, v67, v131, v115
    s_waitcnt lgkmcnt(4)
    v_fma_f32 v68, v68, v132, v116
    v_fma_f32 v69, v69, v133, v117
    v_fma_f32 v70, v70, v134, v118
    v_fma_f32 v71, v71, v135, v119
    s_waitcnt lgkmcnt(2)
    v_fma_f32 v72, v72, v136, v120
    v_fma_f32 v73, v73, v137, v121
    v_fma_f32 v74, v74, v138, v122
    v_fma_f32 v75, v75, v139, v123
    s_waitcnt lgkmcnt(0)
    v_fma_f32 v76, v76, v140, v124
    v_fma_f32 v77, v77, v141, v125
    v_fma_f32 v78, v78, v142, v126
    v_fma_f32 v79, v79, v143, v127
    v_cvt_pk_bf16_f32 v144, v64, v65
    v_cvt_pk_bf16_f32 v145, v66, v67
    v_cvt_pk_bf16_f32 v146, v68, v69
    v_cvt_pk_bf16_f32 v147, v70, v71
    v_cvt_pk_bf16_f32 v148, v72, v73
    v_cvt_pk_bf16_f32 v149, v74, v75
    v_cvt_pk_bf16_f32 v150, v76, v77
    v_cvt_pk_bf16_f32 v151, v78, v79
    s_add_u32 s35, s34, 2048
    buffer_store_dwordx4 v[144:147], v1, s[40:43], s35 offen offset:0 sc0 sc1
    buffer_store_dwordx4 v[148:151], v1, s[40:43], s35 offen offset:1024 sc0 sc1
    v_fma_f32 v80, v80, v128, v112
    v_fma_f32 v81, v81, v129, v113
    v_fma_f32 v82, v82, v130, v114
    v_fma_f32 v83, v83, v131, v115
    v_fma_f32 v84, v84, v132, v116
    v_fma_f32 v85, v85, v133, v117
    v_fma_f32 v86, v86, v134, v118
    v_fma_f32 v87, v87, v135, v119
    v_fma_f32 v88, v88, v136, v120
    v_fma_f32 v89, v89, v137, v121
    v_fma_f32 v90, v90, v138, v122
    v_fma_f32 v91, v91, v139, v123
    v_fma_f32 v92, v92, v140, v124
    v_fma_f32 v93, v93, v141, v125
    v_fma_f32 v94, v94, v142, v126
    v_fma_f32 v95, v95, v143, v127
    v_cvt_pk_bf16_f32 v152, v80, v81
    v_cvt_pk_bf16_f32 v153, v82, v83
    v_cvt_pk_bf16_f32 v154, v84, v85
    v_cvt_pk_bf16_f32 v155, v86, v87
    v_cvt_pk_bf16_f32 v156, v88, v89
    v_cvt_pk_bf16_f32 v157, v90, v91
    v_cvt_pk_bf16_f32 v158, v92, v93
    v_cvt_pk_bf16_f32 v159, v94, v95
    s_add_u32 s35, s34, 133120
    buffer_store_dwordx4 v[152:155], v1, s[40:43], s35 offen offset:0 sc0 sc1
    buffer_store_dwordx4 v[156:159], v1, s[40:43], s35 offen offset:1024 sc0 sc1
    v_fma_f32 v96, v96, v128, v112
    v_fma_f32 v97, v97, v129, v113
    v_fma_f32 v98, v98, v130, v114
    v_fma_f32 v99, v99, v131, v115
    v_fma_f32 v100, v100, v132, v116
    v_fma_f32 v101, v101, v133, v117
    v_fma_f32 v102, v102, v134, v118
    v_fma_f32 v103, v103, v135, v119
    v_fma_f32 v104, v104, v136, v120
    v_fma_f32 v105, v105, v137, v121
    v_fma_f32 v106, v106, v138, v122
    v_fma_f32 v107, v107, v139, v123
    v_fma_f32 v108, v108, v140, v124
    v_fma_f32 v109, v109, v141, v125
    v_fma_f32 v110, v110, v142, v126
    v_fma_f32 v111, v111, v143, v127
    v_cvt_pk_bf16_f32 v160, v96, v97
    v_cvt_pk_bf16_f32 v161, v98, v99
    v_cvt_pk_bf16_f32 v162, v100, v101
    v_cvt_pk_bf16_f32 v163, v102, v103
    v_cvt_pk_bf16_f32 v164, v104, v105
    v_cvt_pk_bf16_f32 v165, v106, v107
    v_cvt_pk_bf16_f32 v166, v108, v109
    v_cvt_pk_bf16_f32 v167, v110, v111
    s_add_u32 s35, s34, 264192
    buffer_store_dwordx4 v[160:163], v1, s[40:43], s35 offen offset:0 sc0 sc1
    buffer_store_dwordx4 v[164:167], v1, s[40:43], s35 offen offset:1024 sc0 sc1
    s_lshl_b32 s36, s7, 4
    s_add_u32 s36, s36, s5
    s_add_u32 s36, s36, 256
    s_lshl_b32 s39, s36, 7
    s_lshl_b32 s38, s6, 6
    v_add_lshl_u32 v10, v0, s38, 20
    v_mov_b32 v12, s76
    v_mov_b32 v13, s77
    s_waitcnt vmcnt(0)
    s_barrier
    buffer_store_dwordx2 v[12:13], v10, s[72:75], s39 offen sc0 sc1
    s_branch gated_mix__mha_block__mixer_gmlp__prompt_kernel_sp
gated_mix__mha_block__mixer_gmlp__prompt_kernel_qk:
    s_nop 1
    s_lshl_b32 s26, s5, 7
    s_lshl_b32 s27, s6, 5
    s_add_u32 s26, s26, s27
    v_lshrrev_b32 v4, 3, v0
    v_and_b32 v5, 7, v0
    v_add_u32 v6, s26, v4
    v_lshrrev_b32 v7, 1, v4
    v_mul_u32_u24 v6, 1152, v6
    v_xor_b32 v7, v7, v5
    s_lshl_b32 s55, s6, 12
    s_mov_b32 s56, 0
    v_lshl_add_u32 v244, v7, 4, v6
    v_xor_b32 v7, 4, v7
    v_lshl_add_u32 v245, v7, 4, v6
    v_add_u32 v246, 16384, v244
    v_add_u32 v247, 24576, v245
    v_add_u32 v245, 8192, v245
    s_add_u32 s16, s8, 0
    s_addc_u32 s17, s9, 0
    s_mov_b32 s18, 2359296
    s_mov_b32 s19, 0x00020000
    s_add_u32 m0, s55, 0
    s_nop 0
    buffer_load_dwordx4 v244, s[16:19], s56 offen offset:0 lds
    buffer_load_dwordx4 v245, s[16:19], s56 offen offset:1024 lds
    buffer_load_dwordx4 v246, s[16:19], s56 offen offset:2048 lds
    buffer_load_dwordx4 v247, s[16:19], s56 offen offset:3072 lds
    s_add_u32 s56, s56, 128
    s_add_u32 s20, s10, 0
    s_addc_u32 s21, s11, 0
    s_mov_b32 s22, 1990656
    s_mov_b32 s23, 0x00020000
    s_mul_i32 s26, s7, 288
    s_add_u32 s26, s26, 0
    s_movk_i32 s28, 3456
    s_mul_i32 s54, s6, 2304
    s_mov_b32 s57, 0
    s_mov_b32 s52, 0xffff
    s_mov_b32 s53, 0
    s_lshl_b32 s27, s6, 2
    v_add_u32 v6, 0, v0
    v_mul_u32_u24 v7, 1821, v6
    v_lshrrev_b32 v7, 16, v7
    v_mul_u32_u24 v11, 36, v7
    v_sub_u32 v6, v6, v11
    v_cmp_lt_u32 vcc, 17, v6
    s_nop 1
    v_cndmask_b32_e64 v11, 0, 1, vcc
    v_mul_u32_u24 v12, 18, v11
    v_sub_u32 v6, v6, v12
    v_add_u32 v7, s27, v7
    v_mul_lo_u32 v7, v7, s28
    v_mul_u32_u24 v12, 1152, v11
    v_add_u32 v7, v7, v12
    v_lshl_add_u32 v7, v6, 4, v7
    v_add_u32 v7, s26, v7
    v_subrev_u32 v248, 0, v7
    v_add_u32 v6, 64, v0
    v_mul_u32_u24 v7, 1821, v6
    v_lshrrev_b32 v7, 16, v7
    v_mul_u32_u24 v11, 36, v7
    v_sub_u32 v6, v6, v11
    v_cmp_lt_u32 vcc, 17, v6
    s_nop 1
    v_cndmask_b32_e64 v11, 0, 1, vcc
    v_mul_u32_u24 v12, 18, v11
    v_sub_u32 v6, v6, v12
    v_add_u32 v7, s27, v7
    v_mul_lo_u32 v7, v7, s28
    v_mul_u32_u24 v12, 1152, v11
    v_add_u32 v7, v7, v12
    v_lshl_add_u32 v7, v6, 4, v7
    v_add_u32 v7, s26, v7
    v_subrev_u32 v249, 1024, v7
    v_add_u32 v6, 128, v0
    v_mul_u32_u24 v7, 1821, v6
    v_lshrrev_b32 v7, 16, v7
    v_mul_u32_u24 v11, 36, v7
    v_sub_u32 v6, v6, v11
    v_cmp_lt_u32 vcc, 17, v6
    s_nop 1
    v_cndmask_b32_e64 v11, 0, 1, vcc
    v_mul_u32_u24 v12, 18, v11
    v_sub_u32 v6, v6, v12
    v_add_u32 v7, s27, v7
    v_mul_lo_u32 v7, v7, s28
    v_mul_u32_u24 v12, 1152, v11
    v_add_u32 v7, v7, v12
    v_lshl_add_u32 v7, v6, 4, v7
    v_add_u32 v7, s26, v7
    v_subrev_u32 v250, 2048, v7
    s_add_u32 m0, s54, 32768
    s_nop 0
    buffer_load_dwordx4 v248, s[20:23], s57 offen offset:0 lds
    buffer_load_dwordx4 v249, s[20:23], s57 offen offset:1024 lds
    s_mov_b64 exec, s[52:53]
    buffer_load_dwordx4 v250, s[20:23], s57 offen offset:2048 lds
    s_mov_b64 exec, -1
    s_add_u32 s57, s57, 55296
    s_add_u32 m0, s54, 41984
    s_nop 0
    buffer_load_dwordx4 v248, s[20:23], s57 offen offset:0 lds
    buffer_load_dwordx4 v249, s[20:23], s57 offen offset:1024 lds
    s_mov_b64 exec, s[52:53]
    buffer_load_dwordx4 v250, s[20:23], s57 offen offset:2048 lds
    s_mov_b64 exec, -1
    s_add_u32 s57, s57, 55296
    s_add_u32 m0, s54, 51200
    s_nop 0
    buffer_load_dwordx4 v248, s[20:23], s57 offen offset:0 lds
    buffer_load_dwordx4 v249, s[20:23], s57 offen offset:1024 lds
    s_mov_b64 exec, s[52:53]
    buffer_load_dwordx4 v250, s[20:23], s57 offen offset:2048 lds
    s_mov_b64 exec, -1
    s_add_u32 s57, s57, 55296
    s_add_u32 m0, s54, 60416
    s_nop 0
    buffer_load_dwordx4 v248, s[20:23], s57 offen offset:0 lds
    buffer_load_dwordx4 v249, s[20:23], s57 offen offset:1024 lds
    s_mov_b64 exec, s[52:53]
    buffer_load_dwordx4 v250, s[20:23], s57 offen offset:2048 lds
    s_mov_b64 exec, -1
    s_add_u32 s57, s57, 55296
    s_add_u32 m0, s55, 16384
    s_nop 0
    buffer_load_dwordx4 v244, s[16:19], s56 offen offset:0 lds
    buffer_load_dwordx4 v245, s[16:19], s56 offen offset:1024 lds
    buffer_load_dwordx4 v246, s[16:19], s56 offen offset:2048 lds
    buffer_load_dwordx4 v247, s[16:19], s56 offen offset:3072 lds
    s_add_u32 s56, s56, 128
    s_add_u32 s48, s68, 0
    s_addc_u32 s49, s69, 0
    s_mov_b32 s50, 256
    s_mov_b32 s51, 0x00020000
    v_mov_b32 v6, 0
    buffer_load_dwordx2 v[4:5], v6, s[48:51], 0 offen sc0 sc1
    s_add_u32 s40, s12, 0
    s_addc_u32 s41, s13, 0
    s_mov_b32 s42, 5308416
    s_mov_b32 s43, 0x00020000
    s_add_u32 s44, s10, 0
    s_addc_u32 s45, s11, 0
    s_mov_b32 s46, 1990656
    s_mov_b32 s47, 0x00020000
    s_lshl_b32 s25, s2, 2
    s_add_u32 s25, s25, s6
    s_lshl_b32 s25, s25, 10
    s_add_u32 s26, s25, 2097152
    s_add_u32 s27, s25, 4194304
    v_lshlrev_b32 v3, 4, v0
    buffer_load_dwordx4 v[252:255], v3, s[16:19], s25 offen
    buffer_load_dwordx4 v[252:255], v3, s[40:43], s25 offen
    buffer_load_dwordx4 v[252:255], v3, s[44:47], s25 offen
    buffer_load_dwordx4 v[252:255], v3, s[40:43], s26 offen
    buffer_load_dwordx4 v[252:255], v3, s[16:19], s26 offen
    buffer_load_dwordx4 v[252:255], v3, s[40:43], s27 offen
    v_and_b32 v8, 31, v0
    v_and_b32 v9, 0x33, v8
    v_and_b32 v10, 4, v8
    v_lshl_or_b32 v9, v10, 1, v9
    v_and_b32 v10, 8, v8
    v_lshrrev_b32 v10, 1, v10
    v_or_b32 v9, v9, v10
    v_lshrrev_b32 v10, 5, v0
    v_bfe_u32 v11, v9, 1, 3
    v_xor_b32 v11, v11, v10
    v_lshlrev_b32 v11, 4, v11
    v_lshl_add_u32 v11, v9, 7, v11
    v_add_u32 v240, s55, v11
    v_xor_b32 v241, 32, v240
    v_xor_b32 v242, 64, v240
    v_xor_b32 v243, 96, v240
    v_mov_b32 v15, v10
    v_bfe_u32 v12, v0, 2, 2
    v_lshl_add_u32 v13, v10, 3, v12
    v_mul_u32_u24 v13, 576, v13
    v_bfe_u32 v14, v0, 4, 1
    v_mul_u32_u24 v14, 288, v14
    v_add_u32 v13, v13, v14
    v_add_u32 v13, 32768, v13
    v_and_b32 v14, 3, v0
    v_mul_u32_u24 v14, 72, v14
    v_add_u32 v2, v13, v14
    v_add_u32 v2, 32, v2
    v_and_b32 v14, 1, v0
    v_lshl_add_u32 v13, v14, 4, v13
    v_and_b32 v14, 2, v0
    v_lshl_add_u32 v1, v14, 2, v13
    s_waitcnt vmcnt(20)
    s_waitcnt lgkmcnt(0)
    s_barrier
    ds_read_b128 v[160:163], v240 offset:0
    ds_read_b64_tr_b16 v[168:169], v1 offset:0
    ds_read_b64_tr_b16 v[170:171], v1 offset:2304
    ds_read_b64_tr_b16 v[172:173], v1 offset:40
    ds_read_b64_tr_b16 v[174:175], v1 offset:2344
    ds_read_b64_tr_b16 v[176:177], v1 offset:72
    ds_read_b64_tr_b16 v[178:179], v1 offset:2376
    ds_read_b64_tr_b16 v[180:181], v1 offset:112
    ds_read_b64_tr_b16 v[182:183], v1 offset:2416
    ds_read_b64_tr_b16 v[184:185], v1 offset:144
    ds_read_b64_tr_b16 v[186:187], v1 offset:2448
    ds_read_b64_tr_b16 v[188:189], v1 offset:184
    ds_read_b64_tr_b16 v[190:191], v1 offset:2488
    ds_read_b64_tr_b16 v[192:193], v1 offset:216
    ds_read_b64_tr_b16 v[194:195], v1 offset:2520
    s_waitcnt lgkmcnt(14)
    ds_read_b64_tr_b16 v[196:197], v1 offset:256
    s_waitcnt lgkmcnt(14)
    ds_read_b64_tr_b16 v[198:199], v1 offset:2560
    s_waitcnt lgkmcnt(14)
    ds_read_b64_tr_b16 v[200:201], v2 offset:0
    s_waitcnt lgkmcnt(14)
    ds_read_b64_tr_b16 v[202:203], v2 offset:2304
    s_waitcnt vmcnt(17)
    s_waitcnt lgkmcnt(0)
    s_barrier
    v_mfma_f32_32x32x16_bf16 v[16:31], v[168:171], v[160:163], 0
    ds_read_b128 v[164:167], v241 offset:0
    ds_read_b64_tr_b16 v[204:205], v1 offset:9216
    ds_read_b64_tr_b16 v[206:207], v1 offset:11520
    ds_read_b64_tr_b16 v[208:209], v1 offset:9256
    v_mfma_f32_32x32x16_bf16 v[32:47], v[172:175], v[160:163], 0
    ds_read_b64_tr_b16 v[210:211], v1 offset:11560
    ds_read_b64_tr_b16 v[212:213], v1 offset:9288
    ds_read_b64_tr_b16 v[214:215], v1 offset:11592
    ds_read_b64_tr_b16 v[216:217], v1 offset:9328
    v_mfma_f32_32x32x16_bf16 v[48:63], v[176:179], v[160:163], 0
    ds_read_b64_tr_b16 v[218:219], v1 offset:11632
    ds_read_b64_tr_b16 v[220:221], v1 offset:9360
    ds_read_b64_tr_b16 v[222:223], v1 offset:11664
    ds_read_b64_tr_b16 v[224:225], v1 offset:9400
    v_mfma_f32_32x32x16_bf16 v[64:79], v[180:183], v[160:163], 0
    ds_read_b64_tr_b16 v[226:227], v1 offset:11704
    ds_read_b64_tr_b16 v[228:229], v1 offset:9432
    ds_read_b64_tr_b16 v[230:231], v1 offset:11736
    s_waitcnt lgkmcnt(14)
    ds_read_b64_tr_b16 v[232:233], v1 offset:9472
    v_mfma_f32_32x32x16_bf16 v[80:95], v[184:187], v[160:163], 0
    s_waitcnt lgkmcnt(14)
    ds_read_b64_tr_b16 v[234:235], v1 offset:11776
    s_waitcnt lgkmcnt(14)
    ds_read_b64_tr_b16 v[236:237], v2 offset:9216
    s_waitcnt lgkmcnt(14)
    ds_read_b64_tr_b16 v[238:239], v2 offset:11520
    v_mfma_f32_32x32x16_bf16 v[96:111], v[188:191], v[160:163], 0
    s_add_u32 m0, s54, 32768
    s_nop 0
    buffer_load_dwordx4 v248, s[20:23], s57 offen offset:0 lds
    v_mfma_f32_32x32x16_bf16 v[112:127], v[192:195], v[160:163], 0
    buffer_load_dwordx4 v249, s[20:23], s57 offen offset:1024 lds
    v_mfma_f32_32x32x16_bf16 v[128:143], v[196:199], v[160:163], 0
    s_mov_b64 exec, s[52:53]
    buffer_load_dwordx4 v250, s[20:23], s57 offen offset:2048 lds
    s_mov_b64 exec, -1
    s_add_u32 s57, s57, 55296
    v_mfma_f32_32x32x16_bf16 v[144:159], v[200:203], v[160:163], 0
    s_waitcnt vmcnt(17)
    s_waitcnt lgkmcnt(0)
    s_barrier
    v_mfma_f32_32x32x16_bf16 v[16:31], v[204:207], v[164:167], v[16:31]
    ds_read_b128 v[160:163], v242 offset:0
    ds_read_b64_tr_b16 v[168:169], v1 offset:18432
    ds_read_b64_tr_b16 v[170:171], v1 offset:20736
    ds_read_b64_tr_b16 v[172:173], v1 offset:18472
    v_mfma_f32_32x32x16_bf16 v[32:47], v[208:211], v[164:167], v[32:47]
    ds_read_b64_tr_b16 v[174:175], v1 offset:20776
    ds_read_b64_tr_b16 v[176:177], v1 offset:18504
    ds_read_b64_tr_b16 v[178:179], v1 offset:20808
    ds_read_b64_tr_b16 v[180:181], v1 offset:18544
    v_mfma_f32_32x32x16_bf16 v[48:63], v[212:215], v[164:167], v[48:63]
    ds_read_b64_tr_b16 v[182:183], v1 offset:20848
    ds_read_b64_tr_b16 v[184:185], v1 offset:18576
    ds_read_b64_tr_b16 v[186:187], v1 offset:20880
    ds_read_b64_tr_b16 v[188:189], v1 offset:18616
    v_mfma_f32_32x32x16_bf16 v[64:79], v[216:219], v[164:167], v[64:79]
    ds_read_b64_tr_b16 v[190:191], v1 offset:20920
    ds_read_b64_tr_b16 v[192:193], v1 offset:18648
    ds_read_b64_tr_b16 v[194:195], v1 offset:20952
    s_waitcnt lgkmcnt(14)
    ds_read_b64_tr_b16 v[196:197], v1 offset:18688
    v_mfma_f32_32x32x16_bf16 v[80:95], v[220:223], v[164:167], v[80:95]
    s_waitcnt lgkmcnt(14)
    ds_read_b64_tr_b16 v[198:199], v1 offset:20992
    s_waitcnt lgkmcnt(14)
    ds_read_b64_tr_b16 v[200:201], v2 offset:18432
    s_waitcnt lgkmcnt(14)
    ds_read_b64_tr_b16 v[202:203], v2 offset:20736
    v_mfma_f32_32x32x16_bf16 v[96:111], v[224:227], v[164:167], v[96:111]
    s_add_u32 m0, s54, 41984
    s_nop 0
    buffer_load_dwordx4 v248, s[20:23], s57 offen offset:0 lds
    v_mfma_f32_32x32x16_bf16 v[112:127], v[228:231], v[164:167], v[112:127]
    buffer_load_dwordx4 v249, s[20:23], s57 offen offset:1024 lds
    v_mfma_f32_32x32x16_bf16 v[128:143], v[232:235], v[164:167], v[128:143]
    s_mov_b64 exec, s[52:53]
    buffer_load_dwordx4 v250, s[20:23], s57 offen offset:2048 lds
    s_mov_b64 exec, -1
    s_add_u32 s57, s57, 55296
    v_mfma_f32_32x32x16_bf16 v[144:159], v[236:239], v[164:167], v[144:159]
    s_waitcnt vmcnt(17)
    s_waitcnt lgkmcnt(0)
    s_barrier
    v_mfma_f32_32x32x16_bf16 v[16:31], v[168:171], v[160:163], v[16:31]
    ds_read_b128 v[164:167], v243 offset:0
    ds_read_b64_tr_b16 v[204:205], v1 offset:27648
    ds_read_b64_tr_b16 v[206:207], v1 offset:29952
    ds_read_b64_tr_b16 v[208:209], v1 offset:27688
    v_mfma_f32_32x32x16_bf16 v[32:47], v[172:175], v[160:163], v[32:47]
    ds_read_b64_tr_b16 v[210:211], v1 offset:29992
    ds_read_b64_tr_b16 v[212:213], v1 offset:27720
    ds_read_b64_tr_b16 v[214:215], v1 offset:30024
    ds_read_b64_tr_b16 v[216:217], v1 offset:27760
    v_mfma_f32_32x32x16_bf16 v[48:63], v[176:179], v[160:163], v[48:63]
    ds_read_b64_tr_b16 v[218:219], v1 offset:30064
    ds_read_b64_tr_b16 v[220:221], v1 offset:27792
    ds_read_b64_tr_b16 v[222:223], v1 offset:30096
    ds_read_b64_tr_b16 v[224:225], v1 offset:27832
    v_mfma_f32_32x32x16_bf16 v[64:79], v[180:183], v[160:163], v[64:79]
    ds_read_b64_tr_b16 v[226:227], v1 offset:30136
    ds_read_b64_tr_b16 v[228:229], v1 offset:27864
    ds_read_b64_tr_b16 v[230:231], v1 offset:30168
    s_waitcnt lgkmcnt(14)
    ds_read_b64_tr_b16 v[232:233], v1 offset:27904
    v_mfma_f32_32x32x16_bf16 v[80:95], v[184:187], v[160:163], v[80:95]
    s_waitcnt lgkmcnt(14)
    ds_read_b64_tr_b16 v[234:235], v1 offset:30208
    s_waitcnt lgkmcnt(14)
    ds_read_b64_tr_b16 v[236:237], v2 offset:27648
    s_waitcnt lgkmcnt(14)
    ds_read_b64_tr_b16 v[238:239], v2 offset:29952
    v_mfma_f32_32x32x16_bf16 v[96:111], v[188:191], v[160:163], v[96:111]
    s_add_u32 m0, s54, 51200
    s_nop 0
    buffer_load_dwordx4 v248, s[20:23], s57 offen offset:0 lds
    v_mfma_f32_32x32x16_bf16 v[112:127], v[192:195], v[160:163], v[112:127]
    buffer_load_dwordx4 v249, s[20:23], s57 offen offset:1024 lds
    v_mfma_f32_32x32x16_bf16 v[128:143], v[196:199], v[160:163], v[128:143]
    s_mov_b64 exec, s[52:53]
    buffer_load_dwordx4 v250, s[20:23], s57 offen offset:2048 lds
    s_mov_b64 exec, -1
    s_add_u32 s57, s57, 55296
    v_mfma_f32_32x32x16_bf16 v[144:159], v[200:203], v[160:163], v[144:159]
    s_waitcnt vmcnt(6)
    s_waitcnt lgkmcnt(0)
    s_barrier
    v_mfma_f32_32x32x16_bf16 v[16:31], v[204:207], v[164:167], v[16:31]
    ds_read_b128 v[160:163], v240 offset:16384
    ds_read_b64_tr_b16 v[168:169], v1 offset:0
    ds_read_b64_tr_b16 v[170:171], v1 offset:2304
    ds_read_b64_tr_b16 v[172:173], v1 offset:40
    v_mfma_f32_32x32x16_bf16 v[32:47], v[208:211], v[164:167], v[32:47]
    ds_read_b64_tr_b16 v[174:175], v1 offset:2344
    ds_read_b64_tr_b16 v[176:177], v1 offset:72
    ds_read_b64_tr_b16 v[178:179], v1 offset:2376
    ds_read_b64_tr_b16 v[180:181], v1 offset:112
    v_mfma_f32_32x32x16_bf16 v[48:63], v[212:215], v[164:167], v[48:63]
    ds_read_b64_tr_b16 v[182:183], v1 offset:2416
    ds_read_b64_tr_b16 v[184:185], v1 offset:144
    ds_read_b64_tr_b16 v[186:187], v1 offset:2448
    ds_read_b64_tr_b16 v[188:189], v1 offset:184
    s_add_u32 m0, s54, 60416
    s_nop 0
    buffer_load_dwordx4 v248, s[20:23], s57 offen offset:0 lds
    v_mfma_f32_32x32x16_bf16 v[64:79], v[216:219], v[164:167], v[64:79]
    ds_read_b64_tr_b16 v[190:191], v1 offset:2488
    ds_read_b64_tr_b16 v[192:193], v1 offset:216
    ds_read_b64_tr_b16 v[194:195], v1 offset:2520
    s_waitcnt lgkmcnt(14)
    ds_read_b64_tr_b16 v[196:197], v1 offset:256
    buffer_load_dwordx4 v249, s[20:23], s57 offen offset:1024 lds
    v_mfma_f32_32x32x16_bf16 v[80:95], v[220:223], v[164:167], v[80:95]
    s_waitcnt lgkmcnt(14)
    ds_read_b64_tr_b16 v[198:199], v1 offset:2560
    s_waitcnt lgkmcnt(14)
    ds_read_b64_tr_b16 v[200:201], v2 offset:0
    s_waitcnt lgkmcnt(14)
    ds_read_b64_tr_b16 v[202:203], v2 offset:2304
    s_mov_b64 exec, s[52:53]
    buffer_load_dwordx4 v250, s[20:23], s57 offen offset:2048 lds
    s_mov_b64 exec, -1
    s_add_u32 s57, s57, 55296
    v_mfma_f32_32x32x16_bf16 v[96:111], v[224:227], v[164:167], v[96:111]
    s_add_u32 m0, s55, 0
    s_nop 0
    buffer_load_dwordx4 v244, s[16:19], s56 offen offset:0 lds
    v_mfma_f32_32x32x16_bf16 v[112:127], v[228:231], v[164:167], v[112:127]
    buffer_load_dwordx4 v245, s[16:19], s56 offen offset:1024 lds
    v_mfma_f32_32x32x16_bf16 v[128:143], v[232:235], v[164:167], v[128:143]
    buffer_load_dwordx4 v246, s[16:19], s56 offen offset:2048 lds
    v_mfma_f32_32x32x16_bf16 v[144:159], v[236:239], v[164:167], v[144:159]
    buffer_load_dwordx4 v247, s[16:19], s56 offen offset:3072 lds
    s_add_u32 s56, s56, 128
    s_waitcnt vmcnt(10)
    s_waitcnt lgkmcnt(0)
    s_barrier
    v_mfma_f32_32x32x16_bf16 v[16:31], v[168:171], v[160:163], v[16:31]
    ds_read_b128 v[164:167], v241 offset:16384
    ds_read_b64_tr_b16 v[204:205], v1 offset:9216
    ds_read_b64_tr_b16 v[206:207], v1 offset:11520
    ds_read_b64_tr_b16 v[208:209], v1 offset:9256
    v_mfma_f32_32x32x16_bf16 v[32:47], v[172:175], v[160:163], v[32:47]
    ds_read_b64_tr_b16 v[210:211], v1 offset:11560
    ds_read_b64_tr_b16 v[212:213], v1 offset:9288
    ds_read_b64_tr_b16 v[214:215], v1 offset:11592
    ds_read_b64_tr_b16 v[216:217], v1 offset:9328
    v_mfma_f32_32x32x16_bf16 v[48:63], v[176:179], v[160:163], v[48:63]
    ds_read_b64_tr_b16 v[218:219], v1 offset:11632
    ds_read_b64_tr_b16 v[220:221], v1 offset:9360
    ds_read_b64_tr_b16 v[222:223], v1 offset:11664
    ds_read_b64_tr_b16 v[224:225], v1 offset:9400
    v_mfma_f32_32x32x16_bf16 v[64:79], v[180:183], v[160:163], v[64:79]
    ds_read_b64_tr_b16 v[226:227], v1 offset:11704
    ds_read_b64_tr_b16 v[228:229], v1 offset:9432
    ds_read_b64_tr_b16 v[230:231], v1 offset:11736
    s_waitcnt lgkmcnt(14)
    ds_read_b64_tr_b16 v[232:233], v1 offset:9472
    v_mfma_f32_32x32x16_bf16 v[80:95], v[184:187], v[160:163], v[80:95]
    s_waitcnt lgkmcnt(14)
    ds_read_b64_tr_b16 v[234:235], v1 offset:11776
    s_waitcnt lgkmcnt(14)
    ds_read_b64_tr_b16 v[236:237], v2 offset:9216
    s_waitcnt lgkmcnt(14)
    ds_read_b64_tr_b16 v[238:239], v2 offset:11520
    v_mfma_f32_32x32x16_bf16 v[96:111], v[188:191], v[160:163], v[96:111]
    s_add_u32 m0, s54, 32768
    s_nop 0
    buffer_load_dwordx4 v248, s[20:23], s57 offen offset:0 lds
    v_mfma_f32_32x32x16_bf16 v[112:127], v[192:195], v[160:163], v[112:127]
    buffer_load_dwordx4 v249, s[20:23], s57 offen offset:1024 lds
    v_mfma_f32_32x32x16_bf16 v[128:143], v[196:199], v[160:163], v[128:143]
    s_mov_b64 exec, s[52:53]
    buffer_load_dwordx4 v250, s[20:23], s57 offen offset:2048 lds
    s_mov_b64 exec, -1
    s_add_u32 s57, s57, 55296
    v_mfma_f32_32x32x16_bf16 v[144:159], v[200:203], v[160:163], v[144:159]
    s_waitcnt vmcnt(10)
    s_waitcnt lgkmcnt(0)
    s_barrier
    v_mfma_f32_32x32x16_bf16 v[16:31], v[204:207], v[164:167], v[16:31]
    ds_read_b128 v[160:163], v242 offset:16384
    ds_read_b64_tr_b16 v[168:169], v1 offset:18432
    ds_read_b64_tr_b16 v[170:171], v1 offset:20736
    ds_read_b64_tr_b16 v[172:173], v1 offset:18472
    v_mfma_f32_32x32x16_bf16 v[32:47], v[208:211], v[164:167], v[32:47]
    ds_read_b64_tr_b16 v[174:175], v1 offset:20776
    ds_read_b64_tr_b16 v[176:177], v1 offset:18504
    ds_read_b64_tr_b16 v[178:179], v1 offset:20808
    ds_read_b64_tr_b16 v[180:181], v1 offset:18544
    v_mfma_f32_32x32x16_bf16 v[48:63], v[212:215], v[164:167], v[48:63]
    ds_read_b64_tr_b16 v[182:183], v1 offset:20848
    ds_read_b64_tr_b16 v[184:185], v1 offset:18576
    ds_read_b64_tr_b16 v[186:187], v1 offset:20880
    ds_read_b64_tr_b16 v[188:189], v1 offset:18616
    v_mfma_f32_32x32x16_bf16 v[64:79], v[216:219], v[164:167], v[64:79]
    ds_read_b64_tr_b16 v[190:191], v1 offset:20920
    ds_read_b64_tr_b16 v[192:193], v1 offset:18648
    ds_read_b64_tr_b16 v[194:195], v1 offset:20952
    s_waitcnt lgkmcnt(14)
    ds_read_b64_tr_b16 v[196:197], v1 offset:18688
    v_mfma_f32_32x32x16_bf16 v[80:95], v[220:223], v[164:167], v[80:95]
    s_waitcnt lgkmcnt(14)
    ds_read_b64_tr_b16 v[198:199], v1 offset:20992
    s_waitcnt lgkmcnt(14)
    ds_read_b64_tr_b16 v[200:201], v2 offset:18432
    s_waitcnt lgkmcnt(14)
    ds_read_b64_tr_b16 v[202:203], v2 offset:20736
    v_mfma_f32_32x32x16_bf16 v[96:111], v[224:227], v[164:167], v[96:111]
    s_add_u32 m0, s54, 41984
    s_nop 0
    buffer_load_dwordx4 v248, s[20:23], s57 offen offset:0 lds
    v_mfma_f32_32x32x16_bf16 v[112:127], v[228:231], v[164:167], v[112:127]
    buffer_load_dwordx4 v249, s[20:23], s57 offen offset:1024 lds
    v_mfma_f32_32x32x16_bf16 v[128:143], v[232:235], v[164:167], v[128:143]
    s_mov_b64 exec, s[52:53]
    buffer_load_dwordx4 v250, s[20:23], s57 offen offset:2048 lds
    s_mov_b64 exec, -1
    s_add_u32 s57, s57, 55296
    v_mfma_f32_32x32x16_bf16 v[144:159], v[236:239], v[164:167], v[144:159]
    s_waitcnt vmcnt(10)
    s_waitcnt lgkmcnt(0)
    s_barrier
    v_mfma_f32_32x32x16_bf16 v[16:31], v[168:171], v[160:163], v[16:31]
    ds_read_b128 v[164:167], v243 offset:16384
    ds_read_b64_tr_b16 v[204:205], v1 offset:27648
    ds_read_b64_tr_b16 v[206:207], v1 offset:29952
    ds_read_b64_tr_b16 v[208:209], v1 offset:27688
    v_mfma_f32_32x32x16_bf16 v[32:47], v[172:175], v[160:163], v[32:47]
    ds_read_b64_tr_b16 v[210:211], v1 offset:29992
    ds_read_b64_tr_b16 v[212:213], v1 offset:27720
    ds_read_b64_tr_b16 v[214:215], v1 offset:30024
    ds_read_b64_tr_b16 v[216:217], v1 offset:27760
    v_mfma_f32_32x32x16_bf16 v[48:63], v[176:179], v[160:163], v[48:63]
    ds_read_b64_tr_b16 v[218:219], v1 offset:30064
    ds_read_b64_tr_b16 v[220:221], v1 offset:27792
    ds_read_b64_tr_b16 v[222:223], v1 offset:30096
    ds_read_b64_tr_b16 v[224:225], v1 offset:27832
    v_mfma_f32_32x32x16_bf16 v[64:79], v[180:183], v[160:163], v[64:79]
    ds_read_b64_tr_b16 v[226:227], v1 offset:30136
    ds_read_b64_tr_b16 v[228:229], v1 offset:27864
    ds_read_b64_tr_b16 v[230:231], v1 offset:30168
    s_waitcnt lgkmcnt(14)
    ds_read_b64_tr_b16 v[232:233], v1 offset:27904
    v_mfma_f32_32x32x16_bf16 v[80:95], v[184:187], v[160:163], v[80:95]
    s_waitcnt lgkmcnt(14)
    ds_read_b64_tr_b16 v[234:235], v1 offset:30208
    s_waitcnt lgkmcnt(14)
    ds_read_b64_tr_b16 v[236:237], v2 offset:27648
    s_waitcnt lgkmcnt(14)
    ds_read_b64_tr_b16 v[238:239], v2 offset:29952
    v_mfma_f32_32x32x16_bf16 v[96:111], v[188:191], v[160:163], v[96:111]
    s_add_u32 m0, s54, 51200
    s_nop 0
    buffer_load_dwordx4 v248, s[20:23], s57 offen offset:0 lds
    v_mfma_f32_32x32x16_bf16 v[112:127], v[192:195], v[160:163], v[112:127]
    buffer_load_dwordx4 v249, s[20:23], s57 offen offset:1024 lds
    v_mfma_f32_32x32x16_bf16 v[128:143], v[196:199], v[160:163], v[128:143]
    s_mov_b64 exec, s[52:53]
    buffer_load_dwordx4 v250, s[20:23], s57 offen offset:2048 lds
    s_mov_b64 exec, -1
    s_add_u32 s57, s57, 55296
    v_mfma_f32_32x32x16_bf16 v[144:159], v[200:203], v[160:163], v[144:159]
    s_waitcnt vmcnt(6)
    s_waitcnt lgkmcnt(0)
    s_barrier
    v_mfma_f32_32x32x16_bf16 v[16:31], v[204:207], v[164:167], v[16:31]
    ds_read_b128 v[160:163], v240 offset:0
    ds_read_b64_tr_b16 v[168:169], v1 offset:0
    ds_read_b64_tr_b16 v[170:171], v1 offset:2304
    ds_read_b64_tr_b16 v[172:173], v1 offset:40
    v_mfma_f32_32x32x16_bf16 v[32:47], v[208:211], v[164:167], v[32:47]
    ds_read_b64_tr_b16 v[174:175], v1 offset:2344
    ds_read_b64_tr_b16 v[176:177], v1 offset:72
    ds_read_b64_tr_b16 v[178:179], v1 offset:2376
    ds_read_b64_tr_b16 v[180:181], v1 offset:112
    v_mfma_f32_32x32x16_bf16 v[48:63], v[212:215], v[164:167], v[48:63]
    ds_read_b64_tr_b16 v[182:183], v1 offset:2416
    ds_read_b64_tr_b16 v[184:185], v1 offset:144
    ds_read_b64_tr_b16 v[186:187], v1 offset:2448
    ds_read_b64_tr_b16 v[188:189], v1 offset:184
    s_add_u32 m0, s54, 60416
    s_nop 0
    buffer_load_dwordx4 v248, s[20:23], s57 offen offset:0 lds
    v_mfma_f32_32x32x16_bf16 v[64:79], v[216:219], v[164:167], v[64:79]
    ds_read_b64_tr_b16 v[190:191], v1 offset:2488
    ds_read_b64_tr_b16 v[192:193], v1 offset:216
    ds_read_b64_tr_b16 v[194:195], v1 offset:2520
    s_waitcnt lgkmcnt(14)
    ds_read_b64_tr_b16 v[196:197], v1 offset:256
    buffer_load_dwordx4 v249, s[20:23], s57 offen offset:1024 lds
    v_mfma_f32_32x32x16_bf16 v[80:95], v[220:223], v[164:167], v[80:95]
    s_waitcnt lgkmcnt(14)
    ds_read_b64_tr_b16 v[198:199], v1 offset:2560
    s_waitcnt lgkmcnt(14)
    ds_read_b64_tr_b16 v[200:201], v2 offset:0
    s_waitcnt lgkmcnt(14)
    ds_read_b64_tr_b16 v[202:203], v2 offset:2304
    s_mov_b64 exec, s[52:53]
    buffer_load_dwordx4 v250, s[20:23], s57 offen offset:2048 lds
    s_mov_b64 exec, -1
    s_add_u32 s57, s57, 55296
    v_mfma_f32_32x32x16_bf16 v[96:111], v[224:227], v[164:167], v[96:111]
    s_add_u32 m0, s55, 16384
    s_nop 0
    buffer_load_dwordx4 v244, s[16:19], s56 offen offset:0 lds
    v_mfma_f32_32x32x16_bf16 v[112:127], v[228:231], v[164:167], v[112:127]
    buffer_load_dwordx4 v245, s[16:19], s56 offen offset:1024 lds
    v_mfma_f32_32x32x16_bf16 v[128:143], v[232:235], v[164:167], v[128:143]
    buffer_load_dwordx4 v246, s[16:19], s56 offen offset:2048 lds
    v_mfma_f32_32x32x16_bf16 v[144:159], v[236:239], v[164:167], v[144:159]
    buffer_load_dwordx4 v247, s[16:19], s56 offen offset:3072 lds
    s_add_u32 s56, s56, 128
    s_waitcnt vmcnt(10)
    s_waitcnt lgkmcnt(0)
    s_barrier
    v_mfma_f32_32x32x16_bf16 v[16:31], v[168:171], v[160:163], v[16:31]
    ds_read_b128 v[164:167], v241 offset:0
    ds_read_b64_tr_b16 v[204:205], v1 offset:9216
    ds_read_b64_tr_b16 v[206:207], v1 offset:11520
    ds_read_b64_tr_b16 v[208:209], v1 offset:9256
    v_mfma_f32_32x32x16_bf16 v[32:47], v[172:175], v[160:163], v[32:47]
    ds_read_b64_tr_b16 v[210:211], v1 offset:11560
    ds_read_b64_tr_b16 v[212:213], v1 offset:9288
    ds_read_b64_tr_b16 v[214:215], v1 offset:11592
    ds_read_b64_tr_b16 v[216:217], v1 offset:9328
    v_mfma_f32_32x32x16_bf16 v[48:63], v[176:179], v[160:163], v[48:63]
    ds_read_b64_tr_b16 v[218:219], v1 offset:11632
    ds_read_b64_tr_b16 v[220:221], v1 offset:9360
    ds_read_b64_tr_b16 v[222:223], v1 offset:11664
    ds_read_b64_tr_b16 v[224:225], v1 offset:9400
    v_mfma_f32_32x32x16_bf16 v[64:79], v[180:183], v[160:163], v[64:79]
    ds_read_b64_tr_b16 v[226:227], v1 offset:11704
    ds_read_b64_tr_b16 v[228:229], v1 offset:9432
    ds_read_b64_tr_b16 v[230:231], v1 offset:11736
    s_waitcnt lgkmcnt(14)
    ds_read_b64_tr_b16 v[232:233], v1 offset:9472
    v_mfma_f32_32x32x16_bf16 v[80:95], v[184:187], v[160:163], v[80:95]
    s_waitcnt lgkmcnt(14)
    ds_read_b64_tr_b16 v[234:235], v1 offset:11776
    s_waitcnt lgkmcnt(14)
    ds_read_b64_tr_b16 v[236:237], v2 offset:9216
    s_waitcnt lgkmcnt(14)
    ds_read_b64_tr_b16 v[238:239], v2 offset:11520
    v_mfma_f32_32x32x16_bf16 v[96:111], v[188:191], v[160:163], v[96:111]
    s_add_u32 m0, s54, 32768
    s_nop 0
    buffer_load_dwordx4 v248, s[20:23], s57 offen offset:0 lds
    v_mfma_f32_32x32x16_bf16 v[112:127], v[192:195], v[160:163], v[112:127]
    buffer_load_dwordx4 v249, s[20:23], s57 offen offset:1024 lds
    v_mfma_f32_32x32x16_bf16 v[128:143], v[196:199], v[160:163], v[128:143]
    s_mov_b64 exec, s[52:53]
    buffer_load_dwordx4 v250, s[20:23], s57 offen offset:2048 lds
    s_mov_b64 exec, -1
    s_add_u32 s57, s57, 55296
    v_mfma_f32_32x32x16_bf16 v[144:159], v[200:203], v[160:163], v[144:159]
    s_waitcnt vmcnt(10)
    s_waitcnt lgkmcnt(0)
    s_barrier
    v_mfma_f32_32x32x16_bf16 v[16:31], v[204:207], v[164:167], v[16:31]
    ds_read_b128 v[160:163], v242 offset:0
    ds_read_b64_tr_b16 v[168:169], v1 offset:18432
    ds_read_b64_tr_b16 v[170:171], v1 offset:20736
    ds_read_b64_tr_b16 v[172:173], v1 offset:18472
    v_mfma_f32_32x32x16_bf16 v[32:47], v[208:211], v[164:167], v[32:47]
    ds_read_b64_tr_b16 v[174:175], v1 offset:20776
    ds_read_b64_tr_b16 v[176:177], v1 offset:18504
    ds_read_b64_tr_b16 v[178:179], v1 offset:20808
    ds_read_b64_tr_b16 v[180:181], v1 offset:18544
    v_mfma_f32_32x32x16_bf16 v[48:63], v[212:215], v[164:167], v[48:63]
    ds_read_b64_tr_b16 v[182:183], v1 offset:20848
    ds_read_b64_tr_b16 v[184:185], v1 offset:18576
    ds_read_b64_tr_b16 v[186:187], v1 offset:20880
    ds_read_b64_tr_b16 v[188:189], v1 offset:18616
    v_mfma_f32_32x32x16_bf16 v[64:79], v[216:219], v[164:167], v[64:79]
    ds_read_b64_tr_b16 v[190:191], v1 offset:20920
    ds_read_b64_tr_b16 v[192:193], v1 offset:18648
    ds_read_b64_tr_b16 v[194:195], v1 offset:20952
    s_waitcnt lgkmcnt(14)
    ds_read_b64_tr_b16 v[196:197], v1 offset:18688
    v_mfma_f32_32x32x16_bf16 v[80:95], v[220:223], v[164:167], v[80:95]
    s_waitcnt lgkmcnt(14)
    ds_read_b64_tr_b16 v[198:199], v1 offset:20992
    s_waitcnt lgkmcnt(14)
    ds_read_b64_tr_b16 v[200:201], v2 offset:18432
    s_waitcnt lgkmcnt(14)
    ds_read_b64_tr_b16 v[202:203], v2 offset:20736
    v_mfma_f32_32x32x16_bf16 v[96:111], v[224:227], v[164:167], v[96:111]
    s_add_u32 m0, s54, 41984
    s_nop 0
    buffer_load_dwordx4 v248, s[20:23], s57 offen offset:0 lds
    v_mfma_f32_32x32x16_bf16 v[112:127], v[228:231], v[164:167], v[112:127]
    buffer_load_dwordx4 v249, s[20:23], s57 offen offset:1024 lds
    v_mfma_f32_32x32x16_bf16 v[128:143], v[232:235], v[164:167], v[128:143]
    s_mov_b64 exec, s[52:53]
    buffer_load_dwordx4 v250, s[20:23], s57 offen offset:2048 lds
    s_mov_b64 exec, -1
    s_add_u32 s57, s57, 55296
    v_mfma_f32_32x32x16_bf16 v[144:159], v[236:239], v[164:167], v[144:159]
    s_waitcnt vmcnt(10)
    s_waitcnt lgkmcnt(0)
    s_barrier
    v_mfma_f32_32x32x16_bf16 v[16:31], v[168:171], v[160:163], v[16:31]
    ds_read_b128 v[164:167], v243 offset:0
    ds_read_b64_tr_b16 v[204:205], v1 offset:27648
    ds_read_b64_tr_b16 v[206:207], v1 offset:29952
    ds_read_b64_tr_b16 v[208:209], v1 offset:27688
    v_mfma_f32_32x32x16_bf16 v[32:47], v[172:175], v[160:163], v[32:47]
    ds_read_b64_tr_b16 v[210:211], v1 offset:29992
    ds_read_b64_tr_b16 v[212:213], v1 offset:27720
    ds_read_b64_tr_b16 v[214:215], v1 offset:30024
    ds_read_b64_tr_b16 v[216:217], v1 offset:27760
    v_mfma_f32_32x32x16_bf16 v[48:63], v[176:179], v[160:163], v[48:63]
    ds_read_b64_tr_b16 v[218:219], v1 offset:30064
    ds_read_b64_tr_b16 v[220:221], v1 offset:27792
    ds_read_b64_tr_b16 v[222:223], v1 offset:30096
    ds_read_b64_tr_b16 v[224:225], v1 offset:27832
    v_mfma_f32_32x32x16_bf16 v[64:79], v[180:183], v[160:163], v[64:79]
    ds_read_b64_tr_b16 v[226:227], v1 offset:30136
    ds_read_b64_tr_b16 v[228:229], v1 offset:27864
    ds_read_b64_tr_b16 v[230:231], v1 offset:30168
    s_waitcnt lgkmcnt(14)
    ds_read_b64_tr_b16 v[232:233], v1 offset:27904
    v_mfma_f32_32x32x16_bf16 v[80:95], v[184:187], v[160:163], v[80:95]
    s_waitcnt lgkmcnt(14)
    ds_read_b64_tr_b16 v[234:235], v1 offset:30208
    s_waitcnt lgkmcnt(14)
    ds_read_b64_tr_b16 v[236:237], v2 offset:27648
    s_waitcnt lgkmcnt(14)
    ds_read_b64_tr_b16 v[238:239], v2 offset:29952
    v_mfma_f32_32x32x16_bf16 v[96:111], v[188:191], v[160:163], v[96:111]
    s_add_u32 m0, s54, 51200
    s_nop 0
    buffer_load_dwordx4 v248, s[20:23], s57 offen offset:0 lds
    v_mfma_f32_32x32x16_bf16 v[112:127], v[192:195], v[160:163], v[112:127]
    buffer_load_dwordx4 v249, s[20:23], s57 offen offset:1024 lds
    v_mfma_f32_32x32x16_bf16 v[128:143], v[196:199], v[160:163], v[128:143]
    s_mov_b64 exec, s[52:53]
    buffer_load_dwordx4 v250, s[20:23], s57 offen offset:2048 lds
    s_mov_b64 exec, -1
    s_add_u32 s57, s57, 55296
    v_mfma_f32_32x32x16_bf16 v[144:159], v[200:203], v[160:163], v[144:159]
    s_waitcnt vmcnt(6)
    s_waitcnt lgkmcnt(0)
    s_barrier
    v_mfma_f32_32x32x16_bf16 v[16:31], v[204:207], v[164:167], v[16:31]
    ds_read_b128 v[160:163], v240 offset:16384
    ds_read_b64_tr_b16 v[168:169], v1 offset:0
    ds_read_b64_tr_b16 v[170:171], v1 offset:2304
    ds_read_b64_tr_b16 v[172:173], v1 offset:40
    v_mfma_f32_32x32x16_bf16 v[32:47], v[208:211], v[164:167], v[32:47]
    ds_read_b64_tr_b16 v[174:175], v1 offset:2344
    ds_read_b64_tr_b16 v[176:177], v1 offset:72
    ds_read_b64_tr_b16 v[178:179], v1 offset:2376
    ds_read_b64_tr_b16 v[180:181], v1 offset:112
    v_mfma_f32_32x32x16_bf16 v[48:63], v[212:215], v[164:167], v[48:63]
    ds_read_b64_tr_b16 v[182:183], v1 offset:2416
    ds_read_b64_tr_b16 v[184:185], v1 offset:144
    ds_read_b64_tr_b16 v[186:187], v1 offset:2448
    ds_read_b64_tr_b16 v[188:189], v1 offset:184
    s_add_u32 m0, s54, 60416
    s_nop 0
    buffer_load_dwordx4 v248, s[20:23], s57 offen offset:0 lds
    v_mfma_f32_32x32x16_bf16 v[64:79], v[216:219], v[164:167], v[64:79]
    ds_read_b64_tr_b16 v[190:191], v1 offset:2488
    ds_read_b64_tr_b16 v[192:193], v1 offset:216
    ds_read_b64_tr_b16 v[194:195], v1 offset:2520
    s_waitcnt lgkmcnt(14)
    ds_read_b64_tr_b16 v[196:197], v1 offset:256
    buffer_load_dwordx4 v249, s[20:23], s57 offen offset:1024 lds
    v_mfma_f32_32x32x16_bf16 v[80:95], v[220:223], v[164:167], v[80:95]
    s_waitcnt lgkmcnt(14)
    ds_read_b64_tr_b16 v[198:199], v1 offset:2560
    s_waitcnt lgkmcnt(14)
    ds_read_b64_tr_b16 v[200:201], v2 offset:0
    s_waitcnt lgkmcnt(14)
    ds_read_b64_tr_b16 v[202:203], v2 offset:2304
    s_mov_b64 exec, s[52:53]
    buffer_load_dwordx4 v250, s[20:23], s57 offen offset:2048 lds
    s_mov_b64 exec, -1
    s_add_u32 s57, s57, 55296
    v_mfma_f32_32x32x16_bf16 v[96:111], v[224:227], v[164:167], v[96:111]
    s_add_u32 m0, s55, 0
    s_nop 0
    buffer_load_dwordx4 v244, s[16:19], s56 offen offset:0 lds
    v_mfma_f32_32x32x16_bf16 v[112:127], v[228:231], v[164:167], v[112:127]
    buffer_load_dwordx4 v245, s[16:19], s56 offen offset:1024 lds
    v_mfma_f32_32x32x16_bf16 v[128:143], v[232:235], v[164:167], v[128:143]
    buffer_load_dwordx4 v246, s[16:19], s56 offen offset:2048 lds
    v_mfma_f32_32x32x16_bf16 v[144:159], v[236:239], v[164:167], v[144:159]
    buffer_load_dwordx4 v247, s[16:19], s56 offen offset:3072 lds
    s_add_u32 s56, s56, 128
    s_waitcnt vmcnt(10)
    s_waitcnt lgkmcnt(0)
    s_barrier
    v_mfma_f32_32x32x16_bf16 v[16:31], v[168:171], v[160:163], v[16:31]
    ds_read_b128 v[164:167], v241 offset:16384
    ds_read_b64_tr_b16 v[204:205], v1 offset:9216
    ds_read_b64_tr_b16 v[206:207], v1 offset:11520
    ds_read_b64_tr_b16 v[208:209], v1 offset:9256
    v_mfma_f32_32x32x16_bf16 v[32:47], v[172:175], v[160:163], v[32:47]
    ds_read_b64_tr_b16 v[210:211], v1 offset:11560
    ds_read_b64_tr_b16 v[212:213], v1 offset:9288
    ds_read_b64_tr_b16 v[214:215], v1 offset:11592
    ds_read_b64_tr_b16 v[216:217], v1 offset:9328
    v_mfma_f32_32x32x16_bf16 v[48:63], v[176:179], v[160:163], v[48:63]
    ds_read_b64_tr_b16 v[218:219], v1 offset:11632
    ds_read_b64_tr_b16 v[220:221], v1 offset:9360
    ds_read_b64_tr_b16 v[222:223], v1 offset:11664
    ds_read_b64_tr_b16 v[224:225], v1 offset:9400
    v_mfma_f32_32x32x16_bf16 v[64:79], v[180:183], v[160:163], v[64:79]
    ds_read_b64_tr_b16 v[226:227], v1 offset:11704
    ds_read_b64_tr_b16 v[228:229], v1 offset:9432
    ds_read_b64_tr_b16 v[230:231], v1 offset:11736
    s_waitcnt lgkmcnt(14)
    ds_read_b64_tr_b16 v[232:233], v1 offset:9472
    v_mfma_f32_32x32x16_bf16 v[80:95], v[184:187], v[160:163], v[80:95]
    s_waitcnt lgkmcnt(14)
    ds_read_b64_tr_b16 v[234:235], v1 offset:11776
    s_waitcnt lgkmcnt(14)
    ds_read_b64_tr_b16 v[236:237], v2 offset:9216
    s_waitcnt lgkmcnt(14)
    ds_read_b64_tr_b16 v[238:239], v2 offset:11520
    v_mfma_f32_32x32x16_bf16 v[96:111], v[188:191], v[160:163], v[96:111]
    s_add_u32 m0, s54, 32768
    s_nop 0
    buffer_load_dwordx4 v248, s[20:23], s57 offen offset:0 lds
    v_mfma_f32_32x32x16_bf16 v[112:127], v[192:195], v[160:163], v[112:127]
    buffer_load_dwordx4 v249, s[20:23], s57 offen offset:1024 lds
    v_mfma_f32_32x32x16_bf16 v[128:143], v[196:199], v[160:163], v[128:143]
    s_mov_b64 exec, s[52:53]
    buffer_load_dwordx4 v250, s[20:23], s57 offen offset:2048 lds
    s_mov_b64 exec, -1
    s_add_u32 s57, s57, 55296
    v_mfma_f32_32x32x16_bf16 v[144:159], v[200:203], v[160:163], v[144:159]
    s_waitcnt vmcnt(10)
    s_waitcnt lgkmcnt(0)
    s_barrier
    v_mfma_f32_32x32x16_bf16 v[16:31], v[204:207], v[164:167], v[16:31]
    ds_read_b128 v[160:163], v242 offset:16384
    ds_read_b64_tr_b16 v[168:169], v1 offset:18432
    ds_read_b64_tr_b16 v[170:171], v1 offset:20736
    ds_read_b64_tr_b16 v[172:173], v1 offset:18472
    v_mfma_f32_32x32x16_bf16 v[32:47], v[208:211], v[164:167], v[32:47]
    ds_read_b64_tr_b16 v[174:175], v1 offset:20776
    ds_read_b64_tr_b16 v[176:177], v1 offset:18504
    ds_read_b64_tr_b16 v[178:179], v1 offset:20808
    ds_read_b64_tr_b16 v[180:181], v1 offset:18544
    v_mfma_f32_32x32x16_bf16 v[48:63], v[212:215], v[164:167], v[48:63]
    ds_read_b64_tr_b16 v[182:183], v1 offset:20848
    ds_read_b64_tr_b16 v[184:185], v1 offset:18576
    ds_read_b64_tr_b16 v[186:187], v1 offset:20880
    ds_read_b64_tr_b16 v[188:189], v1 offset:18616
    v_mfma_f32_32x32x16_bf16 v[64:79], v[216:219], v[164:167], v[64:79]
    ds_read_b64_tr_b16 v[190:191], v1 offset:20920
    ds_read_b64_tr_b16 v[192:193], v1 offset:18648
    ds_read_b64_tr_b16 v[194:195], v1 offset:20952
    s_waitcnt lgkmcnt(14)
    ds_read_b64_tr_b16 v[196:197], v1 offset:18688
    v_mfma_f32_32x32x16_bf16 v[80:95], v[220:223], v[164:167], v[80:95]
    s_waitcnt lgkmcnt(14)
    ds_read_b64_tr_b16 v[198:199], v1 offset:20992
    s_waitcnt lgkmcnt(14)
    ds_read_b64_tr_b16 v[200:201], v2 offset:18432
    s_waitcnt lgkmcnt(14)
    ds_read_b64_tr_b16 v[202:203], v2 offset:20736
    v_mfma_f32_32x32x16_bf16 v[96:111], v[224:227], v[164:167], v[96:111]
    s_add_u32 m0, s54, 41984
    s_nop 0
    buffer_load_dwordx4 v248, s[20:23], s57 offen offset:0 lds
    v_mfma_f32_32x32x16_bf16 v[112:127], v[228:231], v[164:167], v[112:127]
    buffer_load_dwordx4 v249, s[20:23], s57 offen offset:1024 lds
    v_mfma_f32_32x32x16_bf16 v[128:143], v[232:235], v[164:167], v[128:143]
    s_mov_b64 exec, s[52:53]
    buffer_load_dwordx4 v250, s[20:23], s57 offen offset:2048 lds
    s_mov_b64 exec, -1
    s_add_u32 s57, s57, 55296
    v_mfma_f32_32x32x16_bf16 v[144:159], v[236:239], v[164:167], v[144:159]
    s_waitcnt vmcnt(10)
    s_waitcnt lgkmcnt(0)
    s_barrier
    v_mfma_f32_32x32x16_bf16 v[16:31], v[168:171], v[160:163], v[16:31]
    ds_read_b128 v[164:167], v243 offset:16384
    ds_read_b64_tr_b16 v[204:205], v1 offset:27648
    ds_read_b64_tr_b16 v[206:207], v1 offset:29952
    ds_read_b64_tr_b16 v[208:209], v1 offset:27688
    v_mfma_f32_32x32x16_bf16 v[32:47], v[172:175], v[160:163], v[32:47]
    ds_read_b64_tr_b16 v[210:211], v1 offset:29992
    ds_read_b64_tr_b16 v[212:213], v1 offset:27720
    ds_read_b64_tr_b16 v[214:215], v1 offset:30024
    ds_read_b64_tr_b16 v[216:217], v1 offset:27760
    v_mfma_f32_32x32x16_bf16 v[48:63], v[176:179], v[160:163], v[48:63]
    ds_read_b64_tr_b16 v[218:219], v1 offset:30064
    ds_read_b64_tr_b16 v[220:221], v1 offset:27792
    ds_read_b64_tr_b16 v[222:223], v1 offset:30096
    ds_read_b64_tr_b16 v[224:225], v1 offset:27832
    v_mfma_f32_32x32x16_bf16 v[64:79], v[180:183], v[160:163], v[64:79]
    ds_read_b64_tr_b16 v[226:227], v1 offset:30136
    ds_read_b64_tr_b16 v[228:229], v1 offset:27864
    ds_read_b64_tr_b16 v[230:231], v1 offset:30168
    s_waitcnt lgkmcnt(14)
    ds_read_b64_tr_b16 v[232:233], v1 offset:27904
    v_mfma_f32_32x32x16_bf16 v[80:95], v[184:187], v[160:163], v[80:95]
    s_waitcnt lgkmcnt(14)
    ds_read_b64_tr_b16 v[234:235], v1 offset:30208
    s_waitcnt lgkmcnt(14)
    ds_read_b64_tr_b16 v[236:237], v2 offset:27648
    s_waitcnt lgkmcnt(14)
    ds_read_b64_tr_b16 v[238:239], v2 offset:29952
    v_mfma_f32_32x32x16_bf16 v[96:111], v[188:191], v[160:163], v[96:111]
    s_add_u32 m0, s54, 51200
    s_nop 0
    buffer_load_dwordx4 v248, s[20:23], s57 offen offset:0 lds
    v_mfma_f32_32x32x16_bf16 v[112:127], v[192:195], v[160:163], v[112:127]
    buffer_load_dwordx4 v249, s[20:23], s57 offen offset:1024 lds
    v_mfma_f32_32x32x16_bf16 v[128:143], v[196:199], v[160:163], v[128:143]
    s_mov_b64 exec, s[52:53]
    buffer_load_dwordx4 v250, s[20:23], s57 offen offset:2048 lds
    s_mov_b64 exec, -1
    s_add_u32 s57, s57, 55296
    v_mfma_f32_32x32x16_bf16 v[144:159], v[200:203], v[160:163], v[144:159]
    s_waitcnt vmcnt(6)
    s_waitcnt lgkmcnt(0)
    s_barrier
    v_mfma_f32_32x32x16_bf16 v[16:31], v[204:207], v[164:167], v[16:31]
    ds_read_b128 v[160:163], v240 offset:0
    ds_read_b64_tr_b16 v[168:169], v1 offset:0
    ds_read_b64_tr_b16 v[170:171], v1 offset:2304
    ds_read_b64_tr_b16 v[172:173], v1 offset:40
    v_mfma_f32_32x32x16_bf16 v[32:47], v[208:211], v[164:167], v[32:47]
    ds_read_b64_tr_b16 v[174:175], v1 offset:2344
    ds_read_b64_tr_b16 v[176:177], v1 offset:72
    ds_read_b64_tr_b16 v[178:179], v1 offset:2376
    ds_read_b64_tr_b16 v[180:181], v1 offset:112
    v_mfma_f32_32x32x16_bf16 v[48:63], v[212:215], v[164:167], v[48:63]
    ds_read_b64_tr_b16 v[182:183], v1 offset:2416
    ds_read_b64_tr_b16 v[184:185], v1 offset:144
    ds_read_b64_tr_b16 v[186:187], v1 offset:2448
    ds_read_b64_tr_b16 v[188:189], v1 offset:184
    s_add_u32 m0, s54, 60416
    s_nop 0
    buffer_load_dwordx4 v248, s[20:23], s57 offen offset:0 lds
    v_mfma_f32_32x32x16_bf16 v[64:79], v[216:219], v[164:167], v[64:79]
    ds_read_b64_tr_b16 v[190:191], v1 offset:2488
    ds_read_b64_tr_b16 v[192:193], v1 offset:216
    ds_read_b64_tr_b16 v[194:195], v1 offset:2520
    s_waitcnt lgkmcnt(14)
    ds_read_b64_tr_b16 v[196:197], v1 offset:256
    buffer_load_dwordx4 v249, s[20:23], s57 offen offset:1024 lds
    v_mfma_f32_32x32x16_bf16 v[80:95], v[220:223], v[164:167], v[80:95]
    s_waitcnt lgkmcnt(14)
    ds_read_b64_tr_b16 v[198:199], v1 offset:2560
    s_waitcnt lgkmcnt(14)
    ds_read_b64_tr_b16 v[200:201], v2 offset:0
    s_waitcnt lgkmcnt(14)
    ds_read_b64_tr_b16 v[202:203], v2 offset:2304
    s_mov_b64 exec, s[52:53]
    buffer_load_dwordx4 v250, s[20:23], s57 offen offset:2048 lds
    s_mov_b64 exec, -1
    s_add_u32 s57, s57, 55296
    v_mfma_f32_32x32x16_bf16 v[96:111], v[224:227], v[164:167], v[96:111]
    s_add_u32 m0, s55, 16384
    s_nop 0
    buffer_load_dwordx4 v244, s[16:19], s56 offen offset:0 lds
    v_mfma_f32_32x32x16_bf16 v[112:127], v[228:231], v[164:167], v[112:127]
    buffer_load_dwordx4 v245, s[16:19], s56 offen offset:1024 lds
    v_mfma_f32_32x32x16_bf16 v[128:143], v[232:235], v[164:167], v[128:143]
    buffer_load_dwordx4 v246, s[16:19], s56 offen offset:2048 lds
    v_mfma_f32_32x32x16_bf16 v[144:159], v[236:239], v[164:167], v[144:159]
    buffer_load_dwordx4 v247, s[16:19], s56 offen offset:3072 lds
    s_add_u32 s56, s56, 128
    s_waitcnt vmcnt(10)
    s_waitcnt lgkmcnt(0)
    s_barrier
    v_readfirstlane_b32 s76, v4
    v_readfirstlane_b32 s77, v5
    s_mov_b32 s38, 0x40000
gated_mix__mha_block__mixer_gmlp__prompt_kernel_qk_n:
    s_nop 1
    s_cmp_eq_u32 s76, 0
    s_cbranch_scc1 gated_mix__mha_block__mixer_gmlp__prompt_kernel_qk_n_r
    s_sub_u32 s39, s76, s78
    s_add_u32 s39, s39, 2000
    s_cmp_ge_i32 s39, 0
    s_cbranch_scc1 gated_mix__mha_block__mixer_gmlp__prompt_kernel_qk_n_ok
    s_cmp_lt_u32 s38, 262080
    s_cbranch_scc1 gated_mix__mha_block__mixer_gmlp__prompt_kernel_qk_n_ok
gated_mix__mha_block__mixer_gmlp__prompt_kernel_qk_n_r:
    buffer_load_dwordx2 v[4:5], v6, s[48:51], 0 offen sc0 sc1
    s_waitcnt vmcnt(0)
    v_readfirstlane_b32 s76, v4
    v_readfirstlane_b32 s77, v5
    s_sub_u32 s38, s38, 1
    s_cmp_lg_u32 s38, 0
    s_nop 3
    s_cbranch_scc1 gated_mix__mha_block__mixer_gmlp__prompt_kernel_qk_n
gated_mix__mha_block__mixer_gmlp__prompt_kernel_qk_n_ok:
    s_nop 1
    v_mfma_f32_32x32x16_bf16 v[16:31], v[168:171], v[160:163], v[16:31]
    ds_read_b128 v[164:167], v241 offset:0
    ds_read_b64_tr_b16 v[204:205], v1 offset:9216
    ds_read_b64_tr_b16 v[206:207], v1 offset:11520
    ds_read_b64_tr_b16 v[208:209], v1 offset:9256
    v_mfma_f32_32x32x16_bf16 v[32:47], v[172:175], v[160:163], v[32:47]
    ds_read_b64_tr_b16 v[210:211], v1 offset:11560
    ds_read_b64_tr_b16 v[212:213], v1 offset:9288
    ds_read_b64_tr_b16 v[214:215], v1 offset:11592
    ds_read_b64_tr_b16 v[216:217], v1 offset:9328
    v_mfma_f32_32x32x16_bf16 v[48:63], v[176:179], v[160:163], v[48:63]
    ds_read_b64_tr_b16 v[218:219], v1 offset:11632
    ds_read_b64_tr_b16 v[220:221], v1 offset:9360
    ds_read_b64_tr_b16 v[222:223], v1 offset:11664
    ds_read_b64_tr_b16 v[224:225], v1 offset:9400
    v_mfma_f32_32x32x16_bf16 v[64:79], v[180:183], v[160:163], v[64:79]
    ds_read_b64_tr_b16 v[226:227], v1 offset:11704
    ds_read_b64_tr_b16 v[228:229], v1 offset:9432
    ds_read_b64_tr_b16 v[230:231], v1 offset:11736
    s_waitcnt lgkmcnt(14)
    ds_read_b64_tr_b16 v[232:233], v1 offset:9472
    v_mfma_f32_32x32x16_bf16 v[80:95], v[184:187], v[160:163], v[80:95]
    s_waitcnt lgkmcnt(14)
    ds_read_b64_tr_b16 v[234:235], v1 offset:11776
    s_waitcnt lgkmcnt(14)
    ds_read_b64_tr_b16 v[236:237], v2 offset:9216
    s_waitcnt lgkmcnt(14)
    ds_read_b64_tr_b16 v[238:239], v2 offset:11520
    s_and_b32 s39, s2, 255
    v_mfma_f32_32x32x16_bf16 v[96:111], v[188:191], v[160:163], v[96:111]
    s_lshl_b32 s39, s39, 7
    s_lshl_b32 s38, s6, 6
    v_add_lshl_u32 v10, v0, s38, 20
    v_mov_b32 v12, s76
    s_add_u32 m0, s54, 32768
    s_nop 0
    buffer_load_dwordx4 v248, s[20:23], s57 offen offset:0 lds
    v_mfma_f32_32x32x16_bf16 v[112:127], v[192:195], v[160:163], v[112:127]
    v_mov_b32 v13, s77
    buffer_store_dwordx2 v[12:13], v10, s[72:75], s39 offen sc0 sc1
    buffer_load_dwordx4 v249, s[20:23], s57 offen offset:1024 lds
    v_mfma_f32_32x32x16_bf16 v[128:143], v[196:199], v[160:163], v[128:143]
    s_mov_b64 exec, s[52:53]
    buffer_load_dwordx4 v250, s[20:23], s57 offen offset:2048 lds
    s_mov_b64 exec, -1
    s_add_u32 s57, s57, 55296
    v_mfma_f32_32x32x16_bf16 v[144:159], v[200:203], v[160:163], v[144:159]
    s_waitcnt vmcnt(11)
    s_waitcnt lgkmcnt(0)
    s_barrier
    v_mfma_f32_32x32x16_bf16 v[16:31], v[204:207], v[164:167], v[16:31]
    ds_read_b128 v[160:163], v242 offset:0
    ds_read_b64_tr_b16 v[168:169], v1 offset:18432
    ds_read_b64_tr_b16 v[170:171], v1 offset:20736
    ds_read_b64_tr_b16 v[172:173], v1 offset:18472
    v_mfma_f32_32x32x16_bf16 v[32:47], v[208:211], v[164:167], v[32:47]
    ds_read_b64_tr_b16 v[174:175], v1 offset:20776
    ds_read_b64_tr_b16 v[176:177], v1 offset:18504
    ds_read_b64_tr_b16 v[178:179], v1 offset:20808
    ds_read_b64_tr_b16 v[180:181], v1 offset:18544
    v_mfma_f32_32x32x16_bf16 v[48:63], v[212:215], v[164:167], v[48:63]
    ds_read_b64_tr_b16 v[182:183], v1 offset:20848
    ds_read_b64_tr_b16 v[184:185], v1 offset:18576
    ds_read_b64_tr_b16 v[186:187], v1 offset:20880
    ds_read_b64_tr_b16 v[188:189], v1 offset:18616
    v_mfma_f32_32x32x16_bf16 v[64:79], v[216:219], v[164:167], v[64:79]
    ds_read_b64_tr_b16 v[190:191], v1 offset:20920
    ds_read_b64_tr_b16 v[192:193], v1 offset:18648
    ds_read_b64_tr_b16 v[194:195], v1 offset:20952
    s_waitcnt lgkmcnt(14)
    ds_read_b64_tr_b16 v[196:197], v1 offset:18688
    v_mfma_f32_32x32x16_bf16 v[80:95], v[220:223], v[164:167], v[80:95]
    s_waitcnt lgkmcnt(14)
    ds_read_b64_tr_b16 v[198:199], v1 offset:20992
    s_waitcnt lgkmcnt(14)
    ds_read_b64_tr_b16 v[200:201], v2 offset:18432
    s_waitcnt lgkmcnt(14)
    ds_read_b64_tr_b16 v[202:203], v2 offset:20736
    v_mfma_f32_32x32x16_bf16 v[96:111], v[224:227], v[164:167], v[96:111]
    s_add_u32 m0, s54, 41984
    s_nop 0
    buffer_load_dwordx4 v248, s[20:23], s57 offen offset:0 lds
    v_mfma_f32_32x32x16_bf16 v[112:127], v[228:231], v[164:167], v[112:127]
    buffer_load_dwordx4 v249, s[20:23], s57 offen offset:1024 lds
    v_mfma_f32_32x32x16_bf16 v[128:143], v[232:235], v[164:167], v[128:143]
    s_mov_b64 exec, s[52:53]
    buffer_load_dwordx4 v250, s[20:23], s57 offen offset:2048 lds
    s_mov_b64 exec, -1
    s_add_u32 s57, s57, 55296
    v_mfma_f32_32x32x16_bf16 v[144:159], v[236:239], v[164:167], v[144:159]
    s_waitcnt vmcnt(11)
    s_waitcnt lgkmcnt(0)
    s_barrier
    v_mfma_f32_32x32x16_bf16 v[16:31], v[168:171], v[160:163], v[16:31]
    ds_read_b128 v[164:167], v243 offset:0
    ds_read_b64_tr_b16 v[204:205], v1 offset:27648
    ds_read_b64_tr_b16 v[206:207], v1 offset:29952
    ds_read_b64_tr_b16 v[208:209], v1 offset:27688
    v_mfma_f32_32x32x16_bf16 v[32:47], v[172:175], v[160:163], v[32:47]
    ds_read_b64_tr_b16 v[210:211], v1 offset:29992
    ds_read_b64_tr_b16 v[212:213], v1 offset:27720
    ds_read_b64_tr_b16 v[214:215], v1 offset:30024
    ds_read_b64_tr_b16 v[216:217], v1 offset:27760
    v_mfma_f32_32x32x16_bf16 v[48:63], v[176:179], v[160:163], v[48:63]
    ds_read_b64_tr_b16 v[218:219], v1 offset:30064
    ds_read_b64_tr_b16 v[220:221], v1 offset:27792
    ds_read_b64_tr_b16 v[222:223], v1 offset:30096
    ds_read_b64_tr_b16 v[224:225], v1 offset:27832
    v_mfma_f32_32x32x16_bf16 v[64:79], v[180:183], v[160:163], v[64:79]
    ds_read_b64_tr_b16 v[226:227], v1 offset:30136
    ds_read_b64_tr_b16 v[228:229], v1 offset:27864
    ds_read_b64_tr_b16 v[230:231], v1 offset:30168
    s_waitcnt lgkmcnt(14)
    ds_read_b64_tr_b16 v[232:233], v1 offset:27904
    v_mfma_f32_32x32x16_bf16 v[80:95], v[184:187], v[160:163], v[80:95]
    s_waitcnt lgkmcnt(14)
    ds_read_b64_tr_b16 v[234:235], v1 offset:30208
    s_waitcnt lgkmcnt(14)
    ds_read_b64_tr_b16 v[236:237], v2 offset:27648
    s_waitcnt lgkmcnt(14)
    ds_read_b64_tr_b16 v[238:239], v2 offset:29952
    v_mfma_f32_32x32x16_bf16 v[96:111], v[188:191], v[160:163], v[96:111]
    s_add_u32 m0, s54, 51200
    s_nop 0
    buffer_load_dwordx4 v248, s[20:23], s57 offen offset:0 lds
    v_mfma_f32_32x32x16_bf16 v[112:127], v[192:195], v[160:163], v[112:127]
    buffer_load_dwordx4 v249, s[20:23], s57 offen offset:1024 lds
    v_mfma_f32_32x32x16_bf16 v[128:143], v[196:199], v[160:163], v[128:143]
    s_mov_b64 exec, s[52:53]
    buffer_load_dwordx4 v250, s[20:23], s57 offen offset:2048 lds
    s_mov_b64 exec, -1
    s_add_u32 s57, s57, 55296
    v_mfma_f32_32x32x16_bf16 v[144:159], v[200:203], v[160:163], v[144:159]
    s_waitcnt vmcnt(6)
    s_waitcnt lgkmcnt(0)
    s_barrier
    v_mfma_f32_32x32x16_bf16 v[16:31], v[204:207], v[164:167], v[16:31]
    ds_read_b128 v[160:163], v240 offset:16384
    ds_read_b64_tr_b16 v[168:169], v1 offset:0
    ds_read_b64_tr_b16 v[170:171], v1 offset:2304
    ds_read_b64_tr_b16 v[172:173], v1 offset:40
    v_mfma_f32_32x32x16_bf16 v[32:47], v[208:211], v[164:167], v[32:47]
    ds_read_b64_tr_b16 v[174:175], v1 offset:2344
    ds_read_b64_tr_b16 v[176:177], v1 offset:72
    ds_read_b64_tr_b16 v[178:179], v1 offset:2376
    ds_read_b64_tr_b16 v[180:181], v1 offset:112
    v_mfma_f32_32x32x16_bf16 v[48:63], v[212:215], v[164:167], v[48:63]
    ds_read_b64_tr_b16 v[182:183], v1 offset:2416
    ds_read_b64_tr_b16 v[184:185], v1 offset:144
    ds_read_b64_tr_b16 v[186:187], v1 offset:2448
    ds_read_b64_tr_b16 v[188:189], v1 offset:184
    s_add_u32 m0, s54, 60416
    s_nop 0
    buffer_load_dwordx4 v248, s[20:23], s57 offen offset:0 lds
    v_mfma_f32_32x32x16_bf16 v[64:79], v[216:219], v[164:167], v[64:79]
    ds_read_b64_tr_b16 v[190:191], v1 offset:2488
    ds_read_b64_tr_b16 v[192:193], v1 offset:216
    ds_read_b64_tr_b16 v[194:195], v1 offset:2520
    s_waitcnt lgkmcnt(14)
    ds_read_b64_tr_b16 v[196:197], v1 offset:256
    buffer_load_dwordx4 v249, s[20:23], s57 offen offset:1024 lds
    v_mfma_f32_32x32x16_bf16 v[80:95], v[220:223], v[164:167], v[80:95]
    s_waitcnt lgkmcnt(14)
    ds_read_b64_tr_b16 v[198:199], v1 offset:2560
    s_waitcnt lgkmcnt(14)
    ds_read_b64_tr_b16 v[200:201], v2 offset:0
    s_waitcnt lgkmcnt(14)
    ds_read_b64_tr_b16 v[202:203], v2 offset:2304
    s_mov_b64 exec, s[52:53]
    buffer_load_dwordx4 v250, s[20:23], s57 offen offset:2048 lds
    s_mov_b64 exec, -1
    s_add_u32 s57, s57, 55296
    v_mfma_f32_32x32x16_bf16 v[96:111], v[224:227], v[164:167], v[96:111]
    s_add_u32 m0, s55, 0
    s_nop 0
    buffer_load_dwordx4 v244, s[16:19], s56 offen offset:0 lds
    v_mfma_f32_32x32x16_bf16 v[112:127], v[228:231], v[164:167], v[112:127]
    buffer_load_dwordx4 v245, s[16:19], s56 offen offset:1024 lds
    v_mfma_f32_32x32x16_bf16 v[128:143], v[232:235], v[164:167], v[128:143]
    buffer_load_dwordx4 v246, s[16:19], s56 offen offset:2048 lds
    v_mfma_f32_32x32x16_bf16 v[144:159], v[236:239], v[164:167], v[144:159]
    buffer_load_dwordx4 v247, s[16:19], s56 offen offset:3072 lds
    s_add_u32 s56, s56, 128
    s_waitcnt vmcnt(10)
    s_waitcnt lgkmcnt(0)
    s_barrier
    v_mfma_f32_32x32x16_bf16 v[16:31], v[168:171], v[160:163], v[16:31]
    ds_read_b128 v[164:167], v241 offset:16384
    ds_read_b64_tr_b16 v[204:205], v1 offset:9216
    ds_read_b64_tr_b16 v[206:207], v1 offset:11520
    ds_read_b64_tr_b16 v[208:209], v1 offset:9256
    v_mfma_f32_32x32x16_bf16 v[32:47], v[172:175], v[160:163], v[32:47]
    ds_read_b64_tr_b16 v[210:211], v1 offset:11560
    ds_read_b64_tr_b16 v[212:213], v1 offset:9288
    ds_read_b64_tr_b16 v[214:215], v1 offset:11592
    ds_read_b64_tr_b16 v[216:217], v1 offset:9328
    v_mfma_f32_32x32x16_bf16 v[48:63], v[176:179], v[160:163], v[48:63]
    ds_read_b64_tr_b16 v[218:219], v1 offset:11632
    ds_read_b64_tr_b16 v[220:221], v1 offset:9360
    ds_read_b64_tr_b16 v[222:223], v1 offset:11664
    ds_read_b64_tr_b16 v[224:225], v1 offset:9400
    v_mfma_f32_32x32x16_bf16 v[64:79], v[180:183], v[160:163], v[64:79]
    ds_read_b64_tr_b16 v[226:227], v1 offset:11704
    ds_read_b64_tr_b16 v[228:229], v1 offset:9432
    ds_read_b64_tr_b16 v[230:231], v1 offset:11736
    s_waitcnt lgkmcnt(14)
    ds_read_b64_tr_b16 v[232:233], v1 offset:9472
    v_mfma_f32_32x32x16_bf16 v[80:95], v[184:187], v[160:163], v[80:95]
    s_waitcnt lgkmcnt(14)
    ds_read_b64_tr_b16 v[234:235], v1 offset:11776
    s_waitcnt lgkmcnt(14)
    ds_read_b64_tr_b16 v[236:237], v2 offset:9216
    s_waitcnt lgkmcnt(14)
    ds_read_b64_tr_b16 v[238:239], v2 offset:11520
    v_mfma_f32_32x32x16_bf16 v[96:111], v[188:191], v[160:163], v[96:111]
    s_add_u32 m0, s54, 32768
    s_nop 0
    buffer_load_dwordx4 v248, s[20:23], s57 offen offset:0 lds
    v_mfma_f32_32x32x16_bf16 v[112:127], v[192:195], v[160:163], v[112:127]
    buffer_load_dwordx4 v249, s[20:23], s57 offen offset:1024 lds
    v_mfma_f32_32x32x16_bf16 v[128:143], v[196:199], v[160:163], v[128:143]
    s_mov_b64 exec, s[52:53]
    buffer_load_dwordx4 v250, s[20:23], s57 offen offset:2048 lds
    s_mov_b64 exec, -1
    s_add_u32 s57, s57, 55296
    v_mfma_f32_32x32x16_bf16 v[144:159], v[200:203], v[160:163], v[144:159]
    s_waitcnt vmcnt(10)
    s_waitcnt lgkmcnt(0)
    s_barrier
    v_mfma_f32_32x32x16_bf16 v[16:31], v[204:207], v[164:167], v[16:31]
    ds_read_b128 v[160:163], v242 offset:16384
    ds_read_b64_tr_b16 v[168:169], v1 offset:18432
    ds_read_b64_tr_b16 v[170:171], v1 offset:20736
    ds_read_b64_tr_b16 v[172:173], v1 offset:18472
    v_mfma_f32_32x32x16_bf16 v[32:47], v[208:211], v[164:167], v[32:47]
    ds_read_b64_tr_b16 v[174:175], v1 offset:20776
    ds_read_b64_tr_b16 v[176:177], v1 offset:18504
    ds_read_b64_tr_b16 v[178:179], v1 offset:20808
    ds_read_b64_tr_b16 v[180:181], v1 offset:18544
    v_mfma_f32_32x32x16_bf16 v[48:63], v[212:215], v[164:167], v[48:63]
    ds_read_b64_tr_b16 v[182:183], v1 offset:20848
    ds_read_b64_tr_b16 v[184:185], v1 offset:18576
    ds_read_b64_tr_b16 v[186:187], v1 offset:20880
    ds_read_b64_tr_b16 v[188:189], v1 offset:18616
    v_mfma_f32_32x32x16_bf16 v[64:79], v[216:219], v[164:167], v[64:79]
    ds_read_b64_tr_b16 v[190:191], v1 offset:20920
    ds_read_b64_tr_b16 v[192:193], v1 offset:18648
    ds_read_b64_tr_b16 v[194:195], v1 offset:20952
    s_waitcnt lgkmcnt(14)
    ds_read_b64_tr_b16 v[196:197], v1 offset:18688
    v_mfma_f32_32x32x16_bf16 v[80:95], v[220:223], v[164:167], v[80:95]
    s_waitcnt lgkmcnt(14)
    ds_read_b64_tr_b16 v[198:199], v1 offset:20992
    s_waitcnt lgkmcnt(14)
    ds_read_b64_tr_b16 v[200:201], v2 offset:18432
    s_waitcnt lgkmcnt(14)
    ds_read_b64_tr_b16 v[202:203], v2 offset:20736
    v_mfma_f32_32x32x16_bf16 v[96:111], v[224:227], v[164:167], v[96:111]
    s_add_u32 m0, s54, 41984
    s_nop 0
    buffer_load_dwordx4 v248, s[20:23], s57 offen offset:0 lds
    v_mfma_f32_32x32x16_bf16 v[112:127], v[228:231], v[164:167], v[112:127]
    buffer_load_dwordx4 v249, s[20:23], s57 offen offset:1024 lds
    v_mfma_f32_32x32x16_bf16 v[128:143], v[232:235], v[164:167], v[128:143]
    s_mov_b64 exec, s[52:53]
    buffer_load_dwordx4 v250, s[20:23], s57 offen offset:2048 lds
    s_mov_b64 exec, -1
    s_add_u32 s57, s57, 55296
    v_mfma_f32_32x32x16_bf16 v[144:159], v[236:239], v[164:167], v[144:159]
    s_waitcnt vmcnt(10)
    s_waitcnt lgkmcnt(0)
    s_barrier
    v_mfma_f32_32x32x16_bf16 v[16:31], v[168:171], v[160:163], v[16:31]
    ds_read_b128 v[164:167], v243 offset:16384
    ds_read_b64_tr_b16 v[204:205], v1 offset:27648
    ds_read_b64_tr_b16 v[206:207], v1 offset:29952
    ds_read_b64_tr_b16 v[208:209], v1 offset:27688
    v_mfma_f32_32x32x16_bf16 v[32:47], v[172:175], v[160:163], v[32:47]
    ds_read_b64_tr_b16 v[210:211], v1 offset:29992
    ds_read_b64_tr_b16 v[212:213], v1 offset:27720
    ds_read_b64_tr_b16 v[214:215], v1 offset:30024
    ds_read_b64_tr_b16 v[216:217], v1 offset:27760
    v_mfma_f32_32x32x16_bf16 v[48:63], v[176:179], v[160:163], v[48:63]
    ds_read_b64_tr_b16 v[218:219], v1 offset:30064
    ds_read_b64_tr_b16 v[220:221], v1 offset:27792
    ds_read_b64_tr_b16 v[222:223], v1 offset:30096
    ds_read_b64_tr_b16 v[224:225], v1 offset:27832
    v_mfma_f32_32x32x16_bf16 v[64:79], v[180:183], v[160:163], v[64:79]
    ds_read_b64_tr_b16 v[226:227], v1 offset:30136
    ds_read_b64_tr_b16 v[228:229], v1 offset:27864
    ds_read_b64_tr_b16 v[230:231], v1 offset:30168
    s_waitcnt lgkmcnt(14)
    ds_read_b64_tr_b16 v[232:233], v1 offset:27904
    v_mfma_f32_32x32x16_bf16 v[80:95], v[184:187], v[160:163], v[80:95]
    s_waitcnt lgkmcnt(14)
    ds_read_b64_tr_b16 v[234:235], v1 offset:30208
    s_waitcnt lgkmcnt(14)
    ds_read_b64_tr_b16 v[236:237], v2 offset:27648
    s_waitcnt lgkmcnt(14)
    ds_read_b64_tr_b16 v[238:239], v2 offset:29952
    v_mfma_f32_32x32x16_bf16 v[96:111], v[188:191], v[160:163], v[96:111]
    s_add_u32 m0, s54, 51200
    s_nop 0
    buffer_load_dwordx4 v248, s[20:23], s57 offen offset:0 lds
    v_mfma_f32_32x32x16_bf16 v[112:127], v[192:195], v[160:163], v[112:127]
    buffer_load_dwordx4 v249, s[20:23], s57 offen offset:1024 lds
    v_mfma_f32_32x32x16_bf16 v[128:143], v[196:199], v[160:163], v[128:143]
    s_mov_b64 exec, s[52:53]
    buffer_load_dwordx4 v250, s[20:23], s57 offen offset:2048 lds
    s_mov_b64 exec, -1
    s_add_u32 s57, s57, 55296
    v_mfma_f32_32x32x16_bf16 v[144:159], v[200:203], v[160:163], v[144:159]
    s_waitcnt vmcnt(6)
    s_waitcnt lgkmcnt(0)
    s_barrier
    v_mfma_f32_32x32x16_bf16 v[16:31], v[204:207], v[164:167], v[16:31]
    ds_read_b128 v[160:163], v240 offset:0
    ds_read_b64_tr_b16 v[168:169], v1 offset:0
    ds_read_b64_tr_b16 v[170:171], v1 offset:2304
    ds_read_b64_tr_b16 v[172:173], v1 offset:40
    v_mfma_f32_32x32x16_bf16 v[32:47], v[208:211], v[164:167], v[32:47]
    ds_read_b64_tr_b16 v[174:175], v1 offset:2344
    ds_read_b64_tr_b16 v[176:177], v1 offset:72
    ds_read_b64_tr_b16 v[178:179], v1 offset:2376
    ds_read_b64_tr_b16 v[180:181], v1 offset:112
    v_mfma_f32_32x32x16_bf16 v[48:63], v[212:215], v[164:167], v[48:63]
    ds_read_b64_tr_b16 v[182:183], v1 offset:2416
    ds_read_b64_tr_b16 v[184:185], v1 offset:144
    ds_read_b64_tr_b16 v[186:187], v1 offset:2448
    ds_read_b64_tr_b16 v[188:189], v1 offset:184
    s_add_u32 m0, s54, 60416
    s_nop 0
    buffer_load_dwordx4 v248, s[20:23], s57 offen offset:0 lds
    v_mfma_f32_32x32x16_bf16 v[64:79], v[216:219], v[164:167], v[64:79]
    ds_read_b64_tr_b16 v[190:191], v1 offset:2488
    ds_read_b64_tr_b16 v[192:193], v1 offset:216
    ds_read_b64_tr_b16 v[194:195], v1 offset:2520
    s_waitcnt lgkmcnt(14)
    ds_read_b64_tr_b16 v[196:197], v1 offset:256
    buffer_load_dwordx4 v249, s[20:23], s57 offen offset:1024 lds
    v_mfma_f32_32x32x16_bf16 v[80:95], v[220:223], v[164:167], v[80:95]
    s_waitcnt lgkmcnt(14)
    ds_read_b64_tr_b16 v[198:199], v1 offset:2560
    s_waitcnt lgkmcnt(14)
    ds_read_b64_tr_b16 v[200:201], v2 offset:0
    s_waitcnt lgkmcnt(14)
    ds_read_b64_tr_b16 v[202:203], v2 offset:2304
    s_mov_b64 exec, s[52:53]
    buffer_load_dwordx4 v250, s[20:23], s57 offen offset:2048 lds
    s_mov_b64 exec, -1
    s_add_u32 s57, s57, 55296
    v_mfma_f32_32x32x16_bf16 v[96:111], v[224:227], v[164:167], v[96:111]
    s_add_u32 m0, s55, 16384
    s_nop 0
    buffer_load_dwordx4 v244, s[16:19], s56 offen offset:0 lds
    v_mfma_f32_32x32x16_bf16 v[112:127], v[228:231], v[164:167], v[112:127]
    buffer_load_dwordx4 v245, s[16:19], s56 offen offset:1024 lds
    v_mfma_f32_32x32x16_bf16 v[128:143], v[232:235], v[164:167], v[128:143]
    buffer_load_dwordx4 v246, s[16:19], s56 offen offset:2048 lds
    v_mfma_f32_32x32x16_bf16 v[144:159], v[236:239], v[164:167], v[144:159]
    buffer_load_dwordx4 v247, s[16:19], s56 offen offset:3072 lds
    s_add_u32 s56, s56, 128
    s_waitcnt vmcnt(10)
    s_waitcnt lgkmcnt(0)
    s_barrier
    v_mfma_f32_32x32x16_bf16 v[16:31], v[168:171], v[160:163], v[16:31]
    ds_read_b128 v[164:167], v241 offset:0
    ds_read_b64_tr_b16 v[204:205], v1 offset:9216
    ds_read_b64_tr_b16 v[206:207], v1 offset:11520
    ds_read_b64_tr_b16 v[208:209], v1 offset:9256
    v_mfma_f32_32x32x16_bf16 v[32:47], v[172:175], v[160:163], v[32:47]
    ds_read_b64_tr_b16 v[210:211], v1 offset:11560
    ds_read_b64_tr_b16 v[212:213], v1 offset:9288
    ds_read_b64_tr_b16 v[214:215], v1 offset:11592
    ds_read_b64_tr_b16 v[216:217], v1 offset:9328
    v_mfma_f32_32x32x16_bf16 v[48:63], v[176:179], v[160:163], v[48:63]
    ds_read_b64_tr_b16 v[218:219], v1 offset:11632
    ds_read_b64_tr_b16 v[220:221], v1 offset:9360
    ds_read_b64_tr_b16 v[222:223], v1 offset:11664
    ds_read_b64_tr_b16 v[224:225], v1 offset:9400
    v_mfma_f32_32x32x16_bf16 v[64:79], v[180:183], v[160:163], v[64:79]
    ds_read_b64_tr_b16 v[226:227], v1 offset:11704
    ds_read_b64_tr_b16 v[228:229], v1 offset:9432
    ds_read_b64_tr_b16 v[230:231], v1 offset:11736
    s_waitcnt lgkmcnt(14)
    ds_read_b64_tr_b16 v[232:233], v1 offset:9472
    v_mfma_f32_32x32x16_bf16 v[80:95], v[184:187], v[160:163], v[80:95]
    s_waitcnt lgkmcnt(14)
    ds_read_b64_tr_b16 v[234:235], v1 offset:11776
    s_waitcnt lgkmcnt(14)
    ds_read_b64_tr_b16 v[236:237], v2 offset:9216
    s_waitcnt lgkmcnt(14)
    ds_read_b64_tr_b16 v[238:239], v2 offset:11520
    v_mfma_f32_32x32x16_bf16 v[96:111], v[188:191], v[160:163], v[96:111]
    s_add_u32 m0, s54, 32768
    s_nop 0
    buffer_load_dwordx4 v248, s[20:23], s57 offen offset:0 lds
    v_mfma_f32_32x32x16_bf16 v[112:127], v[192:195], v[160:163], v[112:127]
    buffer_load_dwordx4 v249, s[20:23], s57 offen offset:1024 lds
    v_mfma_f32_32x32x16_bf16 v[128:143], v[196:199], v[160:163], v[128:143]
    s_mov_b64 exec, s[52:53]
    buffer_load_dwordx4 v250, s[20:23], s57 offen offset:2048 lds
    s_mov_b64 exec, -1
    s_add_u32 s57, s57, 55296
    v_mfma_f32_32x32x16_bf16 v[144:159], v[200:203], v[160:163], v[144:159]
    s_waitcnt vmcnt(10)
    s_waitcnt lgkmcnt(0)
    s_barrier
    v_mfma_f32_32x32x16_bf16 v[16:31], v[204:207], v[164:167], v[16:31]
    ds_read_b128 v[160:163], v242 offset:0
    ds_read_b64_tr_b16 v[168:169], v1 offset:18432
    ds_read_b64_tr_b16 v[170:171], v1 offset:20736
    ds_read_b64_tr_b16 v[172:173], v1 offset:18472
    v_mfma_f32_32x32x16_bf16 v[32:47], v[208:211], v[164:167], v[32:47]
    ds_read_b64_tr_b16 v[174:175], v1 offset:20776
    ds_read_b64_tr_b16 v[176:177], v1 offset:18504
    ds_read_b64_tr_b16 v[178:179], v1 offset:20808
    ds_read_b64_tr_b16 v[180:181], v1 offset:18544
    v_mfma_f32_32x32x16_bf16 v[48:63], v[212:215], v[164:167], v[48:63]
    ds_read_b64_tr_b16 v[182:183], v1 offset:20848
    ds_read_b64_tr_b16 v[184:185], v1 offset:18576
    ds_read_b64_tr_b16 v[186:187], v1 offset:20880
    ds_read_b64_tr_b16 v[188:189], v1 offset:18616
    v_mfma_f32_32x32x16_bf16 v[64:79], v[216:219], v[164:167], v[64:79]
    ds_read_b64_tr_b16 v[190:191], v1 offset:20920
    ds_read_b64_tr_b16 v[192:193], v1 offset:18648
    ds_read_b64_tr_b16 v[194:195], v1 offset:20952
    s_waitcnt lgkmcnt(14)
    ds_read_b64_tr_b16 v[196:197], v1 offset:18688
    v_mfma_f32_32x32x16_bf16 v[80:95], v[220:223], v[164:167], v[80:95]
    s_waitcnt lgkmcnt(14)
    ds_read_b64_tr_b16 v[198:199], v1 offset:20992
    s_waitcnt lgkmcnt(14)
    ds_read_b64_tr_b16 v[200:201], v2 offset:18432
    s_waitcnt lgkmcnt(14)
    ds_read_b64_tr_b16 v[202:203], v2 offset:20736
    v_mfma_f32_32x32x16_bf16 v[96:111], v[224:227], v[164:167], v[96:111]
    s_add_u32 m0, s54, 41984
    s_nop 0
    buffer_load_dwordx4 v248, s[20:23], s57 offen offset:0 lds
    v_mfma_f32_32x32x16_bf16 v[112:127], v[228:231], v[164:167], v[112:127]
    buffer_load_dwordx4 v249, s[20:23], s57 offen offset:1024 lds
    v_mfma_f32_32x32x16_bf16 v[128:143], v[232:235], v[164:167], v[128:143]
    s_mov_b64 exec, s[52:53]
    buffer_load_dwordx4 v250, s[20:23], s57 offen offset:2048 lds
    s_mov_b64 exec, -1
    s_add_u32 s57, s57, 55296
    v_mfma_f32_32x32x16_bf16 v[144:159], v[236:239], v[164:167], v[144:159]
    s_waitcnt vmcnt(10)
    s_waitcnt lgkmcnt(0)
    s_barrier
    v_mfma_f32_32x32x16_bf16 v[16:31], v[168:171], v[160:163], v[16:31]
    ds_read_b128 v[164:167], v243 offset:0
    ds_read_b64_tr_b16 v[204:205], v1 offset:27648
    ds_read_b64_tr_b16 v[206:207], v1 offset:29952
    ds_read_b64_tr_b16 v[208:209], v1 offset:27688
    v_mfma_f32_32x32x16_bf16 v[32:47], v[172:175], v[160:163], v[32:47]
    ds_read_b64_tr_b16 v[210:211], v1 offset:29992
    ds_read_b64_tr_b16 v[212:213], v1 offset:27720
    ds_read_b64_tr_b16 v[214:215], v1 offset:30024
    ds_read_b64_tr_b16 v[216:217], v1 offset:27760
    v_mfma_f32_32x32x16_bf16 v[48:63], v[176:179], v[160:163], v[48:63]
    ds_read_b64_tr_b16 v[218:219], v1 offset:30064
    ds_read_b64_tr_b16 v[220:221], v1 offset:27792
    ds_read_b64_tr_b16 v[222:223], v1 offset:30096
    ds_read_b64_tr_b16 v[224:225], v1 offset:27832
    v_mfma_f32_32x32x16_bf16 v[64:79], v[180:183], v[160:163], v[64:79]
    ds_read_b64_tr_b16 v[226:227], v1 offset:30136
    ds_read_b64_tr_b16 v[228:229], v1 offset:27864
    ds_read_b64_tr_b16 v[230:231], v1 offset:30168
    s_waitcnt lgkmcnt(14)
    ds_read_b64_tr_b16 v[232:233], v1 offset:27904
    v_mfma_f32_32x32x16_bf16 v[80:95], v[184:187], v[160:163], v[80:95]
    s_waitcnt lgkmcnt(14)
    ds_read_b64_tr_b16 v[234:235], v1 offset:30208
    s_waitcnt lgkmcnt(14)
    ds_read_b64_tr_b16 v[236:237], v2 offset:27648
    s_waitcnt lgkmcnt(14)
    ds_read_b64_tr_b16 v[238:239], v2 offset:29952
    v_mfma_f32_32x32x16_bf16 v[96:111], v[188:191], v[160:163], v[96:111]
    s_add_u32 m0, s54, 51200
    s_nop 0
    buffer_load_dwordx4 v248, s[20:23], s57 offen offset:0 lds
    v_mfma_f32_32x32x16_bf16 v[112:127], v[192:195], v[160:163], v[112:127]
    buffer_load_dwordx4 v249, s[20:23], s57 offen offset:1024 lds
    v_mfma_f32_32x32x16_bf16 v[128:143], v[196:199], v[160:163], v[128:143]
    s_mov_b64 exec, s[52:53]
    buffer_load_dwordx4 v250, s[20:23], s57 offen offset:2048 lds
    s_mov_b64 exec, -1
    s_add_u32 s57, s57, 55296
    v_mfma_f32_32x32x16_bf16 v[144:159], v[200:203], v[160:163], v[144:159]
    s_waitcnt vmcnt(6)
    s_waitcnt lgkmcnt(0)
    s_barrier
    v_mfma_f32_32x32x16_bf16 v[16:31], v[204:207], v[164:167], v[16:31]
    ds_read_b128 v[160:163], v240 offset:16384
    ds_read_b64_tr_b16 v[168:169], v1 offset:0
    ds_read_b64_tr_b16 v[170:171], v1 offset:2304
    ds_read_b64_tr_b16 v[172:173], v1 offset:40
    v_mfma_f32_32x32x16_bf16 v[32:47], v[208:211], v[164:167], v[32:47]
    ds_read_b64_tr_b16 v[174:175], v1 offset:2344
    ds_read_b64_tr_b16 v[176:177], v1 offset:72
    ds_read_b64_tr_b16 v[178:179], v1 offset:2376
    ds_read_b64_tr_b16 v[180:181], v1 offset:112
    v_mfma_f32_32x32x16_bf16 v[48:63], v[212:215], v[164:167], v[48:63]
    ds_read_b64_tr_b16 v[182:183], v1 offset:2416
    ds_read_b64_tr_b16 v[184:185], v1 offset:144
    ds_read_b64_tr_b16 v[186:187], v1 offset:2448
    ds_read_b64_tr_b16 v[188:189], v1 offset:184
    s_add_u32 m0, s54, 60416
    s_nop 0
    buffer_load_dwordx4 v248, s[20:23], s57 offen offset:0 lds
    v_mfma_f32_32x32x16_bf16 v[64:79], v[216:219], v[164:167], v[64:79]
    ds_read_b64_tr_b16 v[190:191], v1 offset:2488
    ds_read_b64_tr_b16 v[192:193], v1 offset:216
    ds_read_b64_tr_b16 v[194:195], v1 offset:2520
    s_waitcnt lgkmcnt(14)
    ds_read_b64_tr_b16 v[196:197], v1 offset:256
    buffer_load_dwordx4 v249, s[20:23], s57 offen offset:1024 lds
    v_mfma_f32_32x32x16_bf16 v[80:95], v[220:223], v[164:167], v[80:95]
    s_waitcnt lgkmcnt(14)
    ds_read_b64_tr_b16 v[198:199], v1 offset:2560
    s_waitcnt lgkmcnt(14)
    ds_read_b64_tr_b16 v[200:201], v2 offset:0
    s_waitcnt lgkmcnt(14)
    ds_read_b64_tr_b16 v[202:203], v2 offset:2304
    s_mov_b64 exec, s[52:53]
    buffer_load_dwordx4 v250, s[20:23], s57 offen offset:2048 lds
    s_mov_b64 exec, -1
    s_add_u32 s57, s57, 55296
    v_mfma_f32_32x32x16_bf16 v[96:111], v[224:227], v[164:167], v[96:111]
    s_add_u32 m0, s55, 0
    s_nop 0
    buffer_load_dwordx4 v244, s[16:19], s56 offen offset:0 lds
    v_mfma_f32_32x32x16_bf16 v[112:127], v[228:231], v[164:167], v[112:127]
    buffer_load_dwordx4 v245, s[16:19], s56 offen offset:1024 lds
    v_mfma_f32_32x32x16_bf16 v[128:143], v[232:235], v[164:167], v[128:143]
    buffer_load_dwordx4 v246, s[16:19], s56 offen offset:2048 lds
    v_mfma_f32_32x32x16_bf16 v[144:159], v[236:239], v[164:167], v[144:159]
    buffer_load_dwordx4 v247, s[16:19], s56 offen offset:3072 lds
    s_add_u32 s56, s56, 128
    s_waitcnt vmcnt(10)
    s_waitcnt lgkmcnt(0)
    s_barrier
    v_mfma_f32_32x32x16_bf16 v[16:31], v[168:171], v[160:163], v[16:31]
    ds_read_b128 v[164:167], v241 offset:16384
    ds_read_b64_tr_b16 v[204:205], v1 offset:9216
    ds_read_b64_tr_b16 v[206:207], v1 offset:11520
    ds_read_b64_tr_b16 v[208:209], v1 offset:9256
    v_mfma_f32_32x32x16_bf16 v[32:47], v[172:175], v[160:163], v[32:47]
    ds_read_b64_tr_b16 v[210:211], v1 offset:11560
    ds_read_b64_tr_b16 v[212:213], v1 offset:9288
    ds_read_b64_tr_b16 v[214:215], v1 offset:11592
    ds_read_b64_tr_b16 v[216:217], v1 offset:9328
    v_mfma_f32_32x32x16_bf16 v[48:63], v[176:179], v[160:163], v[48:63]
    ds_read_b64_tr_b16 v[218:219], v1 offset:11632
    ds_read_b64_tr_b16 v[220:221], v1 offset:9360
    ds_read_b64_tr_b16 v[222:223], v1 offset:11664
    ds_read_b64_tr_b16 v[224:225], v1 offset:9400
    v_mfma_f32_32x32x16_bf16 v[64:79], v[180:183], v[160:163], v[64:79]
    ds_read_b64_tr_b16 v[226:227], v1 offset:11704
    ds_read_b64_tr_b16 v[228:229], v1 offset:9432
    ds_read_b64_tr_b16 v[230:231], v1 offset:11736
    s_waitcnt lgkmcnt(14)
    ds_read_b64_tr_b16 v[232:233], v1 offset:9472
    v_mfma_f32_32x32x16_bf16 v[80:95], v[184:187], v[160:163], v[80:95]
    s_waitcnt lgkmcnt(14)
    ds_read_b64_tr_b16 v[234:235], v1 offset:11776
    s_waitcnt lgkmcnt(14)
    ds_read_b64_tr_b16 v[236:237], v2 offset:9216
    s_waitcnt lgkmcnt(14)
    ds_read_b64_tr_b16 v[238:239], v2 offset:11520
    v_mfma_f32_32x32x16_bf16 v[96:111], v[188:191], v[160:163], v[96:111]
    s_add_u32 m0, s54, 32768
    s_nop 0
    buffer_load_dwordx4 v248, s[20:23], s57 offen offset:0 lds
    v_mfma_f32_32x32x16_bf16 v[112:127], v[192:195], v[160:163], v[112:127]
    buffer_load_dwordx4 v249, s[20:23], s57 offen offset:1024 lds
    v_mfma_f32_32x32x16_bf16 v[128:143], v[196:199], v[160:163], v[128:143]
    s_mov_b64 exec, s[52:53]
    buffer_load_dwordx4 v250, s[20:23], s57 offen offset:2048 lds
    s_mov_b64 exec, -1
    s_add_u32 s57, s57, 55296
    v_mfma_f32_32x32x16_bf16 v[144:159], v[200:203], v[160:163], v[144:159]
    s_waitcnt vmcnt(10)
    s_waitcnt lgkmcnt(0)
    s_barrier
    v_mfma_f32_32x32x16_bf16 v[16:31], v[204:207], v[164:167], v[16:31]
    ds_read_b128 v[160:163], v242 offset:16384
    ds_read_b64_tr_b16 v[168:169], v1 offset:18432
    ds_read_b64_tr_b16 v[170:171], v1 offset:20736
    ds_read_b64_tr_b16 v[172:173], v1 offset:18472
    v_mfma_f32_32x32x16_bf16 v[32:47], v[208:211], v[164:167], v[32:47]
    ds_read_b64_tr_b16 v[174:175], v1 offset:20776
    ds_read_b64_tr_b16 v[176:177], v1 offset:18504
    ds_read_b64_tr_b16 v[178:179], v1 offset:20808
    ds_read_b64_tr_b16 v[180:181], v1 offset:18544
    v_mfma_f32_32x32x16_bf16 v[48:63], v[212:215], v[164:167], v[48:63]
    ds_read_b64_tr_b16 v[182:183], v1 offset:20848
    ds_read_b64_tr_b16 v[184:185], v1 offset:18576
    ds_read_b64_tr_b16 v[186:187], v1 offset:20880
    ds_read_b64_tr_b16 v[188:189], v1 offset:18616
    v_mfma_f32_32x32x16_bf16 v[64:79], v[216:219], v[164:167], v[64:79]
    ds_read_b64_tr_b16 v[190:191], v1 offset:20920
    ds_read_b64_tr_b16 v[192:193], v1 offset:18648
    ds_read_b64_tr_b16 v[194:195], v1 offset:20952
    s_waitcnt lgkmcnt(14)
    ds_read_b64_tr_b16 v[196:197], v1 offset:18688
    v_mfma_f32_32x32x16_bf16 v[80:95], v[220:223], v[164:167], v[80:95]
    s_waitcnt lgkmcnt(14)
    ds_read_b64_tr_b16 v[198:199], v1 offset:20992
    s_waitcnt lgkmcnt(14)
    ds_read_b64_tr_b16 v[200:201], v2 offset:18432
    s_waitcnt lgkmcnt(14)
    ds_read_b64_tr_b16 v[202:203], v2 offset:20736
    v_mfma_f32_32x32x16_bf16 v[96:111], v[224:227], v[164:167], v[96:111]
    s_add_u32 m0, s54, 41984
    s_nop 0
    buffer_load_dwordx4 v248, s[20:23], s57 offen offset:0 lds
    v_mfma_f32_32x32x16_bf16 v[112:127], v[228:231], v[164:167], v[112:127]
    buffer_load_dwordx4 v249, s[20:23], s57 offen offset:1024 lds
    v_mfma_f32_32x32x16_bf16 v[128:143], v[232:235], v[164:167], v[128:143]
    s_mov_b64 exec, s[52:53]
    buffer_load_dwordx4 v250, s[20:23], s57 offen offset:2048 lds
    s_mov_b64 exec, -1
    s_add_u32 s57, s57, 55296
    v_mfma_f32_32x32x16_bf16 v[144:159], v[236:239], v[164:167], v[144:159]
    s_waitcnt vmcnt(10)
    s_waitcnt lgkmcnt(0)
    s_barrier
    v_mfma_f32_32x32x16_bf16 v[16:31], v[168:171], v[160:163], v[16:31]
    ds_read_b128 v[164:167], v243 offset:16384
    ds_read_b64_tr_b16 v[204:205], v1 offset:27648
    ds_read_b64_tr_b16 v[206:207], v1 offset:29952
    ds_read_b64_tr_b16 v[208:209], v1 offset:27688
    v_mfma_f32_32x32x16_bf16 v[32:47], v[172:175], v[160:163], v[32:47]
    ds_read_b64_tr_b16 v[210:211], v1 offset:29992
    ds_read_b64_tr_b16 v[212:213], v1 offset:27720
    ds_read_b64_tr_b16 v[214:215], v1 offset:30024
    ds_read_b64_tr_b16 v[216:217], v1 offset:27760
    v_mfma_f32_32x32x16_bf16 v[48:63], v[176:179], v[160:163], v[48:63]
    ds_read_b64_tr_b16 v[218:219], v1 offset:30064
    ds_read_b64_tr_b16 v[220:221], v1 offset:27792
    ds_read_b64_tr_b16 v[222:223], v1 offset:30096
    ds_read_b64_tr_b16 v[224:225], v1 offset:27832
    v_mfma_f32_32x32x16_bf16 v[64:79], v[180:183], v[160:163], v[64:79]
    ds_read_b64_tr_b16 v[226:227], v1 offset:30136
    ds_read_b64_tr_b16 v[228:229], v1 offset:27864
    ds_read_b64_tr_b16 v[230:231], v1 offset:30168
    s_waitcnt lgkmcnt(14)
    ds_read_b64_tr_b16 v[232:233], v1 offset:27904
    v_mfma_f32_32x32x16_bf16 v[80:95], v[184:187], v[160:163], v[80:95]
    s_waitcnt lgkmcnt(14)
    ds_read_b64_tr_b16 v[234:235], v1 offset:30208
    s_waitcnt lgkmcnt(14)
    ds_read_b64_tr_b16 v[236:237], v2 offset:27648
    s_waitcnt lgkmcnt(14)
    ds_read_b64_tr_b16 v[238:239], v2 offset:29952
    v_mfma_f32_32x32x16_bf16 v[96:111], v[188:191], v[160:163], v[96:111]
    s_add_u32 m0, s54, 51200
    s_nop 0
    buffer_load_dwordx4 v248, s[20:23], s57 offen offset:0 lds
    v_mfma_f32_32x32x16_bf16 v[112:127], v[192:195], v[160:163], v[112:127]
    buffer_load_dwordx4 v249, s[20:23], s57 offen offset:1024 lds
    v_mfma_f32_32x32x16_bf16 v[128:143], v[196:199], v[160:163], v[128:143]
    s_mov_b64 exec, s[52:53]
    buffer_load_dwordx4 v250, s[20:23], s57 offen offset:2048 lds
    s_mov_b64 exec, -1
    s_add_u32 s57, s57, 55296
    v_mfma_f32_32x32x16_bf16 v[144:159], v[200:203], v[160:163], v[144:159]
    s_waitcnt vmcnt(6)
    s_waitcnt lgkmcnt(0)
    s_barrier
    v_mfma_f32_32x32x16_bf16 v[16:31], v[204:207], v[164:167], v[16:31]
    ds_read_b128 v[160:163], v240 offset:0
    ds_read_b64_tr_b16 v[168:169], v1 offset:0
    ds_read_b64_tr_b16 v[170:171], v1 offset:2304
    ds_read_b64_tr_b16 v[172:173], v1 offset:40
    v_mfma_f32_32x32x16_bf16 v[32:47], v[208:211], v[164:167], v[32:47]
    ds_read_b64_tr_b16 v[174:175], v1 offset:2344
    ds_read_b64_tr_b16 v[176:177], v1 offset:72
    ds_read_b64_tr_b16 v[178:179], v1 offset:2376
    ds_read_b64_tr_b16 v[180:181], v1 offset:112
    v_mfma_f32_32x32x16_bf16 v[48:63], v[212:215], v[164:167], v[48:63]
    ds_read_b64_tr_b16 v[182:183], v1 offset:2416
    ds_read_b64_tr_b16 v[184:185], v1 offset:144
    ds_read_b64_tr_b16 v[186:187], v1 offset:2448
    ds_read_b64_tr_b16 v[188:189], v1 offset:184
    v_mfma_f32_32x32x16_bf16 v[64:79], v[216:219], v[164:167], v[64:79]
    ds_read_b64_tr_b16 v[190:191], v1 offset:2488
    ds_read_b64_tr_b16 v[192:193], v1 offset:216
    ds_read_b64_tr_b16 v[194:195], v1 offset:2520
    s_waitcnt lgkmcnt(14)
    ds_read_b64_tr_b16 v[196:197], v1 offset:256
    v_mfma_f32_32x32x16_bf16 v[80:95], v[220:223], v[164:167], v[80:95]
    s_waitcnt lgkmcnt(14)
    ds_read_b64_tr_b16 v[198:199], v1 offset:2560
    s_waitcnt lgkmcnt(14)
    ds_read_b64_tr_b16 v[200:201], v2 offset:0
    s_waitcnt lgkmcnt(14)
    ds_read_b64_tr_b16 v[202:203], v2 offset:2304
    v_mfma_f32_32x32x16_bf16 v[96:111], v[224:227], v[164:167], v[96:111]
    s_add_u32 m0, s54, 60416
    s_nop 0
    buffer_load_dwordx4 v248, s[20:23], s57 offen offset:0 lds
    v_mfma_f32_32x32x16_bf16 v[112:127], v[228:231], v[164:167], v[112:127]
    buffer_load_dwordx4 v249, s[20:23], s57 offen offset:1024 lds
    v_mfma_f32_32x32x16_bf16 v[128:143], v[232:235], v[164:167], v[128:143]
    s_mov_b64 exec, s[52:53]
    buffer_load_dwordx4 v250, s[20:23], s57 offen offset:2048 lds
    s_mov_b64 exec, -1
    s_add_u32 s57, s57, 55296
    v_mfma_f32_32x32x16_bf16 v[144:159], v[236:239], v[164:167], v[144:159]
    s_waitcnt vmcnt(6)
    s_waitcnt lgkmcnt(0)
    s_barrier
    v_mfma_f32_32x32x16_bf16 v[16:31], v[168:171], v[160:163], v[16:31]
    ds_read_b128 v[164:167], v241 offset:0
    ds_read_b64_tr_b16 v[204:205], v1 offset:9216
    ds_read_b64_tr_b16 v[206:207], v1 offset:11520
    ds_read_b64_tr_b16 v[208:209], v1 offset:9256
    v_mfma_f32_32x32x16_bf16 v[32:47], v[172:175], v[160:163], v[32:47]
    ds_read_b64_tr_b16 v[210:211], v1 offset:11560
    ds_read_b64_tr_b16 v[212:213], v1 offset:9288
    ds_read_b64_tr_b16 v[214:215], v1 offset:11592
    ds_read_b64_tr_b16 v[216:217], v1 offset:9328
    v_mfma_f32_32x32x16_bf16 v[48:63], v[176:179], v[160:163], v[48:63]
    ds_read_b64_tr_b16 v[218:219], v1 offset:11632
    ds_read_b64_tr_b16 v[220:221], v1 offset:9360
    ds_read_b64_tr_b16 v[222:223], v1 offset:11664
    ds_read_b64_tr_b16 v[224:225], v1 offset:9400
    v_mfma_f32_32x32x16_bf16 v[64:79], v[180:183], v[160:163], v[64:79]
    ds_read_b64_tr_b16 v[226:227], v1 offset:11704
    ds_read_b64_tr_b16 v[228:229], v1 offset:9432
    ds_read_b64_tr_b16 v[230:231], v1 offset:11736
    s_waitcnt lgkmcnt(14)
    ds_read_b64_tr_b16 v[232:233], v1 offset:9472
    v_mfma_f32_32x32x16_bf16 v[80:95], v[184:187], v[160:163], v[80:95]
    s_waitcnt lgkmcnt(14)
    ds_read_b64_tr_b16 v[234:235], v1 offset:11776
    s_waitcnt lgkmcnt(14)
    ds_read_b64_tr_b16 v[236:237], v2 offset:9216
    s_waitcnt lgkmcnt(14)
    ds_read_b64_tr_b16 v[238:239], v2 offset:11520
    v_mfma_f32_32x32x16_bf16 v[96:111], v[188:191], v[160:163], v[96:111]
    v_mfma_f32_32x32x16_bf16 v[112:127], v[192:195], v[160:163], v[112:127]
    v_mfma_f32_32x32x16_bf16 v[128:143], v[196:199], v[160:163], v[128:143]
    v_mfma_f32_32x32x16_bf16 v[144:159], v[200:203], v[160:163], v[144:159]
    s_waitcnt vmcnt(3)
    s_waitcnt lgkmcnt(0)
    s_barrier
    v_mfma_f32_32x32x16_bf16 v[16:31], v[204:207], v[164:167], v[16:31]
    ds_read_b128 v[160:163], v242 offset:0
    ds_read_b64_tr_b16 v[168:169], v1 offset:18432
    ds_read_b64_tr_b16 v[170:171], v1 offset:20736
    ds_read_b64_tr_b16 v[172:173], v1 offset:18472
    v_mfma_f32_32x32x16_bf16 v[32:47], v[208:211], v[164:167], v[32:47]
    ds_read_b64_tr_b16 v[174:175], v1 offset:20776
    ds_read_b64_tr_b16 v[176:177], v1 offset:18504
    ds_read_b64_tr_b16 v[178:179], v1 offset:20808
    ds_read_b64_tr_b16 v[180:181], v1 offset:18544
    v_mfma_f32_32x32x16_bf16 v[48:63], v[212:215], v[164:167], v[48:63]
    ds_read_b64_tr_b16 v[182:183], v1 offset:20848
    ds_read_b64_tr_b16 v[184:185], v1 offset:18576
    ds_read_b64_tr_b16 v[186:187], v1 offset:20880
    ds_read_b64_tr_b16 v[188:189], v1 offset:18616
    v_mfma_f32_32x32x16_bf16 v[64:79], v[216:219], v[164:167], v[64:79]
    ds_read_b64_tr_b16 v[190:191], v1 offset:20920
    ds_read_b64_tr_b16 v[192:193], v1 offset:18648
    ds_read_b64_tr_b16 v[194:195], v1 offset:20952
    s_waitcnt lgkmcnt(14)
    ds_read_b64_tr_b16 v[196:197], v1 offset:18688
    v_mfma_f32_32x32x16_bf16 v[80:95], v[220:223], v[164:167], v[80:95]
    s_waitcnt lgkmcnt(14)
    ds_read_b64_tr_b16 v[198:199], v1 offset:20992
    s_waitcnt lgkmcnt(14)
    ds_read_b64_tr_b16 v[200:201], v2 offset:18432
    s_waitcnt lgkmcnt(14)
    ds_read_b64_tr_b16 v[202:203], v2 offset:20736
    v_mfma_f32_32x32x16_bf16 v[96:111], v[224:227], v[164:167], v[96:111]
    v_mfma_f32_32x32x16_bf16 v[112:127], v[228:231], v[164:167], v[112:127]
    v_mfma_f32_32x32x16_bf16 v[128:143], v[232:235], v[164:167], v[128:143]
    v_mfma_f32_32x32x16_bf16 v[144:159], v[236:239], v[164:167], v[144:159]
    s_waitcnt vmcnt(0)
    s_waitcnt lgkmcnt(0)
    s_barrier
    v_mfma_f32_32x32x16_bf16 v[16:31], v[168:171], v[160:163], v[16:31]
    ds_read_b128 v[164:167], v243 offset:0
    ds_read_b64_tr_b16 v[204:205], v1 offset:27648
    ds_read_b64_tr_b16 v[206:207], v1 offset:29952
    ds_read_b64_tr_b16 v[208:209], v1 offset:27688
    v_mfma_f32_32x32x16_bf16 v[32:47], v[172:175], v[160:163], v[32:47]
    ds_read_b64_tr_b16 v[210:211], v1 offset:29992
    ds_read_b64_tr_b16 v[212:213], v1 offset:27720
    ds_read_b64_tr_b16 v[214:215], v1 offset:30024
    ds_read_b64_tr_b16 v[216:217], v1 offset:27760
    v_mfma_f32_32x32x16_bf16 v[48:63], v[176:179], v[160:163], v[48:63]
    ds_read_b64_tr_b16 v[218:219], v1 offset:30064
    ds_read_b64_tr_b16 v[220:221], v1 offset:27792
    ds_read_b64_tr_b16 v[222:223], v1 offset:30096
    ds_read_b64_tr_b16 v[224:225], v1 offset:27832
    v_mfma_f32_32x32x16_bf16 v[64:79], v[180:183], v[160:163], v[64:79]
    ds_read_b64_tr_b16 v[226:227], v1 offset:30136
    ds_read_b64_tr_b16 v[228:229], v1 offset:27864
    ds_read_b64_tr_b16 v[230:231], v1 offset:30168
    s_waitcnt lgkmcnt(14)
    ds_read_b64_tr_b16 v[232:233], v1 offset:27904
    v_mfma_f32_32x32x16_bf16 v[80:95], v[184:187], v[160:163], v[80:95]
    s_waitcnt lgkmcnt(14)
    ds_read_b64_tr_b16 v[234:235], v1 offset:30208
    s_waitcnt lgkmcnt(14)
    ds_read_b64_tr_b16 v[236:237], v2 offset:27648
    s_waitcnt lgkmcnt(14)
    ds_read_b64_tr_b16 v[238:239], v2 offset:29952
    v_mfma_f32_32x32x16_bf16 v[96:111], v[188:191], v[160:163], v[96:111]
    v_mfma_f32_32x32x16_bf16 v[112:127], v[192:195], v[160:163], v[112:127]
    v_mfma_f32_32x32x16_bf16 v[128:143], v[196:199], v[160:163], v[128:143]
    v_mfma_f32_32x32x16_bf16 v[144:159], v[200:203], v[160:163], v[144:159]
    v_mfma_f32_32x32x16_bf16 v[16:31], v[204:207], v[164:167], v[16:31]
    s_waitcnt lgkmcnt(14)
    v_mfma_f32_32x32x16_bf16 v[32:47], v[208:211], v[164:167], v[32:47]
    s_waitcnt lgkmcnt(12)
    v_mfma_f32_32x32x16_bf16 v[48:63], v[212:215], v[164:167], v[48:63]
    s_waitcnt lgkmcnt(10)
    v_mfma_f32_32x32x16_bf16 v[64:79], v[216:219], v[164:167], v[64:79]
    s_waitcnt lgkmcnt(8)
    v_mfma_f32_32x32x16_bf16 v[80:95], v[220:223], v[164:167], v[80:95]
    s_waitcnt lgkmcnt(6)
    v_mfma_f32_32x32x16_bf16 v[96:111], v[224:227], v[164:167], v[96:111]
    s_waitcnt lgkmcnt(4)
    v_mfma_f32_32x32x16_bf16 v[112:127], v[228:231], v[164:167], v[112:127]
    s_waitcnt lgkmcnt(2)
    v_mfma_f32_32x32x16_bf16 v[128:143], v[232:235], v[164:167], v[128:143]
    s_waitcnt lgkmcnt(0)
    v_mfma_f32_32x32x16_bf16 v[144:159], v[236:239], v[164:167], v[144:159]
    s_add_u32 s40, s14, 0
    s_addc_u32 s41, s15, 0
    s_mov_b32 s42, 2359296
    s_mov_b32 s43, 0x00020000
    s_add_u32 s44, s14, 3145728
    s_addc_u32 s45, s15, 0
    s_mov_b32 s46, 5242880
    s_mov_b32 s47, 0x00020000
    s_lshl_b32 s32, s5, 2
    s_add_u32 s32, s32, s6
    s_lshl_b32 s33, s7, 9
    s_add_u32 s33, s33, s32
    s_lshl_b32 s34, s33, 10
    s_mul_i32 s35, s33, 2560
    s_lshl_b32 s36, s33, 7
    s_add_u32 s36, s36, 2097152
    s_add_u32 s37, s35, 2304
    v_lshlrev_b32 v1, 9, v15
    v_lshl_add_u32 v1, v9, 4, v1
    v_lshlrev_b32 v2, 4, v0
    v_lshlrev_b32 v3, 14, v15
    v_lshl_add_u32 v3, v9, 2, v3
    s_mov_b32 s38, 327680
    v_mul_lo_u32 v4, v15, s38
    v_lshl_add_u32 v4, v8, 2, v4
    v_mov_b32 v6, 0x3eae1a93
    v_mul_f32 v16, v6, v16
    v_mul_f32 v17, v6, v17
    v_mul_f32 v18, v6, v18
    v_mul_f32 v19, v6, v19
    v_mul_f32 v20, v6, v20
    v_mul_f32 v21, v6, v21
    v_mul_f32 v22, v6, v22
    v_mul_f32 v23, v6, v23
    v_cvt_pk_bf16_f32 v168, v16, v17
    v_cvt_pk_bf16_f32 v169, v18, v19
    v_cvt_pk_bf16_f32 v170, v20, v21
    v_cvt_pk_bf16_f32 v171, v22, v23
    v_cvt_pk_bf16_f32 v172, v24, v25
    v_cvt_pk_bf16_f32 v173, v26, v27
    v_cvt_pk_bf16_f32 v174, v28, v29
    v_cvt_pk_bf16_f32 v175, v30, v31
    buffer_store_dwordx4 v[168:171], v1, s[40:43], s34 offen sc0 sc1
    buffer_store_dwordx4 v[172:175], v2, s[44:47], s35 offen sc0 sc1
    s_add_u32 s34, s34, 65536
    s_add_u32 s35, s35, 163840
    v_mul_f32 v32, v6, v32
    v_mul_f32 v33, v6, v33
    v_mul_f32 v34, v6, v34
    v_mul_f32 v35, v6, v35
    v_mul_f32 v36, v6, v36
    v_mul_f32 v37, v6, v37
    v_mul_f32 v38, v6, v38
    v_mul_f32 v39, v6, v39
    v_cvt_pk_bf16_f32 v176, v32, v33
    v_cvt_pk_bf16_f32 v177, v34, v35
    v_cvt_pk_bf16_f32 v178, v36, v37
    v_cvt_pk_bf16_f32 v179, v38, v39
    v_cvt_pk_bf16_f32 v180, v40, v41
    v_cvt_pk_bf16_f32 v181, v42, v43
    v_cvt_pk_bf16_f32 v182, v44, v45
    v_cvt_pk_bf16_f32 v183, v46, v47
    buffer_store_dwordx4 v[176:179], v1, s[40:43], s34 offen sc0 sc1
    buffer_store_dwordx4 v[180:183], v2, s[44:47], s35 offen sc0 sc1
    s_add_u32 s34, s34, 65536
    s_add_u32 s35, s35, 163840
    v_mul_f32 v48, v6, v48
    v_mul_f32 v49, v6, v49
    v_mul_f32 v50, v6, v50
    v_mul_f32 v51, v6, v51
    v_mul_f32 v52, v6, v52
    v_mul_f32 v53, v6, v53
    v_mul_f32 v54, v6, v54
    v_mul_f32 v55, v6, v55
    v_cvt_pk_bf16_f32 v184, v48, v49
    v_cvt_pk_bf16_f32 v185, v50, v51
    v_cvt_pk_bf16_f32 v186, v52, v53
    v_cvt_pk_bf16_f32 v187, v54, v55
    v_cvt_pk_bf16_f32 v188, v56, v57
    v_cvt_pk_bf16_f32 v189, v58, v59
    v_cvt_pk_bf16_f32 v190, v60, v61
    v_cvt_pk_bf16_f32 v191, v62, v63
    buffer_store_dwordx4 v[184:187], v1, s[40:43], s34 offen sc0 sc1
    buffer_store_dwordx4 v[188:191], v2, s[44:47], s35 offen sc0 sc1
    s_add_u32 s34, s34, 65536
    s_add_u32 s35, s35, 163840
    v_mul_f32 v64, v6, v64
    v_mul_f32 v65, v6, v65
    v_mul_f32 v66, v6, v66
    v_mul_f32 v67, v6, v67
    v_mul_f32 v68, v6, v68
    v_mul_f32 v69, v6, v69
    v_mul_f32 v70, v6, v70
    v_mul_f32 v71, v6, v71
    v_cvt_pk_bf16_f32 v192, v64, v65
    v_cvt_pk_bf16_f32 v193, v66, v67
    v_cvt_pk_bf16_f32 v194, v68, v69
    v_cvt_pk_bf16_f32 v195, v70, v71
    v_cvt_pk_bf16_f32 v196, v72, v73
    v_cvt_pk_bf16_f32 v197, v74, v75
    v_cvt_pk_bf16_f32 v198, v76, v77
    v_cvt_pk_bf16_f32 v199, v78, v79
    buffer_store_dwordx4 v[192:195], v1, s[40:43], s34 offen sc0 sc1
    buffer_store_dwordx4 v[196:199], v2, s[44:47], s35 offen sc0 sc1
    s_add_u32 s34, s34, 65536
    s_add_u32 s35, s35, 163840
    v_mul_f32 v80, v6, v80
    v_mul_f32 v81, v6, v81
    v_mul_f32 v82, v6, v82
    v_mul_f32 v83, v6, v83
    v_mul_f32 v84, v6, v84
    v_mul_f32 v85, v6, v85
    v_mul_f32 v86, v6, v86
    v_mul_f32 v87, v6, v87
    v_cvt_pk_bf16_f32 v168, v80, v81
    v_cvt_pk_bf16_f32 v169, v82, v83
    v_cvt_pk_bf16_f32 v170, v84, v85
    v_cvt_pk_bf16_f32 v171, v86, v87
    v_cvt_pk_bf16_f32 v172, v88, v89
    v_cvt_pk_bf16_f32 v173, v90, v91
    v_cvt_pk_bf16_f32 v174, v92, v93
    v_cvt_pk_bf16_f32 v175, v94, v95
    buffer_store_dwordx4 v[168:171], v1, s[40:43], s34 offen sc0 sc1
    buffer_store_dwordx4 v[172:175], v2, s[44:47], s35 offen sc0 sc1
    s_add_u32 s34, s34, 65536
    s_add_u32 s35, s35, 163840
    v_mul_f32 v96, v6, v96
    v_mul_f32 v97, v6, v97
    v_mul_f32 v98, v6, v98
    v_mul_f32 v99, v6, v99
    v_mul_f32 v100, v6, v100
    v_mul_f32 v101, v6, v101
    v_mul_f32 v102, v6, v102
    v_mul_f32 v103, v6, v103
    v_cvt_pk_bf16_f32 v176, v96, v97
    v_cvt_pk_bf16_f32 v177, v98, v99
    v_cvt_pk_bf16_f32 v178, v100, v101
    v_cvt_pk_bf16_f32 v179, v102, v103
    v_cvt_pk_bf16_f32 v180, v104, v105
    v_cvt_pk_bf16_f32 v181, v106, v107
    v_cvt_pk_bf16_f32 v182, v108, v109
    v_cvt_pk_bf16_f32 v183, v110, v111
    buffer_store_dwordx4 v[176:179], v1, s[40:43], s34 offen sc0 sc1
    buffer_store_dwordx4 v[180:183], v2, s[44:47], s35 offen sc0 sc1
    s_add_u32 s34, s34, 65536
    s_add_u32 s35, s35, 163840
    v_mul_f32 v112, v6, v112
    v_mul_f32 v113, v6, v113
    v_mul_f32 v114, v6, v114
    v_mul_f32 v115, v6, v115
    v_mul_f32 v116, v6, v116
    v_mul_f32 v117, v6, v117
    v_mul_f32 v118, v6, v118
    v_mul_f32 v119, v6, v119
    v_cvt_pk_bf16_f32 v184, v112, v113
    v_cvt_pk_bf16_f32 v185, v114, v115
    v_cvt_pk_bf16_f32 v186, v116, v117
    v_cvt_pk_bf16_f32 v187, v118, v119
    v_cvt_pk_bf16_f32 v188, v120, v121
    v_cvt_pk_bf16_f32 v189, v122, v123
    v_cvt_pk_bf16_f32 v190, v124, v125
    v_cvt_pk_bf16_f32 v191, v126, v127
    buffer_store_dwordx4 v[184:187], v1, s[40:43], s34 offen sc0 sc1
    buffer_store_dwordx4 v[188:191], v2, s[44:47], s35 offen sc0 sc1
    s_add_u32 s34, s34, 65536
    s_add_u32 s35, s35, 163840
    v_mul_f32 v128, v6, v128
    v_mul_f32 v129, v6, v129
    v_mul_f32 v130, v6, v130
    v_mul_f32 v131, v6, v131
    v_mul_f32 v132, v6, v132
    v_mul_f32 v133, v6, v133
    v_mul_f32 v134, v6, v134
    v_mul_f32 v135, v6, v135
    v_cvt_pk_bf16_f32 v192, v128, v129
    v_cvt_pk_bf16_f32 v193, v130, v131
    v_cvt_pk_bf16_f32 v194, v132, v133
    v_cvt_pk_bf16_f32 v195, v134, v135
    v_cvt_pk_bf16_f32 v196, v136, v137
    v_cvt_pk_bf16_f32 v197, v138, v139
    v_cvt_pk_bf16_f32 v198, v140, v141
    v_cvt_pk_bf16_f32 v199, v142, v143
    buffer_store_dwordx4 v[192:195], v1, s[40:43], s34 offen sc0 sc1
    buffer_store_dwordx4 v[196:199], v2, s[44:47], s35 offen sc0 sc1
    s_add_u32 s34, s34, 65536
    s_add_u32 s35, s35, 163840
    v_mul_f32 v144, v6, v144
    v_mul_f32 v145, v6, v145
    v_mul_f32 v146, v6, v146
    v_mul_f32 v147, v6, v147
    v_mul_f32 v148, v6, v148
    v_mul_f32 v149, v6, v149
    v_mul_f32 v150, v6, v150
    v_mul_f32 v151, v6, v151
    v_cvt_pk_bf16_f32 v168, v144, v145
    v_cvt_pk_bf16_f32 v169, v146, v147
    v_cvt_pk_bf16_f32 v170, v148, v149
    v_cvt_pk_bf16_f32 v171, v150, v151
    v_cvt_pk_bf16_f32 v172, v152, v153
    v_cvt_pk_bf16_f32 v173, v154, v155
    v_cvt_pk_bf16_f32 v174, v156, v157
    v_cvt_pk_bf16_f32 v175, v158, v159
    s_add_u32 s38, s36, 0
    s_add_u32 s39, s37, 0
    buffer_store_dword v168, v3, s[40:43], s38 offen sc0 sc1
    buffer_store_dword v172, v4, s[44:47], s39 offen sc0 sc1
    s_add_u32 s38, s36, 8192
    s_add_u32 s39, s37, 163840
    buffer_store_dword v169, v3, s[40:43], s38 offen sc0 sc1
    buffer_store_dword v173, v4, s[44:47], s39 offen sc0 sc1
    s_add_u32 s38, s36, 32768
    s_add_u32 s39, s37, 655360
    buffer_store_dword v170, v3, s[40:43], s38 offen sc0 sc1
    buffer_store_dword v174, v4, s[44:47], s39 offen sc0 sc1
    s_add_u32 s38, s36, 40960
    s_add_u32 s39, s37, 819200
    buffer_store_dword v171, v3, s[40:43], s38 offen sc0 sc1
    buffer_store_dword v175, v4, s[44:47], s39 offen sc0 sc1
    s_lshl_b32 s36, s7, 4
    s_add_u32 s36, s36, s5
    s_add_u32 s36, s36, 768
    s_lshl_b32 s39, s36, 7
    s_lshl_b32 s38, s6, 6
    v_add_lshl_u32 v10, v0, s38, 20
    v_mov_b32 v12, s76
    v_mov_b32 v13, s77
    s_waitcnt vmcnt(0)
    s_barrier
    buffer_store_dwordx2 v[12:13], v10, s[72:75], s39 offen sc0 sc1
    s_load_dwordx4 s[8:11], s[0:1], 40
    s_load_dwordx2 s[66:67], s[0:1], 16
    s_load_dwordx2 s[68:69], s[0:1], 56
    s_load_dwordx2 s[70:71], s[0:1], 72
    s_mov_b32 s24, s5
    s_and_b32 s25, s3, 3
    s_lshl_b32 s25, s25, 2
    s_and_b32 s26, s4, 3
    s_add_u32 s25, s25, s26
    s_lshl_b32 s26, s24, 7
    s_lshl_b32 s27, s6, 5
    s_add_u32 s26, s26, s27
    v_lshrrev_b32 v4, 3, v0
    v_and_b32 v5, 7, v0
    s_lshl_b32 s55, s6, 12
    s_mov_b32 s57, 0
    v_add_u32 v6, 0, v4
    v_bfe_u32 v7, v6, 1, 3
    v_xor_b32 v7, v7, v5
    v_add_u32 v6, s26, v6
    v_lshlrev_b32 v6, 12, v6
    v_lshl_add_u32 v6, v7, 4, v6
    v_subrev_u32 v224, 0, v6
    v_add_u32 v6, 8, v4
    v_bfe_u32 v7, v6, 1, 3
    v_xor_b32 v7, v7, v5
    v_add_u32 v6, s26, v6
    v_lshlrev_b32 v6, 12, v6
    v_lshl_add_u32 v6, v7, 4, v6
    v_subrev_u32 v225, 1024, v6
    v_add_u32 v6, 16, v4
    v_bfe_u32 v7, v6, 1, 3
    v_xor_b32 v7, v7, v5
    v_add_u32 v6, s26, v6
    v_lshlrev_b32 v6, 12, v6
    v_lshl_add_u32 v6, v7, 4, v6
    v_subrev_u32 v226, 2048, v6
    v_add_u32 v6, 24, v4
    v_bfe_u32 v7, v6, 1, 3
    v_xor_b32 v7, v7, v5
    v_add_u32 v6, s26, v6
    v_lshlrev_b32 v6, 12, v6
    v_lshl_add_u32 v6, v7, 4, v6
    v_subrev_u32 v227, 3072, v6
    s_waitcnt lgkmcnt(0)
    s_add_u32 s20, s8, 0
    s_addc_u32 s21, s9, 0
    s_mov_b32 s22, 8388608
    s_mov_b32 s23, 0x00020000
    s_add_u32 m0, s55, 0
    s_nop 0
    buffer_load_dwordx4 v224, s[20:23], s57 offen offset:0 lds
    buffer_load_dwordx4 v225, s[20:23], s57 offen offset:1024 lds
    buffer_load_dwordx4 v226, s[20:23], s57 offen offset:2048 lds
    buffer_load_dwordx4 v227, s[20:23], s57 offen offset:3072 lds
    s_add_u32 s57, s57, 128
    s_add_u32 m0, s55, 18432
    s_nop 0
    buffer_load_dwordx4 v224, s[20:23], s57 offen offset:0 lds
    buffer_load_dwordx4 v225, s[20:23], s57 offen offset:1024 lds
    buffer_load_dwordx4 v226, s[20:23], s57 offen offset:2048 lds
    buffer_load_dwordx4 v227, s[20:23], s57 offen offset:3072 lds
    s_add_u32 s57, s57, 128
    s_add_u32 m0, s55, 36864
    s_nop 0
    buffer_load_dwordx4 v224, s[20:23], s57 offen offset:0 lds
    buffer_load_dwordx4 v225, s[20:23], s57 offen offset:1024 lds
    buffer_load_dwordx4 v226, s[20:23], s57 offen offset:2048 lds
    buffer_load_dwordx4 v227, s[20:23], s57 offen offset:3072 lds
    s_add_u32 s57, s57, 128
    s_add_u32 s16, s14, 17825792
    s_addc_u32 s17, s15, 0
    s_mov_b32 s18, 9437184
    s_mov_b32 s19, 0x00020000
    s_lshl_b32 s26, s25, 2
    s_add_u32 s26, s26, s6
    s_lshl_b32 s26, s26, 17
    v_lshlrev_b32 v1, 4, v0
    v_add_u32 v222, s26, v1
    s_lshr_b32 s26, s25, 1
    s_add_u32 s26, s26, 64
    s_lshl_b32 s26, s26, 17
    s_and_b32 s27, s25, 1
    s_lshl_b32 s27, s27, 8
    s_add_u32 s26, s26, s27
    s_lshl_b32 s27, s6, 10
    s_add_u32 s26, s26, s27
    v_lshrrev_b32 v2, 4, v0
    v_and_b32 v3, 15, v0
    v_lshlrev_b32 v4, 9, v2
    v_lshl_add_u32 v4, v3, 4, v4
    v_add_u32 v223, s26, v4
    s_lshl_b32 s54, s6, 9
    s_add_u32 s54, s54, 16384
    s_mov_b32 s56, 0
    s_mov_b32 s52, -1
    s_mov_b32 s53, 0
    s_lshl_b32 s26, s25, 1
    s_mul_i32 s27, s26, 21846
    s_lshr_b32 s27, s27, 16
    s_add_u32 s26, s26, 1
    s_mul_i32 s28, s26, 21846
    s_lshr_b32 s28, s28, 16
    s_cmp_ge_u32 s25, 4
    s_cselect_b32 s38, 11, 10
    v_mov_b32 v6, s27
    v_mov_b32 v7, s28
    v_cmp_eq_u32 vcc, 1, v2
    s_nop 1
    v_cndmask_b32 v6, v6, v7, vcc
    v_mov_b32 v7, s38
    v_cmp_lt_u32 vcc, 1, v2
    s_nop 1
    v_cndmask_b32 v6, v6, v7, vcc
    v_lshl_add_u32 v7, v6, 4, v3
    v_add_u32 v7, 256, v7
    v_lshlrev_b32 v233, 7, v7
    s_lshl_b32 s26, s25, 1
    v_add_u32 v6, s26, v2
    s_lshr_b32 s27, s25, 2
    s_add_u32 s27, s27, 32
    v_mov_b32 v7, s27
    v_cndmask_b32 v6, v6, v7, vcc
    v_mul_u32_u24 v7, 7282, v6
    v_lshrrev_b32 v7, 16, v7
    v_mul_u32_u24 v11, 9, v7
    v_sub_u32 v6, v6, v11
    v_lshlrev_b32 v6, 4, v6
    v_lshrrev_b32 v6, 6, v6
    v_mul_u32_u24 v7, 3, v7
    v_add_u32 v6, v6, v7
    s_lshl_b32 s26, s24, 4
    s_add_u32 s26, s26, 512
    v_add_u32 v6, s26, v6
    s_add_u32 s26, s24, 832
    v_mov_b32 v7, s26
    v_cmp_eq_u32 vcc, 3, v2
    s_nop 1
    v_cndmask_b32 v6, v6, v7, vcc
    v_lshlrev_b32 v232, 7, v6
    v_and_b32 v6, 0x33, v3
    v_and_b32 v7, 4, v3
    v_lshl_or_b32 v6, v7, 1, v6
    v_and_b32 v7, 8, v3
    v_lshrrev_b32 v7, 1, v7
    v_or_b32 v6, v6, v7
    v_lshlrev_b32 v7, 8, v2
    v_lshl_add_u32 v7, v6, 4, v7
    v_add_u32 v220, 16384, v7
    v_and_b32 v6, 31, v0
    v_lshrrev_b32 v7, 5, v0
    v_bfe_u32 v11, v6, 1, 3
    v_xor_b32 v11, v11, v7
    v_lshlrev_b32 v11, 4, v11
    v_lshl_add_u32 v208, v6, 7, v11
    v_xor_b32 v209, 32, v208
    v_xor_b32 v210, 64, v208
    v_xor_b32 v211, 96, v208
    v_bfe_u32 v11, v3, 1, 3
    v_xor_b32 v11, v11, v2
    v_lshlrev_b32 v11, 4, v11
    v_lshl_add_u32 v11, v3, 7, v11
    v_add_u32 v216, s55, v11
    v_xor_b32 v217, 64, v216
    v_add_u32 v212, 36864, v208
    v_add_u32 v213, 36864, v209
    v_add_u32 v214, 36864, v210
    v_add_u32 v215, 36864, v211
    v_add_u32 v218, 36864, v216
    v_add_u32 v219, 36864, v217
    v_add_u32 v221, 36864, v220
    v_sub_u32 v222, v222, v1
    v_lshl_add_u32 v222, v2, 9, v222
    v_and_b32 v6, 7, v3
    v_lshl_add_u32 v222, v6, 4, v222
    v_and_b32 v6, 8, v3
    v_lshl_add_u32 v222, v6, 5, v222
    s_mul_i32 s12, s3, 30
    s_add_u32 s12, s12, s4
    s_min_u32 s12, s12, 233
    s_mul_i32 s13, s12, 7282
    s_lshr_b32 s13, s13, 16
    s_mul_i32 s78, s13, 9
    s_sub_u32 s78, s12, s78
    s_mul_i32 s58, s13, 80
    s_add_u32 s38, s58, 79
    s_min_u32 s38, s38, 2047
    s_lshr_b32 s59, s58, 7
    s_lshr_b32 s39, s38, 7
    s_sub_u32 s39, s39, s59
    s_lshl_b32 s59, s59, 4
    s_add_u32 s59, s59, 1024
    v_and_b32 v6, 1, v2
    v_mul_u32_u24 v6, s39, v6
    v_lshl_add_u32 v6, v6, 4, v3
    v_add_lshl_u32 v230, v6, s59, 7
    s_lshr_b32 s59, s58, 8
    s_lshr_b32 s39, s38, 8
    s_sub_u32 s39, s39, s59
    s_lshl_b32 s59, s59, 5
    s_add_u32 s59, s59, 1280
    v_lshrrev_b32 v6, 5, v0
    v_mul_u32_u24 v6, s39, v6
    v_and_b32 v7, 31, v0
    v_lshl_add_u32 v6, v6, 5, v7
    v_add_lshl_u32 v231, v6, s59, 7
    s_branch gated_mix__mha_block__mixer_gmlp__prompt_kernel_sp
gated_mix__mha_block__mixer_gmlp__prompt_kernel_sp:
    s_nop 1
    s_add_u32 s40, s14, 27262976
    s_addc_u32 s41, s15, 0
    s_mov_b32 s42, 11796480
    s_mov_b32 s43, 0x00020000
    s_add_u32 s44, s14, 8388608
    s_addc_u32 s45, s15, 0
    s_mov_b32 s46, 9437184
    s_mov_b32 s47, 0x00020000
    s_add_u32 s48, s10, 0
    s_addc_u32 s49, s11, 0
    s_mov_b32 s50, 4096
    s_mov_b32 s51, 0x00020000
    s_add_u32 s60, s14, 2359296
    s_addc_u32 s61, s15, 0
    s_mov_b32 s62, 8192
    s_mov_b32 s63, 0x00020000
    s_cmp_lg_u32 s6, 0
    s_cbranch_scc1 gated_mix__mha_block__mixer_gmlp__prompt_kernel_g_pz_ok
    s_mov_b32 s38, 0x40000
gated_mix__mha_block__mixer_gmlp__prompt_kernel_g_pz:
    buffer_load_dwordx2 v[12:13], v233, s[72:75], 0 offen sc0 sc1
    s_waitcnt vmcnt(0)
    v_cmp_ne_u64 vcc, s[76:77], v[12:13]
    s_sub_u32 s38, s38, 1
    s_nop 2
    s_cbranch_vccz gated_mix__mha_block__mixer_gmlp__prompt_kernel_g_pz_ok
    s_cmp_eq_u32 s38, 0
    s_cbranch_scc1 gated_mix__mha_block__mixer_gmlp__prompt_kernel_g_pz_ok
    s_sleep 2
    s_branch gated_mix__mha_block__mixer_gmlp__prompt_kernel_g_pz
gated_mix__mha_block__mixer_gmlp__prompt_kernel_g_pz_ok:
    s_barrier
    s_add_u32 m0, s54, 0
    s_mov_b64 exec, s[52:53]
    buffer_load_dwordx4 v223, s[16:19], s56 offen sc0 sc1 lds
    s_mov_b64 exec, -1
    buffer_load_dwordx4 v[88:91], v222, s[16:19], s56 offen offset:0 sc0 sc1
    buffer_load_dwordx4 v[92:95], v222, s[16:19], s56 offen offset:2048 sc0 sc1
    buffer_load_dwordx4 v[96:99], v222, s[16:19], s56 offen offset:128 sc0 sc1
    buffer_load_dwordx4 v[100:103], v222, s[16:19], s56 offen offset:2176 sc0 sc1
    s_add_u32 s56, s56, 4096
    s_add_u32 m0, s54, 18432
    s_mov_b64 exec, s[52:53]
    buffer_load_dwordx4 v223, s[16:19], s56 offen sc0 sc1 lds
    s_mov_b64 exec, -1
    buffer_load_dwordx4 v[104:107], v222, s[16:19], s56 offen offset:0 sc0 sc1
    buffer_load_dwordx4 v[108:111], v222, s[16:19], s56 offen offset:2048 sc0 sc1
    buffer_load_dwordx4 v[112:115], v222, s[16:19], s56 offen offset:128 sc0 sc1
    buffer_load_dwordx4 v[116:119], v222, s[16:19], s56 offen offset:2176 sc0 sc1
    s_add_u32 s56, s56, 4096
    s_add_u32 m0, s54, 36864
    s_mov_b64 exec, s[52:53]
    buffer_load_dwordx4 v223, s[16:19], s56 offen sc0 sc1 lds
    s_mov_b64 exec, -1
    buffer_load_dwordx4 v[120:123], v222, s[16:19], s56 offen offset:0 sc0 sc1
    buffer_load_dwordx4 v[124:127], v222, s[16:19], s56 offen offset:2048 sc0 sc1
    buffer_load_dwordx4 v[128:131], v222, s[16:19], s56 offen offset:128 sc0 sc1
    buffer_load_dwordx4 v[132:135], v222, s[16:19], s56 offen offset:2176 sc0 sc1
    s_add_u32 s56, s56, 4096
    v_xor_b32 v184, 0, v216
    v_add_u32 v192, 36864, v184
    v_xor_b32 v185, 0, v217
    v_add_u32 v193, 36864, v185
    v_xor_b32 v186, 4096, v216
    v_add_u32 v194, 36864, v186
    v_xor_b32 v187, 4096, v217
    v_add_u32 v195, 36864, v187
    v_xor_b32 v188, 8192, v216
    v_add_u32 v196, 36864, v188
    v_xor_b32 v189, 8192, v217
    v_add_u32 v197, 36864, v189
    v_xor_b32 v190, 12288, v216
    v_add_u32 v198, 36864, v190
    v_xor_b32 v191, 12288, v217
    v_add_u32 v199, 36864, v191
    v_lshlrev_b32 v208, 9, v2
    v_lshl_add_u32 v208, v3, 4, v208
    s_waitcnt vmcnt(14)
    s_barrier
    ds_read_b128 v[152:155], v184 offset:0
    ds_read_b128 v[156:159], v185 offset:0
    ds_read_b128 v[160:163], v184 offset:2048
    ds_read_b128 v[164:167], v185 offset:2048
    ds_read_b128 v[200:203], v220 offset:0
    ds_read_b128 v[204:207], v220 offset:1024
    s_mov_b32 s64, 2
    s_setprio 0
    s_waitcnt vmcnt(10) lgkmcnt(0)
    v_mfma_f32_16x16x32_bf16 v[16:19], v[88:91], v[152:155], 0
    ds_read_b128 v[168:171], v186 offset:0
    v_mfma_f32_16x16x32_bf16 v[16:19], v[92:95], v[156:159], v[16:19]
    ds_read_b128 v[172:175], v187 offset:0
    v_mfma_f32_16x16x32_bf16 v[20:23], v[96:99], v[152:155], 0
    ds_read_b128 v[176:179], v186 offset:2048
    v_mfma_f32_16x16x32_bf16 v[20:23], v[100:103], v[156:159], v[20:23]
    ds_read_b128 v[180:183], v187 offset:2048
    v_mfma_f32_16x16x32_bf16 v[24:27], v[88:91], v[160:163], 0
    s_add_u32 m0, s55, 55296
    s_nop 0
    buffer_load_dwordx4 v224, s[20:23], s57 offen offset:0 lds
    v_mfma_f32_16x16x32_bf16 v[24:27], v[92:95], v[164:167], v[24:27]
    v_mfma_f32_16x16x32_bf16 v[28:31], v[96:99], v[160:163], 0
    buffer_load_dwordx4 v225, s[20:23], s57 offen offset:1024 lds
    v_mfma_f32_16x16x32_bf16 v[28:31], v[100:103], v[164:167], v[28:31]
    v_mfma_f32_16x16x32_bf16 v[80:83], v[200:203], v[152:155], 0
    buffer_load_dwordx4 v226, s[20:23], s57 offen offset:2048 lds
    v_mfma_f32_16x16x32_bf16 v[80:83], v[204:207], v[156:159], v[80:83]
    v_mfma_f32_16x16x32_bf16 v[84:87], v[200:203], v[160:163], 0
    buffer_load_dwordx4 v227, s[20:23], s57 offen offset:3072 lds
    v_mfma_f32_16x16x32_bf16 v[84:87], v[204:207], v[164:167], v[84:87]
    s_waitcnt lgkmcnt(0)
    v_mfma_f32_16x16x32_bf16 v[32:35], v[88:91], v[168:171], 0
    ds_read_b128 v[152:155], v188 offset:0
    v_mfma_f32_16x16x32_bf16 v[32:35], v[92:95], v[172:175], v[32:35]
    ds_read_b128 v[156:159], v189 offset:0
    v_mfma_f32_16x16x32_bf16 v[36:39], v[96:99], v[168:171], 0
    ds_read_b128 v[160:163], v188 offset:2048
    v_mfma_f32_16x16x32_bf16 v[36:39], v[100:103], v[172:175], v[36:39]
    ds_read_b128 v[164:167], v189 offset:2048
    v_mfma_f32_16x16x32_bf16 v[40:43], v[88:91], v[176:179], 0
    s_add_u32 s57, s57, 128
    s_add_u32 m0, s54, 55296
    s_mov_b64 exec, s[52:53]
    buffer_load_dwordx4 v223, s[16:19], s56 offen sc0 sc1 lds
    s_mov_b64 exec, -1
    v_mfma_f32_16x16x32_bf16 v[40:43], v[92:95], v[180:183], v[40:43]
    v_mfma_f32_16x16x32_bf16 v[44:47], v[96:99], v[176:179], 0
    v_mfma_f32_16x16x32_bf16 v[44:47], v[100:103], v[180:183], v[44:47]
    s_waitcnt lgkmcnt(0)
    v_mfma_f32_16x16x32_bf16 v[48:51], v[88:91], v[152:155], 0
    ds_read_b128 v[168:171], v190 offset:0
    v_mfma_f32_16x16x32_bf16 v[48:51], v[92:95], v[156:159], v[48:51]
    ds_read_b128 v[172:175], v191 offset:0
    v_mfma_f32_16x16x32_bf16 v[52:55], v[96:99], v[152:155], 0
    ds_read_b128 v[176:179], v190 offset:2048
    v_mfma_f32_16x16x32_bf16 v[52:55], v[100:103], v[156:159], v[52:55]
    ds_read_b128 v[180:183], v191 offset:2048
    v_mfma_f32_16x16x32_bf16 v[56:59], v[88:91], v[160:163], 0
    buffer_load_dwordx4 v[136:139], v222, s[16:19], s56 offen offset:0 sc0 sc1
    v_mfma_f32_16x16x32_bf16 v[56:59], v[92:95], v[164:167], v[56:59]
    buffer_load_dwordx4 v[140:143], v222, s[16:19], s56 offen offset:2048 sc0 sc1
    v_mfma_f32_16x16x32_bf16 v[60:63], v[96:99], v[160:163], 0
    buffer_load_dwordx4 v[144:147], v222, s[16:19], s56 offen offset:128 sc0 sc1
    v_mfma_f32_16x16x32_bf16 v[60:63], v[100:103], v[164:167], v[60:63]
    buffer_load_dwordx4 v[148:151], v222, s[16:19], s56 offen offset:2176 sc0 sc1
    s_add_u32 s56, s56, 4096
    s_waitcnt vmcnt(18)
    s_waitcnt lgkmcnt(0)
    s_barrier
    v_mfma_f32_16x16x32_bf16 v[64:67], v[88:91], v[168:171], 0
    ds_read_b128 v[152:155], v184 offset:18432
    ds_read_b128 v[156:159], v185 offset:18432
    v_mfma_f32_16x16x32_bf16 v[64:67], v[92:95], v[172:175], v[64:67]
    ds_read_b128 v[160:163], v184 offset:20480
    v_mfma_f32_16x16x32_bf16 v[68:71], v[96:99], v[168:171], 0
    ds_read_b128 v[164:167], v185 offset:20480
    ds_read_b128 v[200:203], v220 offset:18432
    v_mfma_f32_16x16x32_bf16 v[68:71], v[100:103], v[172:175], v[68:71]
    ds_read_b128 v[204:207], v220 offset:19456
    v_mfma_f32_16x16x32_bf16 v[72:75], v[88:91], v[176:179], 0
    v_mfma_f32_16x16x32_bf16 v[72:75], v[92:95], v[180:183], v[72:75]
    v_mfma_f32_16x16x32_bf16 v[76:79], v[96:99], v[176:179], 0
    v_mfma_f32_16x16x32_bf16 v[76:79], v[100:103], v[180:183], v[76:79]
    s_waitcnt vmcnt(14) lgkmcnt(0)
    v_mfma_f32_16x16x32_bf16 v[16:19], v[104:107], v[152:155], v[16:19]
    ds_read_b128 v[168:171], v186 offset:18432
    v_mfma_f32_16x16x32_bf16 v[16:19], v[108:111], v[156:159], v[16:19]
    ds_read_b128 v[172:175], v187 offset:18432
    v_mfma_f32_16x16x32_bf16 v[20:23], v[112:115], v[152:155], v[20:23]
    ds_read_b128 v[176:179], v186 offset:20480
    v_mfma_f32_16x16x32_bf16 v[20:23], v[116:119], v[156:159], v[20:23]
    ds_read_b128 v[180:183], v187 offset:20480
    v_mfma_f32_16x16x32_bf16 v[24:27], v[104:107], v[160:163], v[24:27]
    s_add_u32 m0, s55, 0
    s_nop 0
    buffer_load_dwordx4 v224, s[20:23], s57 offen offset:0 lds
    v_mfma_f32_16x16x32_bf16 v[24:27], v[108:111], v[164:167], v[24:27]
    v_mfma_f32_16x16x32_bf16 v[28:31], v[112:115], v[160:163], v[28:31]
    buffer_load_dwordx4 v225, s[20:23], s57 offen offset:1024 lds
    v_mfma_f32_16x16x32_bf16 v[28:31], v[116:119], v[164:167], v[28:31]
    v_mfma_f32_16x16x32_bf16 v[80:83], v[200:203], v[152:155], v[80:83]
    buffer_load_dwordx4 v226, s[20:23], s57 offen offset:2048 lds
    v_mfma_f32_16x16x32_bf16 v[80:83], v[204:207], v[156:159], v[80:83]
    v_mfma_f32_16x16x32_bf16 v[84:87], v[200:203], v[160:163], v[84:87]
    buffer_load_dwordx4 v227, s[20:23], s57 offen offset:3072 lds
    v_mfma_f32_16x16x32_bf16 v[84:87], v[204:207], v[164:167], v[84:87]
    s_waitcnt lgkmcnt(0)
    v_mfma_f32_16x16x32_bf16 v[32:35], v[104:107], v[168:171], v[32:35]
    ds_read_b128 v[152:155], v188 offset:18432
    v_mfma_f32_16x16x32_bf16 v[32:35], v[108:111], v[172:175], v[32:35]
    ds_read_b128 v[156:159], v189 offset:18432
    v_mfma_f32_16x16x32_bf16 v[36:39], v[112:115], v[168:171], v[36:39]
    ds_read_b128 v[160:163], v188 offset:20480
    v_mfma_f32_16x16x32_bf16 v[36:39], v[116:119], v[172:175], v[36:39]
    ds_read_b128 v[164:167], v189 offset:20480
    v_mfma_f32_16x16x32_bf16 v[40:43], v[104:107], v[176:179], v[40:43]
    s_add_u32 s57, s57, 128
    s_add_u32 m0, s54, 0
    s_mov_b64 exec, s[52:53]
    buffer_load_dwordx4 v223, s[16:19], s56 offen sc0 sc1 lds
    s_mov_b64 exec, -1
    v_mfma_f32_16x16x32_bf16 v[40:43], v[108:111], v[180:183], v[40:43]
    v_mfma_f32_16x16x32_bf16 v[44:47], v[112:115], v[176:179], v[44:47]
    v_mfma_f32_16x16x32_bf16 v[44:47], v[116:119], v[180:183], v[44:47]
    s_waitcnt lgkmcnt(0)
    v_mfma_f32_16x16x32_bf16 v[48:51], v[104:107], v[152:155], v[48:51]
    ds_read_b128 v[168:171], v190 offset:18432
    v_mfma_f32_16x16x32_bf16 v[48:51], v[108:111], v[156:159], v[48:51]
    ds_read_b128 v[172:175], v191 offset:18432
    v_mfma_f32_16x16x32_bf16 v[52:55], v[112:115], v[152:155], v[52:55]
    ds_read_b128 v[176:179], v190 offset:20480
    v_mfma_f32_16x16x32_bf16 v[52:55], v[116:119], v[156:159], v[52:55]
    ds_read_b128 v[180:183], v191 offset:20480
    v_mfma_f32_16x16x32_bf16 v[56:59], v[104:107], v[160:163], v[56:59]
    buffer_load_dwordx4 v[88:91], v222, s[16:19], s56 offen offset:0 sc0 sc1
    v_mfma_f32_16x16x32_bf16 v[56:59], v[108:111], v[164:167], v[56:59]
    buffer_load_dwordx4 v[92:95], v222, s[16:19], s56 offen offset:2048 sc0 sc1
    v_mfma_f32_16x16x32_bf16 v[60:63], v[112:115], v[160:163], v[60:63]
    buffer_load_dwordx4 v[96:99], v222, s[16:19], s56 offen offset:128 sc0 sc1
    v_mfma_f32_16x16x32_bf16 v[60:63], v[116:119], v[164:167], v[60:63]
    buffer_load_dwordx4 v[100:103], v222, s[16:19], s56 offen offset:2176 sc0 sc1
    s_add_u32 s56, s56, 4096
    s_waitcnt vmcnt(22)
    s_waitcnt lgkmcnt(0)
    s_barrier
    v_mfma_f32_16x16x32_bf16 v[64:67], v[104:107], v[168:171], v[64:67]
    ds_read_b128 v[152:155], v192 offset:0
    ds_read_b128 v[156:159], v193 offset:0
    v_mfma_f32_16x16x32_bf16 v[64:67], v[108:111], v[172:175], v[64:67]
    ds_read_b128 v[160:163], v192 offset:2048
    v_mfma_f32_16x16x32_bf16 v[68:71], v[112:115], v[168:171], v[68:71]
    ds_read_b128 v[164:167], v193 offset:2048
    ds_read_b128 v[200:203], v221 offset:0
    v_mfma_f32_16x16x32_bf16 v[68:71], v[116:119], v[172:175], v[68:71]
    ds_read_b128 v[204:207], v221 offset:1024
    v_mfma_f32_16x16x32_bf16 v[72:75], v[104:107], v[176:179], v[72:75]
    v_mfma_f32_16x16x32_bf16 v[72:75], v[108:111], v[180:183], v[72:75]
    v_mfma_f32_16x16x32_bf16 v[76:79], v[112:115], v[176:179], v[76:79]
    v_mfma_f32_16x16x32_bf16 v[76:79], v[116:119], v[180:183], v[76:79]
    s_waitcnt vmcnt(18) lgkmcnt(0)
    v_mfma_f32_16x16x32_bf16 v[16:19], v[120:123], v[152:155], v[16:19]
    ds_read_b128 v[168:171], v194 offset:0
    v_mfma_f32_16x16x32_bf16 v[16:19], v[124:127], v[156:159], v[16:19]
    ds_read_b128 v[172:175], v195 offset:0
    v_mfma_f32_16x16x32_bf16 v[20:23], v[128:131], v[152:155], v[20:23]
    ds_read_b128 v[176:179], v194 offset:2048
    v_mfma_f32_16x16x32_bf16 v[20:23], v[132:135], v[156:159], v[20:23]
    ds_read_b128 v[180:183], v195 offset:2048
    v_mfma_f32_16x16x32_bf16 v[24:27], v[120:123], v[160:163], v[24:27]
    s_add_u32 m0, s55, 18432
    s_nop 0
    buffer_load_dwordx4 v224, s[20:23], s57 offen offset:0 lds
    v_mfma_f32_16x16x32_bf16 v[24:27], v[124:127], v[164:167], v[24:27]
    v_mfma_f32_16x16x32_bf16 v[28:31], v[128:131], v[160:163], v[28:31]
    buffer_load_dwordx4 v225, s[20:23], s57 offen offset:1024 lds
    v_mfma_f32_16x16x32_bf16 v[28:31], v[132:135], v[164:167], v[28:31]
    v_mfma_f32_16x16x32_bf16 v[80:83], v[200:203], v[152:155], v[80:83]
    buffer_load_dwordx4 v226, s[20:23], s57 offen offset:2048 lds
    v_mfma_f32_16x16x32_bf16 v[80:83], v[204:207], v[156:159], v[80:83]
    v_mfma_f32_16x16x32_bf16 v[84:87], v[200:203], v[160:163], v[84:87]
    buffer_load_dwordx4 v227, s[20:23], s57 offen offset:3072 lds
    v_mfma_f32_16x16x32_bf16 v[84:87], v[204:207], v[164:167], v[84:87]
    s_waitcnt lgkmcnt(0)
    v_mfma_f32_16x16x32_bf16 v[32:35], v[120:123], v[168:171], v[32:35]
    ds_read_b128 v[152:155], v196 offset:0
    v_mfma_f32_16x16x32_bf16 v[32:35], v[124:127], v[172:175], v[32:35]
    ds_read_b128 v[156:159], v197 offset:0
    v_mfma_f32_16x16x32_bf16 v[36:39], v[128:131], v[168:171], v[36:39]
    ds_read_b128 v[160:163], v196 offset:2048
    v_mfma_f32_16x16x32_bf16 v[36:39], v[132:135], v[172:175], v[36:39]
    ds_read_b128 v[164:167], v197 offset:2048
    v_mfma_f32_16x16x32_bf16 v[40:43], v[120:123], v[176:179], v[40:43]
    s_add_u32 s57, s57, 128
    s_add_u32 m0, s54, 18432
    s_mov_b64 exec, s[52:53]
    buffer_load_dwordx4 v223, s[16:19], s56 offen sc0 sc1 lds
    s_mov_b64 exec, -1
    v_mfma_f32_16x16x32_bf16 v[40:43], v[124:127], v[180:183], v[40:43]
    v_mfma_f32_16x16x32_bf16 v[44:47], v[128:131], v[176:179], v[44:47]
    v_mfma_f32_16x16x32_bf16 v[44:47], v[132:135], v[180:183], v[44:47]
    s_waitcnt lgkmcnt(0)
    v_mfma_f32_16x16x32_bf16 v[48:51], v[120:123], v[152:155], v[48:51]
    ds_read_b128 v[168:171], v198 offset:0
    v_mfma_f32_16x16x32_bf16 v[48:51], v[124:127], v[156:159], v[48:51]
    ds_read_b128 v[172:175], v199 offset:0
    v_mfma_f32_16x16x32_bf16 v[52:55], v[128:131], v[152:155], v[52:55]
    ds_read_b128 v[176:179], v198 offset:2048
    v_mfma_f32_16x16x32_bf16 v[52:55], v[132:135], v[156:159], v[52:55]
    ds_read_b128 v[180:183], v199 offset:2048
    v_mfma_f32_16x16x32_bf16 v[56:59], v[120:123], v[160:163], v[56:59]
    buffer_load_dwordx4 v[104:107], v222, s[16:19], s56 offen offset:0 sc0 sc1
    v_mfma_f32_16x16x32_bf16 v[56:59], v[124:127], v[164:167], v[56:59]
    buffer_load_dwordx4 v[108:111], v222, s[16:19], s56 offen offset:2048 sc0 sc1
    v_mfma_f32_16x16x32_bf16 v[60:63], v[128:131], v[160:163], v[60:63]
    buffer_load_dwordx4 v[112:115], v222, s[16:19], s56 offen offset:128 sc0 sc1
    v_mfma_f32_16x16x32_bf16 v[60:63], v[132:135], v[164:167], v[60:63]
    buffer_load_dwordx4 v[116:119], v222, s[16:19], s56 offen offset:2176 sc0 sc1
    s_add_u32 s56, s56, 4096
    s_waitcnt vmcnt(22)
    s_waitcnt lgkmcnt(0)
    s_barrier
    v_mfma_f32_16x16x32_bf16 v[64:67], v[120:123], v[168:171], v[64:67]
    ds_read_b128 v[152:155], v192 offset:18432
    ds_read_b128 v[156:159], v193 offset:18432
    v_mfma_f32_16x16x32_bf16 v[64:67], v[124:127], v[172:175], v[64:67]
    ds_read_b128 v[160:163], v192 offset:20480
    v_mfma_f32_16x16x32_bf16 v[68:71], v[128:131], v[168:171], v[68:71]
    ds_read_b128 v[164:167], v193 offset:20480
    ds_read_b128 v[200:203], v221 offset:18432
    v_mfma_f32_16x16x32_bf16 v[68:71], v[132:135], v[172:175], v[68:71]
    ds_read_b128 v[204:207], v221 offset:19456
    v_mfma_f32_16x16x32_bf16 v[72:75], v[120:123], v[176:179], v[72:75]
    v_mfma_f32_16x16x32_bf16 v[72:75], v[124:127], v[180:183], v[72:75]
    v_mfma_f32_16x16x32_bf16 v[76:79], v[128:131], v[176:179], v[76:79]
    v_mfma_f32_16x16x32_bf16 v[76:79], v[132:135], v[180:183], v[76:79]
    s_waitcnt vmcnt(18) lgkmcnt(0)
    v_mfma_f32_16x16x32_bf16 v[16:19], v[136:139], v[152:155], v[16:19]
    ds_read_b128 v[168:171], v194 offset:18432
    v_mfma_f32_16x16x32_bf16 v[16:19], v[140:143], v[156:159], v[16:19]
    ds_read_b128 v[172:175], v195 offset:18432
    v_mfma_f32_16x16x32_bf16 v[20:23], v[144:147], v[152:155], v[20:23]
    ds_read_b128 v[176:179], v194 offset:20480
    v_mfma_f32_16x16x32_bf16 v[20:23], v[148:151], v[156:159], v[20:23]
    ds_read_b128 v[180:183], v195 offset:20480
    v_mfma_f32_16x16x32_bf16 v[24:27], v[136:139], v[160:163], v[24:27]
    s_add_u32 m0, s55, 36864
    s_nop 0
    buffer_load_dwordx4 v224, s[20:23], s57 offen offset:0 lds
    v_mfma_f32_16x16x32_bf16 v[24:27], v[140:143], v[164:167], v[24:27]
    v_mfma_f32_16x16x32_bf16 v[28:31], v[144:147], v[160:163], v[28:31]
    buffer_load_dwordx4 v225, s[20:23], s57 offen offset:1024 lds
    v_mfma_f32_16x16x32_bf16 v[28:31], v[148:151], v[164:167], v[28:31]
    v_mfma_f32_16x16x32_bf16 v[80:83], v[200:203], v[152:155], v[80:83]
    buffer_load_dwordx4 v226, s[20:23], s57 offen offset:2048 lds
    v_mfma_f32_16x16x32_bf16 v[80:83], v[204:207], v[156:159], v[80:83]
    v_mfma_f32_16x16x32_bf16 v[84:87], v[200:203], v[160:163], v[84:87]
    buffer_load_dwordx4 v227, s[20:23], s57 offen offset:3072 lds
    v_mfma_f32_16x16x32_bf16 v[84:87], v[204:207], v[164:167], v[84:87]
    s_waitcnt lgkmcnt(0)
    v_mfma_f32_16x16x32_bf16 v[32:35], v[136:139], v[168:171], v[32:35]
    ds_read_b128 v[152:155], v196 offset:18432
    v_mfma_f32_16x16x32_bf16 v[32:35], v[140:143], v[172:175], v[32:35]
    ds_read_b128 v[156:159], v197 offset:18432
    v_mfma_f32_16x16x32_bf16 v[36:39], v[144:147], v[168:171], v[36:39]
    ds_read_b128 v[160:163], v196 offset:20480
    v_mfma_f32_16x16x32_bf16 v[36:39], v[148:151], v[172:175], v[36:39]
    ds_read_b128 v[164:167], v197 offset:20480
    v_mfma_f32_16x16x32_bf16 v[40:43], v[136:139], v[176:179], v[40:43]
    s_add_u32 s57, s57, 128
    s_add_u32 m0, s54, 36864
    s_mov_b64 exec, s[52:53]
    buffer_load_dwordx4 v223, s[16:19], s56 offen sc0 sc1 lds
    s_mov_b64 exec, -1
    v_mfma_f32_16x16x32_bf16 v[40:43], v[140:143], v[180:183], v[40:43]
    v_mfma_f32_16x16x32_bf16 v[44:47], v[144:147], v[176:179], v[44:47]
    v_mfma_f32_16x16x32_bf16 v[44:47], v[148:151], v[180:183], v[44:47]
    s_waitcnt lgkmcnt(0)
    v_mfma_f32_16x16x32_bf16 v[48:51], v[136:139], v[152:155], v[48:51]
    ds_read_b128 v[168:171], v198 offset:18432
    v_mfma_f32_16x16x32_bf16 v[48:51], v[140:143], v[156:159], v[48:51]
    ds_read_b128 v[172:175], v199 offset:18432
    v_mfma_f32_16x16x32_bf16 v[52:55], v[144:147], v[152:155], v[52:55]
    ds_read_b128 v[176:179], v198 offset:20480
    v_mfma_f32_16x16x32_bf16 v[52:55], v[148:151], v[156:159], v[52:55]
    ds_read_b128 v[180:183], v199 offset:20480
    v_mfma_f32_16x16x32_bf16 v[56:59], v[136:139], v[160:163], v[56:59]
    buffer_load_dwordx4 v[120:123], v222, s[16:19], s56 offen offset:0 sc0 sc1
    v_mfma_f32_16x16x32_bf16 v[56:59], v[140:143], v[164:167], v[56:59]
    buffer_load_dwordx4 v[124:127], v222, s[16:19], s56 offen offset:2048 sc0 sc1
    v_mfma_f32_16x16x32_bf16 v[60:63], v[144:147], v[160:163], v[60:63]
    buffer_load_dwordx4 v[128:131], v222, s[16:19], s56 offen offset:128 sc0 sc1
    v_mfma_f32_16x16x32_bf16 v[60:63], v[148:151], v[164:167], v[60:63]
    buffer_load_dwordx4 v[132:135], v222, s[16:19], s56 offen offset:2176 sc0 sc1
    s_add_u32 s56, s56, 4096
    s_waitcnt vmcnt(22)
    s_waitcnt lgkmcnt(0)
    s_barrier
    v_mfma_f32_16x16x32_bf16 v[64:67], v[136:139], v[168:171], v[64:67]
    ds_read_b128 v[152:155], v184 offset:0
    ds_read_b128 v[156:159], v185 offset:0
    v_mfma_f32_16x16x32_bf16 v[64:67], v[140:143], v[172:175], v[64:67]
    ds_read_b128 v[160:163], v184 offset:2048
    v_mfma_f32_16x16x32_bf16 v[68:71], v[144:147], v[168:171], v[68:71]
    ds_read_b128 v[164:167], v185 offset:2048
    ds_read_b128 v[200:203], v220 offset:0
    v_mfma_f32_16x16x32_bf16 v[68:71], v[148:151], v[172:175], v[68:71]
    ds_read_b128 v[204:207], v220 offset:1024
    v_mfma_f32_16x16x32_bf16 v[72:75], v[136:139], v[176:179], v[72:75]
    v_mfma_f32_16x16x32_bf16 v[72:75], v[140:143], v[180:183], v[72:75]
    v_mfma_f32_16x16x32_bf16 v[76:79], v[144:147], v[176:179], v[76:79]
    v_mfma_f32_16x16x32_bf16 v[76:79], v[148:151], v[180:183], v[76:79]
    s_sub_u32 s64, s64, 1
    s_cmp_lg_u32 s64, 0
    s_cbranch_scc1 1f
    s_setprio 2
1:
    s_mov_b32 s65, 6
.p2align 6
gated_mix__mha_block__mixer_gmlp__prompt_kernel_g_gl:
    s_waitcnt vmcnt(18) lgkmcnt(0)
    v_mfma_f32_16x16x32_bf16 v[16:19], v[88:91], v[152:155], v[16:19]
    ds_read_b128 v[168:171], v186 offset:0
    v_mfma_f32_16x16x32_bf16 v[16:19], v[92:95], v[156:159], v[16:19]
    ds_read_b128 v[172:175], v187 offset:0
    v_mfma_f32_16x16x32_bf16 v[20:23], v[96:99], v[152:155], v[20:23]
    ds_read_b128 v[176:179], v186 offset:2048
    v_mfma_f32_16x16x32_bf16 v[20:23], v[100:103], v[156:159], v[20:23]
    ds_read_b128 v[180:183], v187 offset:2048
    v_mfma_f32_16x16x32_bf16 v[24:27], v[88:91], v[160:163], v[24:27]
    s_add_u32 m0, s55, 55296
    s_nop 0
    buffer_load_dwordx4 v224, s[20:23], s57 offen offset:0 lds
    v_mfma_f32_16x16x32_bf16 v[24:27], v[92:95], v[164:167], v[24:27]
    v_mfma_f32_16x16x32_bf16 v[28:31], v[96:99], v[160:163], v[28:31]
    buffer_load_dwordx4 v225, s[20:23], s57 offen offset:1024 lds
    v_mfma_f32_16x16x32_bf16 v[28:31], v[100:103], v[164:167], v[28:31]
    v_mfma_f32_16x16x32_bf16 v[80:83], v[200:203], v[152:155], v[80:83]
    buffer_load_dwordx4 v226, s[20:23], s57 offen offset:2048 lds
    v_mfma_f32_16x16x32_bf16 v[80:83], v[204:207], v[156:159], v[80:83]
    v_mfma_f32_16x16x32_bf16 v[84:87], v[200:203], v[160:163], v[84:87]
    buffer_load_dwordx4 v227, s[20:23], s57 offen offset:3072 lds
    v_mfma_f32_16x16x32_bf16 v[84:87], v[204:207], v[164:167], v[84:87]
    s_waitcnt lgkmcnt(0)
    v_mfma_f32_16x16x32_bf16 v[32:35], v[88:91], v[168:171], v[32:35]
    ds_read_b128 v[152:155], v188 offset:0
    v_mfma_f32_16x16x32_bf16 v[32:35], v[92:95], v[172:175], v[32:35]
    ds_read_b128 v[156:159], v189 offset:0
    v_mfma_f32_16x16x32_bf16 v[36:39], v[96:99], v[168:171], v[36:39]
    ds_read_b128 v[160:163], v188 offset:2048
    v_mfma_f32_16x16x32_bf16 v[36:39], v[100:103], v[172:175], v[36:39]
    ds_read_b128 v[164:167], v189 offset:2048
    v_mfma_f32_16x16x32_bf16 v[40:43], v[88:91], v[176:179], v[40:43]
    s_add_u32 s57, s57, 128
    s_add_u32 m0, s54, 55296
    s_mov_b64 exec, s[52:53]
    buffer_load_dwordx4 v223, s[16:19], s56 offen sc0 sc1 lds
    s_mov_b64 exec, -1
    v_mfma_f32_16x16x32_bf16 v[40:43], v[92:95], v[180:183], v[40:43]
    v_mfma_f32_16x16x32_bf16 v[44:47], v[96:99], v[176:179], v[44:47]
    v_mfma_f32_16x16x32_bf16 v[44:47], v[100:103], v[180:183], v[44:47]
    s_waitcnt lgkmcnt(0)
    v_mfma_f32_16x16x32_bf16 v[48:51], v[88:91], v[152:155], v[48:51]
    ds_read_b128 v[168:171], v190 offset:0
    v_mfma_f32_16x16x32_bf16 v[48:51], v[92:95], v[156:159], v[48:51]
    ds_read_b128 v[172:175], v191 offset:0
    v_mfma_f32_16x16x32_bf16 v[52:55], v[96:99], v[152:155], v[52:55]
    ds_read_b128 v[176:179], v190 offset:2048
    v_mfma_f32_16x16x32_bf16 v[52:55], v[100:103], v[156:159], v[52:55]
    ds_read_b128 v[180:183], v191 offset:2048
    v_mfma_f32_16x16x32_bf16 v[56:59], v[88:91], v[160:163], v[56:59]
    buffer_load_dwordx4 v[136:139], v222, s[16:19], s56 offen offset:0 sc0 sc1
    v_mfma_f32_16x16x32_bf16 v[56:59], v[92:95], v[164:167], v[56:59]
    buffer_load_dwordx4 v[140:143], v222, s[16:19], s56 offen offset:2048 sc0 sc1
    v_mfma_f32_16x16x32_bf16 v[60:63], v[96:99], v[160:163], v[60:63]
    buffer_load_dwordx4 v[144:147], v222, s[16:19], s56 offen offset:128 sc0 sc1
    v_mfma_f32_16x16x32_bf16 v[60:63], v[100:103], v[164:167], v[60:63]
    buffer_load_dwordx4 v[148:151], v222, s[16:19], s56 offen offset:2176 sc0 sc1
    s_add_u32 s56, s56, 4096
    s_waitcnt vmcnt(22)
    s_waitcnt lgkmcnt(0)
    s_barrier
    v_mfma_f32_16x16x32_bf16 v[64:67], v[88:91], v[168:171], v[64:67]
    ds_read_b128 v[152:155], v184 offset:18432
    ds_read_b128 v[156:159], v185 offset:18432
    v_mfma_f32_16x16x32_bf16 v[64:67], v[92:95], v[172:175], v[64:67]
    ds_read_b128 v[160:163], v184 offset:20480
    v_mfma_f32_16x16x32_bf16 v[68:71], v[96:99], v[168:171], v[68:71]
    ds_read_b128 v[164:167], v185 offset:20480
    ds_read_b128 v[200:203], v220 offset:18432
    v_mfma_f32_16x16x32_bf16 v[68:71], v[100:103], v[172:175], v[68:71]
    ds_read_b128 v[204:207], v220 offset:19456
    v_mfma_f32_16x16x32_bf16 v[72:75], v[88:91], v[176:179], v[72:75]
    v_mfma_f32_16x16x32_bf16 v[72:75], v[92:95], v[180:183], v[72:75]
    v_mfma_f32_16x16x32_bf16 v[76:79], v[96:99], v[176:179], v[76:79]
    v_mfma_f32_16x16x32_bf16 v[76:79], v[100:103], v[180:183], v[76:79]
    s_waitcnt vmcnt(18) lgkmcnt(0)
    v_mfma_f32_16x16x32_bf16 v[16:19], v[104:107], v[152:155], v[16:19]
    ds_read_b128 v[168:171], v186 offset:18432
    v_mfma_f32_16x16x32_bf16 v[16:19], v[108:111], v[156:159], v[16:19]
    ds_read_b128 v[172:175], v187 offset:18432
    v_mfma_f32_16x16x32_bf16 v[20:23], v[112:115], v[152:155], v[20:23]
    ds_read_b128 v[176:179], v186 offset:20480
    v_mfma_f32_16x16x32_bf16 v[20:23], v[116:119], v[156:159], v[20:23]
    ds_read_b128 v[180:183], v187 offset:20480
    v_mfma_f32_16x16x32_bf16 v[24:27], v[104:107], v[160:163], v[24:27]
    s_add_u32 m0, s55, 0
    s_nop 0
    buffer_load_dwordx4 v224, s[20:23], s57 offen offset:0 lds
    v_mfma_f32_16x16x32_bf16 v[24:27], v[108:111], v[164:167], v[24:27]
    v_mfma_f32_16x16x32_bf16 v[28:31], v[112:115], v[160:163], v[28:31]
    buffer_load_dwordx4 v225, s[20:23], s57 offen offset:1024 lds
    v_mfma_f32_16x16x32_bf16 v[28:31], v[116:119], v[164:167], v[28:31]
    v_mfma_f32_16x16x32_bf16 v[80:83], v[200:203], v[152:155], v[80:83]
    buffer_load_dwordx4 v226, s[20:23], s57 offen offset:2048 lds
    v_mfma_f32_16x16x32_bf16 v[80:83], v[204:207], v[156:159], v[80:83]
    v_mfma_f32_16x16x32_bf16 v[84:87], v[200:203], v[160:163], v[84:87]
    buffer_load_dwordx4 v227, s[20:23], s57 offen offset:3072 lds
    v_mfma_f32_16x16x32_bf16 v[84:87], v[204:207], v[164:167], v[84:87]
    s_waitcnt lgkmcnt(0)
    v_mfma_f32_16x16x32_bf16 v[32:35], v[104:107], v[168:171], v[32:35]
    ds_read_b128 v[152:155], v188 offset:18432
    v_mfma_f32_16x16x32_bf16 v[32:35], v[108:111], v[172:175], v[32:35]
    ds_read_b128 v[156:159], v189 offset:18432
    v_mfma_f32_16x16x32_bf16 v[36:39], v[112:115], v[168:171], v[36:39]
    ds_read_b128 v[160:163], v188 offset:20480
    v_mfma_f32_16x16x32_bf16 v[36:39], v[116:119], v[172:175], v[36:39]
    ds_read_b128 v[164:167], v189 offset:20480
    v_mfma_f32_16x16x32_bf16 v[40:43], v[104:107], v[176:179], v[40:43]
    s_add_u32 s57, s57, 128
    s_add_u32 m0, s54, 0
    s_mov_b64 exec, s[52:53]
    buffer_load_dwordx4 v223, s[16:19], s56 offen sc0 sc1 lds
    s_mov_b64 exec, -1
    v_mfma_f32_16x16x32_bf16 v[40:43], v[108:111], v[180:183], v[40:43]
    v_mfma_f32_16x16x32_bf16 v[44:47], v[112:115], v[176:179], v[44:47]
    v_mfma_f32_16x16x32_bf16 v[44:47], v[116:119], v[180:183], v[44:47]
    s_waitcnt lgkmcnt(0)
    v_mfma_f32_16x16x32_bf16 v[48:51], v[104:107], v[152:155], v[48:51]
    ds_read_b128 v[168:171], v190 offset:18432
    v_mfma_f32_16x16x32_bf16 v[48:51], v[108:111], v[156:159], v[48:51]
    ds_read_b128 v[172:175], v191 offset:18432
    v_mfma_f32_16x16x32_bf16 v[52:55], v[112:115], v[152:155], v[52:55]
    ds_read_b128 v[176:179], v190 offset:20480
    v_mfma_f32_16x16x32_bf16 v[52:55], v[116:119], v[156:159], v[52:55]
    ds_read_b128 v[180:183], v191 offset:20480
    v_mfma_f32_16x16x32_bf16 v[56:59], v[104:107], v[160:163], v[56:59]
    buffer_load_dwordx4 v[88:91], v222, s[16:19], s56 offen offset:0 sc0 sc1
    v_mfma_f32_16x16x32_bf16 v[56:59], v[108:111], v[164:167], v[56:59]
    buffer_load_dwordx4 v[92:95], v222, s[16:19], s56 offen offset:2048 sc0 sc1
    v_mfma_f32_16x16x32_bf16 v[60:63], v[112:115], v[160:163], v[60:63]
    buffer_load_dwordx4 v[96:99], v222, s[16:19], s56 offen offset:128 sc0 sc1
    v_mfma_f32_16x16x32_bf16 v[60:63], v[116:119], v[164:167], v[60:63]
    buffer_load_dwordx4 v[100:103], v222, s[16:19], s56 offen offset:2176 sc0 sc1
    s_add_u32 s56, s56, 4096
    s_waitcnt vmcnt(22)
    s_waitcnt lgkmcnt(0)
    s_barrier
    v_mfma_f32_16x16x32_bf16 v[64:67], v[104:107], v[168:171], v[64:67]
    ds_read_b128 v[152:155], v192 offset:0
    ds_read_b128 v[156:159], v193 offset:0
    v_mfma_f32_16x16x32_bf16 v[64:67], v[108:111], v[172:175], v[64:67]
    ds_read_b128 v[160:163], v192 offset:2048
    v_mfma_f32_16x16x32_bf16 v[68:71], v[112:115], v[168:171], v[68:71]
    ds_read_b128 v[164:167], v193 offset:2048
    ds_read_b128 v[200:203], v221 offset:0
    v_mfma_f32_16x16x32_bf16 v[68:71], v[116:119], v[172:175], v[68:71]
    ds_read_b128 v[204:207], v221 offset:1024
    v_mfma_f32_16x16x32_bf16 v[72:75], v[104:107], v[176:179], v[72:75]
    v_mfma_f32_16x16x32_bf16 v[72:75], v[108:111], v[180:183], v[72:75]
    v_mfma_f32_16x16x32_bf16 v[76:79], v[112:115], v[176:179], v[76:79]
    v_mfma_f32_16x16x32_bf16 v[76:79], v[116:119], v[180:183], v[76:79]
    s_waitcnt vmcnt(18) lgkmcnt(0)
    v_mfma_f32_16x16x32_bf16 v[16:19], v[120:123], v[152:155], v[16:19]
    ds_read_b128 v[168:171], v194 offset:0
    v_mfma_f32_16x16x32_bf16 v[16:19], v[124:127], v[156:159], v[16:19]
    ds_read_b128 v[172:175], v195 offset:0
    v_mfma_f32_16x16x32_bf16 v[20:23], v[128:131], v[152:155], v[20:23]
    ds_read_b128 v[176:179], v194 offset:2048
    v_mfma_f32_16x16x32_bf16 v[20:23], v[132:135], v[156:159], v[20:23]
    ds_read_b128 v[180:183], v195 offset:2048
    v_mfma_f32_16x16x32_bf16 v[24:27], v[120:123], v[160:163], v[24:27]
    s_add_u32 m0, s55, 18432
    s_nop 0
    buffer_load_dwordx4 v224, s[20:23], s57 offen offset:0 lds
    v_mfma_f32_16x16x32_bf16 v[24:27], v[124:127], v[164:167], v[24:27]
    v_mfma_f32_16x16x32_bf16 v[28:31], v[128:131], v[160:163], v[28:31]
    buffer_load_dwordx4 v225, s[20:23], s57 offen offset:1024 lds
    v_mfma_f32_16x16x32_bf16 v[28:31], v[132:135], v[164:167], v[28:31]
    v_mfma_f32_16x16x32_bf16 v[80:83], v[200:203], v[152:155], v[80:83]
    buffer_load_dwordx4 v226, s[20:23], s57 offen offset:2048 lds
    v_mfma_f32_16x16x32_bf16 v[80:83], v[204:207], v[156:159], v[80:83]
    v_mfma_f32_16x16x32_bf16 v[84:87], v[200:203], v[160:163], v[84:87]
    buffer_load_dwordx4 v227, s[20:23], s57 offen offset:3072 lds
    v_mfma_f32_16x16x32_bf16 v[84:87], v[204:207], v[164:167], v[84:87]
    s_waitcnt lgkmcnt(0)
    v_mfma_f32_16x16x32_bf16 v[32:35], v[120:123], v[168:171], v[32:35]
    ds_read_b128 v[152:155], v196 offset:0
    v_mfma_f32_16x16x32_bf16 v[32:35], v[124:127], v[172:175], v[32:35]
    ds_read_b128 v[156:159], v197 offset:0
    v_mfma_f32_16x16x32_bf16 v[36:39], v[128:131], v[168:171], v[36:39]
    ds_read_b128 v[160:163], v196 offset:2048
    v_mfma_f32_16x16x32_bf16 v[36:39], v[132:135], v[172:175], v[36:39]
    ds_read_b128 v[164:167], v197 offset:2048
    v_mfma_f32_16x16x32_bf16 v[40:43], v[120:123], v[176:179], v[40:43]
    s_add_u32 s57, s57, 128
    s_add_u32 m0, s54, 18432
    s_mov_b64 exec, s[52:53]
    buffer_load_dwordx4 v223, s[16:19], s56 offen sc0 sc1 lds
    s_mov_b64 exec, -1
    v_mfma_f32_16x16x32_bf16 v[40:43], v[124:127], v[180:183], v[40:43]
    v_mfma_f32_16x16x32_bf16 v[44:47], v[128:131], v[176:179], v[44:47]
    v_mfma_f32_16x16x32_bf16 v[44:47], v[132:135], v[180:183], v[44:47]
    s_waitcnt lgkmcnt(0)
    v_mfma_f32_16x16x32_bf16 v[48:51], v[120:123], v[152:155], v[48:51]
    ds_read_b128 v[168:171], v198 offset:0
    v_mfma_f32_16x16x32_bf16 v[48:51], v[124:127], v[156:159], v[48:51]
    ds_read_b128 v[172:175], v199 offset:0
    v_mfma_f32_16x16x32_bf16 v[52:55], v[128:131], v[152:155], v[52:55]
    ds_read_b128 v[176:179], v198 offset:2048
    v_mfma_f32_16x16x32_bf16 v[52:55], v[132:135], v[156:159], v[52:55]
    ds_read_b128 v[180:183], v199 offset:2048
    v_mfma_f32_16x16x32_bf16 v[56:59], v[120:123], v[160:163], v[56:59]
    buffer_load_dwordx4 v[104:107], v222, s[16:19], s56 offen offset:0 sc0 sc1
    v_mfma_f32_16x16x32_bf16 v[56:59], v[124:127], v[164:167], v[56:59]
    buffer_load_dwordx4 v[108:111], v222, s[16:19], s56 offen offset:2048 sc0 sc1
    v_mfma_f32_16x16x32_bf16 v[60:63], v[128:131], v[160:163], v[60:63]
    buffer_load_dwordx4 v[112:115], v222, s[16:19], s56 offen offset:128 sc0 sc1
    v_mfma_f32_16x16x32_bf16 v[60:63], v[132:135], v[164:167], v[60:63]
    buffer_load_dwordx4 v[116:119], v222, s[16:19], s56 offen offset:2176 sc0 sc1
    s_add_u32 s56, s56, 4096
    s_waitcnt vmcnt(22)
    s_waitcnt lgkmcnt(0)
    s_barrier
    v_mfma_f32_16x16x32_bf16 v[64:67], v[120:123], v[168:171], v[64:67]
    ds_read_b128 v[152:155], v192 offset:18432
    ds_read_b128 v[156:159], v193 offset:18432
    v_mfma_f32_16x16x32_bf16 v[64:67], v[124:127], v[172:175], v[64:67]
    ds_read_b128 v[160:163], v192 offset:20480
    v_mfma_f32_16x16x32_bf16 v[68:71], v[128:131], v[168:171], v[68:71]
    ds_read_b128 v[164:167], v193 offset:20480
    ds_read_b128 v[200:203], v221 offset:18432
    v_mfma_f32_16x16x32_bf16 v[68:71], v[132:135], v[172:175], v[68:71]
    ds_read_b128 v[204:207], v221 offset:19456
    v_mfma_f32_16x16x32_bf16 v[72:75], v[120:123], v[176:179], v[72:75]
    v_mfma_f32_16x16x32_bf16 v[72:75], v[124:127], v[180:183], v[72:75]
    v_mfma_f32_16x16x32_bf16 v[76:79], v[128:131], v[176:179], v[76:79]
    v_mfma_f32_16x16x32_bf16 v[76:79], v[132:135], v[180:183], v[76:79]
    s_waitcnt vmcnt(18) lgkmcnt(0)
    v_mfma_f32_16x16x32_bf16 v[16:19], v[136:139], v[152:155], v[16:19]
    ds_read_b128 v[168:171], v194 offset:18432
    v_mfma_f32_16x16x32_bf16 v[16:19], v[140:143], v[156:159], v[16:19]
    ds_read_b128 v[172:175], v195 offset:18432
    v_mfma_f32_16x16x32_bf16 v[20:23], v[144:147], v[152:155], v[20:23]
    ds_read_b128 v[176:179], v194 offset:20480
    v_mfma_f32_16x16x32_bf16 v[20:23], v[148:151], v[156:159], v[20:23]
    ds_read_b128 v[180:183], v195 offset:20480
    v_mfma_f32_16x16x32_bf16 v[24:27], v[136:139], v[160:163], v[24:27]
    s_add_u32 m0, s55, 36864
    s_nop 0
    buffer_load_dwordx4 v224, s[20:23], s57 offen offset:0 lds
    v_mfma_f32_16x16x32_bf16 v[24:27], v[140:143], v[164:167], v[24:27]
    v_mfma_f32_16x16x32_bf16 v[28:31], v[144:147], v[160:163], v[28:31]
    buffer_load_dwordx4 v225, s[20:23], s57 offen offset:1024 lds
    v_mfma_f32_16x16x32_bf16 v[28:31], v[148:151], v[164:167], v[28:31]
    v_mfma_f32_16x16x32_bf16 v[80:83], v[200:203], v[152:155], v[80:83]
    buffer_load_dwordx4 v226, s[20:23], s57 offen offset:2048 lds
    v_mfma_f32_16x16x32_bf16 v[80:83], v[204:207], v[156:159], v[80:83]
    v_mfma_f32_16x16x32_bf16 v[84:87], v[200:203], v[160:163], v[84:87]
    buffer_load_dwordx4 v227, s[20:23], s57 offen offset:3072 lds
    v_mfma_f32_16x16x32_bf16 v[84:87], v[204:207], v[164:167], v[84:87]
    s_waitcnt lgkmcnt(0)
    v_mfma_f32_16x16x32_bf16 v[32:35], v[136:139], v[168:171], v[32:35]
    ds_read_b128 v[152:155], v196 offset:18432
    v_mfma_f32_16x16x32_bf16 v[32:35], v[140:143], v[172:175], v[32:35]
    ds_read_b128 v[156:159], v197 offset:18432
    v_mfma_f32_16x16x32_bf16 v[36:39], v[144:147], v[168:171], v[36:39]
    ds_read_b128 v[160:163], v196 offset:20480
    v_mfma_f32_16x16x32_bf16 v[36:39], v[148:151], v[172:175], v[36:39]
    ds_read_b128 v[164:167], v197 offset:20480
    v_mfma_f32_16x16x32_bf16 v[40:43], v[136:139], v[176:179], v[40:43]
    s_add_u32 s57, s57, 128
    s_add_u32 m0, s54, 36864
    s_mov_b64 exec, s[52:53]
    buffer_load_dwordx4 v223, s[16:19], s56 offen sc0 sc1 lds
    s_mov_b64 exec, -1
    v_mfma_f32_16x16x32_bf16 v[40:43], v[140:143], v[180:183], v[40:43]
    v_mfma_f32_16x16x32_bf16 v[44:47], v[144:147], v[176:179], v[44:47]
    v_mfma_f32_16x16x32_bf16 v[44:47], v[148:151], v[180:183], v[44:47]
    s_waitcnt lgkmcnt(0)
    v_mfma_f32_16x16x32_bf16 v[48:51], v[136:139], v[152:155], v[48:51]
    ds_read_b128 v[168:171], v198 offset:18432
    v_mfma_f32_16x16x32_bf16 v[48:51], v[140:143], v[156:159], v[48:51]
    ds_read_b128 v[172:175], v199 offset:18432
    v_mfma_f32_16x16x32_bf16 v[52:55], v[144:147], v[152:155], v[52:55]
    ds_read_b128 v[176:179], v198 offset:20480
    v_mfma_f32_16x16x32_bf16 v[52:55], v[148:151], v[156:159], v[52:55]
    ds_read_b128 v[180:183], v199 offset:20480
    v_mfma_f32_16x16x32_bf16 v[56:59], v[136:139], v[160:163], v[56:59]
    buffer_load_dwordx4 v[120:123], v222, s[16:19], s56 offen offset:0 sc0 sc1
    v_mfma_f32_16x16x32_bf16 v[56:59], v[140:143], v[164:167], v[56:59]
    buffer_load_dwordx4 v[124:127], v222, s[16:19], s56 offen offset:2048 sc0 sc1
    v_mfma_f32_16x16x32_bf16 v[60:63], v[144:147], v[160:163], v[60:63]
    buffer_load_dwordx4 v[128:131], v222, s[16:19], s56 offen offset:128 sc0 sc1
    v_mfma_f32_16x16x32_bf16 v[60:63], v[148:151], v[164:167], v[60:63]
    buffer_load_dwordx4 v[132:135], v222, s[16:19], s56 offen offset:2176 sc0 sc1
    s_add_u32 s56, s56, 4096
    s_waitcnt vmcnt(22)
    s_waitcnt lgkmcnt(0)
    s_barrier
    v_mfma_f32_16x16x32_bf16 v[64:67], v[136:139], v[168:171], v[64:67]
    ds_read_b128 v[152:155], v184 offset:0
    ds_read_b128 v[156:159], v185 offset:0
    v_mfma_f32_16x16x32_bf16 v[64:67], v[140:143], v[172:175], v[64:67]
    ds_read_b128 v[160:163], v184 offset:2048
    v_mfma_f32_16x16x32_bf16 v[68:71], v[144:147], v[168:171], v[68:71]
    ds_read_b128 v[164:167], v185 offset:2048
    ds_read_b128 v[200:203], v220 offset:0
    v_mfma_f32_16x16x32_bf16 v[68:71], v[148:151], v[172:175], v[68:71]
    ds_read_b128 v[204:207], v220 offset:1024
    v_mfma_f32_16x16x32_bf16 v[72:75], v[136:139], v[176:179], v[72:75]
    v_mfma_f32_16x16x32_bf16 v[72:75], v[140:143], v[180:183], v[72:75]
    v_mfma_f32_16x16x32_bf16 v[76:79], v[144:147], v[176:179], v[76:79]
    v_mfma_f32_16x16x32_bf16 v[76:79], v[148:151], v[180:183], v[76:79]
    s_sub_u32 s64, s64, 1
    s_cmp_lg_u32 s64, 0
    s_cbranch_scc1 1f
    s_setprio 2
1:
    s_sub_u32 s65, s65, 1
    s_cmp_lg_u32 s65, 0
    s_cbranch_scc1 gated_mix__mha_block__mixer_gmlp__prompt_kernel_g_gl
    s_waitcnt vmcnt(18) lgkmcnt(0)
    v_mfma_f32_16x16x32_bf16 v[16:19], v[88:91], v[152:155], v[16:19]
    ds_read_b128 v[168:171], v186 offset:0
    v_mfma_f32_16x16x32_bf16 v[16:19], v[92:95], v[156:159], v[16:19]
    ds_read_b128 v[172:175], v187 offset:0
    v_mfma_f32_16x16x32_bf16 v[20:23], v[96:99], v[152:155], v[20:23]
    ds_read_b128 v[176:179], v186 offset:2048
    v_mfma_f32_16x16x32_bf16 v[20:23], v[100:103], v[156:159], v[20:23]
    ds_read_b128 v[180:183], v187 offset:2048
    v_mfma_f32_16x16x32_bf16 v[24:27], v[88:91], v[160:163], v[24:27]
    s_add_u32 m0, s55, 55296
    s_nop 0
    buffer_load_dwordx4 v224, s[20:23], s57 offen offset:0 lds
    v_mfma_f32_16x16x32_bf16 v[24:27], v[92:95], v[164:167], v[24:27]
    v_mfma_f32_16x16x32_bf16 v[28:31], v[96:99], v[160:163], v[28:31]
    buffer_load_dwordx4 v225, s[20:23], s57 offen offset:1024 lds
    v_mfma_f32_16x16x32_bf16 v[28:31], v[100:103], v[164:167], v[28:31]
    v_mfma_f32_16x16x32_bf16 v[80:83], v[200:203], v[152:155], v[80:83]
    buffer_load_dwordx4 v226, s[20:23], s57 offen offset:2048 lds
    v_mfma_f32_16x16x32_bf16 v[80:83], v[204:207], v[156:159], v[80:83]
    v_mfma_f32_16x16x32_bf16 v[84:87], v[200:203], v[160:163], v[84:87]
    buffer_load_dwordx4 v227, s[20:23], s57 offen offset:3072 lds
    v_mfma_f32_16x16x32_bf16 v[84:87], v[204:207], v[164:167], v[84:87]
    s_waitcnt lgkmcnt(0)
    v_mfma_f32_16x16x32_bf16 v[32:35], v[88:91], v[168:171], v[32:35]
    ds_read_b128 v[152:155], v188 offset:0
    v_mfma_f32_16x16x32_bf16 v[32:35], v[92:95], v[172:175], v[32:35]
    ds_read_b128 v[156:159], v189 offset:0
    v_mfma_f32_16x16x32_bf16 v[36:39], v[96:99], v[168:171], v[36:39]
    ds_read_b128 v[160:163], v188 offset:2048
    v_mfma_f32_16x16x32_bf16 v[36:39], v[100:103], v[172:175], v[36:39]
    ds_read_b128 v[164:167], v189 offset:2048
    v_mfma_f32_16x16x32_bf16 v[40:43], v[88:91], v[176:179], v[40:43]
    s_add_u32 s57, s57, 128
    s_add_u32 m0, s54, 55296
    s_mov_b64 exec, s[52:53]
    buffer_load_dwordx4 v223, s[16:19], s56 offen sc0 sc1 lds
    s_mov_b64 exec, -1
    v_mfma_f32_16x16x32_bf16 v[40:43], v[92:95], v[180:183], v[40:43]
    v_mfma_f32_16x16x32_bf16 v[44:47], v[96:99], v[176:179], v[44:47]
    v_mfma_f32_16x16x32_bf16 v[44:47], v[100:103], v[180:183], v[44:47]
    s_waitcnt lgkmcnt(0)
    v_mfma_f32_16x16x32_bf16 v[48:51], v[88:91], v[152:155], v[48:51]
    ds_read_b128 v[168:171], v190 offset:0
    v_mfma_f32_16x16x32_bf16 v[48:51], v[92:95], v[156:159], v[48:51]
    ds_read_b128 v[172:175], v191 offset:0
    v_mfma_f32_16x16x32_bf16 v[52:55], v[96:99], v[152:155], v[52:55]
    ds_read_b128 v[176:179], v190 offset:2048
    v_mfma_f32_16x16x32_bf16 v[52:55], v[100:103], v[156:159], v[52:55]
    ds_read_b128 v[180:183], v191 offset:2048
    v_mfma_f32_16x16x32_bf16 v[56:59], v[88:91], v[160:163], v[56:59]
    buffer_load_dwordx4 v[136:139], v222, s[16:19], s56 offen offset:0 sc0 sc1
    v_mfma_f32_16x16x32_bf16 v[56:59], v[92:95], v[164:167], v[56:59]
    buffer_load_dwordx4 v[140:143], v222, s[16:19], s56 offen offset:2048 sc0 sc1
    v_mfma_f32_16x16x32_bf16 v[60:63], v[96:99], v[160:163], v[60:63]
    buffer_load_dwordx4 v[144:147], v222, s[16:19], s56 offen offset:128 sc0 sc1
    v_mfma_f32_16x16x32_bf16 v[60:63], v[100:103], v[164:167], v[60:63]
    buffer_load_dwordx4 v[148:151], v222, s[16:19], s56 offen offset:2176 sc0 sc1
    s_add_u32 s56, s56, 4096
    s_waitcnt vmcnt(22)
    s_waitcnt lgkmcnt(0)
    s_barrier
    v_mfma_f32_16x16x32_bf16 v[64:67], v[88:91], v[168:171], v[64:67]
    ds_read_b128 v[152:155], v184 offset:18432
    ds_read_b128 v[156:159], v185 offset:18432
    v_mfma_f32_16x16x32_bf16 v[64:67], v[92:95], v[172:175], v[64:67]
    ds_read_b128 v[160:163], v184 offset:20480
    v_mfma_f32_16x16x32_bf16 v[68:71], v[96:99], v[168:171], v[68:71]
    ds_read_b128 v[164:167], v185 offset:20480
    ds_read_b128 v[200:203], v220 offset:18432
    v_mfma_f32_16x16x32_bf16 v[68:71], v[100:103], v[172:175], v[68:71]
    ds_read_b128 v[204:207], v220 offset:19456
    v_mfma_f32_16x16x32_bf16 v[72:75], v[88:91], v[176:179], v[72:75]
    v_mfma_f32_16x16x32_bf16 v[72:75], v[92:95], v[180:183], v[72:75]
    v_mfma_f32_16x16x32_bf16 v[76:79], v[96:99], v[176:179], v[76:79]
    v_mfma_f32_16x16x32_bf16 v[76:79], v[100:103], v[180:183], v[76:79]
    s_waitcnt vmcnt(18) lgkmcnt(0)
    v_mfma_f32_16x16x32_bf16 v[16:19], v[104:107], v[152:155], v[16:19]
    ds_read_b128 v[168:171], v186 offset:18432
    v_mfma_f32_16x16x32_bf16 v[16:19], v[108:111], v[156:159], v[16:19]
    ds_read_b128 v[172:175], v187 offset:18432
    v_mfma_f32_16x16x32_bf16 v[20:23], v[112:115], v[152:155], v[20:23]
    ds_read_b128 v[176:179], v186 offset:20480
    v_mfma_f32_16x16x32_bf16 v[20:23], v[116:119], v[156:159], v[20:23]
    ds_read_b128 v[180:183], v187 offset:20480
    v_mfma_f32_16x16x32_bf16 v[24:27], v[104:107], v[160:163], v[24:27]
    v_mfma_f32_16x16x32_bf16 v[24:27], v[108:111], v[164:167], v[24:27]
    v_mfma_f32_16x16x32_bf16 v[28:31], v[112:115], v[160:163], v[28:31]
    v_mfma_f32_16x16x32_bf16 v[28:31], v[116:119], v[164:167], v[28:31]
    v_mfma_f32_16x16x32_bf16 v[80:83], v[200:203], v[152:155], v[80:83]
    v_mfma_f32_16x16x32_bf16 v[80:83], v[204:207], v[156:159], v[80:83]
    v_mfma_f32_16x16x32_bf16 v[84:87], v[200:203], v[160:163], v[84:87]
    v_mfma_f32_16x16x32_bf16 v[84:87], v[204:207], v[164:167], v[84:87]
    s_waitcnt lgkmcnt(0)
    v_mfma_f32_16x16x32_bf16 v[32:35], v[104:107], v[168:171], v[32:35]
    ds_read_b128 v[152:155], v188 offset:18432
    v_mfma_f32_16x16x32_bf16 v[32:35], v[108:111], v[172:175], v[32:35]
    ds_read_b128 v[156:159], v189 offset:18432
    v_mfma_f32_16x16x32_bf16 v[36:39], v[112:115], v[168:171], v[36:39]
    ds_read_b128 v[160:163], v188 offset:20480
    v_mfma_f32_16x16x32_bf16 v[36:39], v[116:119], v[172:175], v[36:39]
    ds_read_b128 v[164:167], v189 offset:20480
    v_mfma_f32_16x16x32_bf16 v[40:43], v[104:107], v[176:179], v[40:43]
    buffer_load_dwordx2 v[234:235], v232, s[72:75], 0 offen sc0 sc1
    v_mfma_f32_16x16x32_bf16 v[40:43], v[108:111], v[180:183], v[40:43]
    v_mfma_f32_16x16x32_bf16 v[44:47], v[112:115], v[176:179], v[44:47]
    v_mfma_f32_16x16x32_bf16 v[44:47], v[116:119], v[180:183], v[44:47]
    s_waitcnt lgkmcnt(0)
    v_mfma_f32_16x16x32_bf16 v[48:51], v[104:107], v[152:155], v[48:51]
    ds_read_b128 v[168:171], v190 offset:18432
    v_mfma_f32_16x16x32_bf16 v[48:51], v[108:111], v[156:159], v[48:51]
    ds_read_b128 v[172:175], v191 offset:18432
    v_mfma_f32_16x16x32_bf16 v[52:55], v[112:115], v[152:155], v[52:55]
    ds_read_b128 v[176:179], v190 offset:20480
    v_mfma_f32_16x16x32_bf16 v[52:55], v[116:119], v[156:159], v[52:55]
    ds_read_b128 v[180:183], v191 offset:20480
    v_mfma_f32_16x16x32_bf16 v[56:59], v[104:107], v[160:163], v[56:59]
    v_mfma_f32_16x16x32_bf16 v[56:59], v[108:111], v[164:167], v[56:59]
    v_mfma_f32_16x16x32_bf16 v[60:63], v[112:115], v[160:163], v[60:63]
    v_mfma_f32_16x16x32_bf16 v[60:63], v[116:119], v[164:167], v[60:63]
    s_waitcnt vmcnt(14)
    s_waitcnt lgkmcnt(0)
    s_barrier
    v_mfma_f32_16x16x32_bf16 v[64:67], v[104:107], v[168:171], v[64:67]
    ds_read_b128 v[152:155], v192 offset:0
    ds_read_b128 v[156:159], v193 offset:0
    v_mfma_f32_16x16x32_bf16 v[64:67], v[108:111], v[172:175], v[64:67]
    ds_read_b128 v[160:163], v192 offset:2048
    v_mfma_f32_16x16x32_bf16 v[68:71], v[112:115], v[168:171], v[68:71]
    ds_read_b128 v[164:167], v193 offset:2048
    ds_read_b128 v[200:203], v221 offset:0
    v_mfma_f32_16x16x32_bf16 v[68:71], v[116:119], v[172:175], v[68:71]
    ds_read_b128 v[204:207], v221 offset:1024
    v_mfma_f32_16x16x32_bf16 v[72:75], v[104:107], v[176:179], v[72:75]
    v_mfma_f32_16x16x32_bf16 v[72:75], v[108:111], v[180:183], v[72:75]
    v_mfma_f32_16x16x32_bf16 v[76:79], v[112:115], v[176:179], v[76:79]
    v_mfma_f32_16x16x32_bf16 v[76:79], v[116:119], v[180:183], v[76:79]
    s_waitcnt vmcnt(0)
    v_cmp_ne_u64 vcc, s[76:77], v[234:235]
    s_nop 3
    s_cbranch_vccz gated_mix__mha_block__mixer_gmlp__prompt_kernel_g_p1_ok
    s_mov_b32 s38, 0x40000
gated_mix__mha_block__mixer_gmlp__prompt_kernel_g_p1:
    buffer_load_dwordx2 v[234:235], v232, s[72:75], 0 offen sc0 sc1
    s_waitcnt vmcnt(0)
    v_cmp_ne_u64 vcc, s[76:77], v[234:235]
    s_sub_u32 s38, s38, 1
    s_nop 2
    s_cbranch_vccz gated_mix__mha_block__mixer_gmlp__prompt_kernel_g_p1_ok
    s_cmp_eq_u32 s38, 0
    s_cbranch_scc1 gated_mix__mha_block__mixer_gmlp__prompt_kernel_g_p1_ok
    s_sleep 4
    s_branch gated_mix__mha_block__mixer_gmlp__prompt_kernel_g_p1
gated_mix__mha_block__mixer_gmlp__prompt_kernel_g_p1_ok:
    s_waitcnt lgkmcnt(0)
    v_mfma_f32_16x16x32_bf16 v[16:19], v[120:123], v[152:155], v[16:19]
    ds_read_b128 v[168:171], v194 offset:0
    v_mfma_f32_16x16x32_bf16 v[16:19], v[124:127], v[156:159], v[16:19]
    ds_read_b128 v[172:175], v195 offset:0
    v_mfma_f32_16x16x32_bf16 v[20:23], v[128:131], v[152:155], v[20:23]
    ds_read_b128 v[176:179], v194 offset:2048
    v_mfma_f32_16x16x32_bf16 v[20:23], v[132:135], v[156:159], v[20:23]
    ds_read_b128 v[180:183], v195 offset:2048
    v_mfma_f32_16x16x32_bf16 v[24:27], v[120:123], v[160:163], v[24:27]
    s_lshl_b32 s26, s24, 2
    s_lshl_b32 s27, s25, 2
    s_add_u32 s27, s27, s6
    v_lshlrev_b32 v11, 1, v3
    v_mfma_f32_16x16x32_bf16 v[24:27], v[124:127], v[164:167], v[24:27]
    v_lshlrev_b32 v10, 2, v3
    v_mfma_f32_16x16x32_bf16 v[28:31], v[128:131], v[160:163], v[28:31]
    s_xor_b32 s30, s6, 0
    s_add_u32 s30, s30, s26
    s_mul_i32 s28, s30, 72
    s_add_u32 s28, s28, s27
    s_lshl_b32 s28, s28, 11
    s_lshl_b32 s32, s30, 6
    s_lshl_b32 s33, s30, 7
    buffer_load_dwordx4 v[88:91], v208, s[44:47], s28 offen offset:0 sc0 sc1
    v_mfma_f32_16x16x32_bf16 v[28:31], v[132:135], v[164:167], v[28:31]
    buffer_load_ushort v240, v11, s[48:51], s32 offen offset:0
    v_mfma_f32_16x16x32_bf16 v[80:83], v[200:203], v[152:155], v[80:83]
    buffer_load_dword v248, v10, s[60:63], s33 offen offset:0 sc0 sc1
    v_mfma_f32_16x16x32_bf16 v[80:83], v[204:207], v[156:159], v[80:83]
    buffer_load_dwordx4 v[92:95], v208, s[44:47], s28 offen offset:256 sc0 sc1
    v_mfma_f32_16x16x32_bf16 v[84:87], v[200:203], v[160:163], v[84:87]
    buffer_load_ushort v241, v11, s[48:51], s32 offen offset:32
    v_mfma_f32_16x16x32_bf16 v[84:87], v[204:207], v[164:167], v[84:87]
    buffer_load_dword v249, v10, s[60:63], s33 offen offset:64 sc0 sc1
    s_xor_b32 s30, s6, 1
    s_add_u32 s30, s30, s26
    s_mul_i32 s28, s30, 72
    s_add_u32 s28, s28, s27
    s_lshl_b32 s28, s28, 11
    s_waitcnt lgkmcnt(0)
    v_mfma_f32_16x16x32_bf16 v[32:35], v[120:123], v[168:171], v[32:35]
    ds_read_b128 v[152:155], v196 offset:0
    v_mfma_f32_16x16x32_bf16 v[32:35], v[124:127], v[172:175], v[32:35]
    ds_read_b128 v[156:159], v197 offset:0
    v_mfma_f32_16x16x32_bf16 v[36:39], v[128:131], v[168:171], v[36:39]
    ds_read_b128 v[160:163], v196 offset:2048
    v_mfma_f32_16x16x32_bf16 v[36:39], v[132:135], v[172:175], v[36:39]
    ds_read_b128 v[164:167], v197 offset:2048
    v_mfma_f32_16x16x32_bf16 v[40:43], v[120:123], v[176:179], v[40:43]
    s_lshl_b32 s32, s30, 6
    s_lshl_b32 s33, s30, 7
    buffer_load_dwordx4 v[96:99], v208, s[44:47], s28 offen offset:0 sc0 sc1
    buffer_load_ushort v242, v11, s[48:51], s32 offen offset:0
    buffer_load_dword v250, v10, s[60:63], s33 offen offset:0 sc0 sc1
    v_mfma_f32_16x16x32_bf16 v[40:43], v[124:127], v[180:183], v[40:43]
    buffer_load_dwordx4 v[100:103], v208, s[44:47], s28 offen offset:256 sc0 sc1
    buffer_load_ushort v243, v11, s[48:51], s32 offen offset:32
    buffer_load_dword v251, v10, s[60:63], s33 offen offset:64 sc0 sc1
    v_mfma_f32_16x16x32_bf16 v[44:47], v[128:131], v[176:179], v[44:47]
    s_xor_b32 s30, s6, 2
    s_add_u32 s30, s30, s26
    s_mul_i32 s28, s30, 72
    s_add_u32 s28, s28, s27
    s_lshl_b32 s28, s28, 11
    s_lshl_b32 s32, s30, 6
    s_lshl_b32 s33, s30, 7
    buffer_load_dwordx4 v[104:107], v208, s[44:47], s28 offen offset:0 sc0 sc1
    buffer_load_ushort v244, v11, s[48:51], s32 offen offset:0
    buffer_load_dword v252, v10, s[60:63], s33 offen offset:0 sc0 sc1
    v_mfma_f32_16x16x32_bf16 v[44:47], v[132:135], v[180:183], v[44:47]
    buffer_load_dwordx4 v[108:111], v208, s[44:47], s28 offen offset:256 sc0 sc1
    buffer_load_ushort v245, v11, s[48:51], s32 offen offset:32
    buffer_load_dword v253, v10, s[60:63], s33 offen offset:64 sc0 sc1
    s_xor_b32 s30, s6, 3
    s_add_u32 s30, s30, s26
    s_mul_i32 s28, s30, 72
    s_waitcnt lgkmcnt(0)
    v_mfma_f32_16x16x32_bf16 v[48:51], v[120:123], v[152:155], v[48:51]
    ds_read_b128 v[168:171], v198 offset:0
    v_mfma_f32_16x16x32_bf16 v[48:51], v[124:127], v[156:159], v[48:51]
    ds_read_b128 v[172:175], v199 offset:0
    v_mfma_f32_16x16x32_bf16 v[52:55], v[128:131], v[152:155], v[52:55]
    ds_read_b128 v[176:179], v198 offset:2048
    v_mfma_f32_16x16x32_bf16 v[52:55], v[132:135], v[156:159], v[52:55]
    ds_read_b128 v[180:183], v199 offset:2048
    v_mfma_f32_16x16x32_bf16 v[56:59], v[120:123], v[160:163], v[56:59]
    s_add_u32 s28, s28, s27
    s_lshl_b32 s28, s28, 11
    s_lshl_b32 s32, s30, 6
    s_lshl_b32 s33, s30, 7
    buffer_load_dwordx4 v[112:115], v208, s[44:47], s28 offen offset:0 sc0 sc1
    buffer_load_ushort v246, v11, s[48:51], s32 offen offset:0
    buffer_load_dword v254, v10, s[60:63], s33 offen offset:0 sc0 sc1
    buffer_load_dwordx4 v[116:119], v208, s[44:47], s28 offen offset:256 sc0 sc1
    v_mfma_f32_16x16x32_bf16 v[56:59], v[124:127], v[164:167], v[56:59]
    buffer_load_ushort v247, v11, s[48:51], s32 offen offset:32
    buffer_load_dword v255, v10, s[60:63], s33 offen offset:64 sc0 sc1
    s_add_u32 s30, s26, s6
    s_mul_i32 s31, s30, 72
    s_add_u32 s31, s31, 64
    s_lshl_b32 s31, s31, 11
    s_lshl_b32 s32, s25, 10
    s_add_u32 s31, s31, s32
    v_lshrrev_b32 v9, 5, v0
    v_mfma_f32_16x16x32_bf16 v[60:63], v[128:131], v[160:163], v[60:63]
    v_lshlrev_b32 v9, 9, v9
    v_lshl_add_u32 v9, v3, 4, v9
    v_and_b32 v10, 1, v2
    v_mfma_f32_16x16x32_bf16 v[60:63], v[132:135], v[164:167], v[60:63]
    v_lshl_add_u32 v9, v10, 3, v9
    buffer_load_dwordx2 v[236:237], v9, s[44:47], s31 offen offset:0 sc0 sc1
    buffer_load_dwordx2 v[238:239], v9, s[44:47], s31 offen offset:256 sc0 sc1
    s_waitcnt lgkmcnt(0)
    s_barrier
    v_mfma_f32_16x16x32_bf16 v[64:67], v[120:123], v[168:171], v[64:67]
    ds_read_b128 v[152:155], v192 offset:18432
    ds_read_b128 v[156:159], v193 offset:18432
    v_mfma_f32_16x16x32_bf16 v[64:67], v[124:127], v[172:175], v[64:67]
    ds_read_b128 v[160:163], v192 offset:20480
    v_mfma_f32_16x16x32_bf16 v[68:71], v[128:131], v[168:171], v[68:71]
    ds_read_b128 v[164:167], v193 offset:20480
    ds_read_b128 v[200:203], v221 offset:18432
    v_mfma_f32_16x16x32_bf16 v[68:71], v[132:135], v[172:175], v[68:71]
    ds_read_b128 v[204:207], v221 offset:19456
    v_mfma_f32_16x16x32_bf16 v[72:75], v[120:123], v[176:179], v[72:75]
    v_mfma_f32_16x16x32_bf16 v[72:75], v[124:127], v[180:183], v[72:75]
    v_mfma_f32_16x16x32_bf16 v[76:79], v[128:131], v[176:179], v[76:79]
    v_mfma_f32_16x16x32_bf16 v[76:79], v[132:135], v[180:183], v[76:79]
    s_waitcnt lgkmcnt(0)
    v_mfma_f32_16x16x32_bf16 v[16:19], v[136:139], v[152:155], v[16:19]
    ds_read_b128 v[168:171], v194 offset:18432
    v_mfma_f32_16x16x32_bf16 v[16:19], v[140:143], v[156:159], v[16:19]
    ds_read_b128 v[172:175], v195 offset:18432
    v_mfma_f32_16x16x32_bf16 v[20:23], v[144:147], v[152:155], v[20:23]
    ds_read_b128 v[176:179], v194 offset:20480
    v_mfma_f32_16x16x32_bf16 v[20:23], v[148:151], v[156:159], v[20:23]
    ds_read_b128 v[180:183], v195 offset:20480
    v_mfma_f32_16x16x32_bf16 v[24:27], v[136:139], v[160:163], v[24:27]
    v_mfma_f32_16x16x32_bf16 v[24:27], v[140:143], v[164:167], v[24:27]
    v_mfma_f32_16x16x32_bf16 v[28:31], v[144:147], v[160:163], v[28:31]
    v_mfma_f32_16x16x32_bf16 v[28:31], v[148:151], v[164:167], v[28:31]
    v_mfma_f32_16x16x32_bf16 v[80:83], v[200:203], v[152:155], v[80:83]
    v_mfma_f32_16x16x32_bf16 v[80:83], v[204:207], v[156:159], v[80:83]
    v_mfma_f32_16x16x32_bf16 v[84:87], v[200:203], v[160:163], v[84:87]
    v_mfma_f32_16x16x32_bf16 v[84:87], v[204:207], v[164:167], v[84:87]
    s_waitcnt lgkmcnt(0)
    v_mfma_f32_16x16x32_bf16 v[32:35], v[136:139], v[168:171], v[32:35]
    ds_read_b128 v[152:155], v196 offset:18432
    v_mfma_f32_16x16x32_bf16 v[32:35], v[140:143], v[172:175], v[32:35]
    ds_read_b128 v[156:159], v197 offset:18432
    v_mfma_f32_16x16x32_bf16 v[36:39], v[144:147], v[168:171], v[36:39]
    ds_read_b128 v[160:163], v196 offset:20480
    v_mfma_f32_16x16x32_bf16 v[36:39], v[148:151], v[172:175], v[36:39]
    ds_read_b128 v[164:167], v197 offset:20480
    v_mfma_f32_16x16x32_bf16 v[40:43], v[136:139], v[176:179], v[40:43]
    v_mfma_f32_16x16x32_bf16 v[40:43], v[140:143], v[180:183], v[40:43]
    v_mfma_f32_16x16x32_bf16 v[44:47], v[144:147], v[176:179], v[44:47]
    v_mfma_f32_16x16x32_bf16 v[44:47], v[148:151], v[180:183], v[44:47]
    s_waitcnt lgkmcnt(0)
    v_mfma_f32_16x16x32_bf16 v[48:51], v[136:139], v[152:155], v[48:51]
    ds_read_b128 v[168:171], v198 offset:18432
    v_mfma_f32_16x16x32_bf16 v[48:51], v[140:143], v[156:159], v[48:51]
    ds_read_b128 v[172:175], v199 offset:18432
    v_mfma_f32_16x16x32_bf16 v[52:55], v[144:147], v[152:155], v[52:55]
    ds_read_b128 v[176:179], v198 offset:20480
    v_mfma_f32_16x16x32_bf16 v[52:55], v[148:151], v[156:159], v[52:55]
    ds_read_b128 v[180:183], v199 offset:20480
    v_mfma_f32_16x16x32_bf16 v[56:59], v[136:139], v[160:163], v[56:59]
    v_mfma_f32_16x16x32_bf16 v[56:59], v[140:143], v[164:167], v[56:59]
    v_mfma_f32_16x16x32_bf16 v[60:63], v[144:147], v[160:163], v[60:63]
    v_mfma_f32_16x16x32_bf16 v[60:63], v[148:151], v[164:167], v[60:63]
    s_waitcnt lgkmcnt(0)
    v_mfma_f32_16x16x32_bf16 v[64:67], v[136:139], v[168:171], v[64:67]
    v_mfma_f32_16x16x32_bf16 v[64:67], v[140:143], v[172:175], v[64:67]
    v_mfma_f32_16x16x32_bf16 v[68:71], v[144:147], v[168:171], v[68:71]
    v_mfma_f32_16x16x32_bf16 v[68:71], v[148:151], v[172:175], v[68:71]
    v_mfma_f32_16x16x32_bf16 v[72:75], v[136:139], v[176:179], v[72:75]
    v_mfma_f32_16x16x32_bf16 v[72:75], v[140:143], v[180:183], v[72:75]
    v_mfma_f32_16x16x32_bf16 v[76:79], v[144:147], v[176:179], v[76:79]
    v_mfma_f32_16x16x32_bf16 v[76:79], v[148:151], v[180:183], v[76:79]
    s_sub_u32 s64, s64, 1
    s_cmp_lg_u32 s64, 0
    s_cbranch_scc1 1f
    s_setprio 2
1:
    s_setprio 3
    s_waitcnt vmcnt(24)
    v_lshlrev_b32 v240, 16, v240
    s_waitcnt vmcnt(23)
    v_sub_f32 v248, 1.0, v248
    s_waitcnt vmcnt(21)
    v_lshlrev_b32 v241, 16, v241
    s_waitcnt vmcnt(20)
    v_sub_f32 v249, 1.0, v249
    s_waitcnt vmcnt(18)
    v_lshlrev_b32 v242, 16, v242
    s_waitcnt vmcnt(17)
    v_sub_f32 v250, 1.0, v250
    s_waitcnt vmcnt(15)
    v_lshlrev_b32 v243, 16, v243
    s_waitcnt vmcnt(14)
    v_sub_f32 v251, 1.0, v251
    s_waitcnt vmcnt(12)
    v_lshlrev_b32 v244, 16, v244
    s_waitcnt vmcnt(11)
    v_sub_f32 v252, 1.0, v252
    s_waitcnt vmcnt(9)
    v_lshlrev_b32 v245, 16, v245
    s_waitcnt vmcnt(8)
    v_sub_f32 v253, 1.0, v253
    s_waitcnt vmcnt(6)
    v_lshlrev_b32 v246, 16, v246
    s_waitcnt vmcnt(5)
    v_sub_f32 v254, 1.0, v254
    s_waitcnt vmcnt(3)
    v_lshlrev_b32 v247, 16, v247
    s_waitcnt vmcnt(2)
    v_sub_f32 v255, 1.0, v255
    v_mul_f32 v240, v248, v240
    v_mul_f32 v241, v249, v241
    v_mul_f32 v242, v250, v242
    v_mul_f32 v243, v251, v243
    v_mul_f32 v244, v252, v244
    v_mul_f32 v245, v253, v245
    v_mul_f32 v246, v254, v246
    v_mul_f32 v247, v255, v247
    s_mul_i32 s34, s26, 184320
    s_lshl_b32 s35, s27, 11
    s_add_u32 s34, s34, s35
    s_add_u32 s34, s34, 36864
    s_mul_i32 s36, s30, 184320
    s_lshl_b32 s37, s25, 10
    s_add_u32 s36, s36, s37
    s_add_u32 s36, s36, 167936
    v_lshlrev_b32 v156, 16, v88
    v_and_b32 v157, 0xffff0000, v88
    v_lshlrev_b32 v158, 16, v89
    v_and_b32 v159, 0xffff0000, v89
    v_lshlrev_b32 v160, 16, v90
    v_and_b32 v161, 0xffff0000, v90
    v_lshlrev_b32 v162, 16, v91
    v_and_b32 v163, 0xffff0000, v91
    v_fma_f32 v16, v16, v248, v240
    v_fma_f32 v17, v17, v248, v240
    v_fma_f32 v18, v18, v248, v240
    v_fma_f32 v19, v19, v248, v240
    v_fma_f32 v20, v20, v248, v240
    v_fma_f32 v21, v21, v248, v240
    v_fma_f32 v22, v22, v248, v240
    v_fma_f32 v23, v23, v248, v240
    v_mul_f32 v16, v16, v156
    v_mul_f32 v17, v17, v157
    v_mul_f32 v18, v18, v158
    v_mul_f32 v19, v19, v159
    v_mul_f32 v20, v20, v160
    v_mul_f32 v21, v21, v161
    v_mul_f32 v22, v22, v162
    v_mul_f32 v23, v23, v163
    v_cvt_pk_bf16_f32 v152, v16, v17
    v_cvt_pk_bf16_f32 v153, v18, v19
    v_cvt_pk_bf16_f32 v154, v20, v21
    v_cvt_pk_bf16_f32 v155, v22, v23
    s_xor_b32 s35, s6, 0
    s_mul_i32 s35, s35, 184320
    s_add_u32 s35, s35, s34
    buffer_store_dwordx4 v[152:155], v208, s[40:43], s35 offen offset:0 sc0 sc1
    v_lshlrev_b32 v168, 16, v92
    v_and_b32 v169, 0xffff0000, v92
    v_lshlrev_b32 v170, 16, v93
    v_and_b32 v171, 0xffff0000, v93
    v_lshlrev_b32 v172, 16, v94
    v_and_b32 v173, 0xffff0000, v94
    v_lshlrev_b32 v174, 16, v95
    v_and_b32 v175, 0xffff0000, v95
    v_fma_f32 v24, v24, v249, v241
    v_fma_f32 v25, v25, v249, v241
    v_fma_f32 v26, v26, v249, v241
    v_fma_f32 v27, v27, v249, v241
    v_fma_f32 v28, v28, v249, v241
    v_fma_f32 v29, v29, v249, v241
    v_fma_f32 v30, v30, v249, v241
    v_fma_f32 v31, v31, v249, v241
    v_mul_f32 v24, v24, v168
    v_mul_f32 v25, v25, v169
    v_mul_f32 v26, v26, v170
    v_mul_f32 v27, v27, v171
    v_mul_f32 v28, v28, v172
    v_mul_f32 v29, v29, v173
    v_mul_f32 v30, v30, v174
    v_mul_f32 v31, v31, v175
    v_cvt_pk_bf16_f32 v164, v24, v25
    v_cvt_pk_bf16_f32 v165, v26, v27
    v_cvt_pk_bf16_f32 v166, v28, v29
    v_cvt_pk_bf16_f32 v167, v30, v31
    s_xor_b32 s35, s6, 0
    s_mul_i32 s35, s35, 184320
    s_add_u32 s35, s35, s34
    buffer_store_dwordx4 v[164:167], v208, s[40:43], s35 offen offset:256 sc0 sc1
    v_lshlrev_b32 v180, 16, v96
    v_and_b32 v181, 0xffff0000, v96
    v_lshlrev_b32 v182, 16, v97
    v_and_b32 v183, 0xffff0000, v97
    v_lshlrev_b32 v184, 16, v98
    v_and_b32 v185, 0xffff0000, v98
    v_lshlrev_b32 v186, 16, v99
    v_and_b32 v187, 0xffff0000, v99
    v_fma_f32 v32, v32, v250, v242
    v_fma_f32 v33, v33, v250, v242
    v_fma_f32 v34, v34, v250, v242
    v_fma_f32 v35, v35, v250, v242
    v_fma_f32 v36, v36, v250, v242
    v_fma_f32 v37, v37, v250, v242
    v_fma_f32 v38, v38, v250, v242
    v_fma_f32 v39, v39, v250, v242
    v_mul_f32 v32, v32, v180
    v_mul_f32 v33, v33, v181
    v_mul_f32 v34, v34, v182
    v_mul_f32 v35, v35, v183
    v_mul_f32 v36, v36, v184
    v_mul_f32 v37, v37, v185
    v_mul_f32 v38, v38, v186
    v_mul_f32 v39, v39, v187
    v_cvt_pk_bf16_f32 v176, v32, v33
    v_cvt_pk_bf16_f32 v177, v34, v35
    v_cvt_pk_bf16_f32 v178, v36, v37
    v_cvt_pk_bf16_f32 v179, v38, v39
    s_xor_b32 s35, s6, 1
    s_mul_i32 s35, s35, 184320
    s_add_u32 s35, s35, s34
    buffer_store_dwordx4 v[176:179], v208, s[40:43], s35 offen offset:0 sc0 sc1
    v_lshlrev_b32 v192, 16, v100
    v_and_b32 v193, 0xffff0000, v100
    v_lshlrev_b32 v194, 16, v101
    v_and_b32 v195, 0xffff0000, v101
    v_lshlrev_b32 v196, 16, v102
    v_and_b32 v197, 0xffff0000, v102
    v_lshlrev_b32 v198, 16, v103
    v_and_b32 v199, 0xffff0000, v103
    v_fma_f32 v40, v40, v251, v243
    v_fma_f32 v41, v41, v251, v243
    v_fma_f32 v42, v42, v251, v243
    v_fma_f32 v43, v43, v251, v243
    v_fma_f32 v44, v44, v251, v243
    v_fma_f32 v45, v45, v251, v243
    v_fma_f32 v46, v46, v251, v243
    v_fma_f32 v47, v47, v251, v243
    v_mul_f32 v40, v40, v192
    v_mul_f32 v41, v41, v193
    v_mul_f32 v42, v42, v194
    v_mul_f32 v43, v43, v195
    v_mul_f32 v44, v44, v196
    v_mul_f32 v45, v45, v197
    v_mul_f32 v46, v46, v198
    v_mul_f32 v47, v47, v199
    v_cvt_pk_bf16_f32 v188, v40, v41
    v_cvt_pk_bf16_f32 v189, v42, v43
    v_cvt_pk_bf16_f32 v190, v44, v45
    v_cvt_pk_bf16_f32 v191, v46, v47
    s_xor_b32 s35, s6, 1
    s_mul_i32 s35, s35, 184320
    s_add_u32 s35, s35, s34
    buffer_store_dwordx4 v[188:191], v208, s[40:43], s35 offen offset:256 sc0 sc1
    v_lshlrev_b32 v156, 16, v104
    v_and_b32 v157, 0xffff0000, v104
    v_lshlrev_b32 v158, 16, v105
    v_and_b32 v159, 0xffff0000, v105
    v_lshlrev_b32 v160, 16, v106
    v_and_b32 v161, 0xffff0000, v106
    v_lshlrev_b32 v162, 16, v107
    v_and_b32 v163, 0xffff0000, v107
    v_fma_f32 v48, v48, v252, v244
    v_fma_f32 v49, v49, v252, v244
    v_fma_f32 v50, v50, v252, v244
    v_fma_f32 v51, v51, v252, v244
    v_fma_f32 v52, v52, v252, v244
    v_fma_f32 v53, v53, v252, v244
    v_fma_f32 v54, v54, v252, v244
    v_fma_f32 v55, v55, v252, v244
    v_mul_f32 v48, v48, v156
    v_mul_f32 v49, v49, v157
    v_mul_f32 v50, v50, v158
    v_mul_f32 v51, v51, v159
    v_mul_f32 v52, v52, v160
    v_mul_f32 v53, v53, v161
    v_mul_f32 v54, v54, v162
    v_mul_f32 v55, v55, v163
    v_cvt_pk_bf16_f32 v152, v48, v49
    v_cvt_pk_bf16_f32 v153, v50, v51
    v_cvt_pk_bf16_f32 v154, v52, v53
    v_cvt_pk_bf16_f32 v155, v54, v55
    s_xor_b32 s35, s6, 2
    s_mul_i32 s35, s35, 184320
    s_add_u32 s35, s35, s34
    buffer_store_dwordx4 v[152:155], v208, s[40:43], s35 offen offset:0 sc0 sc1
    v_lshlrev_b32 v168, 16, v108
    v_and_b32 v169, 0xffff0000, v108
    v_lshlrev_b32 v170, 16, v109
    v_and_b32 v171, 0xffff0000, v109
    v_lshlrev_b32 v172, 16, v110
    v_and_b32 v173, 0xffff0000, v110
    v_lshlrev_b32 v174, 16, v111
    v_and_b32 v175, 0xffff0000, v111
    v_fma_f32 v56, v56, v253, v245
    v_fma_f32 v57, v57, v253, v245
    v_fma_f32 v58, v58, v253, v245
    v_fma_f32 v59, v59, v253, v245
    v_fma_f32 v60, v60, v253, v245
    v_fma_f32 v61, v61, v253, v245
    v_fma_f32 v62, v62, v253, v245
    v_fma_f32 v63, v63, v253, v245
    v_mul_f32 v56, v56, v168
    v_mul_f32 v57, v57, v169
    v_mul_f32 v58, v58, v170
    v_mul_f32 v59, v59, v171
    v_mul_f32 v60, v60, v172
    v_mul_f32 v61, v61, v173
    v_mul_f32 v62, v62, v174
    v_mul_f32 v63, v63, v175
    v_cvt_pk_bf16_f32 v164, v56, v57
    v_cvt_pk_bf16_f32 v165, v58, v59
    v_cvt_pk_bf16_f32 v166, v60, v61
    v_cvt_pk_bf16_f32 v167, v62, v63
    s_xor_b32 s35, s6, 2
    s_mul_i32 s35, s35, 184320
    s_add_u32 s35, s35, s34
    buffer_store_dwordx4 v[164:167], v208, s[40:43], s35 offen offset:256 sc0 sc1
    v_lshlrev_b32 v180, 16, v112
    v_and_b32 v181, 0xffff0000, v112
    v_lshlrev_b32 v182, 16, v113
    v_and_b32 v183, 0xffff0000, v113
    v_lshlrev_b32 v184, 16, v114
    v_and_b32 v185, 0xffff0000, v114
    v_lshlrev_b32 v186, 16, v115
    v_and_b32 v187, 0xffff0000, v115
    v_fma_f32 v64, v64, v254, v246
    v_fma_f32 v65, v65, v254, v246
    v_fma_f32 v66, v66, v254, v246
    v_fma_f32 v67, v67, v254, v246
    v_fma_f32 v68, v68, v254, v246
    v_fma_f32 v69, v69, v254, v246
    v_fma_f32 v70, v70, v254, v246
    v_fma_f32 v71, v71, v254, v246
    v_mul_f32 v64, v64, v180
    v_mul_f32 v65, v65, v181
    v_mul_f32 v66, v66, v182
    v_mul_f32 v67, v67, v183
    v_mul_f32 v68, v68, v184
    v_mul_f32 v69, v69, v185
    v_mul_f32 v70, v70, v186
    v_mul_f32 v71, v71, v187
    v_cvt_pk_bf16_f32 v176, v64, v65
    v_cvt_pk_bf16_f32 v177, v66, v67
    v_cvt_pk_bf16_f32 v178, v68, v69
    v_cvt_pk_bf16_f32 v179, v70, v71
    s_xor_b32 s35, s6, 3
    s_mul_i32 s35, s35, 184320
    s_add_u32 s35, s35, s34
    buffer_store_dwordx4 v[176:179], v208, s[40:43], s35 offen offset:0 sc0 sc1
    v_lshlrev_b32 v192, 16, v116
    v_and_b32 v193, 0xffff0000, v116
    v_lshlrev_b32 v194, 16, v117
    v_and_b32 v195, 0xffff0000, v117
    v_lshlrev_b32 v196, 16, v118
    v_and_b32 v197, 0xffff0000, v118
    v_lshlrev_b32 v198, 16, v119
    v_and_b32 v199, 0xffff0000, v119
    v_fma_f32 v72, v72, v255, v247
    v_fma_f32 v73, v73, v255, v247
    v_fma_f32 v74, v74, v255, v247
    v_fma_f32 v75, v75, v255, v247
    v_fma_f32 v76, v76, v255, v247
    v_fma_f32 v77, v77, v255, v247
    v_fma_f32 v78, v78, v255, v247
    v_fma_f32 v79, v79, v255, v247
    v_mul_f32 v72, v72, v192
    v_mul_f32 v73, v73, v193
    v_mul_f32 v74, v74, v194
    v_mul_f32 v75, v75, v195
    v_mul_f32 v76, v76, v196
    v_mul_f32 v77, v77, v197
    v_mul_f32 v78, v78, v198
    v_mul_f32 v79, v79, v199
    v_cvt_pk_bf16_f32 v188, v72, v73
    v_cvt_pk_bf16_f32 v189, v74, v75
    v_cvt_pk_bf16_f32 v190, v76, v77
    v_cvt_pk_bf16_f32 v191, v78, v79
    s_xor_b32 s35, s6, 3
    s_mul_i32 s35, s35, 184320
    s_add_u32 s35, s35, s34
    buffer_store_dwordx4 v[188:191], v208, s[40:43], s35 offen offset:256 sc0 sc1
    s_waitcnt vmcnt(9)
    v_lshlrev_b32 v156, 16, v236
    v_and_b32 v157, 0xffff0000, v236
    v_lshlrev_b32 v158, 16, v237
    v_and_b32 v159, 0xffff0000, v237
    v_fma_f32 v80, v80, v248, v240
    v_fma_f32 v81, v81, v248, v240
    v_fma_f32 v82, v82, v248, v240
    v_fma_f32 v83, v83, v248, v240
    v_mul_f32 v80, v80, v156
    v_mul_f32 v81, v81, v157
    v_mul_f32 v82, v82, v158
    v_mul_f32 v83, v83, v159
    v_cvt_pk_bf16_f32 v152, v80, v81
    v_cvt_pk_bf16_f32 v153, v82, v83
    buffer_store_dwordx2 v[152:153], v9, s[40:43], s36 offen offset:0 sc0 sc1
    s_waitcnt vmcnt(9)
    v_lshlrev_b32 v168, 16, v238
    v_and_b32 v169, 0xffff0000, v238
    v_lshlrev_b32 v170, 16, v239
    v_and_b32 v171, 0xffff0000, v239
    v_fma_f32 v84, v84, v249, v241
    v_fma_f32 v85, v85, v249, v241
    v_fma_f32 v86, v86, v249, v241
    v_fma_f32 v87, v87, v249, v241
    v_mul_f32 v84, v84, v168
    v_mul_f32 v85, v85, v169
    v_mul_f32 v86, v86, v170
    v_mul_f32 v87, v87, v171
    v_cvt_pk_bf16_f32 v164, v84, v85
    v_cvt_pk_bf16_f32 v165, v86, v87
    buffer_store_dwordx2 v[164:165], v9, s[40:43], s36 offen offset:256 sc0 sc1
    s_add_u32 s16, s68, 0
    s_addc_u32 s17, s69, 0
    s_mov_b32 s18, 2654208
    s_mov_b32 s19, 0x00020000
    s_add_u32 s20, s66, 0
    s_addc_u32 s21, s67, 0
    s_mov_b32 s22, 663552
    s_mov_b32 s23, 0x00020000
    s_add_u32 s48, s70, 0
    s_addc_u32 s49, s71, 0
    s_mov_b32 s50, 2359296
    s_mov_b32 s51, 0x00020000
    s_add_u32 s44, s14, 40108032
    s_addc_u32 s45, s15, 0
    s_mov_b32 s46, 262144
    s_mov_b32 s47, 0x00020000
    s_movk_i32 s35, 1152
    s_lshl_b32 s37, s78, 7
    s_lshl_b32 s54, s6, 12
    v_lshrrev_b32 v4, 3, v0
    v_and_b32 v5, 7, v0
    v_and_b32 v6, 2, v4
    v_xor_b32 v5, v5, v6
    s_lshl_b32 s36, s24, 4
    s_add_u32 s36, s36, s25
    s_add_u32 s36, s36, 1024
    s_mul_i32 s32, s3, 30
    s_add_u32 s32, s32, s4
    s_cmp_ge_u32 s4, 30
    s_cselect_b32 s32, 999, s32
    s_cmp_lt_u32 s32, 234
    s_cbranch_scc1 gated_mix__mha_block__mixer_gmlp__prompt_kernel_g_go
    s_lshl_b32 s39, s36, 7
    s_lshl_b32 s38, s6, 6
    v_add_lshl_u32 v10, v0, s38, 20
    v_mov_b32 v12, s76
    v_mov_b32 v13, s77
    s_waitcnt vmcnt(0)
    s_barrier
    buffer_store_dwordx2 v[12:13], v10, s[72:75], s39 offen sc0 sc1
    s_branch gated_mix__mha_block__mixer_gmlp__prompt_kernel_g_done
gated_mix__mha_block__mixer_gmlp__prompt_kernel_g_go:
    v_add_u32 v6, 0, v4
    v_mul_lo_u32 v6, v6, s35
    v_xor_b32 v7, 0, v5
    v_lshl_add_u32 v6, v7, 4, v6
    v_add_u32 v6, s37, v6
    v_subrev_u32 v213, 0, v6
    v_add_u32 v6, 8, v4
    v_mul_lo_u32 v6, v6, s35
    v_xor_b32 v7, 4, v5
    v_lshl_add_u32 v6, v7, 4, v6
    v_add_u32 v6, s37, v6
    v_subrev_u32 v214, 1024, v6
    v_add_u32 v6, 16, v4
    v_mul_lo_u32 v6, v6, s35
    v_xor_b32 v7, 0, v5
    v_lshl_add_u32 v6, v7, 4, v6
    v_add_u32 v6, s37, v6
    v_subrev_u32 v215, 2048, v6
    v_add_u32 v6, 24, v4
    v_mul_lo_u32 v6, v6, s35
    v_xor_b32 v7, 4, v5
    v_lshl_add_u32 v6, v7, 4, v6
    v_add_u32 v6, s37, v6
    v_subrev_u32 v216, 3072, v6
    s_mul_i32 s57, s6, 36864
    s_add_u32 m0, s54, 0
    s_nop 0
    buffer_load_dwordx4 v213, s[16:19], s57 offen offset:0 lds
    buffer_load_dwordx4 v214, s[16:19], s57 offen offset:1024 lds
    buffer_load_dwordx4 v215, s[16:19], s57 offen offset:2048 lds
    buffer_load_dwordx4 v216, s[16:19], s57 offen offset:3072 lds
    s_add_u32 s57, s57, 147456
    s_add_u32 m0, s54, 16384
    s_nop 0
    buffer_load_dwordx4 v213, s[16:19], s57 offen offset:0 lds
    buffer_load_dwordx4 v214, s[16:19], s57 offen offset:1024 lds
    buffer_load_dwordx4 v215, s[16:19], s57 offen offset:2048 lds
    buffer_load_dwordx4 v216, s[16:19], s57 offen offset:3072 lds
    s_add_u32 s57, s57, 147456
    s_add_u32 m0, s54, 32768
    s_nop 0
    buffer_load_dwordx4 v213, s[16:19], s57 offen offset:0 lds
    buffer_load_dwordx4 v214, s[16:19], s57 offen offset:1024 lds
    buffer_load_dwordx4 v215, s[16:19], s57 offen offset:2048 lds
    buffer_load_dwordx4 v216, s[16:19], s57 offen offset:3072 lds
    s_add_u32 s57, s57, 147456
    s_mul_i32 s30, s13, 5
    v_lshlrev_b32 v6, 9, v2
    v_lshl_add_u32 v6, v3, 4, v6
    s_add_u32 s32, s30, 0
    s_lshr_b32 s33, s32, 1
    s_mul_i32 s33, s33, 184320
    s_and_b32 s32, s32, 1
    s_lshl_b32 s32, s32, 8
    s_add_u32 s33, s33, s32
    v_add_u32 v208, s33, v6
    s_add_u32 s32, s30, 1
    s_lshr_b32 s33, s32, 1
    s_mul_i32 s33, s33, 184320
    s_and_b32 s32, s32, 1
    s_lshl_b32 s32, s32, 8
    s_add_u32 s33, s33, s32
    v_add_u32 v209, s33, v6
    s_add_u32 s32, s30, 2
    s_lshr_b32 s33, s32, 1
    s_mul_i32 s33, s33, 184320
    s_and_b32 s32, s32, 1
    s_lshl_b32 s32, s32, 8
    s_add_u32 s33, s33, s32
    v_add_u32 v210, s33, v6
    s_add_u32 s32, s30, 3
    s_lshr_b32 s33, s32, 1
    s_mul_i32 s33, s33, 184320
    s_and_b32 s32, s32, 1
    s_lshl_b32 s32, s32, 8
    s_add_u32 s33, s33, s32
    v_add_u32 v211, s33, v6
    s_add_u32 s32, s30, 4
    s_lshr_b32 s33, s32, 1
    s_mul_i32 s33, s33, 184320
    s_and_b32 s32, s32, 1
    s_lshl_b32 s32, s32, 8
    s_add_u32 s33, s33, s32
    v_add_u32 v212, s33, v6
    v_bfe_u32 v6, v0, 2, 2
    v_lshl_add_u32 v7, v2, 3, v6
    v_lshlrev_b32 v7, 7, v7
    v_lshrrev_b32 v8, 1, v6
    v_and_b32 v9, 1, v2
    v_lshl_or_b32 v8, v9, 1, v8
    v_xor_b32 v8, s6, v8
    v_lshl_add_u32 v7, v8, 5, v7
    v_and_b32 v6, 3, v0
    v_lshl_add_u32 v7, v6, 3, v7
    v_add_u32 v220, s54, v7
    v_xor_b32 v221, 32, v220
    v_xor_b32 v222, 64, v220
    v_xor_b32 v223, 96, v220
    v_add_lshl_u32 v6, v3, s58, 2
    v_lshl_add_u32 v217, v2, 15, v6
    v_add_u32 v224, 65536, v220
    v_add_u32 v225, 65536, v221
    v_add_u32 v226, 65536, v222
    v_add_u32 v227, 65536, v223
    s_lshl_b32 s39, s36, 7
    s_lshl_b32 s38, s6, 6
    v_add_lshl_u32 v10, v0, s38, 20
    v_mov_b32 v12, s76
    v_mov_b32 v13, s77
    s_waitcnt vmcnt(12)
    s_barrier
    buffer_store_dwordx2 v[12:13], v10, s[72:75], s39 offen sc0 sc1
    s_waitcnt vmcnt(1)
    ds_read_b64_tr_b16 v[176:177], v220 offset:0
    ds_read_b64_tr_b16 v[178:179], v220 offset:512
    ds_read_b64_tr_b16 v[180:181], v221 offset:0
    ds_read_b64_tr_b16 v[182:183], v221 offset:512
    ds_read_b64_tr_b16 v[184:185], v222 offset:0
    ds_read_b64_tr_b16 v[186:187], v222 offset:512
    ds_read_b64_tr_b16 v[188:189], v223 offset:0
    ds_read_b64_tr_b16 v[190:191], v223 offset:512
    ds_read_b64_tr_b16 v[192:193], v220 offset:16384
    ds_read_b64_tr_b16 v[194:195], v220 offset:16896
    ds_read_b64_tr_b16 v[196:197], v221 offset:16384
    ds_read_b64_tr_b16 v[198:199], v221 offset:16896
    ds_read_b64_tr_b16 v[200:201], v222 offset:16384
    ds_read_b64_tr_b16 v[202:203], v222 offset:16896
    ds_read_b64_tr_b16 v[204:205], v223 offset:16384
    s_waitcnt lgkmcnt(14)
    ds_read_b64_tr_b16 v[206:207], v223 offset:16896
    s_waitcnt lgkmcnt(14)
    ds_read_b64_tr_b16 v[236:237], v220 offset:32768
    s_waitcnt lgkmcnt(14)
    ds_read_b64_tr_b16 v[238:239], v220 offset:33280
    s_waitcnt lgkmcnt(14)
    ds_read_b64_tr_b16 v[240:241], v221 offset:32768
    s_waitcnt lgkmcnt(14)
    ds_read_b64_tr_b16 v[242:243], v221 offset:33280
    s_waitcnt lgkmcnt(14)
    ds_read_b64_tr_b16 v[244:245], v222 offset:32768
    s_waitcnt lgkmcnt(14)
    ds_read_b64_tr_b16 v[246:247], v222 offset:33280
    s_waitcnt lgkmcnt(14)
    ds_read_b64_tr_b16 v[248:249], v223 offset:32768
    s_waitcnt lgkmcnt(14)
    ds_read_b64_tr_b16 v[250:251], v223 offset:33280
    s_waitcnt lgkmcnt(0)
    s_cmp_eq_u32 s6, 0
    s_cbranch_scc1 gated_mix__mha_block__mixer_gmlp__prompt_kernel_g_w0
    s_add_u32 m0, s54, 49152
    s_nop 0
    buffer_load_dwordx4 v213, s[16:19], s57 offen offset:0 lds
    buffer_load_dwordx4 v214, s[16:19], s57 offen offset:1024 lds
    buffer_load_dwordx4 v215, s[16:19], s57 offen offset:2048 lds
    buffer_load_dwordx4 v216, s[16:19], s57 offen offset:3072 lds
    s_add_u32 s57, s57, 147456
    s_add_u32 m0, s54, 65536
    s_nop 0
    buffer_load_dwordx4 v213, s[16:19], s57 offen offset:0 lds
    buffer_load_dwordx4 v214, s[16:19], s57 offen offset:1024 lds
    buffer_load_dwordx4 v215, s[16:19], s57 offen offset:2048 lds
    buffer_load_dwordx4 v216, s[16:19], s57 offen offset:3072 lds
    s_add_u32 s57, s57, 147456
    s_add_u32 m0, s54, 0
    s_nop 0
    buffer_load_dwordx4 v213, s[16:19], s57 offen offset:0 lds
    buffer_load_dwordx4 v214, s[16:19], s57 offen offset:1024 lds
    buffer_load_dwordx4 v215, s[16:19], s57 offen offset:2048 lds
    buffer_load_dwordx4 v216, s[16:19], s57 offen offset:3072 lds
    s_add_u32 s57, s57, 147456
    s_add_u32 m0, s54, 16384
    s_nop 0
    buffer_load_dwordx4 v213, s[16:19], s57 offen offset:0 lds
    buffer_load_dwordx4 v214, s[16:19], s57 offen offset:1024 lds
    buffer_load_dwordx4 v215, s[16:19], s57 offen offset:2048 lds
    buffer_load_dwordx4 v216, s[16:19], s57 offen offset:3072 lds
    s_add_u32 s57, s57, 147456
    s_add_u32 m0, s54, 32768
    s_nop 0
    buffer_load_dwordx4 v213, s[16:19], s57 offen offset:0 lds
    buffer_load_dwordx4 v214, s[16:19], s57 offen offset:1024 lds
    buffer_load_dwordx4 v215, s[16:19], s57 offen offset:2048 lds
    buffer_load_dwordx4 v216, s[16:19], s57 offen offset:3072 lds
    s_add_u32 s57, s57, 147456
    s_barrier
    s_branch gated_mix__mha_block__mixer_gmlp__prompt_kernel_g_w1
gated_mix__mha_block__mixer_gmlp__prompt_kernel_g_w0:
    s_add_u32 m0, s54, 49152
    s_nop 0
    buffer_load_dwordx4 v213, s[16:19], s57 offen offset:0 lds
    buffer_load_dwordx4 v214, s[16:19], s57 offen offset:1024 lds
    buffer_load_dwordx4 v215, s[16:19], s57 offen offset:2048 lds
    buffer_load_dwordx4 v216, s[16:19], s57 offen offset:3072 lds
    s_add_u32 s57, s57, 147456
    s_add_u32 m0, s54, 65536
    s_nop 0
    buffer_load_dwordx4 v213, s[16:19], s57 offen offset:0 lds
    buffer_load_dwordx4 v214, s[16:19], s57 offen offset:1024 lds
    buffer_load_dwordx4 v215, s[16:19], s57 offen offset:2048 lds
    buffer_load_dwordx4 v216, s[16:19], s57 offen offset:3072 lds
    s_add_u32 s57, s57, 147456
    s_add_u32 m0, s54, 0
    s_nop 0
    buffer_load_dwordx4 v213, s[16:19], s57 offen offset:0 lds
    buffer_load_dwordx4 v214, s[16:19], s57 offen offset:1024 lds
    buffer_load_dwordx4 v215, s[16:19], s57 offen offset:2048 lds
    buffer_load_dwordx4 v216, s[16:19], s57 offen offset:3072 lds
    s_add_u32 s57, s57, 147456
    s_add_u32 m0, s54, 16384
    s_nop 0
    buffer_load_dwordx4 v213, s[16:19], s57 offen offset:0 lds
    buffer_load_dwordx4 v214, s[16:19], s57 offen offset:1024 lds
    buffer_load_dwordx4 v215, s[16:19], s57 offen offset:2048 lds
    buffer_load_dwordx4 v216, s[16:19], s57 offen offset:3072 lds
    s_add_u32 s57, s57, 147456
    s_add_u32 m0, s54, 32768
    s_nop 0
    buffer_load_dwordx4 v213, s[16:19], s57 offen offset:0 lds
    buffer_load_dwordx4 v214, s[16:19], s57 offen offset:1024 lds
    buffer_load_dwordx4 v215, s[16:19], s57 offen offset:2048 lds
    buffer_load_dwordx4 v216, s[16:19], s57 offen offset:3072 lds
    s_add_u32 s57, s57, 147456
    s_mov_b32 s38, 0x40000
gated_mix__mha_block__mixer_gmlp__prompt_kernel_g_pu:
    buffer_load_dwordx2 v[234:235], v230, s[72:75], 0 offen sc0 sc1
    s_waitcnt vmcnt(0)
    v_cmp_ne_u64 vcc, s[76:77], v[234:235]
    s_sub_u32 s38, s38, 1
    s_nop 2
    s_cbranch_vccz gated_mix__mha_block__mixer_gmlp__prompt_kernel_g_pu_ok
    s_cmp_eq_u32 s38, 0
    s_cbranch_scc1 gated_mix__mha_block__mixer_gmlp__prompt_kernel_g_pu_ok
    s_sleep 2
    s_branch gated_mix__mha_block__mixer_gmlp__prompt_kernel_g_pu
gated_mix__mha_block__mixer_gmlp__prompt_kernel_g_pu_ok:
    s_barrier
gated_mix__mha_block__mixer_gmlp__prompt_kernel_g_w1:
    s_lshl_b32 s56, s6, 11
    s_add_u32 s56, s56, 36864
    buffer_load_dwordx4 v[96:99], v208, s[40:43], s56 offen sc0 sc1
    buffer_load_dwordx4 v[100:103], v209, s[40:43], s56 offen sc0 sc1
    buffer_load_dwordx4 v[104:107], v210, s[40:43], s56 offen sc0 sc1
    buffer_load_dwordx4 v[108:111], v211, s[40:43], s56 offen sc0 sc1
    buffer_load_dwordx4 v[112:115], v212, s[40:43], s56 offen sc0 sc1
    s_add_u32 s56, s56, 8192
    buffer_load_dwordx4 v[116:119], v208, s[40:43], s56 offen sc0 sc1
    buffer_load_dwordx4 v[120:123], v209, s[40:43], s56 offen sc0 sc1
    buffer_load_dwordx4 v[124:127], v210, s[40:43], s56 offen sc0 sc1
    buffer_load_dwordx4 v[128:131], v211, s[40:43], s56 offen sc0 sc1
    buffer_load_dwordx4 v[132:135], v212, s[40:43], s56 offen sc0 sc1
    s_add_u32 s56, s56, 8192
    buffer_load_dwordx4 v[136:139], v208, s[40:43], s56 offen sc0 sc1
    buffer_load_dwordx4 v[140:143], v209, s[40:43], s56 offen sc0 sc1
    buffer_load_dwordx4 v[144:147], v210, s[40:43], s56 offen sc0 sc1
    buffer_load_dwordx4 v[148:151], v211, s[40:43], s56 offen sc0 sc1
    buffer_load_dwordx4 v[152:155], v212, s[40:43], s56 offen sc0 sc1
    s_add_u32 s56, s56, 8192
    buffer_load_dwordx4 v[156:159], v208, s[40:43], s56 offen sc0 sc1
    buffer_load_dwordx4 v[160:163], v209, s[40:43], s56 offen sc0 sc1
    buffer_load_dwordx4 v[164:167], v210, s[40:43], s56 offen sc0 sc1
    buffer_load_dwordx4 v[168:171], v211, s[40:43], s56 offen sc0 sc1
    buffer_load_dwordx4 v[172:175], v212, s[40:43], s56 offen sc0 sc1
    s_add_u32 s56, s56, 8192
    s_setprio 1
    s_waitcnt vmcnt(19)
    v_mfma_f32_16x16x32_bf16 v[16:19], v[176:179], v[96:99], 0
    v_mfma_f32_16x16x32_bf16 v[36:39], v[180:183], v[96:99], 0
    v_mfma_f32_16x16x32_bf16 v[56:59], v[184:187], v[96:99], 0
    v_mfma_f32_16x16x32_bf16 v[76:79], v[188:191], v[96:99], 0
    s_waitcnt vmcnt(18)
    v_mfma_f32_16x16x32_bf16 v[20:23], v[176:179], v[100:103], 0
    v_mfma_f32_16x16x32_bf16 v[40:43], v[180:183], v[100:103], 0
    v_mfma_f32_16x16x32_bf16 v[60:63], v[184:187], v[100:103], 0
    v_mfma_f32_16x16x32_bf16 v[80:83], v[188:191], v[100:103], 0
    s_waitcnt vmcnt(17)
    v_mfma_f32_16x16x32_bf16 v[24:27], v[176:179], v[104:107], 0
    v_mfma_f32_16x16x32_bf16 v[44:47], v[180:183], v[104:107], 0
    v_mfma_f32_16x16x32_bf16 v[64:67], v[184:187], v[104:107], 0
    v_mfma_f32_16x16x32_bf16 v[84:87], v[188:191], v[104:107], 0
    s_waitcnt vmcnt(16)
    v_mfma_f32_16x16x32_bf16 v[28:31], v[176:179], v[108:111], 0
    v_mfma_f32_16x16x32_bf16 v[48:51], v[180:183], v[108:111], 0
    v_mfma_f32_16x16x32_bf16 v[68:71], v[184:187], v[108:111], 0
    v_mfma_f32_16x16x32_bf16 v[88:91], v[188:191], v[108:111], 0
    s_waitcnt vmcnt(15)
    v_mfma_f32_16x16x32_bf16 v[32:35], v[176:179], v[112:115], 0
    v_mfma_f32_16x16x32_bf16 v[52:55], v[180:183], v[112:115], 0
    v_mfma_f32_16x16x32_bf16 v[72:75], v[184:187], v[112:115], 0
    v_mfma_f32_16x16x32_bf16 v[92:95], v[188:191], v[112:115], 0
    s_waitcnt vmcnt(14)
    v_mfma_f32_16x16x32_bf16 v[16:19], v[192:195], v[116:119], v[16:19]
    v_mfma_f32_16x16x32_bf16 v[36:39], v[196:199], v[116:119], v[36:39]
    v_mfma_f32_16x16x32_bf16 v[56:59], v[200:203], v[116:119], v[56:59]
    v_mfma_f32_16x16x32_bf16 v[76:79], v[204:207], v[116:119], v[76:79]
    buffer_load_dwordx4 v[96:99], v208, s[40:43], s56 offen sc0 sc1
    s_waitcnt vmcnt(14)
    v_mfma_f32_16x16x32_bf16 v[20:23], v[192:195], v[120:123], v[20:23]
    v_mfma_f32_16x16x32_bf16 v[40:43], v[196:199], v[120:123], v[40:43]
    v_mfma_f32_16x16x32_bf16 v[60:63], v[200:203], v[120:123], v[60:63]
    buffer_load_dwordx4 v[100:103], v209, s[40:43], s56 offen sc0 sc1
    v_mfma_f32_16x16x32_bf16 v[80:83], v[204:207], v[120:123], v[80:83]
    s_waitcnt vmcnt(14)
    v_mfma_f32_16x16x32_bf16 v[24:27], v[192:195], v[124:127], v[24:27]
    v_mfma_f32_16x16x32_bf16 v[44:47], v[196:199], v[124:127], v[44:47]
    buffer_load_dwordx4 v[104:107], v210, s[40:43], s56 offen sc0 sc1
    v_mfma_f32_16x16x32_bf16 v[64:67], v[200:203], v[124:127], v[64:67]
    v_mfma_f32_16x16x32_bf16 v[84:87], v[204:207], v[124:127], v[84:87]
    s_waitcnt vmcnt(14)
    v_mfma_f32_16x16x32_bf16 v[28:31], v[192:195], v[128:131], v[28:31]
    v_mfma_f32_16x16x32_bf16 v[48:51], v[196:199], v[128:131], v[48:51]
    buffer_load_dwordx4 v[108:111], v211, s[40:43], s56 offen sc0 sc1
    v_mfma_f32_16x16x32_bf16 v[68:71], v[200:203], v[128:131], v[68:71]
    v_mfma_f32_16x16x32_bf16 v[88:91], v[204:207], v[128:131], v[88:91]
    s_waitcnt vmcnt(14)
    v_mfma_f32_16x16x32_bf16 v[32:35], v[192:195], v[132:135], v[32:35]
    buffer_load_dwordx4 v[112:115], v212, s[40:43], s56 offen sc0 sc1
    v_mfma_f32_16x16x32_bf16 v[52:55], v[196:199], v[132:135], v[52:55]
    v_mfma_f32_16x16x32_bf16 v[72:75], v[200:203], v[132:135], v[72:75]
    v_mfma_f32_16x16x32_bf16 v[92:95], v[204:207], v[132:135], v[92:95]
    s_add_u32 s56, s56, 8192
    s_waitcnt vmcnt(14)
    v_mfma_f32_16x16x32_bf16 v[16:19], v[236:239], v[136:139], v[16:19]
    v_mfma_f32_16x16x32_bf16 v[36:39], v[240:243], v[136:139], v[36:39]
    ds_read_b64_tr_b16 v[192:193], v220 offset:49152
    v_mfma_f32_16x16x32_bf16 v[56:59], v[244:247], v[136:139], v[56:59]
    ds_read_b64_tr_b16 v[194:195], v220 offset:49664
    v_mfma_f32_16x16x32_bf16 v[76:79], v[248:251], v[136:139], v[76:79]
    s_waitcnt vmcnt(13)
    v_mfma_f32_16x16x32_bf16 v[20:23], v[236:239], v[140:143], v[20:23]
    ds_read_b64_tr_b16 v[196:197], v221 offset:49152
    v_mfma_f32_16x16x32_bf16 v[40:43], v[240:243], v[140:143], v[40:43]
    ds_read_b64_tr_b16 v[198:199], v221 offset:49664
    v_mfma_f32_16x16x32_bf16 v[60:63], v[244:247], v[140:143], v[60:63]
    v_mfma_f32_16x16x32_bf16 v[80:83], v[248:251], v[140:143], v[80:83]
    ds_read_b64_tr_b16 v[200:201], v222 offset:49152
    s_waitcnt vmcnt(12)
    v_mfma_f32_16x16x32_bf16 v[24:27], v[236:239], v[144:147], v[24:27]
    ds_read_b64_tr_b16 v[202:203], v222 offset:49664
    v_mfma_f32_16x16x32_bf16 v[44:47], v[240:243], v[144:147], v[44:47]
    ds_read_b64_tr_b16 v[204:205], v223 offset:49152
    v_mfma_f32_16x16x32_bf16 v[64:67], v[244:247], v[144:147], v[64:67]
    v_mfma_f32_16x16x32_bf16 v[84:87], v[248:251], v[144:147], v[84:87]
    ds_read_b64_tr_b16 v[206:207], v223 offset:49664
    s_waitcnt vmcnt(11)
    v_mfma_f32_16x16x32_bf16 v[28:31], v[236:239], v[148:151], v[28:31]
    buffer_load_dwordx4 v[116:119], v208, s[40:43], s56 offen sc0 sc1
    v_mfma_f32_16x16x32_bf16 v[48:51], v[240:243], v[148:151], v[48:51]
    v_mfma_f32_16x16x32_bf16 v[68:71], v[244:247], v[148:151], v[68:71]
    buffer_load_dwordx4 v[120:123], v209, s[40:43], s56 offen sc0 sc1
    v_mfma_f32_16x16x32_bf16 v[88:91], v[248:251], v[148:151], v[88:91]
    buffer_load_dwordx4 v[124:127], v210, s[40:43], s56 offen sc0 sc1
    s_waitcnt vmcnt(13)
    v_mfma_f32_16x16x32_bf16 v[32:35], v[236:239], v[152:155], v[32:35]
    v_mfma_f32_16x16x32_bf16 v[52:55], v[240:243], v[152:155], v[52:55]
    buffer_load_dwordx4 v[128:131], v211, s[40:43], s56 offen sc0 sc1
    v_mfma_f32_16x16x32_bf16 v[72:75], v[244:247], v[152:155], v[72:75]
    buffer_load_dwordx4 v[132:135], v212, s[40:43], s56 offen sc0 sc1
    v_mfma_f32_16x16x32_bf16 v[92:95], v[248:251], v[152:155], v[92:95]
    s_add_u32 s56, s56, 8192
    s_waitcnt vmcnt(14) lgkmcnt(6)
    v_mfma_f32_16x16x32_bf16 v[16:19], v[192:195], v[156:159], v[16:19]
    s_waitcnt lgkmcnt(4)
    v_mfma_f32_16x16x32_bf16 v[36:39], v[196:199], v[156:159], v[36:39]
    ds_read_b64_tr_b16 v[176:177], v224 offset:0
    s_waitcnt lgkmcnt(3)
    v_mfma_f32_16x16x32_bf16 v[56:59], v[200:203], v[156:159], v[56:59]
    ds_read_b64_tr_b16 v[178:179], v224 offset:512
    s_waitcnt lgkmcnt(2)
    v_mfma_f32_16x16x32_bf16 v[76:79], v[204:207], v[156:159], v[76:79]
    s_waitcnt vmcnt(13)
    v_mfma_f32_16x16x32_bf16 v[20:23], v[192:195], v[160:163], v[20:23]
    ds_read_b64_tr_b16 v[180:181], v225 offset:0
    v_mfma_f32_16x16x32_bf16 v[40:43], v[196:199], v[160:163], v[40:43]
    ds_read_b64_tr_b16 v[182:183], v225 offset:512
    v_mfma_f32_16x16x32_bf16 v[60:63], v[200:203], v[160:163], v[60:63]
    v_mfma_f32_16x16x32_bf16 v[80:83], v[204:207], v[160:163], v[80:83]
    ds_read_b64_tr_b16 v[184:185], v226 offset:0
    s_waitcnt vmcnt(12)
    v_mfma_f32_16x16x32_bf16 v[24:27], v[192:195], v[164:167], v[24:27]
    ds_read_b64_tr_b16 v[186:187], v226 offset:512
    v_mfma_f32_16x16x32_bf16 v[44:47], v[196:199], v[164:167], v[44:47]
    ds_read_b64_tr_b16 v[188:189], v227 offset:0
    v_mfma_f32_16x16x32_bf16 v[64:67], v[200:203], v[164:167], v[64:67]
    v_mfma_f32_16x16x32_bf16 v[84:87], v[204:207], v[164:167], v[84:87]
    ds_read_b64_tr_b16 v[190:191], v227 offset:512
    s_waitcnt vmcnt(11)
    v_mfma_f32_16x16x32_bf16 v[28:31], v[192:195], v[168:171], v[28:31]
    buffer_load_dwordx4 v[136:139], v208, s[40:43], s56 offen sc0 sc1
    v_mfma_f32_16x16x32_bf16 v[48:51], v[196:199], v[168:171], v[48:51]
    v_mfma_f32_16x16x32_bf16 v[68:71], v[200:203], v[168:171], v[68:71]
    buffer_load_dwordx4 v[140:143], v209, s[40:43], s56 offen sc0 sc1
    v_mfma_f32_16x16x32_bf16 v[88:91], v[204:207], v[168:171], v[88:91]
    buffer_load_dwordx4 v[144:147], v210, s[40:43], s56 offen sc0 sc1
    s_waitcnt vmcnt(13)
    v_mfma_f32_16x16x32_bf16 v[32:35], v[192:195], v[172:175], v[32:35]
    v_mfma_f32_16x16x32_bf16 v[52:55], v[196:199], v[172:175], v[52:55]
    buffer_load_dwordx4 v[148:151], v211, s[40:43], s56 offen sc0 sc1
    v_mfma_f32_16x16x32_bf16 v[72:75], v[200:203], v[172:175], v[72:75]
    buffer_load_dwordx4 v[152:155], v212, s[40:43], s56 offen sc0 sc1
    v_mfma_f32_16x16x32_bf16 v[92:95], v[204:207], v[172:175], v[92:95]
    s_add_u32 s56, s56, 8192
    s_waitcnt vmcnt(14) lgkmcnt(6)
    v_mfma_f32_16x16x32_bf16 v[16:19], v[176:179], v[96:99], v[16:19]
    ds_read_b64_tr_b16 v[192:193], v220 offset:0
    s_waitcnt lgkmcnt(5)
    v_mfma_f32_16x16x32_bf16 v[36:39], v[180:183], v[96:99], v[36:39]
    ds_read_b64_tr_b16 v[194:195], v220 offset:512
    s_waitcnt lgkmcnt(4)
    v_mfma_f32_16x16x32_bf16 v[56:59], v[184:187], v[96:99], v[56:59]
    ds_read_b64_tr_b16 v[196:197], v221 offset:0
    s_waitcnt lgkmcnt(3)
    v_mfma_f32_16x16x32_bf16 v[76:79], v[188:191], v[96:99], v[76:79]
    ds_read_b64_tr_b16 v[198:199], v221 offset:512
    s_waitcnt vmcnt(13)
    v_mfma_f32_16x16x32_bf16 v[20:23], v[176:179], v[100:103], v[20:23]
    ds_read_b64_tr_b16 v[200:201], v222 offset:0
    v_mfma_f32_16x16x32_bf16 v[40:43], v[180:183], v[100:103], v[40:43]
    ds_read_b64_tr_b16 v[202:203], v222 offset:512
    v_mfma_f32_16x16x32_bf16 v[60:63], v[184:187], v[100:103], v[60:63]
    ds_read_b64_tr_b16 v[204:205], v223 offset:0
    v_mfma_f32_16x16x32_bf16 v[80:83], v[188:191], v[100:103], v[80:83]
    ds_read_b64_tr_b16 v[206:207], v223 offset:512
    s_waitcnt vmcnt(12)
    v_mfma_f32_16x16x32_bf16 v[24:27], v[176:179], v[104:107], v[24:27]
    buffer_load_dwordx4 v[156:159], v208, s[40:43], s56 offen sc0 sc1
    v_mfma_f32_16x16x32_bf16 v[44:47], v[180:183], v[104:107], v[44:47]
    buffer_load_dwordx4 v[160:163], v209, s[40:43], s56 offen sc0 sc1
    v_mfma_f32_16x16x32_bf16 v[64:67], v[184:187], v[104:107], v[64:67]
    buffer_load_dwordx4 v[164:167], v210, s[40:43], s56 offen sc0 sc1
    v_mfma_f32_16x16x32_bf16 v[84:87], v[188:191], v[104:107], v[84:87]
    buffer_load_dwordx4 v[168:171], v211, s[40:43], s56 offen sc0 sc1
    s_waitcnt vmcnt(15)
    v_mfma_f32_16x16x32_bf16 v[28:31], v[176:179], v[108:111], v[28:31]
    buffer_load_dwordx4 v[172:175], v212, s[40:43], s56 offen sc0 sc1
    v_mfma_f32_16x16x32_bf16 v[48:51], v[180:183], v[108:111], v[48:51]
    s_add_u32 s56, s56, 8192
    v_mfma_f32_16x16x32_bf16 v[68:71], v[184:187], v[108:111], v[68:71]
    s_add_u32 m0, s54, 49152
    v_mfma_f32_16x16x32_bf16 v[88:91], v[188:191], v[108:111], v[88:91]
    buffer_load_dwordx4 v213, s[16:19], s57 offen offset:0 lds
    s_waitcnt vmcnt(16)
    v_mfma_f32_16x16x32_bf16 v[32:35], v[176:179], v[112:115], v[32:35]
    buffer_load_dwordx4 v214, s[16:19], s57 offen offset:1024 lds
    v_mfma_f32_16x16x32_bf16 v[52:55], v[180:183], v[112:115], v[52:55]
    buffer_load_dwordx4 v215, s[16:19], s57 offen offset:2048 lds
    v_mfma_f32_16x16x32_bf16 v[72:75], v[184:187], v[112:115], v[72:75]
    buffer_load_dwordx4 v216, s[16:19], s57 offen offset:3072 lds
    v_mfma_f32_16x16x32_bf16 v[92:95], v[188:191], v[112:115], v[92:95]
    s_add_u32 s57, s57, 147456
    s_waitcnt vmcnt(18) lgkmcnt(6)
    v_mfma_f32_16x16x32_bf16 v[16:19], v[192:195], v[116:119], v[16:19]
    ds_read_b64_tr_b16 v[176:177], v220 offset:16384
    s_waitcnt lgkmcnt(5)
    v_mfma_f32_16x16x32_bf16 v[36:39], v[196:199], v[116:119], v[36:39]
    ds_read_b64_tr_b16 v[178:179], v220 offset:16896
    s_waitcnt lgkmcnt(4)
    v_mfma_f32_16x16x32_bf16 v[56:59], v[200:203], v[116:119], v[56:59]
    ds_read_b64_tr_b16 v[180:181], v221 offset:16384
    s_waitcnt lgkmcnt(3)
    v_mfma_f32_16x16x32_bf16 v[76:79], v[204:207], v[116:119], v[76:79]
    ds_read_b64_tr_b16 v[182:183], v221 offset:16896
    s_waitcnt vmcnt(17)
    v_mfma_f32_16x16x32_bf16 v[20:23], v[192:195], v[120:123], v[20:23]
    ds_read_b64_tr_b16 v[184:185], v222 offset:16384
    v_mfma_f32_16x16x32_bf16 v[40:43], v[196:199], v[120:123], v[40:43]
    ds_read_b64_tr_b16 v[186:187], v222 offset:16896
    v_mfma_f32_16x16x32_bf16 v[60:63], v[200:203], v[120:123], v[60:63]
    ds_read_b64_tr_b16 v[188:189], v223 offset:16384
    v_mfma_f32_16x16x32_bf16 v[80:83], v[204:207], v[120:123], v[80:83]
    ds_read_b64_tr_b16 v[190:191], v223 offset:16896
    s_waitcnt vmcnt(16)
    v_mfma_f32_16x16x32_bf16 v[24:27], v[192:195], v[124:127], v[24:27]
    buffer_load_dwordx4 v[96:99], v208, s[40:43], s56 offen sc0 sc1
    v_mfma_f32_16x16x32_bf16 v[44:47], v[196:199], v[124:127], v[44:47]
    buffer_load_dwordx4 v[100:103], v209, s[40:43], s56 offen sc0 sc1
    v_mfma_f32_16x16x32_bf16 v[64:67], v[200:203], v[124:127], v[64:67]
    buffer_load_dwordx4 v[104:107], v210, s[40:43], s56 offen sc0 sc1
    v_mfma_f32_16x16x32_bf16 v[84:87], v[204:207], v[124:127], v[84:87]
    buffer_load_dwordx4 v[108:111], v211, s[40:43], s56 offen sc0 sc1
    s_waitcnt vmcnt(19)
    v_mfma_f32_16x16x32_bf16 v[28:31], v[192:195], v[128:131], v[28:31]
    buffer_load_dwordx4 v[112:115], v212, s[40:43], s56 offen sc0 sc1
    v_mfma_f32_16x16x32_bf16 v[48:51], v[196:199], v[128:131], v[48:51]
    s_add_u32 s56, s56, 8192
    v_mfma_f32_16x16x32_bf16 v[68:71], v[200:203], v[128:131], v[68:71]
    s_add_u32 m0, s54, 65536
    v_mfma_f32_16x16x32_bf16 v[88:91], v[204:207], v[128:131], v[88:91]
    buffer_load_dwordx4 v213, s[16:19], s57 offen offset:0 lds
    s_waitcnt vmcnt(20)
    v_mfma_f32_16x16x32_bf16 v[32:35], v[192:195], v[132:135], v[32:35]
    buffer_load_dwordx4 v214, s[16:19], s57 offen offset:1024 lds
    v_mfma_f32_16x16x32_bf16 v[52:55], v[196:199], v[132:135], v[52:55]
    buffer_load_dwordx4 v215, s[16:19], s57 offen offset:2048 lds
    v_mfma_f32_16x16x32_bf16 v[72:75], v[200:203], v[132:135], v[72:75]
    buffer_load_dwordx4 v216, s[16:19], s57 offen offset:3072 lds
    v_mfma_f32_16x16x32_bf16 v[92:95], v[204:207], v[132:135], v[92:95]
    s_add_u32 s57, s57, 147456
    s_waitcnt vmcnt(22) lgkmcnt(6)
    v_mfma_f32_16x16x32_bf16 v[16:19], v[176:179], v[136:139], v[16:19]
    ds_read_b64_tr_b16 v[192:193], v220 offset:32768
    s_waitcnt lgkmcnt(5)
    v_mfma_f32_16x16x32_bf16 v[36:39], v[180:183], v[136:139], v[36:39]
    ds_read_b64_tr_b16 v[194:195], v220 offset:33280
    s_waitcnt lgkmcnt(4)
    v_mfma_f32_16x16x32_bf16 v[56:59], v[184:187], v[136:139], v[56:59]
    ds_read_b64_tr_b16 v[196:197], v221 offset:32768
    s_waitcnt lgkmcnt(3)
    v_mfma_f32_16x16x32_bf16 v[76:79], v[188:191], v[136:139], v[76:79]
    ds_read_b64_tr_b16 v[198:199], v221 offset:33280
    s_waitcnt vmcnt(21)
    v_mfma_f32_16x16x32_bf16 v[20:23], v[176:179], v[140:143], v[20:23]
    ds_read_b64_tr_b16 v[200:201], v222 offset:32768
    v_mfma_f32_16x16x32_bf16 v[40:43], v[180:183], v[140:143], v[40:43]
    ds_read_b64_tr_b16 v[202:203], v222 offset:33280
    v_mfma_f32_16x16x32_bf16 v[60:63], v[184:187], v[140:143], v[60:63]
    ds_read_b64_tr_b16 v[204:205], v223 offset:32768
    v_mfma_f32_16x16x32_bf16 v[80:83], v[188:191], v[140:143], v[80:83]
    ds_read_b64_tr_b16 v[206:207], v223 offset:33280
    s_waitcnt vmcnt(20)
    v_mfma_f32_16x16x32_bf16 v[24:27], v[176:179], v[144:147], v[24:27]
    buffer_load_dwordx4 v[116:119], v208, s[40:43], s56 offen sc0 sc1
    v_mfma_f32_16x16x32_bf16 v[44:47], v[180:183], v[144:147], v[44:47]
    buffer_load_dwordx4 v[120:123], v209, s[40:43], s56 offen sc0 sc1
    v_mfma_f32_16x16x32_bf16 v[64:67], v[184:187], v[144:147], v[64:67]
    buffer_load_dwordx4 v[124:127], v210, s[40:43], s56 offen sc0 sc1
    v_mfma_f32_16x16x32_bf16 v[84:87], v[188:191], v[144:147], v[84:87]
    buffer_load_dwordx4 v[128:131], v211, s[40:43], s56 offen sc0 sc1
    s_waitcnt vmcnt(23)
    v_mfma_f32_16x16x32_bf16 v[28:31], v[176:179], v[148:151], v[28:31]
    buffer_load_dwordx4 v[132:135], v212, s[40:43], s56 offen sc0 sc1
    v_mfma_f32_16x16x32_bf16 v[48:51], v[180:183], v[148:151], v[48:51]
    s_add_u32 s56, s56, 8192
    v_mfma_f32_16x16x32_bf16 v[68:71], v[184:187], v[148:151], v[68:71]
    s_add_u32 m0, s54, 0
    v_mfma_f32_16x16x32_bf16 v[88:91], v[188:191], v[148:151], v[88:91]
    buffer_load_dwordx4 v213, s[16:19], s57 offen offset:0 lds
    s_waitcnt vmcnt(24)
    v_mfma_f32_16x16x32_bf16 v[32:35], v[176:179], v[152:155], v[32:35]
    buffer_load_dwordx4 v214, s[16:19], s57 offen offset:1024 lds
    v_mfma_f32_16x16x32_bf16 v[52:55], v[180:183], v[152:155], v[52:55]
    buffer_load_dwordx4 v215, s[16:19], s57 offen offset:2048 lds
    v_mfma_f32_16x16x32_bf16 v[72:75], v[184:187], v[152:155], v[72:75]
    buffer_load_dwordx4 v216, s[16:19], s57 offen offset:3072 lds
    v_mfma_f32_16x16x32_bf16 v[92:95], v[188:191], v[152:155], v[92:95]
    s_add_u32 s57, s57, 147456
    s_waitcnt vmcnt(18)
    s_waitcnt lgkmcnt(6)
    v_mfma_f32_16x16x32_bf16 v[16:19], v[192:195], v[156:159], v[16:19]
    ds_read_b64_tr_b16 v[176:177], v220 offset:49152
    s_waitcnt lgkmcnt(5)
    v_mfma_f32_16x16x32_bf16 v[36:39], v[196:199], v[156:159], v[36:39]
    ds_read_b64_tr_b16 v[178:179], v220 offset:49664
    s_waitcnt lgkmcnt(4)
    v_mfma_f32_16x16x32_bf16 v[56:59], v[200:203], v[156:159], v[56:59]
    ds_read_b64_tr_b16 v[180:181], v221 offset:49152
    s_waitcnt lgkmcnt(3)
    v_mfma_f32_16x16x32_bf16 v[76:79], v[204:207], v[156:159], v[76:79]
    ds_read_b64_tr_b16 v[182:183], v221 offset:49664
    v_mfma_f32_16x16x32_bf16 v[20:23], v[192:195], v[160:163], v[20:23]
    ds_read_b64_tr_b16 v[184:185], v222 offset:49152
    v_mfma_f32_16x16x32_bf16 v[40:43], v[196:199], v[160:163], v[40:43]
    ds_read_b64_tr_b16 v[186:187], v222 offset:49664
    v_mfma_f32_16x16x32_bf16 v[60:63], v[200:203], v[160:163], v[60:63]
    ds_read_b64_tr_b16 v[188:189], v223 offset:49152
    v_mfma_f32_16x16x32_bf16 v[80:83], v[204:207], v[160:163], v[80:83]
    ds_read_b64_tr_b16 v[190:191], v223 offset:49664
    v_mfma_f32_16x16x32_bf16 v[24:27], v[192:195], v[164:167], v[24:27]
    buffer_load_dwordx4 v[136:139], v208, s[40:43], s56 offen sc0 sc1
    v_mfma_f32_16x16x32_bf16 v[44:47], v[196:199], v[164:167], v[44:47]
    buffer_load_dwordx4 v[140:143], v209, s[40:43], s56 offen sc0 sc1
    v_mfma_f32_16x16x32_bf16 v[64:67], v[200:203], v[164:167], v[64:67]
    buffer_load_dwordx4 v[144:147], v210, s[40:43], s56 offen sc0 sc1
    v_mfma_f32_16x16x32_bf16 v[84:87], v[204:207], v[164:167], v[84:87]
    buffer_load_dwordx4 v[148:151], v211, s[40:43], s56 offen sc0 sc1
    v_mfma_f32_16x16x32_bf16 v[28:31], v[192:195], v[168:171], v[28:31]
    buffer_load_dwordx4 v[152:155], v212, s[40:43], s56 offen sc0 sc1
    v_mfma_f32_16x16x32_bf16 v[48:51], v[196:199], v[168:171], v[48:51]
    s_add_u32 s56, s56, 8192
    v_mfma_f32_16x16x32_bf16 v[68:71], v[200:203], v[168:171], v[68:71]
    s_add_u32 m0, s54, 16384
    v_mfma_f32_16x16x32_bf16 v[88:91], v[204:207], v[168:171], v[88:91]
    buffer_load_dwordx4 v213, s[16:19], s57 offen offset:0 lds
    v_mfma_f32_16x16x32_bf16 v[32:35], v[192:195], v[172:175], v[32:35]
    buffer_load_dwordx4 v214, s[16:19], s57 offen offset:1024 lds
    v_mfma_f32_16x16x32_bf16 v[52:55], v[196:199], v[172:175], v[52:55]
    buffer_load_dwordx4 v215, s[16:19], s57 offen offset:2048 lds
    v_mfma_f32_16x16x32_bf16 v[72:75], v[200:203], v[172:175], v[72:75]
    buffer_load_dwordx4 v216, s[16:19], s57 offen offset:3072 lds
    v_mfma_f32_16x16x32_bf16 v[92:95], v[204:207], v[172:175], v[92:95]
    s_add_u32 s57, s57, 147456
    s_waitcnt vmcnt(18)
    s_waitcnt lgkmcnt(6)
    v_mfma_f32_16x16x32_bf16 v[16:19], v[176:179], v[96:99], v[16:19]
    ds_read_b64_tr_b16 v[192:193], v224 offset:0
    s_waitcnt lgkmcnt(5)
    v_mfma_f32_16x16x32_bf16 v[36:39], v[180:183], v[96:99], v[36:39]
    ds_read_b64_tr_b16 v[194:195], v224 offset:512
    s_waitcnt lgkmcnt(4)
    v_mfma_f32_16x16x32_bf16 v[56:59], v[184:187], v[96:99], v[56:59]
    ds_read_b64_tr_b16 v[196:197], v225 offset:0
    s_waitcnt lgkmcnt(3)
    v_mfma_f32_16x16x32_bf16 v[76:79], v[188:191], v[96:99], v[76:79]
    ds_read_b64_tr_b16 v[198:199], v225 offset:512
    v_mfma_f32_16x16x32_bf16 v[20:23], v[176:179], v[100:103], v[20:23]
    ds_read_b64_tr_b16 v[200:201], v226 offset:0
    v_mfma_f32_16x16x32_bf16 v[40:43], v[180:183], v[100:103], v[40:43]
    ds_read_b64_tr_b16 v[202:203], v226 offset:512
    v_mfma_f32_16x16x32_bf16 v[60:63], v[184:187], v[100:103], v[60:63]
    ds_read_b64_tr_b16 v[204:205], v227 offset:0
    v_mfma_f32_16x16x32_bf16 v[80:83], v[188:191], v[100:103], v[80:83]
    ds_read_b64_tr_b16 v[206:207], v227 offset:512
    v_mfma_f32_16x16x32_bf16 v[24:27], v[176:179], v[104:107], v[24:27]
    buffer_load_dwordx4 v[156:159], v208, s[40:43], s56 offen sc0 sc1
    v_mfma_f32_16x16x32_bf16 v[44:47], v[180:183], v[104:107], v[44:47]
    buffer_load_dwordx4 v[160:163], v209, s[40:43], s56 offen sc0 sc1
    v_mfma_f32_16x16x32_bf16 v[64:67], v[184:187], v[104:107], v[64:67]
    buffer_load_dwordx4 v[164:167], v210, s[40:43], s56 offen sc0 sc1
    v_mfma_f32_16x16x32_bf16 v[84:87], v[188:191], v[104:107], v[84:87]
    buffer_load_dwordx4 v[168:171], v211, s[40:43], s56 offen sc0 sc1
    v_mfma_f32_16x16x32_bf16 v[28:31], v[176:179], v[108:111], v[28:31]
    buffer_load_dwordx4 v[172:175], v212, s[40:43], s56 offen sc0 sc1
    v_mfma_f32_16x16x32_bf16 v[48:51], v[180:183], v[108:111], v[48:51]
    s_add_u32 s56, s56, 8192
    v_mfma_f32_16x16x32_bf16 v[68:71], v[184:187], v[108:111], v[68:71]
    s_add_u32 m0, s54, 32768
    v_mfma_f32_16x16x32_bf16 v[88:91], v[188:191], v[108:111], v[88:91]
    buffer_load_dwordx4 v213, s[16:19], s57 offen offset:0 lds
    v_mfma_f32_16x16x32_bf16 v[32:35], v[176:179], v[112:115], v[32:35]
    buffer_load_dwordx4 v214, s[16:19], s57 offen offset:1024 lds
    v_mfma_f32_16x16x32_bf16 v[52:55], v[180:183], v[112:115], v[52:55]
    buffer_load_dwordx4 v215, s[16:19], s57 offen offset:2048 lds
    v_mfma_f32_16x16x32_bf16 v[72:75], v[184:187], v[112:115], v[72:75]
    buffer_load_dwordx4 v216, s[16:19], s57 offen offset:3072 lds
    v_mfma_f32_16x16x32_bf16 v[92:95], v[188:191], v[112:115], v[92:95]
    s_add_u32 s57, s57, 147456
    s_waitcnt vmcnt(18)
    s_waitcnt lgkmcnt(6)
    v_mfma_f32_16x16x32_bf16 v[16:19], v[192:195], v[116:119], v[16:19]
    ds_read_b64_tr_b16 v[176:177], v220 offset:0
    s_waitcnt lgkmcnt(5)
    v_mfma_f32_16x16x32_bf16 v[36:39], v[196:199], v[116:119], v[36:39]
    ds_read_b64_tr_b16 v[178:179], v220 offset:512
    s_waitcnt lgkmcnt(4)
    v_mfma_f32_16x16x32_bf16 v[56:59], v[200:203], v[116:119], v[56:59]
    ds_read_b64_tr_b16 v[180:181], v221 offset:0
    s_waitcnt lgkmcnt(3)
    v_mfma_f32_16x16x32_bf16 v[76:79], v[204:207], v[116:119], v[76:79]
    ds_read_b64_tr_b16 v[182:183], v221 offset:512
    v_mfma_f32_16x16x32_bf16 v[20:23], v[192:195], v[120:123], v[20:23]
    ds_read_b64_tr_b16 v[184:185], v222 offset:0
    v_mfma_f32_16x16x32_bf16 v[40:43], v[196:199], v[120:123], v[40:43]
    ds_read_b64_tr_b16 v[186:187], v222 offset:512
    v_mfma_f32_16x16x32_bf16 v[60:63], v[200:203], v[120:123], v[60:63]
    ds_read_b64_tr_b16 v[188:189], v223 offset:0
    v_mfma_f32_16x16x32_bf16 v[80:83], v[204:207], v[120:123], v[80:83]
    ds_read_b64_tr_b16 v[190:191], v223 offset:512
    v_mfma_f32_16x16x32_bf16 v[24:27], v[192:195], v[124:127], v[24:27]
    buffer_load_dwordx4 v[96:99], v208, s[40:43], s56 offen sc0 sc1
    v_mfma_f32_16x16x32_bf16 v[44:47], v[196:199], v[124:127], v[44:47]
    buffer_load_dwordx4 v[100:103], v209, s[40:43], s56 offen sc0 sc1
    v_mfma_f32_16x16x32_bf16 v[64:67], v[200:203], v[124:127], v[64:67]
    buffer_load_dwordx4 v[104:107], v210, s[40:43], s56 offen sc0 sc1
    v_mfma_f32_16x16x32_bf16 v[84:87], v[204:207], v[124:127], v[84:87]
    buffer_load_dwordx4 v[108:111], v211, s[40:43], s56 offen sc0 sc1
    v_mfma_f32_16x16x32_bf16 v[28:31], v[192:195], v[128:131], v[28:31]
    buffer_load_dwordx4 v[112:115], v212, s[40:43], s56 offen sc0 sc1
    v_mfma_f32_16x16x32_bf16 v[48:51], v[196:199], v[128:131], v[48:51]
    s_add_u32 s56, s56, 8192
    v_mfma_f32_16x16x32_bf16 v[68:71], v[200:203], v[128:131], v[68:71]
    s_add_u32 m0, s54, 49152
    v_mfma_f32_16x16x32_bf16 v[88:91], v[204:207], v[128:131], v[88:91]
    buffer_load_dwordx4 v213, s[16:19], s57 offen offset:0 lds
    v_mfma_f32_16x16x32_bf16 v[32:35], v[192:195], v[132:135], v[32:35]
    buffer_load_dwordx4 v214, s[16:19], s57 offen offset:1024 lds
    v_mfma_f32_16x16x32_bf16 v[52:55], v[196:199], v[132:135], v[52:55]
    buffer_load_dwordx4 v215, s[16:19], s57 offen offset:2048 lds
    v_mfma_f32_16x16x32_bf16 v[72:75], v[200:203], v[132:135], v[72:75]
    buffer_load_dwordx4 v216, s[16:19], s57 offen offset:3072 lds
    v_mfma_f32_16x16x32_bf16 v[92:95], v[204:207], v[132:135], v[92:95]
    s_add_u32 s57, s57, 147456
    s_waitcnt vmcnt(18)
    s_waitcnt lgkmcnt(6)
    v_mfma_f32_16x16x32_bf16 v[16:19], v[176:179], v[136:139], v[16:19]
    ds_read_b64_tr_b16 v[192:193], v220 offset:16384
    s_waitcnt lgkmcnt(5)
    v_mfma_f32_16x16x32_bf16 v[36:39], v[180:183], v[136:139], v[36:39]
    ds_read_b64_tr_b16 v[194:195], v220 offset:16896
    s_waitcnt lgkmcnt(4)
    v_mfma_f32_16x16x32_bf16 v[56:59], v[184:187], v[136:139], v[56:59]
    ds_read_b64_tr_b16 v[196:197], v221 offset:16384
    s_waitcnt lgkmcnt(3)
    v_mfma_f32_16x16x32_bf16 v[76:79], v[188:191], v[136:139], v[76:79]
    ds_read_b64_tr_b16 v[198:199], v221 offset:16896
    v_mfma_f32_16x16x32_bf16 v[20:23], v[176:179], v[140:143], v[20:23]
    ds_read_b64_tr_b16 v[200:201], v222 offset:16384
    v_mfma_f32_16x16x32_bf16 v[40:43], v[180:183], v[140:143], v[40:43]
    ds_read_b64_tr_b16 v[202:203], v222 offset:16896
    v_mfma_f32_16x16x32_bf16 v[60:63], v[184:187], v[140:143], v[60:63]
    ds_read_b64_tr_b16 v[204:205], v223 offset:16384
    v_mfma_f32_16x16x32_bf16 v[80:83], v[188:191], v[140:143], v[80:83]
    ds_read_b64_tr_b16 v[206:207], v223 offset:16896
    v_mfma_f32_16x16x32_bf16 v[24:27], v[176:179], v[144:147], v[24:27]
    buffer_load_dwordx4 v[116:119], v208, s[40:43], s56 offen sc0 sc1
    v_mfma_f32_16x16x32_bf16 v[44:47], v[180:183], v[144:147], v[44:47]
    buffer_load_dwordx4 v[120:123], v209, s[40:43], s56 offen sc0 sc1
    v_mfma_f32_16x16x32_bf16 v[64:67], v[184:187], v[144:147], v[64:67]
    buffer_load_dwordx4 v[124:127], v210, s[40:43], s56 offen sc0 sc1
    v_mfma_f32_16x16x32_bf16 v[84:87], v[188:191], v[144:147], v[84:87]
    buffer_load_dwordx4 v[128:131], v211, s[40:43], s56 offen sc0 sc1
    v_mfma_f32_16x16x32_bf16 v[28:31], v[176:179], v[148:151], v[28:31]
    buffer_load_dwordx4 v[132:135], v212, s[40:43], s56 offen sc0 sc1
    v_mfma_f32_16x16x32_bf16 v[48:51], v[180:183], v[148:151], v[48:51]
    s_add_u32 s56, s56, 8192
    v_mfma_f32_16x16x32_bf16 v[68:71], v[184:187], v[148:151], v[68:71]
    s_add_u32 m0, s54, 65536
    v_mfma_f32_16x16x32_bf16 v[88:91], v[188:191], v[148:151], v[88:91]
    buffer_load_dwordx4 v213, s[16:19], s57 offen offset:0 lds
    v_mfma_f32_16x16x32_bf16 v[32:35], v[176:179], v[152:155], v[32:35]
    buffer_load_dwordx4 v214, s[16:19], s57 offen offset:1024 lds
    v_mfma_f32_16x16x32_bf16 v[52:55], v[180:183], v[152:155], v[52:55]
    buffer_load_dwordx4 v215, s[16:19], s57 offen offset:2048 lds
    v_mfma_f32_16x16x32_bf16 v[72:75], v[184:187], v[152:155], v[72:75]
    buffer_load_dwordx4 v216, s[16:19], s57 offen offset:3072 lds
    v_mfma_f32_16x16x32_bf16 v[92:95], v[188:191], v[152:155], v[92:95]
    s_add_u32 s57, s57, 147456
    s_waitcnt vmcnt(18)
    s_waitcnt lgkmcnt(6)
    v_mfma_f32_16x16x32_bf16 v[16:19], v[192:195], v[156:159], v[16:19]
    ds_read_b64_tr_b16 v[176:177], v220 offset:32768
    s_waitcnt lgkmcnt(5)
    v_mfma_f32_16x16x32_bf16 v[36:39], v[196:199], v[156:159], v[36:39]
    ds_read_b64_tr_b16 v[178:179], v220 offset:33280
    s_waitcnt lgkmcnt(4)
    v_mfma_f32_16x16x32_bf16 v[56:59], v[200:203], v[156:159], v[56:59]
    ds_read_b64_tr_b16 v[180:181], v221 offset:32768
    s_waitcnt lgkmcnt(3)
    v_mfma_f32_16x16x32_bf16 v[76:79], v[204:207], v[156:159], v[76:79]
    ds_read_b64_tr_b16 v[182:183], v221 offset:33280
    v_mfma_f32_16x16x32_bf16 v[20:23], v[192:195], v[160:163], v[20:23]
    ds_read_b64_tr_b16 v[184:185], v222 offset:32768
    v_mfma_f32_16x16x32_bf16 v[40:43], v[196:199], v[160:163], v[40:43]
    ds_read_b64_tr_b16 v[186:187], v222 offset:33280
    v_mfma_f32_16x16x32_bf16 v[60:63], v[200:203], v[160:163], v[60:63]
    ds_read_b64_tr_b16 v[188:189], v223 offset:32768
    v_mfma_f32_16x16x32_bf16 v[80:83], v[204:207], v[160:163], v[80:83]
    ds_read_b64_tr_b16 v[190:191], v223 offset:33280
    v_mfma_f32_16x16x32_bf16 v[24:27], v[192:195], v[164:167], v[24:27]
    buffer_load_dwordx4 v[136:139], v208, s[40:43], s56 offen sc0 sc1
    v_mfma_f32_16x16x32_bf16 v[44:47], v[196:199], v[164:167], v[44:47]
    buffer_load_dwordx4 v[140:143], v209, s[40:43], s56 offen sc0 sc1
    v_mfma_f32_16x16x32_bf16 v[64:67], v[200:203], v[164:167], v[64:67]
    buffer_load_dwordx4 v[144:147], v210, s[40:43], s56 offen sc0 sc1
    v_mfma_f32_16x16x32_bf16 v[84:87], v[204:207], v[164:167], v[84:87]
    buffer_load_dwordx4 v[148:151], v211, s[40:43], s56 offen sc0 sc1
    v_mfma_f32_16x16x32_bf16 v[28:31], v[192:195], v[168:171], v[28:31]
    buffer_load_dwordx4 v[152:155], v212, s[40:43], s56 offen sc0 sc1
    v_mfma_f32_16x16x32_bf16 v[48:51], v[196:199], v[168:171], v[48:51]
    s_add_u32 s56, s56, 8192
    v_mfma_f32_16x16x32_bf16 v[68:71], v[200:203], v[168:171], v[68:71]
    s_add_u32 m0, s54, 0
    v_mfma_f32_16x16x32_bf16 v[88:91], v[204:207], v[168:171], v[88:91]
    buffer_load_dwordx4 v213, s[16:19], s57 offen offset:0 lds
    v_mfma_f32_16x16x32_bf16 v[32:35], v[192:195], v[172:175], v[32:35]
    buffer_load_dwordx4 v214, s[16:19], s57 offen offset:1024 lds
    v_mfma_f32_16x16x32_bf16 v[52:55], v[196:199], v[172:175], v[52:55]
    buffer_load_dwordx4 v215, s[16:19], s57 offen offset:2048 lds
    v_mfma_f32_16x16x32_bf16 v[72:75], v[200:203], v[172:175], v[72:75]
    buffer_load_dwordx4 v216, s[16:19], s57 offen offset:3072 lds
    v_mfma_f32_16x16x32_bf16 v[92:95], v[204:207], v[172:175], v[92:95]
    s_add_u32 s57, s57, 147456
    s_waitcnt vmcnt(18)
    s_waitcnt lgkmcnt(6)
    v_mfma_f32_16x16x32_bf16 v[16:19], v[176:179], v[96:99], v[16:19]
    ds_read_b64_tr_b16 v[192:193], v220 offset:49152
    s_waitcnt lgkmcnt(5)
    v_mfma_f32_16x16x32_bf16 v[36:39], v[180:183], v[96:99], v[36:39]
    ds_read_b64_tr_b16 v[194:195], v220 offset:49664
    s_waitcnt lgkmcnt(4)
    v_mfma_f32_16x16x32_bf16 v[56:59], v[184:187], v[96:99], v[56:59]
    ds_read_b64_tr_b16 v[196:197], v221 offset:49152
    s_waitcnt lgkmcnt(3)
    v_mfma_f32_16x16x32_bf16 v[76:79], v[188:191], v[96:99], v[76:79]
    ds_read_b64_tr_b16 v[198:199], v221 offset:49664
    v_mfma_f32_16x16x32_bf16 v[20:23], v[176:179], v[100:103], v[20:23]
    ds_read_b64_tr_b16 v[200:201], v222 offset:49152
    v_mfma_f32_16x16x32_bf16 v[40:43], v[180:183], v[100:103], v[40:43]
    ds_read_b64_tr_b16 v[202:203], v222 offset:49664
    v_mfma_f32_16x16x32_bf16 v[60:63], v[184:187], v[100:103], v[60:63]
    ds_read_b64_tr_b16 v[204:205], v223 offset:49152
    v_mfma_f32_16x16x32_bf16 v[80:83], v[188:191], v[100:103], v[80:83]
    ds_read_b64_tr_b16 v[206:207], v223 offset:49664
    v_mfma_f32_16x16x32_bf16 v[24:27], v[176:179], v[104:107], v[24:27]
    buffer_load_dwordx4 v[156:159], v208, s[40:43], s56 offen sc0 sc1
    v_mfma_f32_16x16x32_bf16 v[44:47], v[180:183], v[104:107], v[44:47]
    buffer_load_dwordx4 v[160:163], v209, s[40:43], s56 offen sc0 sc1
    v_mfma_f32_16x16x32_bf16 v[64:67], v[184:187], v[104:107], v[64:67]
    buffer_load_dwordx4 v[164:167], v210, s[40:43], s56 offen sc0 sc1
    v_mfma_f32_16x16x32_bf16 v[84:87], v[188:191], v[104:107], v[84:87]
    buffer_load_dwordx4 v[168:171], v211, s[40:43], s56 offen sc0 sc1
    v_mfma_f32_16x16x32_bf16 v[28:31], v[176:179], v[108:111], v[28:31]
    buffer_load_dwordx4 v[172:175], v212, s[40:43], s56 offen sc0 sc1
    v_mfma_f32_16x16x32_bf16 v[48:51], v[180:183], v[108:111], v[48:51]
    s_add_u32 s56, s56, 8192
    v_mfma_f32_16x16x32_bf16 v[68:71], v[184:187], v[108:111], v[68:71]
    s_add_u32 m0, s54, 16384
    v_mfma_f32_16x16x32_bf16 v[88:91], v[188:191], v[108:111], v[88:91]
    buffer_load_dwordx4 v213, s[16:19], s57 offen offset:0 lds
    v_mfma_f32_16x16x32_bf16 v[32:35], v[176:179], v[112:115], v[32:35]
    buffer_load_dwordx4 v214, s[16:19], s57 offen offset:1024 lds
    v_mfma_f32_16x16x32_bf16 v[52:55], v[180:183], v[112:115], v[52:55]
    buffer_load_dwordx4 v215, s[16:19], s57 offen offset:2048 lds
    v_mfma_f32_16x16x32_bf16 v[72:75], v[184:187], v[112:115], v[72:75]
    buffer_load_dwordx4 v216, s[16:19], s57 offen offset:3072 lds
    v_mfma_f32_16x16x32_bf16 v[92:95], v[188:191], v[112:115], v[92:95]
    s_add_u32 s57, s57, 147456
    s_waitcnt vmcnt(18)
    s_waitcnt lgkmcnt(6)
    v_mfma_f32_16x16x32_bf16 v[16:19], v[192:195], v[116:119], v[16:19]
    ds_read_b64_tr_b16 v[176:177], v224 offset:0
    s_waitcnt lgkmcnt(5)
    v_mfma_f32_16x16x32_bf16 v[36:39], v[196:199], v[116:119], v[36:39]
    ds_read_b64_tr_b16 v[178:179], v224 offset:512
    s_waitcnt lgkmcnt(4)
    v_mfma_f32_16x16x32_bf16 v[56:59], v[200:203], v[116:119], v[56:59]
    ds_read_b64_tr_b16 v[180:181], v225 offset:0
    s_waitcnt lgkmcnt(3)
    v_mfma_f32_16x16x32_bf16 v[76:79], v[204:207], v[116:119], v[76:79]
    ds_read_b64_tr_b16 v[182:183], v225 offset:512
    v_mfma_f32_16x16x32_bf16 v[20:23], v[192:195], v[120:123], v[20:23]
    ds_read_b64_tr_b16 v[184:185], v226 offset:0
    v_mfma_f32_16x16x32_bf16 v[40:43], v[196:199], v[120:123], v[40:43]
    ds_read_b64_tr_b16 v[186:187], v226 offset:512
    v_mfma_f32_16x16x32_bf16 v[60:63], v[200:203], v[120:123], v[60:63]
    ds_read_b64_tr_b16 v[188:189], v227 offset:0
    v_mfma_f32_16x16x32_bf16 v[80:83], v[204:207], v[120:123], v[80:83]
    ds_read_b64_tr_b16 v[190:191], v227 offset:512
    v_mfma_f32_16x16x32_bf16 v[24:27], v[192:195], v[124:127], v[24:27]
    buffer_load_dwordx4 v[96:99], v208, s[40:43], s56 offen sc0 sc1
    v_mfma_f32_16x16x32_bf16 v[44:47], v[196:199], v[124:127], v[44:47]
    buffer_load_dwordx4 v[100:103], v209, s[40:43], s56 offen sc0 sc1
    v_mfma_f32_16x16x32_bf16 v[64:67], v[200:203], v[124:127], v[64:67]
    buffer_load_dwordx4 v[104:107], v210, s[40:43], s56 offen sc0 sc1
    v_mfma_f32_16x16x32_bf16 v[84:87], v[204:207], v[124:127], v[84:87]
    buffer_load_dwordx4 v[108:111], v211, s[40:43], s56 offen sc0 sc1
    v_mfma_f32_16x16x32_bf16 v[28:31], v[192:195], v[128:131], v[28:31]
    buffer_load_dwordx4 v[112:115], v212, s[40:43], s56 offen sc0 sc1
    v_mfma_f32_16x16x32_bf16 v[48:51], v[196:199], v[128:131], v[48:51]
    s_add_u32 s56, s56, 8192
    v_mfma_f32_16x16x32_bf16 v[68:71], v[200:203], v[128:131], v[68:71]
    s_add_u32 m0, s54, 32768
    v_mfma_f32_16x16x32_bf16 v[88:91], v[204:207], v[128:131], v[88:91]
    buffer_load_dwordx4 v213, s[16:19], s57 offen offset:0 lds
    v_mfma_f32_16x16x32_bf16 v[32:35], v[192:195], v[132:135], v[32:35]
    buffer_load_dwordx4 v214, s[16:19], s57 offen offset:1024 lds
    v_mfma_f32_16x16x32_bf16 v[52:55], v[196:199], v[132:135], v[52:55]
    buffer_load_dwordx4 v215, s[16:19], s57 offen offset:2048 lds
    v_mfma_f32_16x16x32_bf16 v[72:75], v[200:203], v[132:135], v[72:75]
    buffer_load_dwordx4 v216, s[16:19], s57 offen offset:3072 lds
    v_mfma_f32_16x16x32_bf16 v[92:95], v[204:207], v[132:135], v[92:95]
    s_add_u32 s57, s57, 147456
    s_waitcnt vmcnt(18)
    s_waitcnt lgkmcnt(6)
    v_mfma_f32_16x16x32_bf16 v[16:19], v[176:179], v[136:139], v[16:19]
    ds_read_b64_tr_b16 v[192:193], v220 offset:0
    ds_read_b64_tr_b16 v[194:195], v220 offset:512
    s_waitcnt lgkmcnt(6)
    v_mfma_f32_16x16x32_bf16 v[36:39], v[180:183], v[136:139], v[36:39]
    ds_read_b64_tr_b16 v[196:197], v221 offset:0
    ds_read_b64_tr_b16 v[198:199], v221 offset:512
    s_waitcnt lgkmcnt(6)
    v_mfma_f32_16x16x32_bf16 v[56:59], v[184:187], v[136:139], v[56:59]
    ds_read_b64_tr_b16 v[200:201], v222 offset:0
    ds_read_b64_tr_b16 v[202:203], v222 offset:512
    s_waitcnt lgkmcnt(6)
    v_mfma_f32_16x16x32_bf16 v[76:79], v[188:191], v[136:139], v[76:79]
    ds_read_b64_tr_b16 v[204:205], v223 offset:0
    ds_read_b64_tr_b16 v[206:207], v223 offset:512
    buffer_load_dwordx4 v[116:119], v208, s[40:43], s56 offen sc0 sc1
    v_mfma_f32_16x16x32_bf16 v[20:23], v[176:179], v[140:143], v[20:23]
    buffer_load_dwordx4 v[120:123], v209, s[40:43], s56 offen sc0 sc1
    buffer_load_dwordx4 v[124:127], v210, s[40:43], s56 offen sc0 sc1
    v_mfma_f32_16x16x32_bf16 v[40:43], v[180:183], v[140:143], v[40:43]
    buffer_load_dwordx4 v[128:131], v211, s[40:43], s56 offen sc0 sc1
    buffer_load_dwordx4 v[132:135], v212, s[40:43], s56 offen sc0 sc1
    v_mfma_f32_16x16x32_bf16 v[60:63], v[184:187], v[140:143], v[60:63]
    s_add_u32 s56, s56, 8192
    v_add_u32 v6, 0, v4
    v_mfma_f32_16x16x32_bf16 v[80:83], v[188:191], v[140:143], v[80:83]
    v_mul_lo_u32 v6, v6, s35
    v_xor_b32 v7, 0, v5
    v_lshl_add_u32 v6, v7, 4, v6
    v_mfma_f32_16x16x32_bf16 v[24:27], v[176:179], v[144:147], v[24:27]
    v_add_u32 v6, s37, v6
    v_subrev_u32 v213, 0, v6
    v_mfma_f32_16x16x32_bf16 v[44:47], v[180:183], v[144:147], v[44:47]
    v_add_u32 v6, 8, v4
    v_mul_lo_u32 v6, v6, s35
    v_mfma_f32_16x16x32_bf16 v[64:67], v[184:187], v[144:147], v[64:67]
    v_xor_b32 v7, 4, v5
    v_lshl_add_u32 v6, v7, 4, v6
    v_mfma_f32_16x16x32_bf16 v[84:87], v[188:191], v[144:147], v[84:87]
    v_add_u32 v6, s37, v6
    v_subrev_u32 v214, 1024, v6
    v_add_u32 v6, 18, v4
    v_mfma_f32_16x16x32_bf16 v[28:31], v[176:179], v[148:151], v[28:31]
    v_mul_lo_u32 v6, v6, s35
    v_xor_b32 v7, 0, v5
    v_mfma_f32_16x16x32_bf16 v[48:51], v[180:183], v[148:151], v[48:51]
    v_lshl_add_u32 v6, v7, 4, v6
    v_add_u32 v6, s37, v6
    v_mfma_f32_16x16x32_bf16 v[68:71], v[184:187], v[148:151], v[68:71]
    v_subrev_u32 v215, 2048, v6
    v_add_u32 v6, 26, v4
    v_mfma_f32_16x16x32_bf16 v[88:91], v[188:191], v[148:151], v[88:91]
    v_mul_lo_u32 v6, v6, s35
    v_xor_b32 v7, 4, v5
    v_lshl_add_u32 v6, v7, 4, v6
    v_mfma_f32_16x16x32_bf16 v[32:35], v[176:179], v[152:155], v[32:35]
    v_add_u32 v6, s37, v6
    v_subrev_u32 v216, 3072, v6
    v_mfma_f32_16x16x32_bf16 v[52:55], v[180:183], v[152:155], v[52:55]
    s_mul_i32 s57, s6, 41472
    s_add_u32 m0, s54, 49152
    v_mfma_f32_16x16x32_bf16 v[72:75], v[184:187], v[152:155], v[72:75]
    buffer_load_dwordx4 v213, s[20:23], s57 offen offset:0 lds
    buffer_load_dwordx4 v214, s[20:23], s57 offen offset:1024 lds
    v_mfma_f32_16x16x32_bf16 v[92:95], v[188:191], v[152:155], v[92:95]
    buffer_load_dwordx4 v215, s[20:23], s57 offen offset:2048 lds
    buffer_load_dwordx4 v216, s[20:23], s57 offen offset:3072 lds
    s_add_u32 s57, s57, 165888
    s_waitcnt vmcnt(18)
    s_waitcnt lgkmcnt(6)
    v_mfma_f32_16x16x32_bf16 v[16:19], v[192:195], v[156:159], v[16:19]
    s_waitcnt lgkmcnt(4)
    v_mfma_f32_16x16x32_bf16 v[36:39], v[196:199], v[156:159], v[36:39]
    ds_read_b64_tr_b16 v[176:177], v220 offset:16384
    s_waitcnt lgkmcnt(3)
    v_mfma_f32_16x16x32_bf16 v[56:59], v[200:203], v[156:159], v[56:59]
    ds_read_b64_tr_b16 v[178:179], v220 offset:16896
    s_waitcnt lgkmcnt(2)
    v_mfma_f32_16x16x32_bf16 v[76:79], v[204:207], v[156:159], v[76:79]
    v_mfma_f32_16x16x32_bf16 v[20:23], v[192:195], v[160:163], v[20:23]
    ds_read_b64_tr_b16 v[180:181], v221 offset:16384
    v_mfma_f32_16x16x32_bf16 v[40:43], v[196:199], v[160:163], v[40:43]
    ds_read_b64_tr_b16 v[182:183], v221 offset:16896
    v_mfma_f32_16x16x32_bf16 v[60:63], v[200:203], v[160:163], v[60:63]
    v_mfma_f32_16x16x32_bf16 v[80:83], v[204:207], v[160:163], v[80:83]
    ds_read_b64_tr_b16 v[184:185], v222 offset:16384
    v_mfma_f32_16x16x32_bf16 v[24:27], v[192:195], v[164:167], v[24:27]
    ds_read_b64_tr_b16 v[186:187], v222 offset:16896
    v_mfma_f32_16x16x32_bf16 v[44:47], v[196:199], v[164:167], v[44:47]
    ds_read_b64_tr_b16 v[188:189], v223 offset:16384
    v_mfma_f32_16x16x32_bf16 v[64:67], v[200:203], v[164:167], v[64:67]
    v_mfma_f32_16x16x32_bf16 v[84:87], v[204:207], v[164:167], v[84:87]
    ds_read_b64_tr_b16 v[190:191], v223 offset:16896
    v_mfma_f32_16x16x32_bf16 v[28:31], v[192:195], v[168:171], v[28:31]
    s_add_u32 m0, s54, 65536
    v_mfma_f32_16x16x32_bf16 v[48:51], v[196:199], v[168:171], v[48:51]
    v_mfma_f32_16x16x32_bf16 v[68:71], v[200:203], v[168:171], v[68:71]
    buffer_load_dwordx4 v213, s[20:23], s57 offen offset:0 lds
    v_mfma_f32_16x16x32_bf16 v[88:91], v[204:207], v[168:171], v[88:91]
    buffer_load_dwordx4 v214, s[20:23], s57 offen offset:1024 lds
    v_mfma_f32_16x16x32_bf16 v[32:35], v[192:195], v[172:175], v[32:35]
    v_mfma_f32_16x16x32_bf16 v[52:55], v[196:199], v[172:175], v[52:55]
    buffer_load_dwordx4 v215, s[20:23], s57 offen offset:2048 lds
    v_mfma_f32_16x16x32_bf16 v[72:75], v[200:203], v[172:175], v[72:75]
    buffer_load_dwordx4 v216, s[20:23], s57 offen offset:3072 lds
    v_mfma_f32_16x16x32_bf16 v[92:95], v[204:207], v[172:175], v[92:95]
    s_add_u32 s57, s57, 165888
    s_waitcnt vmcnt(13)
    s_waitcnt lgkmcnt(6)
    v_mfma_f32_16x16x32_bf16 v[16:19], v[176:179], v[96:99], v[16:19]
    s_waitcnt lgkmcnt(4)
    v_mfma_f32_16x16x32_bf16 v[36:39], v[180:183], v[96:99], v[36:39]
    ds_read_b64_tr_b16 v[192:193], v220 offset:32768
    s_waitcnt lgkmcnt(3)
    v_mfma_f32_16x16x32_bf16 v[56:59], v[184:187], v[96:99], v[56:59]
    ds_read_b64_tr_b16 v[194:195], v220 offset:33280
    s_waitcnt lgkmcnt(2)
    v_mfma_f32_16x16x32_bf16 v[76:79], v[188:191], v[96:99], v[76:79]
    v_mfma_f32_16x16x32_bf16 v[20:23], v[176:179], v[100:103], v[20:23]
    ds_read_b64_tr_b16 v[196:197], v221 offset:32768
    v_mfma_f32_16x16x32_bf16 v[40:43], v[180:183], v[100:103], v[40:43]
    ds_read_b64_tr_b16 v[198:199], v221 offset:33280
    v_mfma_f32_16x16x32_bf16 v[60:63], v[184:187], v[100:103], v[60:63]
    v_mfma_f32_16x16x32_bf16 v[80:83], v[188:191], v[100:103], v[80:83]
    ds_read_b64_tr_b16 v[200:201], v222 offset:32768
    v_mfma_f32_16x16x32_bf16 v[24:27], v[176:179], v[104:107], v[24:27]
    ds_read_b64_tr_b16 v[202:203], v222 offset:33280
    v_mfma_f32_16x16x32_bf16 v[44:47], v[180:183], v[104:107], v[44:47]
    ds_read_b64_tr_b16 v[204:205], v223 offset:32768
    v_mfma_f32_16x16x32_bf16 v[64:67], v[184:187], v[104:107], v[64:67]
    v_mfma_f32_16x16x32_bf16 v[84:87], v[188:191], v[104:107], v[84:87]
    ds_read_b64_tr_b16 v[206:207], v223 offset:33280
    v_mfma_f32_16x16x32_bf16 v[28:31], v[176:179], v[108:111], v[28:31]
    s_add_u32 m0, s54, 0
    v_mfma_f32_16x16x32_bf16 v[48:51], v[180:183], v[108:111], v[48:51]
    v_mfma_f32_16x16x32_bf16 v[68:71], v[184:187], v[108:111], v[68:71]
    buffer_load_dwordx4 v213, s[20:23], s57 offen offset:0 lds
    v_mfma_f32_16x16x32_bf16 v[88:91], v[188:191], v[108:111], v[88:91]
    buffer_load_dwordx4 v214, s[20:23], s57 offen offset:1024 lds
    v_mfma_f32_16x16x32_bf16 v[32:35], v[176:179], v[112:115], v[32:35]
    v_mfma_f32_16x16x32_bf16 v[52:55], v[180:183], v[112:115], v[52:55]
    buffer_load_dwordx4 v215, s[20:23], s57 offen offset:2048 lds
    v_mfma_f32_16x16x32_bf16 v[72:75], v[184:187], v[112:115], v[72:75]
    buffer_load_dwordx4 v216, s[20:23], s57 offen offset:3072 lds
    v_mfma_f32_16x16x32_bf16 v[92:95], v[188:191], v[112:115], v[92:95]
    s_add_u32 s57, s57, 165888
    s_waitcnt vmcnt(8)
    s_waitcnt lgkmcnt(6)
    v_mfma_f32_16x16x32_bf16 v[16:19], v[192:195], v[116:119], v[16:19]
    s_waitcnt lgkmcnt(4)
    v_mfma_f32_16x16x32_bf16 v[36:39], v[196:199], v[116:119], v[36:39]
    buffer_load_dwordx2 v[234:235], v231, s[72:75], 0 offen sc0 sc1
    s_waitcnt lgkmcnt(2)
    v_mfma_f32_16x16x32_bf16 v[56:59], v[200:203], v[116:119], v[56:59]
    ds_read_b64_tr_b16 v[176:177], v220 offset:49152
    s_waitcnt lgkmcnt(1)
    v_mfma_f32_16x16x32_bf16 v[76:79], v[204:207], v[116:119], v[76:79]
    ds_read_b64_tr_b16 v[178:179], v220 offset:49664
    v_mfma_f32_16x16x32_bf16 v[20:23], v[192:195], v[120:123], v[20:23]
    v_mfma_f32_16x16x32_bf16 v[40:43], v[196:199], v[120:123], v[40:43]
    ds_read_b64_tr_b16 v[180:181], v221 offset:49152
    v_mfma_f32_16x16x32_bf16 v[60:63], v[200:203], v[120:123], v[60:63]
    ds_read_b64_tr_b16 v[182:183], v221 offset:49664
    v_mfma_f32_16x16x32_bf16 v[80:83], v[204:207], v[120:123], v[80:83]
    ds_read_b64_tr_b16 v[184:185], v222 offset:49152
    v_mfma_f32_16x16x32_bf16 v[24:27], v[192:195], v[124:127], v[24:27]
    v_mfma_f32_16x16x32_bf16 v[44:47], v[196:199], v[124:127], v[44:47]
    ds_read_b64_tr_b16 v[186:187], v222 offset:49664
    v_mfma_f32_16x16x32_bf16 v[64:67], v[200:203], v[124:127], v[64:67]
    ds_read_b64_tr_b16 v[188:189], v223 offset:49152
    v_mfma_f32_16x16x32_bf16 v[84:87], v[204:207], v[124:127], v[84:87]
    ds_read_b64_tr_b16 v[190:191], v223 offset:49664
    v_mfma_f32_16x16x32_bf16 v[28:31], v[192:195], v[128:131], v[28:31]
    v_mfma_f32_16x16x32_bf16 v[48:51], v[196:199], v[128:131], v[48:51]
    s_add_u32 m0, s54, 16384
    v_mfma_f32_16x16x32_bf16 v[68:71], v[200:203], v[128:131], v[68:71]
    buffer_load_dwordx4 v213, s[20:23], s57 offen offset:0 lds
    v_mfma_f32_16x16x32_bf16 v[88:91], v[204:207], v[128:131], v[88:91]
    buffer_load_dwordx4 v214, s[20:23], s57 offen offset:1024 lds
    v_mfma_f32_16x16x32_bf16 v[32:35], v[192:195], v[132:135], v[32:35]
    v_mfma_f32_16x16x32_bf16 v[52:55], v[196:199], v[132:135], v[52:55]
    buffer_load_dwordx4 v215, s[20:23], s57 offen offset:2048 lds
    v_mfma_f32_16x16x32_bf16 v[72:75], v[200:203], v[132:135], v[72:75]
    buffer_load_dwordx4 v216, s[20:23], s57 offen offset:3072 lds
    v_mfma_f32_16x16x32_bf16 v[92:95], v[204:207], v[132:135], v[92:95]
    s_add_u32 s57, s57, 165888
    v_add_u32 v6, 0, v4
    v_lshrrev_b32 v7, 1, v6
    v_lshl_add_u32 v6, v7, 4, v6
    v_add_u32 v6, 16, v6
    v_mul_lo_u32 v6, v6, s35
    v_xor_b32 v7, 0, v5
    v_lshl_add_u32 v6, v7, 4, v6
    v_add_u32 v6, s37, v6
    v_subrev_u32 v213, 0, v6
    v_add_u32 v6, 8, v4
    v_lshrrev_b32 v7, 1, v6
    v_lshl_add_u32 v6, v7, 4, v6
    v_add_u32 v6, 16, v6
    v_mul_lo_u32 v6, v6, s35
    v_xor_b32 v7, 4, v5
    v_lshl_add_u32 v6, v7, 4, v6
    v_add_u32 v6, s37, v6
    v_subrev_u32 v214, 1024, v6
    v_add_u32 v6, 16, v4
    v_lshrrev_b32 v7, 1, v6
    v_lshl_add_u32 v6, v7, 4, v6
    v_add_u32 v6, 16, v6
    v_mul_lo_u32 v6, v6, s35
    v_xor_b32 v7, 0, v5
    v_lshl_add_u32 v6, v7, 4, v6
    v_add_u32 v6, s37, v6
    v_subrev_u32 v215, 2048, v6
    v_add_u32 v6, 24, v4
    v_lshrrev_b32 v7, 1, v6
    v_lshl_add_u32 v6, v7, 4, v6
    v_add_u32 v6, 16, v6
    v_mul_lo_u32 v6, v6, s35
    v_xor_b32 v7, 4, v5
    v_lshl_add_u32 v6, v7, 4, v6
    v_add_u32 v6, s37, v6
    v_subrev_u32 v216, 3072, v6
    s_mul_i32 s57, s6, 331776
    s_add_u32 m0, s54, 32768
    s_nop 0
    buffer_load_dwordx4 v213, s[20:23], s57 offen offset:0 lds
    buffer_load_dwordx4 v214, s[20:23], s57 offen offset:1024 lds
    buffer_load_dwordx4 v215, s[20:23], s57 offen offset:2048 lds
    buffer_load_dwordx4 v216, s[20:23], s57 offen offset:3072 lds
    s_add_u32 s57, s57, 165888
    s_waitcnt vmcnt(8)
    v_cmp_ne_u64 vcc, s[76:77], v[234:235]
    s_nop 3
    s_cbranch_vccz gated_mix__mha_block__mixer_gmlp__prompt_kernel_g_po_ok
    s_mov_b32 s38, 0x40000
gated_mix__mha_block__mixer_gmlp__prompt_kernel_g_po:
    buffer_load_dwordx2 v[234:235], v231, s[72:75], 0 offen sc0 sc1
    s_waitcnt vmcnt(0)
    v_cmp_ne_u64 vcc, s[76:77], v[234:235]
    s_sub_u32 s38, s38, 1
    s_nop 2
    s_cbranch_vccz gated_mix__mha_block__mixer_gmlp__prompt_kernel_g_po_ok
    s_cmp_eq_u32 s38, 0
    s_cbranch_scc1 gated_mix__mha_block__mixer_gmlp__prompt_kernel_g_po_ok
    s_sleep 4
    s_branch gated_mix__mha_block__mixer_gmlp__prompt_kernel_g_po
gated_mix__mha_block__mixer_gmlp__prompt_kernel_g_po_ok:
    s_setprio 3
    s_lshl_b32 s56, s6, 11
    s_add_u32 s56, s56, 0
    buffer_load_dwordx4 v[136:139], v208, s[40:43], s56 offen sc0 sc1
    buffer_load_dwordx4 v[140:143], v209, s[40:43], s56 offen sc0 sc1
    buffer_load_dwordx4 v[144:147], v210, s[40:43], s56 offen sc0 sc1
    buffer_load_dwordx4 v[148:151], v211, s[40:43], s56 offen sc0 sc1
    buffer_load_dwordx4 v[152:155], v212, s[40:43], s56 offen sc0 sc1
    s_add_u32 s56, s56, 8192
    buffer_load_dwordx4 v[156:159], v208, s[40:43], s56 offen sc0 sc1
    buffer_load_dwordx4 v[160:163], v209, s[40:43], s56 offen sc0 sc1
    buffer_load_dwordx4 v[164:167], v210, s[40:43], s56 offen sc0 sc1
    buffer_load_dwordx4 v[168:171], v211, s[40:43], s56 offen sc0 sc1
    buffer_load_dwordx4 v[172:175], v212, s[40:43], s56 offen sc0 sc1
    s_add_u32 s56, s56, 8192
    buffer_load_dwordx4 v[96:99], v208, s[40:43], s56 offen sc0 sc1
    buffer_load_dwordx4 v[100:103], v209, s[40:43], s56 offen sc0 sc1
    buffer_load_dwordx4 v[104:107], v210, s[40:43], s56 offen sc0 sc1
    buffer_load_dwordx4 v[108:111], v211, s[40:43], s56 offen sc0 sc1
    buffer_load_dwordx4 v[112:115], v212, s[40:43], s56 offen sc0 sc1
    s_add_u32 s56, s56, 8192
    buffer_load_dwordx4 v[116:119], v208, s[40:43], s56 offen sc0 sc1
    buffer_load_dwordx4 v[120:123], v209, s[40:43], s56 offen sc0 sc1
    buffer_load_dwordx4 v[124:127], v210, s[40:43], s56 offen sc0 sc1
    buffer_load_dwordx4 v[128:131], v211, s[40:43], s56 offen sc0 sc1
    buffer_load_dwordx4 v[132:135], v212, s[40:43], s56 offen sc0 sc1
    s_add_u32 s56, s56, 8192
    s_lshl_b32 s56, s6, 17
    s_add_u32 s56, s56, 0
    buffer_load_dword v236, v217, s[44:47], s56 offen offset:0 sc0 sc1
    buffer_load_dword v240, v217, s[44:47], s56 offen offset:64 sc0 sc1
    buffer_load_dword v244, v217, s[44:47], s56 offen offset:128 sc0 sc1
    buffer_load_dword v248, v217, s[44:47], s56 offen offset:192 sc0 sc1
    buffer_load_dword v252, v217, s[44:47], s56 offen offset:256 sc0 sc1
    s_lshl_b32 s56, s6, 17
    s_add_u32 s56, s56, 8192
    buffer_load_dword v237, v217, s[44:47], s56 offen offset:0 sc0 sc1
    buffer_load_dword v241, v217, s[44:47], s56 offen offset:64 sc0 sc1
    buffer_load_dword v245, v217, s[44:47], s56 offen offset:128 sc0 sc1
    buffer_load_dword v249, v217, s[44:47], s56 offen offset:192 sc0 sc1
    buffer_load_dword v253, v217, s[44:47], s56 offen offset:256 sc0 sc1
    s_lshl_b32 s56, s6, 17
    s_add_u32 s56, s56, 16384
    buffer_load_dword v238, v217, s[44:47], s56 offen offset:0 sc0 sc1
    buffer_load_dword v242, v217, s[44:47], s56 offen offset:64 sc0 sc1
    buffer_load_dword v246, v217, s[44:47], s56 offen offset:128 sc0 sc1
    buffer_load_dword v250, v217, s[44:47], s56 offen offset:192 sc0 sc1
    buffer_load_dword v254, v217, s[44:47], s56 offen offset:256 sc0 sc1
    s_lshl_b32 s56, s6, 17
    s_add_u32 s56, s56, 24576
    buffer_load_dword v239, v217, s[44:47], s56 offen offset:0 sc0 sc1
    buffer_load_dword v243, v217, s[44:47], s56 offen offset:64 sc0 sc1
    buffer_load_dword v247, v217, s[44:47], s56 offen offset:128 sc0 sc1
    buffer_load_dword v251, v217, s[44:47], s56 offen offset:192 sc0 sc1
    buffer_load_dword v255, v217, s[44:47], s56 offen offset:256 sc0 sc1
    s_waitcnt vmcnt(39) lgkmcnt(6)
    v_mfma_f32_16x16x32_bf16 v[16:19], v[176:179], v[136:139], v[16:19]
    s_waitcnt lgkmcnt(4)
    v_mfma_f32_16x16x32_bf16 v[36:39], v[180:183], v[136:139], v[36:39]
    s_waitcnt lgkmcnt(2)
    v_mfma_f32_16x16x32_bf16 v[56:59], v[184:187], v[136:139], v[56:59]
    ds_read_b64_tr_b16 v[192:193], v224 offset:0
    s_waitcnt lgkmcnt(1)
    v_mfma_f32_16x16x32_bf16 v[76:79], v[188:191], v[136:139], v[76:79]
    s_waitcnt vmcnt(38)
    v_mfma_f32_16x16x32_bf16 v[20:23], v[176:179], v[140:143], v[20:23]
    ds_read_b64_tr_b16 v[194:195], v224 offset:512
    v_mfma_f32_16x16x32_bf16 v[40:43], v[180:183], v[140:143], v[40:43]
    v_mfma_f32_16x16x32_bf16 v[60:63], v[184:187], v[140:143], v[60:63]
    v_mfma_f32_16x16x32_bf16 v[80:83], v[188:191], v[140:143], v[80:83]
    ds_read_b64_tr_b16 v[196:197], v225 offset:0
    s_waitcnt vmcnt(37)
    v_mfma_f32_16x16x32_bf16 v[24:27], v[176:179], v[144:147], v[24:27]
    v_mfma_f32_16x16x32_bf16 v[44:47], v[180:183], v[144:147], v[44:47]
    ds_read_b64_tr_b16 v[198:199], v225 offset:512
    v_mfma_f32_16x16x32_bf16 v[64:67], v[184:187], v[144:147], v[64:67]
    v_mfma_f32_16x16x32_bf16 v[84:87], v[188:191], v[144:147], v[84:87]
    s_waitcnt vmcnt(36)
    v_mfma_f32_16x16x32_bf16 v[28:31], v[176:179], v[148:151], v[28:31]
    ds_read_b64_tr_b16 v[200:201], v226 offset:0
    v_mfma_f32_16x16x32_bf16 v[48:51], v[180:183], v[148:151], v[48:51]
    v_mfma_f32_16x16x32_bf16 v[68:71], v[184:187], v[148:151], v[68:71]
    ds_read_b64_tr_b16 v[202:203], v226 offset:512
    v_mfma_f32_16x16x32_bf16 v[88:91], v[188:191], v[148:151], v[88:91]
    s_waitcnt vmcnt(35)
    v_mfma_f32_16x16x32_bf16 v[32:35], v[176:179], v[152:155], v[32:35]
    v_mfma_f32_16x16x32_bf16 v[52:55], v[180:183], v[152:155], v[52:55]
    ds_read_b64_tr_b16 v[204:205], v227 offset:0
    v_mfma_f32_16x16x32_bf16 v[72:75], v[184:187], v[152:155], v[72:75]
    v_mfma_f32_16x16x32_bf16 v[92:95], v[188:191], v[152:155], v[92:95]
    ds_read_b64_tr_b16 v[206:207], v227 offset:512
    s_waitcnt vmcnt(34) lgkmcnt(6)
    v_mfma_f32_16x16x32_bf16 v[16:19], v[192:195], v[156:159], v[16:19]
    s_waitcnt lgkmcnt(4)
    v_mfma_f32_16x16x32_bf16 v[36:39], v[196:199], v[156:159], v[36:39]
    s_waitcnt lgkmcnt(2)
    v_mfma_f32_16x16x32_bf16 v[56:59], v[200:203], v[156:159], v[56:59]
    ds_read_b64_tr_b16 v[176:177], v220 offset:0
    s_waitcnt lgkmcnt(1)
    v_mfma_f32_16x16x32_bf16 v[76:79], v[204:207], v[156:159], v[76:79]
    s_waitcnt vmcnt(33)
    v_mfma_f32_16x16x32_bf16 v[20:23], v[192:195], v[160:163], v[20:23]
    ds_read_b64_tr_b16 v[178:179], v220 offset:512
    v_mfma_f32_16x16x32_bf16 v[40:43], v[196:199], v[160:163], v[40:43]
    v_mfma_f32_16x16x32_bf16 v[60:63], v[200:203], v[160:163], v[60:63]
    v_mfma_f32_16x16x32_bf16 v[80:83], v[204:207], v[160:163], v[80:83]
    ds_read_b64_tr_b16 v[180:181], v221 offset:0
    s_waitcnt vmcnt(32)
    v_mfma_f32_16x16x32_bf16 v[24:27], v[192:195], v[164:167], v[24:27]
    v_mfma_f32_16x16x32_bf16 v[44:47], v[196:199], v[164:167], v[44:47]
    ds_read_b64_tr_b16 v[182:183], v221 offset:512
    v_mfma_f32_16x16x32_bf16 v[64:67], v[200:203], v[164:167], v[64:67]
    v_mfma_f32_16x16x32_bf16 v[84:87], v[204:207], v[164:167], v[84:87]
    s_waitcnt vmcnt(31)
    v_mfma_f32_16x16x32_bf16 v[28:31], v[192:195], v[168:171], v[28:31]
    ds_read_b64_tr_b16 v[184:185], v222 offset:0
    v_mfma_f32_16x16x32_bf16 v[48:51], v[196:199], v[168:171], v[48:51]
    v_mfma_f32_16x16x32_bf16 v[68:71], v[200:203], v[168:171], v[68:71]
    ds_read_b64_tr_b16 v[186:187], v222 offset:512
    v_mfma_f32_16x16x32_bf16 v[88:91], v[204:207], v[168:171], v[88:91]
    s_waitcnt vmcnt(30)
    v_mfma_f32_16x16x32_bf16 v[32:35], v[192:195], v[172:175], v[32:35]
    v_mfma_f32_16x16x32_bf16 v[52:55], v[196:199], v[172:175], v[52:55]
    ds_read_b64_tr_b16 v[188:189], v223 offset:0
    v_mfma_f32_16x16x32_bf16 v[72:75], v[200:203], v[172:175], v[72:75]
    v_mfma_f32_16x16x32_bf16 v[92:95], v[204:207], v[172:175], v[92:95]
    ds_read_b64_tr_b16 v[190:191], v223 offset:512
    s_waitcnt vmcnt(29) lgkmcnt(6)
    v_mfma_f32_16x16x32_bf16 v[16:19], v[176:179], v[96:99], v[16:19]
    s_waitcnt lgkmcnt(4)
    v_mfma_f32_16x16x32_bf16 v[36:39], v[180:183], v[96:99], v[36:39]
    s_waitcnt lgkmcnt(2)
    v_mfma_f32_16x16x32_bf16 v[56:59], v[184:187], v[96:99], v[56:59]
    ds_read_b64_tr_b16 v[192:193], v220 offset:16384
    s_waitcnt lgkmcnt(1)
    v_mfma_f32_16x16x32_bf16 v[76:79], v[188:191], v[96:99], v[76:79]
    s_waitcnt vmcnt(28)
    v_mfma_f32_16x16x32_bf16 v[20:23], v[176:179], v[100:103], v[20:23]
    ds_read_b64_tr_b16 v[194:195], v220 offset:16896
    v_mfma_f32_16x16x32_bf16 v[40:43], v[180:183], v[100:103], v[40:43]
    v_mfma_f32_16x16x32_bf16 v[60:63], v[184:187], v[100:103], v[60:63]
    v_mfma_f32_16x16x32_bf16 v[80:83], v[188:191], v[100:103], v[80:83]
    ds_read_b64_tr_b16 v[196:197], v221 offset:16384
    s_waitcnt vmcnt(27)
    v_mfma_f32_16x16x32_bf16 v[24:27], v[176:179], v[104:107], v[24:27]
    v_mfma_f32_16x16x32_bf16 v[44:47], v[180:183], v[104:107], v[44:47]
    ds_read_b64_tr_b16 v[198:199], v221 offset:16896
    v_mfma_f32_16x16x32_bf16 v[64:67], v[184:187], v[104:107], v[64:67]
    v_mfma_f32_16x16x32_bf16 v[84:87], v[188:191], v[104:107], v[84:87]
    s_waitcnt vmcnt(26)
    v_mfma_f32_16x16x32_bf16 v[28:31], v[176:179], v[108:111], v[28:31]
    ds_read_b64_tr_b16 v[200:201], v222 offset:16384
    v_mfma_f32_16x16x32_bf16 v[48:51], v[180:183], v[108:111], v[48:51]
    v_mfma_f32_16x16x32_bf16 v[68:71], v[184:187], v[108:111], v[68:71]
    ds_read_b64_tr_b16 v[202:203], v222 offset:16896
    v_mfma_f32_16x16x32_bf16 v[88:91], v[188:191], v[108:111], v[88:91]
    s_waitcnt vmcnt(25)
    v_mfma_f32_16x16x32_bf16 v[32:35], v[176:179], v[112:115], v[32:35]
    v_mfma_f32_16x16x32_bf16 v[52:55], v[180:183], v[112:115], v[52:55]
    ds_read_b64_tr_b16 v[204:205], v223 offset:16384
    v_mfma_f32_16x16x32_bf16 v[72:75], v[184:187], v[112:115], v[72:75]
    v_mfma_f32_16x16x32_bf16 v[92:95], v[188:191], v[112:115], v[92:95]
    ds_read_b64_tr_b16 v[206:207], v223 offset:16896
    s_waitcnt vmcnt(24) lgkmcnt(6)
    v_mfma_f32_16x16x32_bf16 v[16:19], v[192:195], v[116:119], v[16:19]
    s_waitcnt lgkmcnt(4)
    v_mfma_f32_16x16x32_bf16 v[36:39], v[196:199], v[116:119], v[36:39]
    s_waitcnt lgkmcnt(2)
    v_mfma_f32_16x16x32_bf16 v[56:59], v[200:203], v[116:119], v[56:59]
    ds_read_b64_tr_b16 v[176:177], v220 offset:32768
    s_waitcnt lgkmcnt(1)
    v_mfma_f32_16x16x32_bf16 v[76:79], v[204:207], v[116:119], v[76:79]
    s_waitcnt vmcnt(23)
    v_mfma_f32_16x16x32_bf16 v[20:23], v[192:195], v[120:123], v[20:23]
    ds_read_b64_tr_b16 v[178:179], v220 offset:33280
    v_mfma_f32_16x16x32_bf16 v[40:43], v[196:199], v[120:123], v[40:43]
    v_mfma_f32_16x16x32_bf16 v[60:63], v[200:203], v[120:123], v[60:63]
    v_mfma_f32_16x16x32_bf16 v[80:83], v[204:207], v[120:123], v[80:83]
    ds_read_b64_tr_b16 v[180:181], v221 offset:32768
    s_waitcnt vmcnt(22)
    v_mfma_f32_16x16x32_bf16 v[24:27], v[192:195], v[124:127], v[24:27]
    v_mfma_f32_16x16x32_bf16 v[44:47], v[196:199], v[124:127], v[44:47]
    ds_read_b64_tr_b16 v[182:183], v221 offset:33280
    v_mfma_f32_16x16x32_bf16 v[64:67], v[200:203], v[124:127], v[64:67]
    v_mfma_f32_16x16x32_bf16 v[84:87], v[204:207], v[124:127], v[84:87]
    s_waitcnt vmcnt(21)
    v_mfma_f32_16x16x32_bf16 v[28:31], v[192:195], v[128:131], v[28:31]
    ds_read_b64_tr_b16 v[184:185], v222 offset:32768
    v_mfma_f32_16x16x32_bf16 v[48:51], v[196:199], v[128:131], v[48:51]
    v_mfma_f32_16x16x32_bf16 v[68:71], v[200:203], v[128:131], v[68:71]
    ds_read_b64_tr_b16 v[186:187], v222 offset:33280
    v_mfma_f32_16x16x32_bf16 v[88:91], v[204:207], v[128:131], v[88:91]
    s_waitcnt vmcnt(20)
    v_mfma_f32_16x16x32_bf16 v[32:35], v[192:195], v[132:135], v[32:35]
    v_mfma_f32_16x16x32_bf16 v[52:55], v[196:199], v[132:135], v[52:55]
    ds_read_b64_tr_b16 v[188:189], v223 offset:32768
    v_mfma_f32_16x16x32_bf16 v[72:75], v[200:203], v[132:135], v[72:75]
    v_mfma_f32_16x16x32_bf16 v[92:95], v[204:207], v[132:135], v[92:95]
    ds_read_b64_tr_b16 v[190:191], v223 offset:33280
    s_waitcnt vmcnt(4) lgkmcnt(6)
    v_mfma_f32_16x16x32_bf16 v[16:19], v[176:179], v[236:239], v[16:19]
    s_waitcnt lgkmcnt(4)
    v_mfma_f32_16x16x32_bf16 v[36:39], v[180:183], v[236:239], v[36:39]
    s_waitcnt lgkmcnt(2)
    v_mfma_f32_16x16x32_bf16 v[56:59], v[184:187], v[236:239], v[56:59]
    s_waitcnt lgkmcnt(0)
    v_mfma_f32_16x16x32_bf16 v[76:79], v[188:191], v[236:239], v[76:79]
    s_waitcnt vmcnt(3)
    v_mfma_f32_16x16x32_bf16 v[20:23], v[176:179], v[240:243], v[20:23]
    v_mfma_f32_16x16x32_bf16 v[40:43], v[180:183], v[240:243], v[40:43]
    v_mfma_f32_16x16x32_bf16 v[60:63], v[184:187], v[240:243], v[60:63]
    v_mfma_f32_16x16x32_bf16 v[80:83], v[188:191], v[240:243], v[80:83]
    s_waitcnt vmcnt(2)
    v_mfma_f32_16x16x32_bf16 v[24:27], v[176:179], v[244:247], v[24:27]
    v_mfma_f32_16x16x32_bf16 v[44:47], v[180:183], v[244:247], v[44:47]
    v_mfma_f32_16x16x32_bf16 v[64:67], v[184:187], v[244:247], v[64:67]
    v_mfma_f32_16x16x32_bf16 v[84:87], v[188:191], v[244:247], v[84:87]
    s_waitcnt vmcnt(1)
    v_mfma_f32_16x16x32_bf16 v[28:31], v[176:179], v[248:251], v[28:31]
    v_mfma_f32_16x16x32_bf16 v[48:51], v[180:183], v[248:251], v[48:51]
    v_mfma_f32_16x16x32_bf16 v[68:71], v[184:187], v[248:251], v[68:71]
    v_mfma_f32_16x16x32_bf16 v[88:91], v[188:191], v[248:251], v[88:91]
    s_waitcnt vmcnt(0)
    v_mfma_f32_16x16x32_bf16 v[32:35], v[176:179], v[252:255], v[32:35]
    v_mfma_f32_16x16x32_bf16 v[52:55], v[180:183], v[252:255], v[52:55]
    v_mfma_f32_16x16x32_bf16 v[72:75], v[184:187], v[252:255], v[72:75]
    v_mfma_f32_16x16x32_bf16 v[92:95], v[188:191], v[252:255], v[92:95]
    s_barrier
    v_lshlrev_b32 v6, 4, v0
    s_xor_b32 s32, s6, 1
    s_mul_i32 s32, s32, 15360
    v_add_u32 v7, s32, v6
    ds_write_b128 v7, v[36:39] offset:0
    ds_write_b128 v7, v[40:43] offset:1024
    ds_write_b128 v7, v[44:47] offset:2048
    ds_write_b128 v7, v[48:51] offset:3072
    ds_write_b128 v7, v[52:55] offset:4096
    s_xor_b32 s32, s6, 2
    s_mul_i32 s32, s32, 15360
    v_add_u32 v7, s32, v6
    ds_write_b128 v7, v[56:59] offset:5120
    ds_write_b128 v7, v[60:63] offset:6144
    ds_write_b128 v7, v[64:67] offset:7168
    ds_write_b128 v7, v[68:71] offset:8192
    ds_write_b128 v7, v[72:75] offset:9216
    s_xor_b32 s32, s6, 3
    s_mul_i32 s32, s32, 15360
    v_add_u32 v7, s32, v6
    ds_write_b128 v7, v[76:79] offset:10240
    ds_write_b128 v7, v[80:83] offset:11264
    ds_write_b128 v7, v[84:87] offset:12288
    ds_write_b128 v7, v[88:91] offset:13312
    ds_write_b128 v7, v[92:95] offset:14336
    s_mul_i32 s32, s6, 15360
    s_nop 0
    v_add_u32 v7, s32, v6
    v_add_u32 v8, s58, v3
    v_mul_lo_u32 v8, v8, s35
    s_lshl_b32 s32, s6, 5
    s_add_u32 s32, s32, s37
    v_lshl_add_u32 v8, v2, 3, v8
    v_add_u32 v8, s32, v8
    s_waitcnt lgkmcnt(0)
    s_barrier
    ds_read_b128 v[96:99], v7 offset:0
    ds_read_b128 v[100:103], v7 offset:5120
    ds_read_b128 v[104:107], v7 offset:10240
    ds_read_b128 v[108:111], v7 offset:1024
    ds_read_b128 v[112:115], v7 offset:6144
    ds_read_b128 v[116:119], v7 offset:11264
    ds_read_b128 v[120:123], v7 offset:2048
    ds_read_b128 v[124:127], v7 offset:7168
    ds_read_b128 v[128:131], v7 offset:12288
    ds_read_b128 v[132:135], v7 offset:3072
    ds_read_b128 v[136:139], v7 offset:8192
    ds_read_b128 v[140:143], v7 offset:13312
    ds_read_b128 v[144:147], v7 offset:4096
    ds_read_b128 v[148:151], v7 offset:9216
    ds_read_b128 v[152:155], v7 offset:14336
    s_waitcnt lgkmcnt(14)
    v_add_f32 v16, v16, v96
    v_add_f32 v17, v17, v97
    v_add_f32 v18, v18, v98
    v_add_f32 v19, v19, v99
    s_waitcnt lgkmcnt(13)
    v_add_f32 v16, v16, v100
    v_add_f32 v17, v17, v101
    v_add_f32 v18, v18, v102
    v_add_f32 v19, v19, v103
    s_waitcnt lgkmcnt(12)
    v_add_f32 v16, v16, v104
    v_add_f32 v17, v17, v105
    v_add_f32 v18, v18, v106
    v_add_f32 v19, v19, v107
    v_cvt_pk_bf16_f32 v176, v16, v17
    v_cvt_pk_bf16_f32 v177, v18, v19
    s_mov_b32 s32, 0
    buffer_store_dwordx2 v[176:177], v8, s[48:51], s32 offen
    s_waitcnt lgkmcnt(11)
    v_add_f32 v20, v20, v108
    v_add_f32 v21, v21, v109
    v_add_f32 v22, v22, v110
    v_add_f32 v23, v23, v111
    s_waitcnt lgkmcnt(10)
    v_add_f32 v20, v20, v112
    v_add_f32 v21, v21, v113
    v_add_f32 v22, v22, v114
    v_add_f32 v23, v23, v115
    s_waitcnt lgkmcnt(9)
    v_add_f32 v20, v20, v116
    v_add_f32 v21, v21, v117
    v_add_f32 v22, v22, v118
    v_add_f32 v23, v23, v119
    v_cvt_pk_bf16_f32 v178, v20, v21
    v_cvt_pk_bf16_f32 v179, v22, v23
    s_mov_b32 s32, 18432
    buffer_store_dwordx2 v[178:179], v8, s[48:51], s32 offen
    s_waitcnt lgkmcnt(8)
    v_add_f32 v24, v24, v120
    v_add_f32 v25, v25, v121
    v_add_f32 v26, v26, v122
    v_add_f32 v27, v27, v123
    s_waitcnt lgkmcnt(7)
    v_add_f32 v24, v24, v124
    v_add_f32 v25, v25, v125
    v_add_f32 v26, v26, v126
    v_add_f32 v27, v27, v127
    s_waitcnt lgkmcnt(6)
    v_add_f32 v24, v24, v128
    v_add_f32 v25, v25, v129
    v_add_f32 v26, v26, v130
    v_add_f32 v27, v27, v131
    v_cvt_pk_bf16_f32 v180, v24, v25
    v_cvt_pk_bf16_f32 v181, v26, v27
    s_mov_b32 s32, 36864
    buffer_store_dwordx2 v[180:181], v8, s[48:51], s32 offen
    s_waitcnt lgkmcnt(5)
    v_add_f32 v28, v28, v132
    v_add_f32 v29, v29, v133
    v_add_f32 v30, v30, v134
    v_add_f32 v31, v31, v135
    s_waitcnt lgkmcnt(4)
    v_add_f32 v28, v28, v136
    v_add_f32 v29, v29, v137
    v_add_f32 v30, v30, v138
    v_add_f32 v31, v31, v139
    s_waitcnt lgkmcnt(3)
    v_add_f32 v28, v28, v140
    v_add_f32 v29, v29, v141
    v_add_f32 v30, v30, v142
    v_add_f32 v31, v31, v143
    v_cvt_pk_bf16_f32 v182, v28, v29
    v_cvt_pk_bf16_f32 v183, v30, v31
    s_mov_b32 s32, 55296
    buffer_store_dwordx2 v[182:183], v8, s[48:51], s32 offen
    s_waitcnt lgkmcnt(2)
    v_add_f32 v32, v32, v144
    v_add_f32 v33, v33, v145
    v_add_f32 v34, v34, v146
    v_add_f32 v35, v35, v147
    s_waitcnt lgkmcnt(1)
    v_add_f32 v32, v32, v148
    v_add_f32 v33, v33, v149
    v_add_f32 v34, v34, v150
    v_add_f32 v35, v35, v151
    s_waitcnt lgkmcnt(0)
    v_add_f32 v32, v32, v152
    v_add_f32 v33, v33, v153
    v_add_f32 v34, v34, v154
    v_add_f32 v35, v35, v155
    v_cvt_pk_bf16_f32 v184, v32, v33
    v_cvt_pk_bf16_f32 v185, v34, v35
    s_mov_b32 s32, 73728
    buffer_store_dwordx2 v[184:185], v8, s[48:51], s32 offen
gated_mix__mha_block__mixer_gmlp__prompt_kernel_g_done:
    s_endpgm
gated_mix__mha_block__mixer_gmlp__prompt_kernel_end:
    s_endpgm
.section .rodata,"a"
.p2align 6
.amdhsa_kernel gated_mix__mha_block__mixer_gmlp__prompt_kernel
  .amdhsa_next_free_vgpr 256
  .amdhsa_next_free_sgpr 80
  .amdhsa_accum_offset 256
  .amdhsa_group_segment_fixed_size 0
  .amdhsa_kernarg_size 96
  .amdhsa_user_sgpr_count 2
  .amdhsa_user_sgpr_kernarg_segment_ptr 1
  .amdhsa_system_sgpr_workgroup_id_x 1
.end_amdhsa_kernel
```
